```python
import torch

def _softmax(x, axis=-1):
    return torch.softmax(x, dim=axis)

def _gelu(x):
    return torch.nn.functional.gelu(x, approximate='tanh')

def _silu(x):
    return torch.nn.functional.silu(x)

def _sigmoid(x):
    return torch.sigmoid(x)

def _layernorm(x, axis=-1, eps=1e-05):
    m = x.mean(dim=axis, keepdim=True)
    v = x.var(dim=axis, keepdim=True, unbiased=False)
    return (x - m) / torch.sqrt(v + eps)

def _scatter_add(tgt, idx, src, axis=0):
    return tgt.clone().index_add_(axis, idx, src)

def _segment_sum(src, seg, n):
    out = torch.zeros((n,) + src.shape[1:], dtype=src.dtype)
    return out.index_add_(0, seg, src)

def _pad(x, pw):
    flat = tuple((v for pair in reversed(pw) for v in pair))
    return torch.nn.functional.pad(x, flat)
kernel_name = 'sequential_preLN__memory_aug_recurrent_mem_tr__mixer_gmlp__prompt'

def setup_inputs():

    _w = lambda a: (lambda t: t.to(torch.bfloat16) if t.is_floating_point() else t)(torch.as_tensor(a))

    def _A_setup():
        B, S, Dm = (1, 2048, 640)
        H, Dh = (32, 192)
        M, seg = (8, 32)
        seg = min(seg, S)
        S = S // seg * seg
        return {'x': _w((lambda *s: torch.randn(*s, dtype=torch.bfloat16) * 0.05)(B, S, Dm)), 'mem0': _w((lambda *s: torch.randn(*s, dtype=torch.bfloat16) * 0.2)(B, M, Dm)), 'Wq': _w((lambda *s: torch.randn(*s, dtype=torch.bfloat16) * 1.6)(Dm, H, Dh) * Dm ** (-0.5)), 'Wk': _w((lambda *s: torch.randn(*s, dtype=torch.bfloat16) * 1.6)(Dm, H, Dh) * Dm ** (-0.5)), 'Wv': _w((lambda *s: torch.randn(*s, dtype=torch.bfloat16) * 0.2)(Dm, H, Dh) * Dm ** (-0.5)), 'Wo': _w((lambda *s: torch.randn(*s, dtype=torch.bfloat16) * 0.2)(H, Dh, Dm) * (H * Dh) ** (-0.5)), 'seg_len': seg}
    _A_in = _A_setup()

    def _B_setup():
        B, S, D, F = (1, 2048, 640, 1536)
        Fh = F // 2
        return {'x': _w((lambda *s: torch.randn(*s, dtype=torch.bfloat16) * 0.05)(B, S, D)), 'w_in': _w((lambda *s: torch.randn(*s, dtype=torch.bfloat16) * 0.4)(D, 2 * Fh)), 'w_sp': _w(0.01 * (lambda *s: torch.randn(*s, dtype=torch.bfloat16) * 0.4)(S, S)), 'b_sp': _w(1.0 + 0.01 * (lambda *s: torch.randn(*s, dtype=torch.bfloat16) * 0.05)(S)), 'w_out': _w((lambda *s: torch.randn(*s, dtype=torch.bfloat16) * 0.05)(Fh, D))}
    _B_in = _B_setup()
    return {'A_x': _A_in['x'], 'A_mem0': _A_in['mem0'], 'A_Wq': _A_in['Wq'], 'A_Wk': _A_in['Wk'], 'A_Wv': _A_in['Wv'], 'A_Wo': _A_in['Wo'], 'A_seg_len': _A_in['seg_len'], 'B_x': _B_in['x'], 'B_w_in': _B_in['w_in'], 'B_w_sp': _B_in['w_sp'], 'B_b_sp': _B_in['b_sp'], 'B_w_out': _B_in['w_out']}

def reference(A_x, A_mem0, A_Wq, A_Wk, A_Wv, A_Wo, A_seg_len, B_x, B_w_in, B_w_sp, B_b_sp, B_w_out):

    def _A_ref(x, mem0, Wq, Wk, Wv, Wo, seg_len):
        B, S, Dm = x.shape
        H, Dh = (Wq.shape[1], Wq.shape[2])
        M = mem0.shape[1]
        scale = Dh ** (-0.5)
        n_seg = S // seg_len
        L = M + seg_len
        idx = torch.arange(L)
        mask = (idx[:, None] < M) | (idx[:, None] >= idx[None, :])
        mem = mem0
        outs = []
        for s in range(n_seg):
            xs = x[:, s * seg_len:(s + 1) * seg_len, :].clone()
            h = torch.concatenate([mem, xs], axis=1)
            q = torch.einsum('btd,dhe->bhte', h, Wq)
            k = torch.einsum('btd,dhe->bhte', h, Wk)
            v = torch.einsum('btd,dhe->bhte', h, Wv)
            scores = torch.einsum('bhqe,bhke->bhqk', q, k) * scale
            scores = torch.where(mask[None, None], scores, -1000000000.0)
            p = _softmax(scores, axis=-1)
            o = torch.einsum('bhqk,bhke->bhqe', p, v)
            o = torch.einsum('bhte,hed->btd', o, Wo)
            mem = o[:, :M, :].clone()
            outs.append(o[:, M:, :])
        return torch.concatenate(outs, axis=1)

    def _B_ref(x, w_in, w_sp, b_sp, w_out):
        B, S, D = x.shape
        F = w_in.shape[-1]
        Fh = F // 2
        z = _gelu(torch.einsum('bsd,df->bsf', x, w_in))
        z1 = z[..., :Fh].clone()
        z2 = _layernorm(z[..., Fh:], axis=-1)
        g = torch.einsum('ts,bsf->btf', w_sp, z2) + b_sp[None, :, None]
        return torch.einsum('bsf,fd->bsd', z1 * g, w_out)
    x = A_x
    h = x + _A_ref(_layernorm(x, axis=-1), A_mem0, A_Wq, A_Wk, A_Wv, A_Wo, A_seg_len)
    h2 = h + _B_ref(_layernorm(h, axis=-1), B_w_in, B_w_sp, B_b_sp, B_w_out)
    return h2
```

```asm
; @launch grid=(256,1,1) block=(256,1,1) lds=163840
.amdgcn_target "amdgcn-amd-amdhsa--gfx950"
.text
.globl sequential_preLN__memory_aug_recurrent_mem_tr__mixer_gmlp__prompt_kernel
.p2align 8
.type sequential_preLN__memory_aug_recurrent_mem_tr__mixer_gmlp__prompt_kernel,@function
sequential_preLN__memory_aug_recurrent_mem_tr__mixer_gmlp__prompt_kernel:
    s_cmp_lt_u32 s2, 256
    s_cbranch_scc1 M_in
    s_endpgm
M_in:
    s_load_dwordx4 s[4:7], s[0:1], 104
    s_load_dwordx8 s[92:99], s[0:1], 16
    v_and_b32 v1, 63, v0
    v_lshrrev_b32 v2, 6, v0
    s_nop 0
    v_readfirstlane_b32 s21, v2
    s_waitcnt lgkmcnt(0)
    s_mov_b32 s8, s6
    s_and_b32 s9, s7, 0xffff
    s_mov_b32 s10, 0x10000000
    s_mov_b32 s11, 0x20000
    s_mov_b32 s88, s4
    s_and_b32 s89, s5, 0xffff
    s_mov_b32 s90, 0x100
    s_mov_b32 s91, 0x20000
    s_getreg_b32 s23, hwreg(HW_REG_XCC_ID)
    s_sub_u32 s23, s23, s2
    s_add_u32 s23, s23, 0
    s_and_b32 s23, s23, 7
    s_add_u32 s23, s23, 1
    s_add_u32 s28, s2, s21
    s_cmp_lg_u32 s28, 0
    s_cbranch_scc1 M_disp
    v_mov_b32 v4, 140
    v_mov_b32 v5, s23
    buffer_store_dword v5, v4, s[88:91], 0 offen sc1
    s_waitcnt vmcnt(0)
    s_branch M_disp
M_redo:
    s_mov_b32 s23, s28
    s_waitcnt vmcnt(0) lgkmcnt(0)
    s_barrier
M_disp:
    s_add_u32 s29, s2, s23
    s_sub_u32 s29, s29, 1
    s_lshr_b32 s25, s2, 3
    s_lshl_b32 s25, s25, 2
    s_and_b32 s28, s29, 3
    s_add_u32 s25, s25, s28
    s_and_b32 s28, s29, 4
    s_lshl_b32 s28, s28, 5
    s_add_u32 s25, s25, s28
    s_sub_u32 s28, s25, 104
    s_sub_u32 s29, s25, 160
    s_add_u32 s30, s28, 160
    s_add_u32 s31, s29, 104
    s_cmp_lt_u32 s28, 24
    s_cselect_b32 s25, s30, s25
    s_cmp_lt_u32 s29, 24
    s_cselect_b32 s25, s31, s25
    s_mov_b32 s22, 0
    s_mov_b32 s24, 1
    s_and_b32 s20, s25, 31
    s_cmp_lt_u32 s25, 32
    s_cbranch_scc1 M_h
    s_cmp_lt_u32 s25, 64
    s_cbranch_scc1 M_z
    s_cmp_lt_u32 s25, 80
    s_cbranch_scc1 M_c0
    s_sub_u32 s30, s25, 80
    s_cmp_lt_u32 s25, 128
    s_cbranch_scc1 M_il
    s_cmp_lt_u32 s25, 192
    s_cbranch_scc1 M_vu0
    s_cmp_lt_u32 s25, 224
    s_cbranch_scc1 M_qk
    s_sub_u32 s30, s25, 176
    s_branch M_il
M_c0:
    s_sub_u32 s30, s25, 64
    s_load_dwordx2 s[28:29], s[0:1], 8
    v_lshlrev_b32 v5, 4, v0
    s_lshl_b32 s31, s30, 12
    v_add_u32 v8, s31, v5
    v_lshrrev_b32 v9, 8, v8
    v_bfe_u32 v10, v8, 5, 1
    v_lshl_add_u32 v9, v9, 1, v10
    v_bfe_u32 v10, v8, 6, 2
    v_bfe_u32 v11, v8, 4, 1
    v_lshl_add_u32 v10, v10, 1, v11
    v_mul_u32_u24 v10, 1280, v10
    v_lshl_add_u32 v10, v9, 4, v10
    v_mov_b32 v11, 0x7ff00000
    v_cmp_gt_u32 vcc, 10240, v8
    v_add_u32 v8, 20480, v8
    v_lshrrev_b32 v9, 13, v8
    v_lshlrev_b32 v9, 13, v9
    v_add_u32 v8, v8, v9
    v_cndmask_b32 v10, v11, v10, vcc
    v_cndmask_b32 v8, v11, v8, vcc
    v_lshlrev_b32 v6, 2, v1
    s_mov_b32 s36, -1
    s_mov_b32 s37, -1
    s_lshl_b32 s38, s30, 14
    s_lshl_b32 s33, s21, 11
    s_add_u32 s38, s38, s33
    s_add_u32 s38, s38, 0xab0000
    s_waitcnt lgkmcnt(0)
    s_mov_b32 s12, s28
    s_and_b32 s13, s29, 0xffff
    s_mov_b32 s14, 0x2800
    s_mov_b32 s15, 0x20000
    buffer_load_dwordx4 v[16:19], v10, s[12:15], 0 offen
    buffer_store_dword v6, v6, s[8:11], s38 offen sc1
    s_waitcnt vmcnt(0)
    s_add_u32 s33, s38, 512
    s_memtime s[40:41]
    s_waitcnt lgkmcnt(0)
    buffer_store_dword v6, v6, s[8:11], s33 offen sc1
    s_waitcnt vmcnt(0)
    s_memtime s[42:43]
    s_waitcnt lgkmcnt(0)
    s_sub_u32 s42, s42, s40
    s_min_u32 s36, s36, s42
    s_add_u32 s33, s38, 8704
    s_memtime s[40:41]
    s_waitcnt lgkmcnt(0)
    buffer_store_dword v6, v6, s[8:11], s33 offen sc1
    s_waitcnt vmcnt(0)
    s_memtime s[42:43]
    s_waitcnt lgkmcnt(0)
    s_sub_u32 s42, s42, s40
    s_min_u32 s37, s37, s42
    s_add_u32 s33, s38, 8960
    s_memtime s[40:41]
    s_waitcnt lgkmcnt(0)
    buffer_store_dword v6, v6, s[8:11], s33 offen sc1
    s_waitcnt vmcnt(0)
    s_memtime s[42:43]
    s_waitcnt lgkmcnt(0)
    s_sub_u32 s42, s42, s40
    s_min_u32 s37, s37, s42
    s_add_u32 s33, s38, 768
    s_memtime s[40:41]
    s_waitcnt lgkmcnt(0)
    buffer_store_dword v6, v6, s[8:11], s33 offen sc1
    s_waitcnt vmcnt(0)
    s_memtime s[42:43]
    s_waitcnt lgkmcnt(0)
    s_sub_u32 s42, s42, s40
    s_min_u32 s36, s36, s42
    s_add_u32 s33, s38, 1024
    s_memtime s[40:41]
    s_waitcnt lgkmcnt(0)
    buffer_store_dword v6, v6, s[8:11], s33 offen sc1
    s_waitcnt vmcnt(0)
    s_memtime s[42:43]
    s_waitcnt lgkmcnt(0)
    s_sub_u32 s42, s42, s40
    s_min_u32 s36, s36, s42
    s_add_u32 s33, s38, 9216
    s_memtime s[40:41]
    s_waitcnt lgkmcnt(0)
    buffer_store_dword v6, v6, s[8:11], s33 offen sc1
    s_waitcnt vmcnt(0)
    s_memtime s[42:43]
    s_waitcnt lgkmcnt(0)
    s_sub_u32 s42, s42, s40
    s_min_u32 s37, s37, s42
    s_add_u32 s33, s38, 9472
    s_memtime s[40:41]
    s_waitcnt lgkmcnt(0)
    buffer_store_dword v6, v6, s[8:11], s33 offen sc1
    s_waitcnt vmcnt(0)
    s_memtime s[42:43]
    s_waitcnt lgkmcnt(0)
    s_sub_u32 s42, s42, s40
    s_min_u32 s37, s37, s42
    s_add_u32 s33, s38, 1280
    s_memtime s[40:41]
    s_waitcnt lgkmcnt(0)
    buffer_store_dword v6, v6, s[8:11], s33 offen sc1
    s_waitcnt vmcnt(0)
    s_memtime s[42:43]
    s_waitcnt lgkmcnt(0)
    s_sub_u32 s42, s42, s40
    s_min_u32 s36, s36, s42
    s_add_u32 s33, s38, 1536
    s_memtime s[40:41]
    s_waitcnt lgkmcnt(0)
    buffer_store_dword v6, v6, s[8:11], s33 offen sc1
    s_waitcnt vmcnt(0)
    s_memtime s[42:43]
    s_waitcnt lgkmcnt(0)
    s_sub_u32 s42, s42, s40
    s_min_u32 s36, s36, s42
    s_add_u32 s33, s38, 9728
    s_memtime s[40:41]
    s_waitcnt lgkmcnt(0)
    buffer_store_dword v6, v6, s[8:11], s33 offen sc1
    s_waitcnt vmcnt(0)
    s_memtime s[42:43]
    s_waitcnt lgkmcnt(0)
    s_sub_u32 s42, s42, s40
    s_min_u32 s37, s37, s42
    v_mov_b32 v12, 140
    s_mov_b32 s39, 0
L_rw_1:
    buffer_load_dword v13, v12, s[88:91], 0 offen sc1
    s_add_u32 s39, s39, 1
    s_cmp_gt_u32 s39, 400000
    s_cbranch_scc1 M_fail
    s_waitcnt vmcnt(0)
    v_cmp_eq_u32 vcc, 0, v13
    s_cbranch_vccnz L_rw_1
    v_readfirstlane_b32 s28, v13
    s_cmp_lg_u32 s28, s23
    s_cbranch_scc1 M_redo
    v_mov_b32 v12, -1
    v_mov_b32 v13, -1
    v_mov_b32 v14, -1
    v_mov_b32 v15, -1
    s_add_u32 s29, s31, 0xc00000
    buffer_store_dwordx4 v[12:15], v5, s[8:11], s29 offen sc1
    s_and_b32 s28, s31, 0x7000
    s_add_u32 s29, s28, 0xaa0000
    s_add_u32 s28, s28, 0xc10000
    s_cmp_lt_u32 s30, 8
    s_cselect_b32 s29, s29, s28
    buffer_store_dwordx4 v[12:15], v5, s[8:11], s29 offen sc1
    s_mov_b32 s28, 0xbfc0000
    s_mov_b32 s29, 0xbfc2000
    v_min_u32 v16, -2, v16
    v_min_u32 v17, -2, v17
    v_min_u32 v18, -2, v18
    v_min_u32 v19, -2, v19
    buffer_store_dwordx4 v[16:19], v8, s[8:11], s28 offen sc1
    buffer_store_dwordx4 v[16:19], v8, s[8:11], s29 offen sc1
    s_cmp_lt_u32 s37, s36
    s_cselect_b32 s34, 1, 0
    s_lshl_b32 s28, s21, 2
    v_mov_b32 v4, s28
    v_mov_b32 v7, s34
    ds_write_b32 v4, v7
    v_mov_b32 v4, 0
    s_waitcnt lgkmcnt(0)
    s_barrier
    ds_read_b128 v[20:23], v4
    s_waitcnt lgkmcnt(0)
    v_add3_u32 v20, v20, v21, v22
    v_add_u32 v20, v20, v23
    s_nop 0
    v_readfirstlane_b32 s34, v20
    s_mov_b32 s35, 2
    s_waitcnt vmcnt(0)
    s_barrier
    s_cmp_lg_u32 s21, 0
    s_cbranch_scc1 M_ix_id
    s_lshl_b32 s34, s34, 16
    s_add_u32 s34, s34, 1
    v_mov_b32 v8, s34
    v_mov_b32 v9, 0x7ff00000
    v_cmp_eq_u32 vcc, 0, v1
    s_nop 1
    v_cndmask_b32_e64 v9, v9, 0, vcc
    s_cmp_ge_u32 s35, 2
    s_cbranch_scc1 M_ix_na
    s_lshl_b32 s35, s35, 2
    buffer_store_dword v8, v9, s[88:91], s35 offen offset:132 sc1
M_ix_na:
    buffer_atomic_add v8, v9, s[88:91], 0 offen sc0 sc1
    s_waitcnt vmcnt(0)
    v_readfirstlane_b32 s28, v8
    s_add_u32 s28, s28, s34
    s_and_b32 s29, s28, 0xffff
    s_cmp_lg_u32 s29, 96
    s_cbranch_scc1 M_ix_id
    s_lshr_b32 s28, s28, 16
    s_cmp_gt_u32 s28, 32
    s_cselect_b32 s28, 2, 1
    v_mov_b32 v8, s28
    buffer_store_dword v8, v9, s[88:91], 0 offen offset:128 sc1
M_ix_id:
    s_sub_u32 s20, s25, 64
    s_branch M_c
M_il:
    s_load_dwordx2 s[28:29], s[0:1], 0
    v_lshlrev_b32 v2, 4, v1
    v_and_b32 v3, 15, v1
    v_lshrrev_b32 v4, 4, v1
    v_mul_u32_u24 v5, 1280, v3
    v_lshl_add_u32 v5, v4, 4, v5
    s_min_u32 s31, s30, 63
    s_mul_i32 s31, s31, 40960
    s_lshr_b32 s32, s21, 1
    s_mul_i32 s32, s32, 20480
    s_and_b32 s33, s21, 1
    s_mul_i32 s33, s33, 640
    s_add_u32 s32, s32, s33
    s_add_u32 s32, s32, s31
    s_waitcnt lgkmcnt(0)
    s_mov_b32 s12, s28
    s_and_b32 s13, s29, 0xffff
    s_mov_b32 s14, 0x280000
    s_mov_b32 s15, 0x20000
    buffer_load_dwordx4 v[16:19], v5, s[12:15], s32 offen offset:0
    buffer_load_dwordx4 v[20:23], v5, s[12:15], s32 offen offset:64
    buffer_load_dwordx4 v[24:27], v5, s[12:15], s32 offen offset:128
    buffer_load_dwordx4 v[28:31], v5, s[12:15], s32 offen offset:192
    buffer_load_dwordx4 v[32:35], v5, s[12:15], s32 offen offset:256
    buffer_load_dwordx4 v[36:39], v5, s[12:15], s32 offen offset:320
    buffer_load_dwordx4 v[40:43], v5, s[12:15], s32 offen offset:384
    buffer_load_dwordx4 v[44:47], v5, s[12:15], s32 offen offset:448
    buffer_load_dwordx4 v[48:51], v5, s[12:15], s32 offen offset:512
    buffer_load_dwordx4 v[52:55], v5, s[12:15], s32 offen offset:576
    v_mov_b32 v8, 140
    s_mov_b32 s39, 0
L_rw_2:
    buffer_load_dword v9, v8, s[88:91], 0 offen sc1
    s_add_u32 s39, s39, 1
    s_cmp_gt_u32 s39, 400000
    s_cbranch_scc1 M_fail
    s_waitcnt vmcnt(0)
    v_cmp_eq_u32 vcc, 0, v9
    s_cbranch_vccnz L_rw_2
    v_readfirstlane_b32 s28, v9
    s_cmp_lg_u32 s28, s23
    s_cbranch_scc1 M_redo
    v_lshlrev_b32 v6, 4, v0
    v_mov_b32 v8, 0
    v_mov_b32 v9, 0
    v_mov_b32 v10, 0
    v_mov_b32 v11, 0
    s_mul_i32 s28, s30, 24576
    s_add_u32 s28, s28, 0x800000
    buffer_store_dwordx4 v[8:11], v6, s[8:11], s28 offen sc1
    s_add_u32 s28, s28, 4096
    buffer_store_dwordx4 v[8:11], v6, s[8:11], s28 offen sc1
    s_add_u32 s28, s28, 4096
    buffer_store_dwordx4 v[8:11], v6, s[8:11], s28 offen sc1
    s_add_u32 s28, s28, 4096
    buffer_store_dwordx4 v[8:11], v6, s[8:11], s28 offen sc1
    s_add_u32 s28, s28, 4096
    buffer_store_dwordx4 v[8:11], v6, s[8:11], s28 offen sc1
    s_add_u32 s28, s28, 4096
    buffer_store_dwordx4 v[8:11], v6, s[8:11], s28 offen sc1
    s_add_u32 s28, s28, 4096
    v_mov_b32 v60, -1
    v_mov_b32 v61, -1
    v_mov_b32 v62, -1
    v_mov_b32 v63, -1
    s_lshr_b32 s28, s30, 1
    s_mul_i32 s28, s28, 24576
    s_min_u32 s28, s28, 0xca000
    s_and_b32 s29, s30, 1
    s_lshl_b32 s29, s29, 20
    s_add_u32 s28, s28, s29
    s_add_u32 s28, s28, 0xc000000
    buffer_store_dwordx4 v[60:63], v6, s[8:11], s28 offen sc1
    s_add_u32 s28, s28, 4096
    buffer_store_dwordx4 v[60:63], v6, s[8:11], s28 offen sc1
    s_add_u32 s28, s28, 4096
    buffer_store_dwordx4 v[60:63], v6, s[8:11], s28 offen sc1
    s_add_u32 s28, s28, 4096
    buffer_store_dwordx4 v[60:63], v6, s[8:11], s28 offen sc1
    s_add_u32 s28, s28, 4096
    buffer_store_dwordx4 v[60:63], v6, s[8:11], s28 offen sc1
    s_add_u32 s28, s28, 4096
    buffer_store_dwordx4 v[60:63], v6, s[8:11], s28 offen sc1
    s_add_u32 s28, s28, 4096
    s_cmp_ge_u32 s30, 64
    s_cbranch_scc1 M_il_nl
    s_mov_b32 s34, 0x3f803f80
    s_mov_b32 s35, 0xffff0000
    s_lshl_b32 s28, s21, 7
    v_lshlrev_b32 v7, 3, v3
    v_add_u32 v7, s28, v7
    v_xor_b32 v6, 128, v7
    s_waitcnt vmcnt(12)
    v_dot2_f32_bf16 v12, v16, s34, 0
    v_dot2_f32_bf16 v13, v16, v16, 0
    v_dot2_f32_bf16 v14, v17, s34, 0
    v_dot2_f32_bf16 v15, v17, v17, 0
    v_dot2_f32_bf16 v12, v18, s34, v12
    v_dot2_f32_bf16 v13, v18, v18, v13
    v_dot2_f32_bf16 v14, v19, s34, v14
    v_dot2_f32_bf16 v15, v19, v19, v15
    v_dot2_f32_bf16 v12, v20, s34, v12
    v_dot2_f32_bf16 v13, v20, v20, v13
    v_dot2_f32_bf16 v14, v21, s34, v14
    v_dot2_f32_bf16 v15, v21, v21, v15
    v_dot2_f32_bf16 v12, v22, s34, v12
    v_dot2_f32_bf16 v13, v22, v22, v13
    v_dot2_f32_bf16 v14, v23, s34, v14
    v_dot2_f32_bf16 v15, v23, v23, v15
    v_dot2_f32_bf16 v12, v24, s34, v12
    v_dot2_f32_bf16 v13, v24, v24, v13
    v_dot2_f32_bf16 v14, v25, s34, v14
    v_dot2_f32_bf16 v15, v25, v25, v15
    v_dot2_f32_bf16 v12, v26, s34, v12
    v_dot2_f32_bf16 v13, v26, v26, v13
    v_dot2_f32_bf16 v14, v27, s34, v14
    v_dot2_f32_bf16 v15, v27, v27, v15
    v_dot2_f32_bf16 v12, v28, s34, v12
    v_dot2_f32_bf16 v13, v28, v28, v13
    v_dot2_f32_bf16 v14, v29, s34, v14
    v_dot2_f32_bf16 v15, v29, v29, v15
    v_dot2_f32_bf16 v12, v30, s34, v12
    v_dot2_f32_bf16 v13, v30, v30, v13
    v_dot2_f32_bf16 v14, v31, s34, v14
    v_dot2_f32_bf16 v15, v31, v31, v15
    v_dot2_f32_bf16 v12, v32, s34, v12
    v_dot2_f32_bf16 v13, v32, v32, v13
    v_dot2_f32_bf16 v14, v33, s34, v14
    v_dot2_f32_bf16 v15, v33, v33, v15
    v_dot2_f32_bf16 v12, v34, s34, v12
    v_dot2_f32_bf16 v13, v34, v34, v13
    v_dot2_f32_bf16 v14, v35, s34, v14
    v_dot2_f32_bf16 v15, v35, v35, v15
    v_dot2_f32_bf16 v12, v36, s34, v12
    v_dot2_f32_bf16 v13, v36, v36, v13
    v_dot2_f32_bf16 v14, v37, s34, v14
    v_dot2_f32_bf16 v15, v37, v37, v15
    v_dot2_f32_bf16 v12, v38, s34, v12
    v_dot2_f32_bf16 v13, v38, v38, v13
    v_dot2_f32_bf16 v14, v39, s34, v14
    v_dot2_f32_bf16 v15, v39, v39, v15
    v_dot2_f32_bf16 v12, v40, s34, v12
    v_dot2_f32_bf16 v13, v40, v40, v13
    v_dot2_f32_bf16 v14, v41, s34, v14
    v_dot2_f32_bf16 v15, v41, v41, v15
    v_dot2_f32_bf16 v12, v42, s34, v12
    v_dot2_f32_bf16 v13, v42, v42, v13
    v_dot2_f32_bf16 v14, v43, s34, v14
    v_dot2_f32_bf16 v15, v43, v43, v15
    v_dot2_f32_bf16 v12, v44, s34, v12
    v_dot2_f32_bf16 v13, v44, v44, v13
    v_dot2_f32_bf16 v14, v45, s34, v14
    v_dot2_f32_bf16 v15, v45, v45, v15
    v_dot2_f32_bf16 v12, v46, s34, v12
    v_dot2_f32_bf16 v13, v46, v46, v13
    v_dot2_f32_bf16 v14, v47, s34, v14
    v_dot2_f32_bf16 v15, v47, v47, v15
    v_dot2_f32_bf16 v12, v48, s34, v12
    v_dot2_f32_bf16 v13, v48, v48, v13
    v_dot2_f32_bf16 v14, v49, s34, v14
    v_dot2_f32_bf16 v15, v49, v49, v15
    v_dot2_f32_bf16 v12, v50, s34, v12
    v_dot2_f32_bf16 v13, v50, v50, v13
    v_dot2_f32_bf16 v14, v51, s34, v14
    v_dot2_f32_bf16 v15, v51, v51, v15
    v_dot2_f32_bf16 v12, v52, s34, v12
    v_dot2_f32_bf16 v13, v52, v52, v13
    v_dot2_f32_bf16 v14, v53, s34, v14
    v_dot2_f32_bf16 v15, v53, v53, v15
    v_dot2_f32_bf16 v12, v54, s34, v12
    v_dot2_f32_bf16 v13, v54, v54, v13
    v_dot2_f32_bf16 v14, v55, s34, v14
    v_dot2_f32_bf16 v15, v55, v55, v15
    s_nop 2
    v_pk_add_f32 v[12:13], v[12:13], v[14:15]
    v_mov_b32 v14, v12
    v_mov_b32 v15, v13
    s_nop 1
    v_permlane32_swap_b32 v12, v14
    v_permlane32_swap_b32 v13, v15
    v_pk_add_f32 v[12:13], v[12:13], v[14:15]
    v_mov_b32 v14, v12
    v_mov_b32 v15, v13
    s_nop 1
    v_permlane16_swap_b32 v12, v14
    v_permlane16_swap_b32 v13, v15
    v_pk_add_f32 v[12:13], v[12:13], v[14:15]
    ds_write_b64 v7, v[12:13]
    s_waitcnt lgkmcnt(0)
    s_barrier
    ds_read_b64 v[14:15], v6
    s_mul_i32 s28, s21, 10240
    s_add_u32 s31, s31, s28
    s_waitcnt lgkmcnt(0)
    v_pk_add_f32 v[12:13], v[12:13], v[14:15]
    v_mul_f32 v12, 0.0015625, v12
    v_mul_f32 v13, 0.0015625, v13
    v_fma_f32 v13, -v12, v12, v13
    v_max_f32 v13, 0, v13
    v_add_f32 v13, 1e-5, v13
    v_rsq_f32 v14, v13
    s_nop 0
    v_mul_f32_e64 v12, -v12, v14
    v_lshlrev_b32 v56, 16, v16
    v_and_b32 v57, s35, v16
    v_pk_fma_f32 v[56:57], v[56:57], v[14:15], v[12:13] op_sel_hi:[1,0,0]
    v_cvt_pk_bf16_f32 v16, v56, v57
    v_lshlrev_b32 v58, 16, v17
    v_and_b32 v59, s35, v17
    v_pk_fma_f32 v[58:59], v[58:59], v[14:15], v[12:13] op_sel_hi:[1,0,0]
    v_cvt_pk_bf16_f32 v17, v58, v59
    v_lshlrev_b32 v56, 16, v18
    v_and_b32 v57, s35, v18
    v_pk_fma_f32 v[56:57], v[56:57], v[14:15], v[12:13] op_sel_hi:[1,0,0]
    v_cvt_pk_bf16_f32 v18, v56, v57
    v_lshlrev_b32 v58, 16, v19
    v_and_b32 v59, s35, v19
    v_pk_fma_f32 v[58:59], v[58:59], v[14:15], v[12:13] op_sel_hi:[1,0,0]
    v_cvt_pk_bf16_f32 v19, v58, v59
    buffer_store_dwordx4 v[16:19], v2, s[8:11], s31 offen offset:0 sc1
    v_lshlrev_b32 v56, 16, v20
    v_and_b32 v57, s35, v20
    v_pk_fma_f32 v[56:57], v[56:57], v[14:15], v[12:13] op_sel_hi:[1,0,0]
    v_cvt_pk_bf16_f32 v20, v56, v57
    v_lshlrev_b32 v58, 16, v21
    v_and_b32 v59, s35, v21
    v_pk_fma_f32 v[58:59], v[58:59], v[14:15], v[12:13] op_sel_hi:[1,0,0]
    v_cvt_pk_bf16_f32 v21, v58, v59
    v_lshlrev_b32 v56, 16, v22
    v_and_b32 v57, s35, v22
    v_pk_fma_f32 v[56:57], v[56:57], v[14:15], v[12:13] op_sel_hi:[1,0,0]
    v_cvt_pk_bf16_f32 v22, v56, v57
    v_lshlrev_b32 v58, 16, v23
    v_and_b32 v59, s35, v23
    v_pk_fma_f32 v[58:59], v[58:59], v[14:15], v[12:13] op_sel_hi:[1,0,0]
    v_cvt_pk_bf16_f32 v23, v58, v59
    buffer_store_dwordx4 v[20:23], v2, s[8:11], s31 offen offset:1024 sc1
    v_lshlrev_b32 v56, 16, v24
    v_and_b32 v57, s35, v24
    v_pk_fma_f32 v[56:57], v[56:57], v[14:15], v[12:13] op_sel_hi:[1,0,0]
    v_cvt_pk_bf16_f32 v24, v56, v57
    v_lshlrev_b32 v58, 16, v25
    v_and_b32 v59, s35, v25
    v_pk_fma_f32 v[58:59], v[58:59], v[14:15], v[12:13] op_sel_hi:[1,0,0]
    v_cvt_pk_bf16_f32 v25, v58, v59
    v_lshlrev_b32 v56, 16, v26
    v_and_b32 v57, s35, v26
    v_pk_fma_f32 v[56:57], v[56:57], v[14:15], v[12:13] op_sel_hi:[1,0,0]
    v_cvt_pk_bf16_f32 v26, v56, v57
    v_lshlrev_b32 v58, 16, v27
    v_and_b32 v59, s35, v27
    v_pk_fma_f32 v[58:59], v[58:59], v[14:15], v[12:13] op_sel_hi:[1,0,0]
    v_cvt_pk_bf16_f32 v27, v58, v59
    buffer_store_dwordx4 v[24:27], v2, s[8:11], s31 offen offset:2048 sc1
    v_lshlrev_b32 v56, 16, v28
    v_and_b32 v57, s35, v28
    v_pk_fma_f32 v[56:57], v[56:57], v[14:15], v[12:13] op_sel_hi:[1,0,0]
    v_cvt_pk_bf16_f32 v28, v56, v57
    v_lshlrev_b32 v58, 16, v29
    v_and_b32 v59, s35, v29
    v_pk_fma_f32 v[58:59], v[58:59], v[14:15], v[12:13] op_sel_hi:[1,0,0]
    v_cvt_pk_bf16_f32 v29, v58, v59
    v_lshlrev_b32 v56, 16, v30
    v_and_b32 v57, s35, v30
    v_pk_fma_f32 v[56:57], v[56:57], v[14:15], v[12:13] op_sel_hi:[1,0,0]
    v_cvt_pk_bf16_f32 v30, v56, v57
    v_lshlrev_b32 v58, 16, v31
    v_and_b32 v59, s35, v31
    v_pk_fma_f32 v[58:59], v[58:59], v[14:15], v[12:13] op_sel_hi:[1,0,0]
    v_cvt_pk_bf16_f32 v31, v58, v59
    buffer_store_dwordx4 v[28:31], v2, s[8:11], s31 offen offset:3072 sc1
    s_add_u32 s31, s31, 4096
    v_lshlrev_b32 v56, 16, v32
    v_and_b32 v57, s35, v32
    v_pk_fma_f32 v[56:57], v[56:57], v[14:15], v[12:13] op_sel_hi:[1,0,0]
    v_cvt_pk_bf16_f32 v32, v56, v57
    v_lshlrev_b32 v58, 16, v33
    v_and_b32 v59, s35, v33
    v_pk_fma_f32 v[58:59], v[58:59], v[14:15], v[12:13] op_sel_hi:[1,0,0]
    v_cvt_pk_bf16_f32 v33, v58, v59
    v_lshlrev_b32 v56, 16, v34
    v_and_b32 v57, s35, v34
    v_pk_fma_f32 v[56:57], v[56:57], v[14:15], v[12:13] op_sel_hi:[1,0,0]
    v_cvt_pk_bf16_f32 v34, v56, v57
    v_lshlrev_b32 v58, 16, v35
    v_and_b32 v59, s35, v35
    v_pk_fma_f32 v[58:59], v[58:59], v[14:15], v[12:13] op_sel_hi:[1,0,0]
    v_cvt_pk_bf16_f32 v35, v58, v59
    buffer_store_dwordx4 v[32:35], v2, s[8:11], s31 offen offset:0 sc1
    v_lshlrev_b32 v56, 16, v36
    v_and_b32 v57, s35, v36
    v_pk_fma_f32 v[56:57], v[56:57], v[14:15], v[12:13] op_sel_hi:[1,0,0]
    v_cvt_pk_bf16_f32 v36, v56, v57
    v_lshlrev_b32 v58, 16, v37
    v_and_b32 v59, s35, v37
    v_pk_fma_f32 v[58:59], v[58:59], v[14:15], v[12:13] op_sel_hi:[1,0,0]
    v_cvt_pk_bf16_f32 v37, v58, v59
    v_lshlrev_b32 v56, 16, v38
    v_and_b32 v57, s35, v38
    v_pk_fma_f32 v[56:57], v[56:57], v[14:15], v[12:13] op_sel_hi:[1,0,0]
    v_cvt_pk_bf16_f32 v38, v56, v57
    v_lshlrev_b32 v58, 16, v39
    v_and_b32 v59, s35, v39
    v_pk_fma_f32 v[58:59], v[58:59], v[14:15], v[12:13] op_sel_hi:[1,0,0]
    v_cvt_pk_bf16_f32 v39, v58, v59
    buffer_store_dwordx4 v[36:39], v2, s[8:11], s31 offen offset:1024 sc1
    v_lshlrev_b32 v56, 16, v40
    v_and_b32 v57, s35, v40
    v_pk_fma_f32 v[56:57], v[56:57], v[14:15], v[12:13] op_sel_hi:[1,0,0]
    v_cvt_pk_bf16_f32 v40, v56, v57
    v_lshlrev_b32 v58, 16, v41
    v_and_b32 v59, s35, v41
    v_pk_fma_f32 v[58:59], v[58:59], v[14:15], v[12:13] op_sel_hi:[1,0,0]
    v_cvt_pk_bf16_f32 v41, v58, v59
    v_lshlrev_b32 v56, 16, v42
    v_and_b32 v57, s35, v42
    v_pk_fma_f32 v[56:57], v[56:57], v[14:15], v[12:13] op_sel_hi:[1,0,0]
    v_cvt_pk_bf16_f32 v42, v56, v57
    v_lshlrev_b32 v58, 16, v43
    v_and_b32 v59, s35, v43
    v_pk_fma_f32 v[58:59], v[58:59], v[14:15], v[12:13] op_sel_hi:[1,0,0]
    v_cvt_pk_bf16_f32 v43, v58, v59
    buffer_store_dwordx4 v[40:43], v2, s[8:11], s31 offen offset:2048 sc1
    v_lshlrev_b32 v56, 16, v44
    v_and_b32 v57, s35, v44
    v_pk_fma_f32 v[56:57], v[56:57], v[14:15], v[12:13] op_sel_hi:[1,0,0]
    v_cvt_pk_bf16_f32 v44, v56, v57
    v_lshlrev_b32 v58, 16, v45
    v_and_b32 v59, s35, v45
    v_pk_fma_f32 v[58:59], v[58:59], v[14:15], v[12:13] op_sel_hi:[1,0,0]
    v_cvt_pk_bf16_f32 v45, v58, v59
    v_lshlrev_b32 v56, 16, v46
    v_and_b32 v57, s35, v46
    v_pk_fma_f32 v[56:57], v[56:57], v[14:15], v[12:13] op_sel_hi:[1,0,0]
    v_cvt_pk_bf16_f32 v46, v56, v57
    v_lshlrev_b32 v58, 16, v47
    v_and_b32 v59, s35, v47
    v_pk_fma_f32 v[58:59], v[58:59], v[14:15], v[12:13] op_sel_hi:[1,0,0]
    v_cvt_pk_bf16_f32 v47, v58, v59
    buffer_store_dwordx4 v[44:47], v2, s[8:11], s31 offen offset:3072 sc1
    s_add_u32 s31, s31, 4096
    v_lshlrev_b32 v56, 16, v48
    v_and_b32 v57, s35, v48
    v_pk_fma_f32 v[56:57], v[56:57], v[14:15], v[12:13] op_sel_hi:[1,0,0]
    v_cvt_pk_bf16_f32 v48, v56, v57
    v_lshlrev_b32 v58, 16, v49
    v_and_b32 v59, s35, v49
    v_pk_fma_f32 v[58:59], v[58:59], v[14:15], v[12:13] op_sel_hi:[1,0,0]
    v_cvt_pk_bf16_f32 v49, v58, v59
    v_lshlrev_b32 v56, 16, v50
    v_and_b32 v57, s35, v50
    v_pk_fma_f32 v[56:57], v[56:57], v[14:15], v[12:13] op_sel_hi:[1,0,0]
    v_cvt_pk_bf16_f32 v50, v56, v57
    v_lshlrev_b32 v58, 16, v51
    v_and_b32 v59, s35, v51
    v_pk_fma_f32 v[58:59], v[58:59], v[14:15], v[12:13] op_sel_hi:[1,0,0]
    v_cvt_pk_bf16_f32 v51, v58, v59
    buffer_store_dwordx4 v[48:51], v2, s[8:11], s31 offen offset:0 sc1
    v_lshlrev_b32 v56, 16, v52
    v_and_b32 v57, s35, v52
    v_pk_fma_f32 v[56:57], v[56:57], v[14:15], v[12:13] op_sel_hi:[1,0,0]
    v_cvt_pk_bf16_f32 v52, v56, v57
    v_lshlrev_b32 v58, 16, v53
    v_and_b32 v59, s35, v53
    v_pk_fma_f32 v[58:59], v[58:59], v[14:15], v[12:13] op_sel_hi:[1,0,0]
    v_cvt_pk_bf16_f32 v53, v58, v59
    v_lshlrev_b32 v56, 16, v54
    v_and_b32 v57, s35, v54
    v_pk_fma_f32 v[56:57], v[56:57], v[14:15], v[12:13] op_sel_hi:[1,0,0]
    v_cvt_pk_bf16_f32 v54, v56, v57
    v_lshlrev_b32 v58, 16, v55
    v_and_b32 v59, s35, v55
    v_pk_fma_f32 v[58:59], v[58:59], v[14:15], v[12:13] op_sel_hi:[1,0,0]
    v_cvt_pk_bf16_f32 v55, v58, v59
    buffer_store_dwordx4 v[52:55], v2, s[8:11], s31 offen offset:1024 sc1
M_il_nl:
    s_mov_b32 s34, 0
    s_mov_b32 s35, s30
    s_waitcnt vmcnt(0)
    s_barrier
    s_cmp_lg_u32 s21, 0
    s_cbranch_scc1 M_il_id
    s_lshl_b32 s34, s34, 16
    s_add_u32 s34, s34, 1
    v_mov_b32 v8, s34
    v_mov_b32 v9, 0x7ff00000
    v_cmp_eq_u32 vcc, 0, v1
    s_nop 1
    v_cndmask_b32_e64 v9, v9, 0, vcc
    s_cmp_ge_u32 s35, 2
    s_cbranch_scc1 M_il_na
    s_lshl_b32 s35, s35, 2
    buffer_store_dword v8, v9, s[88:91], s35 offen offset:132 sc1
M_il_na:
    buffer_atomic_add v8, v9, s[88:91], 0 offen sc0 sc1
    s_waitcnt vmcnt(0)
    v_readfirstlane_b32 s28, v8
    s_add_u32 s28, s28, s34
    s_and_b32 s29, s28, 0xffff
    s_cmp_lg_u32 s29, 96
    s_cbranch_scc1 M_il_id
    s_lshr_b32 s28, s28, 16
    s_cmp_gt_u32 s28, 32
    s_cselect_b32 s28, 2, 1
    v_mov_b32 v8, s28
    buffer_store_dword v8, v9, s[88:91], 0 offen offset:128 sc1
M_il_id:
    s_and_b32 s28, s25, 0xfc
    s_cmp_eq_u32 s28, 84
    s_cselect_b32 s29, 1, 0
    s_cmp_eq_u32 s28, 240
    s_cselect_b32 s29, 1, s29
    s_cmp_eq_u32 s29, 0
    s_cbranch_scc1 M_nt
    s_load_dwordx8 s[40:47], s[0:1], 64
    s_load_dwordx2 s[48:49], s[0:1], 96
    s_cmp_ge_u32 s21, 2
    s_cbranch_scc1 M_nt2
    v_mul_u32_u24 v8, 0x201100, v0
    buffer_load_dword v9, v8, s[8:11], 0 offen
M_nt2:
    s_waitcnt lgkmcnt(0)
    s_cmp_lg_u32 s21, 3
    s_cbranch_scc1 M_nt
    v_lshlrev_b32 v8, 20, v1
    s_mov_b32 s12, s40
    s_and_b32 s13, s41, 0xffff
    s_mov_b32 s14, 0x1e0000
    s_mov_b32 s15, 0x20000
    buffer_load_dword v9, v8, s[12:15], 0 offen
    s_mov_b32 s12, s42
    s_and_b32 s13, s43, 0xffff
    s_mov_b32 s14, 0x800000
    s_mov_b32 s15, 0x20000
    buffer_load_dword v9, v8, s[12:15], 0 offen
    s_mov_b32 s12, s44
    s_and_b32 s13, s45, 0xffff
    s_mov_b32 s14, 0x1000
    s_mov_b32 s15, 0x20000
    buffer_load_dword v9, v8, s[12:15], 0 offen
    s_mov_b32 s12, s46
    s_and_b32 s13, s47, 0xffff
    s_mov_b32 s14, 0xf0000
    s_mov_b32 s15, 0x20000
    buffer_load_dword v9, v8, s[12:15], 0 offen
    s_mov_b32 s12, s48
    s_and_b32 s13, s49, 0xffff
    s_mov_b32 s14, 0x280000
    s_mov_b32 s15, 0x20000
    buffer_load_dword v9, v8, s[12:15], 0 offen
M_nt:
    s_sub_u32 s20, s25, 64
    s_cmp_lt_u32 s25, 104
    s_cbranch_scc1 M_c
    v_mov_b32 v16, 128
    s_mov_b32 s39, 0
L_go_3:
    buffer_load_dword v17, v16, s[88:91], 0 offen sc1
    buffer_load_dword v18, v16, s[88:91], 0 offen offset:12 sc1
    s_add_u32 s39, s39, 1
    s_cmp_gt_u32 s39, 400000
    s_cbranch_scc1 M_fail
    s_waitcnt vmcnt(0)
    v_cmp_eq_u32 vcc, 0, v18
    s_cbranch_vccnz L_go_3
    v_readfirstlane_b32 s28, v18
    s_cmp_lg_u32 s28, s23
    s_cbranch_scc1 M_redo
    v_cmp_ne_u32 vcc, 0, v17
    s_cbranch_vccnz L_go_3k
    s_sleep 3
    s_branch L_go_3
L_go_3k:
    v_readfirstlane_b32 s53, v17
    s_sub_u32 s53, s53, 1
    s_and_b32 s53, s53, 1
    s_lshl_b32 s52, s53, 13
    s_add_u32 s52, s52, 0xa00000
    s_xor_b32 s56, s53, 1
    s_lshl_b32 s56, s56, 13
    s_lshr_b32 s55, s25, 2
    s_and_b32 s55, s55, 15
    s_mul_i32 s55, s55, 256
    s_mov_b32 s58, 0
    s_and_b32 s20, s25, 7
    s_cmp_lt_u32 s25, 112
    s_cbranch_scc1 M_x
    s_cmp_lt_u32 s25, 128
    s_cbranch_scc1 M_g10
    s_cmp_ge_u32 s25, 254
    s_cbranch_scc1 M_wt
    s_sub_u32 s28, s25, 224
    s_mul_i32 s22, s28, 26
    s_lshr_b32 s22, s22, 8
    s_mul_i32 s29, s22, 10
    s_sub_u32 s20, s28, s29
    s_load_dwordx2 s[28:29], s[0:1], 0
    s_waitcnt lgkmcnt(0)
    s_mov_b32 s12, s28
    s_and_b32 s13, s29, 0xffff
    s_mov_b32 s14, 0x280000
    s_mov_b32 s15, 0x20000
    v_lshlrev_b32 v2, 4, v1
    v_and_b32 v4, 7, v1
    v_lshlrev_b32 v4, 7, v4
    s_lshl_b32 s28, s21, 10
    v_add_u32 v4, s28, v4
    v_and_b32 v5, 15, v1
    v_lshrrev_b32 v6, 4, v1
    v_mul_u32_u24 v5, 1280, v5
    v_lshl_add_u32 v5, v6, 3, v5
    s_and_b32 s30, s21, 1
    s_mul_i32 s30, s30, 20480
    s_lshr_b32 s29, s21, 1
    s_lshl_b32 s28, s20, 1
    s_add_u32 s29, s29, s28
    s_lshl_b32 s28, s29, 6
    s_add_u32 s28, s28, s30
    v_add_u32 v5, s28, v5
    s_lshl_b32 s28, s29, 10
    s_add_u32 s28, s28, s30
    v_add_u32 v13, s28, v2
    s_lshl_b32 s28, s21, 13
    v_add_u32 v6, s28, v2
    s_lshl_b32 s28, s21, 11
    v_add_u32 v7, s28, v2
    s_lshl_b32 s50, s20, 16
    s_add_u32 s50, s50, s28
    s_add_u32 s50, s50, 0xc000000
    s_mov_b32 s48, 0xffff0000
    s_lshl_b32 s28, s20, 7
    v_mov_b32 v14, 0x7ff00000
    v_lshl_add_u32 v15, v0, 2, s28
    v_cmp_gt_u32 vcc, 32, v0
    s_nop 1
    v_cndmask_b32 v14, v14, v15, vcc
    v_mov_b32 v15, 1
    v_add_u32 v8, 0x200000, v4
    v_add_u32 v3, 0x103000, v4
    v_subrev_u32 v3, s56, v3
    v_cmp_gt_u32 vcc, 32, v1
    s_mul_i32 s51, s22, 1310720
    s_lshl_b32 s29, s20, 17
    v_cndmask_b32 v3, v3, v8, vcc
    s_add_u32 s51, s51, s29
    s_lshl_b32 s29, s21, 13
    s_add_u32 s51, s51, s29
    s_add_u32 s51, s51, 0x4000000
    s_lshl_b32 s43, s22, 12
    s_add_u32 s44, s43, 0x800000
    s_mov_b32 s39, 0
M_o_f1:
    buffer_load_dword v20, v4, s[8:11], s44 offen sc1
    s_add_u32 s39, s39, 1
    s_cmp_gt_u32 s39, 400000
    s_cbranch_scc1 M_fail
    s_waitcnt vmcnt(0)
    v_cmp_eq_u32 vcc, 0, v20
    s_cbranch_vccz M_o_f1_ok
    s_sleep 8
    s_branch M_o_f1
M_o_f1_ok:
    s_add_u32 s29, s51, 0
    buffer_load_dwordx4 a[0:3], v2, s[8:11], s29 offen offset:0 sc1
    buffer_load_dwordx4 a[4:7], v2, s[8:11], s29 offen offset:1024 sc1
    buffer_load_dwordx4 a[8:11], v2, s[8:11], s29 offen offset:2048 sc1
    buffer_load_dwordx4 a[12:15], v2, s[8:11], s29 offen offset:3072 sc1
    s_add_u32 s29, s51, 4096
    buffer_load_dwordx4 a[16:19], v2, s[8:11], s29 offen offset:0 sc1
    buffer_load_dwordx4 a[20:23], v2, s[8:11], s29 offen offset:1024 sc1
    buffer_load_dwordx4 a[24:27], v2, s[8:11], s29 offen offset:2048 sc1
    buffer_load_dwordx4 a[28:31], v2, s[8:11], s29 offen offset:3072 sc1
    s_add_u32 s29, s51, 32768
    buffer_load_dwordx4 a[32:35], v2, s[8:11], s29 offen offset:0 sc1
    buffer_load_dwordx4 a[36:39], v2, s[8:11], s29 offen offset:1024 sc1
    buffer_load_dwordx4 a[40:43], v2, s[8:11], s29 offen offset:2048 sc1
    buffer_load_dwordx4 a[44:47], v2, s[8:11], s29 offen offset:3072 sc1
    s_add_u32 s29, s51, 36864
    buffer_load_dwordx4 a[48:51], v2, s[8:11], s29 offen offset:0 sc1
    buffer_load_dwordx4 a[52:55], v2, s[8:11], s29 offen offset:1024 sc1
    buffer_load_dwordx4 a[56:59], v2, s[8:11], s29 offen offset:2048 sc1
    buffer_load_dwordx4 a[60:63], v2, s[8:11], s29 offen offset:3072 sc1
    s_add_u32 s29, s51, 65536
    buffer_load_dwordx4 a[64:67], v2, s[8:11], s29 offen offset:0 sc1
    buffer_load_dwordx4 a[68:71], v2, s[8:11], s29 offen offset:1024 sc1
    buffer_load_dwordx4 a[72:75], v2, s[8:11], s29 offen offset:2048 sc1
    buffer_load_dwordx4 a[76:79], v2, s[8:11], s29 offen offset:3072 sc1
    s_add_u32 s29, s51, 69632
    buffer_load_dwordx4 a[80:83], v2, s[8:11], s29 offen offset:0 sc1
    buffer_load_dwordx4 a[84:87], v2, s[8:11], s29 offen offset:1024 sc1
    buffer_load_dwordx4 a[88:91], v2, s[8:11], s29 offen offset:2048 sc1
    buffer_load_dwordx4 a[92:95], v2, s[8:11], s29 offen offset:3072 sc1
    s_add_u32 s29, s51, 98304
    buffer_load_dwordx4 a[96:99], v2, s[8:11], s29 offen offset:0 sc1
    buffer_load_dwordx4 a[100:103], v2, s[8:11], s29 offen offset:1024 sc1
    buffer_load_dwordx4 a[104:107], v2, s[8:11], s29 offen offset:2048 sc1
    buffer_load_dwordx4 a[108:111], v2, s[8:11], s29 offen offset:3072 sc1
    s_add_u32 s29, s51, 102400
    buffer_load_dwordx4 a[112:115], v2, s[8:11], s29 offen offset:0 sc1
    buffer_load_dwordx4 a[116:119], v2, s[8:11], s29 offen offset:1024 sc1
    buffer_load_dwordx4 a[120:123], v2, s[8:11], s29 offen offset:2048 sc1
    buffer_load_dwordx4 a[124:127], v2, s[8:11], s29 offen offset:3072 sc1
    s_add_u32 s51, s51, 3932160
    s_nop 0
M_o_loop:
    s_lshl_b32 s43, s22, 12
    s_add_u32 s43, s43, s56
    s_mul_i32 s45, s22, 40960
    buffer_load_dwordx2 v[16:17], v5, s[12:15], s45 offen
    buffer_load_dwordx2 v[18:19], v5, s[12:15], s45 offen offset:32
    s_add_u32 s44, s43, 0x8c0000
    s_mov_b32 s39, 0
M_o_f3:
    buffer_load_dword v20, v4, s[8:11], s44 offen sc1
    s_add_u32 s39, s39, 1
    s_cmp_gt_u32 s39, 400000
    s_cbranch_scc1 M_fail
    s_waitcnt vmcnt(0)
    v_cmp_eq_u32 vcc, 0, v20
    s_cbranch_vccz M_o_f3_ok
    s_sleep 3
    s_cmp_ge_i32 s22, 58
    s_cbranch_scc1 M_o_f3
    s_sleep 6
    s_branch M_o_f3
M_o_f3_ok:
    s_lshr_b32 s28, s22, 1
    s_xor_b32 s28, s28, s53
    s_and_b32 s28, s28, 1
    s_xor_b32 s28, s28, 1
    s_lshl_b32 s28, s28, 13
    s_lshl_b32 s47, s22, 20
    s_add_u32 s47, s47, s28
    s_add_u32 s47, s47, s50
    s_mov_b32 s39, 0
M_o_z:
    s_add_u32 s49, s47, 0
    buffer_load_dwordx4 v[208:211], v2, s[8:11], s49 offen offset:0 sc1
    buffer_load_dwordx4 v[212:215], v2, s[8:11], s49 offen offset:1024 sc1
    s_add_u32 s49, s47, 16384
    buffer_load_dwordx4 v[216:219], v2, s[8:11], s49 offen offset:0 sc1
    buffer_load_dwordx4 v[220:223], v2, s[8:11], s49 offen offset:1024 sc1
    s_add_u32 s49, s47, 32768
    buffer_load_dwordx4 v[224:227], v2, s[8:11], s49 offen offset:0 sc1
    buffer_load_dwordx4 v[228:231], v2, s[8:11], s49 offen offset:1024 sc1
    s_add_u32 s49, s47, 49152
    buffer_load_dwordx4 v[232:235], v2, s[8:11], s49 offen offset:0 sc1
    buffer_load_dwordx4 v[236:239], v2, s[8:11], s49 offen offset:1024 sc1
    s_add_u32 s39, s39, 1
    s_cmp_gt_u32 s39, 400000
    s_cbranch_scc1 M_fail
    s_waitcnt vmcnt(0)
    v_max3_u32 v20, v208, v209, v210
    v_max3_u32 v20, v20, v211, v212
    v_max3_u32 v20, v20, v213, v214
    v_max3_u32 v20, v20, v215, v216
    v_max3_u32 v20, v20, v217, v218
    v_max3_u32 v20, v20, v219, v220
    v_max3_u32 v20, v20, v221, v222
    v_max3_u32 v20, v20, v223, v224
    v_max3_u32 v20, v20, v225, v226
    v_max3_u32 v20, v20, v227, v228
    v_max3_u32 v20, v20, v229, v230
    v_max3_u32 v20, v20, v231, v232
    v_max3_u32 v20, v20, v233, v234
    v_max3_u32 v20, v20, v235, v236
    v_max3_u32 v20, v20, v237, v238
    v_max_u32 v20, v20, v239
    v_cmp_eq_u32 vcc, -1, v20
    s_cbranch_vccnz M_o_z
    s_add_u32 s44, s43, 0x700000
    s_cmp_lt_u32 s22, 61
    s_cselect_b64 vcc, -1, 0
    v_cndmask_b32 v3, v8, v3, vcc
    s_mul_i32 s47, s22, 81920
    s_add_u32 s47, s47, 0xaa00000
    s_lshl_b32 s29, s21, 12
    s_add_u32 s46, s47, s29
    s_add_u32 s46, s46, 65536
    s_lshl_b32 s29, s21, 14
    s_add_u32 s47, s47, s29
    s_mov_b32 s39, 0
M_o_f2:
    buffer_load_dword v20, v3, s[8:11], s44 offen sc1
    s_add_u32 s39, s39, 1
    s_cmp_gt_u32 s39, 400000
    s_cbranch_scc1 M_fail
    s_waitcnt vmcnt(0)
    v_cmp_eq_u32 vcc, 0, v20
    s_cbranch_vccz M_o_f2_ok
    s_sleep 1
    s_cmp_ge_i32 s22, 58
    s_cbranch_scc1 M_o_f2
    s_sleep 6
    s_branch M_o_f2
M_o_f2_ok:
    buffer_load_dwordx4 v[128:131], v2, s[8:11], s47 offen offset:0 sc1
    buffer_load_dwordx4 v[132:135], v2, s[8:11], s47 offen offset:1024 sc1
    buffer_load_dwordx4 v[136:139], v2, s[8:11], s47 offen offset:2048 sc1
    buffer_load_dwordx4 v[140:143], v2, s[8:11], s47 offen offset:3072 sc1
    s_add_u32 s47, s47, 4096
    buffer_load_dwordx4 v[144:147], v2, s[8:11], s47 offen offset:0 sc1
    buffer_load_dwordx4 v[148:151], v2, s[8:11], s47 offen offset:1024 sc1
    buffer_load_dwordx4 v[152:155], v2, s[8:11], s47 offen offset:2048 sc1
    buffer_load_dwordx4 v[156:159], v2, s[8:11], s47 offen offset:3072 sc1
    s_add_u32 s47, s47, 4096
    buffer_load_dwordx4 v[160:163], v2, s[8:11], s47 offen offset:0 sc1
    buffer_load_dwordx4 v[164:167], v2, s[8:11], s47 offen offset:1024 sc1
    s_waitcnt vmcnt(9)
    v_mfma_f32_16x16x32_bf16 v[24:27], a[0:3], v[128:131], 0
    buffer_load_dwordx4 v[168:171], v2, s[8:11], s47 offen offset:2048 sc1
    v_mfma_f32_16x16x32_bf16 v[28:31], a[32:35], v[128:131], 0
    v_mfma_f32_16x16x32_bf16 v[40:43], a[64:67], v[128:131], 0
    v_mfma_f32_16x16x32_bf16 v[44:47], a[96:99], v[128:131], 0
    s_waitcnt vmcnt(9)
    v_mfma_f32_16x16x32_bf16 v[32:35], a[0:3], v[132:135], 0
    buffer_load_dwordx4 v[172:175], v2, s[8:11], s47 offen offset:3072 sc1
    s_add_u32 s47, s47, 4096
    v_mfma_f32_16x16x32_bf16 v[36:39], a[32:35], v[132:135], 0
    v_mfma_f32_16x16x32_bf16 v[48:51], a[64:67], v[132:135], 0
    v_mfma_f32_16x16x32_bf16 v[52:55], a[96:99], v[132:135], 0
    s_waitcnt vmcnt(9)
    v_mfma_f32_16x16x32_bf16 v[24:27], a[4:7], v[136:139], v[24:27]
    buffer_load_dwordx4 v[176:179], v2, s[8:11], s47 offen offset:0 sc1
    v_mfma_f32_16x16x32_bf16 v[28:31], a[36:39], v[136:139], v[28:31]
    v_mfma_f32_16x16x32_bf16 v[40:43], a[68:71], v[136:139], v[40:43]
    v_mfma_f32_16x16x32_bf16 v[44:47], a[100:103], v[136:139], v[44:47]
    s_waitcnt vmcnt(9)
    v_mfma_f32_16x16x32_bf16 v[32:35], a[4:7], v[140:143], v[32:35]
    buffer_load_dwordx4 v[180:183], v2, s[8:11], s47 offen offset:1024 sc1
    v_mfma_f32_16x16x32_bf16 v[36:39], a[36:39], v[140:143], v[36:39]
    v_mfma_f32_16x16x32_bf16 v[48:51], a[68:71], v[140:143], v[48:51]
    v_mfma_f32_16x16x32_bf16 v[52:55], a[100:103], v[140:143], v[52:55]
    s_waitcnt vmcnt(9)
    v_mfma_f32_16x16x32_bf16 v[24:27], a[8:11], v[144:147], v[24:27]
    buffer_load_dwordx4 v[184:187], v2, s[8:11], s47 offen offset:2048 sc1
    v_mfma_f32_16x16x32_bf16 v[28:31], a[40:43], v[144:147], v[28:31]
    v_mfma_f32_16x16x32_bf16 v[40:43], a[72:75], v[144:147], v[40:43]
    v_mfma_f32_16x16x32_bf16 v[44:47], a[104:107], v[144:147], v[44:47]
    s_waitcnt vmcnt(9)
    v_mfma_f32_16x16x32_bf16 v[32:35], a[8:11], v[148:151], v[32:35]
    buffer_load_dwordx4 v[188:191], v2, s[8:11], s47 offen offset:3072 sc1
    v_mfma_f32_16x16x32_bf16 v[36:39], a[40:43], v[148:151], v[36:39]
    v_mfma_f32_16x16x32_bf16 v[48:51], a[72:75], v[148:151], v[48:51]
    v_mfma_f32_16x16x32_bf16 v[52:55], a[104:107], v[148:151], v[52:55]
    s_waitcnt vmcnt(9)
    v_mfma_f32_16x16x32_bf16 v[24:27], a[12:15], v[152:155], v[24:27]
    buffer_load_dwordx4 v[192:195], v2, s[8:11], s46 offen offset:0 sc1
    v_mfma_f32_16x16x32_bf16 v[28:31], a[44:47], v[152:155], v[28:31]
    v_mfma_f32_16x16x32_bf16 v[40:43], a[76:79], v[152:155], v[40:43]
    v_mfma_f32_16x16x32_bf16 v[44:47], a[108:111], v[152:155], v[44:47]
    s_waitcnt vmcnt(9)
    v_mfma_f32_16x16x32_bf16 v[32:35], a[12:15], v[156:159], v[32:35]
    buffer_load_dwordx4 v[196:199], v2, s[8:11], s46 offen offset:1024 sc1
    v_mfma_f32_16x16x32_bf16 v[36:39], a[44:47], v[156:159], v[36:39]
    v_mfma_f32_16x16x32_bf16 v[48:51], a[76:79], v[156:159], v[48:51]
    v_mfma_f32_16x16x32_bf16 v[52:55], a[108:111], v[156:159], v[52:55]
    s_waitcnt vmcnt(9)
    v_mfma_f32_16x16x32_bf16 v[24:27], a[16:19], v[160:163], v[24:27]
    buffer_load_dwordx4 v[200:203], v2, s[8:11], s46 offen offset:2048 sc1
    v_mfma_f32_16x16x32_bf16 v[28:31], a[48:51], v[160:163], v[28:31]
    v_mfma_f32_16x16x32_bf16 v[40:43], a[80:83], v[160:163], v[40:43]
    v_mfma_f32_16x16x32_bf16 v[44:47], a[112:115], v[160:163], v[44:47]
    s_waitcnt vmcnt(9)
    v_mfma_f32_16x16x32_bf16 v[32:35], a[16:19], v[164:167], v[32:35]
    buffer_load_dwordx4 v[204:207], v2, s[8:11], s46 offen offset:3072 sc1
    v_mfma_f32_16x16x32_bf16 v[36:39], a[48:51], v[164:167], v[36:39]
    v_mfma_f32_16x16x32_bf16 v[48:51], a[80:83], v[164:167], v[48:51]
    v_mfma_f32_16x16x32_bf16 v[52:55], a[112:115], v[164:167], v[52:55]
    s_waitcnt vmcnt(9)
    v_mfma_f32_16x16x32_bf16 v[24:27], a[20:23], v[168:171], v[24:27]
    v_mfma_f32_16x16x32_bf16 v[28:31], a[52:55], v[168:171], v[28:31]
    v_mfma_f32_16x16x32_bf16 v[40:43], a[84:87], v[168:171], v[40:43]
    v_mfma_f32_16x16x32_bf16 v[44:47], a[116:119], v[168:171], v[44:47]
    s_waitcnt vmcnt(8)
    v_mfma_f32_16x16x32_bf16 v[32:35], a[20:23], v[172:175], v[32:35]
    v_mfma_f32_16x16x32_bf16 v[36:39], a[52:55], v[172:175], v[36:39]
    v_mfma_f32_16x16x32_bf16 v[48:51], a[84:87], v[172:175], v[48:51]
    v_mfma_f32_16x16x32_bf16 v[52:55], a[116:119], v[172:175], v[52:55]
    s_waitcnt vmcnt(7)
    v_mfma_f32_16x16x32_bf16 v[24:27], a[24:27], v[176:179], v[24:27]
    v_mfma_f32_16x16x32_bf16 v[28:31], a[56:59], v[176:179], v[28:31]
    v_mfma_f32_16x16x32_bf16 v[40:43], a[88:91], v[176:179], v[40:43]
    v_mfma_f32_16x16x32_bf16 v[44:47], a[120:123], v[176:179], v[44:47]
    s_waitcnt vmcnt(6)
    v_mfma_f32_16x16x32_bf16 v[32:35], a[24:27], v[180:183], v[32:35]
    v_mfma_f32_16x16x32_bf16 v[36:39], a[56:59], v[180:183], v[36:39]
    v_mfma_f32_16x16x32_bf16 v[48:51], a[88:91], v[180:183], v[48:51]
    v_mfma_f32_16x16x32_bf16 v[52:55], a[120:123], v[180:183], v[52:55]
    s_waitcnt vmcnt(5)
    v_mfma_f32_16x16x32_bf16 v[24:27], a[28:31], v[184:187], v[24:27]
    v_mfma_f32_16x16x32_bf16 v[28:31], a[60:63], v[184:187], v[28:31]
    v_mfma_f32_16x16x32_bf16 v[40:43], a[92:95], v[184:187], v[40:43]
    v_mfma_f32_16x16x32_bf16 v[44:47], a[124:127], v[184:187], v[44:47]
    s_waitcnt vmcnt(4)
    v_mfma_f32_16x16x32_bf16 v[32:35], a[28:31], v[188:191], v[32:35]
    v_mfma_f32_16x16x32_bf16 v[36:39], a[60:63], v[188:191], v[36:39]
    v_mfma_f32_16x16x32_bf16 v[48:51], a[92:95], v[188:191], v[48:51]
    v_mfma_f32_16x16x32_bf16 v[52:55], a[124:127], v[188:191], v[52:55]
    s_waitcnt vmcnt(3)
    v_mfma_f32_16x16x32_bf16 v[24:27], v[208:211], v[192:195], v[24:27]
    v_mfma_f32_16x16x32_bf16 v[28:31], v[216:219], v[192:195], v[28:31]
    v_mfma_f32_16x16x32_bf16 v[40:43], v[224:227], v[192:195], v[40:43]
    v_mfma_f32_16x16x32_bf16 v[44:47], v[232:235], v[192:195], v[44:47]
    s_waitcnt vmcnt(2)
    v_mfma_f32_16x16x32_bf16 v[32:35], v[208:211], v[196:199], v[32:35]
    v_mfma_f32_16x16x32_bf16 v[36:39], v[216:219], v[196:199], v[36:39]
    v_mfma_f32_16x16x32_bf16 v[48:51], v[224:227], v[196:199], v[48:51]
    v_mfma_f32_16x16x32_bf16 v[52:55], v[232:235], v[196:199], v[52:55]
    s_waitcnt vmcnt(1)
    v_mfma_f32_16x16x32_bf16 v[24:27], v[212:215], v[200:203], v[24:27]
    v_mfma_f32_16x16x32_bf16 v[28:31], v[220:223], v[200:203], v[28:31]
    v_mfma_f32_16x16x32_bf16 v[40:43], v[228:231], v[200:203], v[40:43]
    v_mfma_f32_16x16x32_bf16 v[44:47], v[236:239], v[200:203], v[44:47]
    s_waitcnt vmcnt(0)
    v_mfma_f32_16x16x32_bf16 v[32:35], v[212:215], v[204:207], v[32:35]
    v_mfma_f32_16x16x32_bf16 v[36:39], v[220:223], v[204:207], v[36:39]
    v_mfma_f32_16x16x32_bf16 v[48:51], v[228:231], v[204:207], v[48:51]
    v_mfma_f32_16x16x32_bf16 v[52:55], v[236:239], v[204:207], v[52:55]
    s_nop 3
    ds_write_b128 v6, v[24:27] offset:0
    ds_write_b128 v6, v[28:31] offset:1024
    ds_write_b128 v6, v[40:43] offset:4096
    ds_write_b128 v6, v[44:47] offset:5120
    ds_write_b128 v6, v[32:35] offset:2048
    ds_write_b128 v6, v[36:39] offset:3072
    ds_write_b128 v6, v[48:51] offset:6144
    ds_write_b128 v6, v[52:55] offset:7168
    s_waitcnt lgkmcnt(0)
    s_barrier
    ds_read_b128 v[64:67], v7 offset:0
    ds_read_b128 v[68:71], v7 offset:8192
    ds_read_b128 v[72:75], v7 offset:16384
    ds_read_b128 v[76:79], v7 offset:24576
    ds_read_b128 v[80:83], v7 offset:1024
    ds_read_b128 v[84:87], v7 offset:9216
    ds_read_b128 v[88:91], v7 offset:17408
    ds_read_b128 v[92:95], v7 offset:25600
    v_lshlrev_b32 v24, 16, v16
    v_and_b32 v25, s48, v16
    v_lshlrev_b32 v26, 16, v17
    v_and_b32 v27, s48, v17
    v_lshlrev_b32 v28, 16, v18
    v_and_b32 v29, s48, v18
    v_lshlrev_b32 v30, 16, v19
    v_and_b32 v31, s48, v19
    s_add_u32 s45, s45, 0xb000000
    s_add_u32 s44, s43, 0x940000
    s_waitcnt lgkmcnt(4)
    v_pk_add_f32 v[64:65], v[64:65], v[68:69]
    v_pk_add_f32 v[66:67], v[66:67], v[70:71]
    v_pk_add_f32 v[72:73], v[72:73], v[76:77]
    v_pk_add_f32 v[74:75], v[74:75], v[78:79]
    v_pk_add_f32 v[64:65], v[64:65], v[24:25]
    v_pk_add_f32 v[66:67], v[66:67], v[26:27]
    v_pk_add_f32 v[64:65], v[64:65], v[72:73]
    v_pk_add_f32 v[66:67], v[66:67], v[74:75]
    v_cvt_pk_bf16_f32 v32, v64, v65
    v_cvt_pk_bf16_f32 v33, v66, v67
    s_waitcnt lgkmcnt(0)
    v_pk_add_f32 v[80:81], v[80:81], v[84:85]
    v_pk_add_f32 v[82:83], v[82:83], v[86:87]
    v_pk_add_f32 v[88:89], v[88:89], v[92:93]
    v_pk_add_f32 v[90:91], v[90:91], v[94:95]
    v_pk_add_f32 v[80:81], v[80:81], v[28:29]
    v_pk_add_f32 v[82:83], v[82:83], v[30:31]
    v_pk_add_f32 v[80:81], v[80:81], v[88:89]
    v_pk_add_f32 v[82:83], v[82:83], v[90:91]
    v_cvt_pk_bf16_f32 v34, v80, v81
    v_cvt_pk_bf16_f32 v35, v82, v83
    buffer_store_dwordx4 v[32:35], v13, s[8:11], s45 offen sc1
    s_cmp_ge_u32 s22, 61
    s_cbranch_scc1 M_o_last
    s_add_u32 s29, s51, 0
    buffer_load_dwordx4 a[0:3], v2, s[8:11], s29 offen offset:0 sc1
    buffer_load_dwordx4 a[4:7], v2, s[8:11], s29 offen offset:1024 sc1
    buffer_load_dwordx4 a[8:11], v2, s[8:11], s29 offen offset:2048 sc1
    buffer_load_dwordx4 a[12:15], v2, s[8:11], s29 offen offset:3072 sc1
    s_add_u32 s29, s51, 4096
    buffer_load_dwordx4 a[16:19], v2, s[8:11], s29 offen offset:0 sc1
    buffer_load_dwordx4 a[20:23], v2, s[8:11], s29 offen offset:1024 sc1
    buffer_load_dwordx4 a[24:27], v2, s[8:11], s29 offen offset:2048 sc1
    buffer_load_dwordx4 a[28:31], v2, s[8:11], s29 offen offset:3072 sc1
    s_add_u32 s29, s51, 32768
    buffer_load_dwordx4 a[32:35], v2, s[8:11], s29 offen offset:0 sc1
    buffer_load_dwordx4 a[36:39], v2, s[8:11], s29 offen offset:1024 sc1
    buffer_load_dwordx4 a[40:43], v2, s[8:11], s29 offen offset:2048 sc1
    buffer_load_dwordx4 a[44:47], v2, s[8:11], s29 offen offset:3072 sc1
    s_add_u32 s29, s51, 36864
    buffer_load_dwordx4 a[48:51], v2, s[8:11], s29 offen offset:0 sc1
    buffer_load_dwordx4 a[52:55], v2, s[8:11], s29 offen offset:1024 sc1
    buffer_load_dwordx4 a[56:59], v2, s[8:11], s29 offen offset:2048 sc1
    buffer_load_dwordx4 a[60:63], v2, s[8:11], s29 offen offset:3072 sc1
    s_add_u32 s29, s51, 65536
    buffer_load_dwordx4 a[64:67], v2, s[8:11], s29 offen offset:0 sc1
    buffer_load_dwordx4 a[68:71], v2, s[8:11], s29 offen offset:1024 sc1
    buffer_load_dwordx4 a[72:75], v2, s[8:11], s29 offen offset:2048 sc1
    buffer_load_dwordx4 a[76:79], v2, s[8:11], s29 offen offset:3072 sc1
    s_add_u32 s29, s51, 69632
    buffer_load_dwordx4 a[80:83], v2, s[8:11], s29 offen offset:0 sc1
    buffer_load_dwordx4 a[84:87], v2, s[8:11], s29 offen offset:1024 sc1
    buffer_load_dwordx4 a[88:91], v2, s[8:11], s29 offen offset:2048 sc1
    buffer_load_dwordx4 a[92:95], v2, s[8:11], s29 offen offset:3072 sc1
    s_add_u32 s29, s51, 98304
    buffer_load_dwordx4 a[96:99], v2, s[8:11], s29 offen offset:0 sc1
    buffer_load_dwordx4 a[100:103], v2, s[8:11], s29 offen offset:1024 sc1
    buffer_load_dwordx4 a[104:107], v2, s[8:11], s29 offen offset:2048 sc1
    buffer_load_dwordx4 a[108:111], v2, s[8:11], s29 offen offset:3072 sc1
    s_add_u32 s29, s51, 102400
    buffer_load_dwordx4 a[112:115], v2, s[8:11], s29 offen offset:0 sc1
    buffer_load_dwordx4 a[116:119], v2, s[8:11], s29 offen offset:1024 sc1
    buffer_load_dwordx4 a[120:123], v2, s[8:11], s29 offen offset:2048 sc1
    buffer_load_dwordx4 a[124:127], v2, s[8:11], s29 offen offset:3072 sc1
    s_add_u32 s51, s51, 3932160
    s_nop 0
    s_waitcnt vmcnt(32)
    s_barrier
    buffer_store_dword v15, v14, s[8:11], s44 offen sc1
    s_add_u32 s22, s22, 3
    s_branch M_o_loop
M_o_last:
    s_waitcnt vmcnt(0)
    s_barrier
    buffer_store_dword v15, v14, s[8:11], s44 offen sc1
    s_branch M_g3
M_wt:
    s_and_b32 s27, s25, 1
    s_lshl_b32 s27, s27, 4
    s_mov_b32 s26, 16
    s_load_dwordx2 s[28:29], s[0:1], 72
    s_waitcnt lgkmcnt(0)
    s_mov_b32 s12, s28
    s_and_b32 s13, s29, 0xffff
    s_mov_b32 s14, 0x800000
    s_mov_b32 s15, 0x20000
    v_lshlrev_b32 v2, 4, v1
    s_lshl_b32 s31, s21, 14
    s_lshl_b32 s30, s27, 16
    s_add_u32 s30, s30, s31
    s_lshl_b32 s28, s21, 6
    v_xor_b32 v4, s28, v2
    s_add_u32 s28, s28, 16
    v_xor_b32 v5, s28, v2
    s_add_u32 s28, s28, 16
    v_xor_b32 v6, s28, v2
    s_add_u32 s28, s28, 16
    v_xor_b32 v7, s28, v2
    s_add_u32 s28, s28, 16
    v_and_b32 v8, 15, v1
    v_lshrrev_b32 v9, 4, v1
    v_xor_b32 v9, v9, v8
    v_lshlrev_b32 v9, 4, v9
    v_lshl_add_u32 v9, v8, 12, v9
    s_lshl_b32 s28, s21, 10
    v_add_u32 v10, s28, v9
    v_xor_b32 v11, 64, v10
    v_xor_b32 v12, 128, v10
    v_xor_b32 v13, 192, v10
    s_mov_b32 s32, s27
    s_add_u32 s35, s32, s26
    s_add_u32 m0, s31, 0
    s_add_u32 s28, s30, 0
    buffer_load_dwordx4 v4, s[12:15], s28 offen offset:0 nt lds
    buffer_load_dwordx4 v4, s[12:15], s28 offen offset:1024 nt lds
    buffer_load_dwordx4 v4, s[12:15], s28 offen offset:2048 nt lds
    buffer_load_dwordx4 v4, s[12:15], s28 offen offset:3072 nt lds
    s_add_u32 m0, s31, 4096
    s_add_u32 s28, s30, 4096
    buffer_load_dwordx4 v5, s[12:15], s28 offen offset:0 nt lds
    buffer_load_dwordx4 v5, s[12:15], s28 offen offset:1024 nt lds
    buffer_load_dwordx4 v5, s[12:15], s28 offen offset:2048 nt lds
    buffer_load_dwordx4 v5, s[12:15], s28 offen offset:3072 nt lds
    s_add_u32 m0, s31, 8192
    s_add_u32 s28, s30, 8192
    buffer_load_dwordx4 v6, s[12:15], s28 offen offset:0 nt lds
    buffer_load_dwordx4 v6, s[12:15], s28 offen offset:1024 nt lds
    buffer_load_dwordx4 v6, s[12:15], s28 offen offset:2048 nt lds
    buffer_load_dwordx4 v6, s[12:15], s28 offen offset:3072 nt lds
    s_add_u32 m0, s31, 12288
    s_add_u32 s28, s30, 12288
    buffer_load_dwordx4 v7, s[12:15], s28 offen offset:0 nt lds
    buffer_load_dwordx4 v7, s[12:15], s28 offen offset:1024 nt lds
    buffer_load_dwordx4 v7, s[12:15], s28 offen offset:2048 nt lds
    buffer_load_dwordx4 v7, s[12:15], s28 offen offset:3072 nt lds
    s_xor_b32 s31, s31, 65536
    s_add_u32 s30, s30, 65536
    s_and_b32 s30, s30, 0x7fffff
    s_add_u32 m0, s31, 0
    s_add_u32 s28, s30, 0
    buffer_load_dwordx4 v4, s[12:15], s28 offen offset:0 nt lds
    buffer_load_dwordx4 v4, s[12:15], s28 offen offset:1024 nt lds
    buffer_load_dwordx4 v4, s[12:15], s28 offen offset:2048 nt lds
    buffer_load_dwordx4 v4, s[12:15], s28 offen offset:3072 nt lds
    s_add_u32 m0, s31, 4096
    s_add_u32 s28, s30, 4096
    buffer_load_dwordx4 v5, s[12:15], s28 offen offset:0 nt lds
    buffer_load_dwordx4 v5, s[12:15], s28 offen offset:1024 nt lds
    buffer_load_dwordx4 v5, s[12:15], s28 offen offset:2048 nt lds
    buffer_load_dwordx4 v5, s[12:15], s28 offen offset:3072 nt lds
    s_add_u32 m0, s31, 8192
    s_add_u32 s28, s30, 8192
    buffer_load_dwordx4 v6, s[12:15], s28 offen offset:0 nt lds
    buffer_load_dwordx4 v6, s[12:15], s28 offen offset:1024 nt lds
    buffer_load_dwordx4 v6, s[12:15], s28 offen offset:2048 nt lds
    buffer_load_dwordx4 v6, s[12:15], s28 offen offset:3072 nt lds
    s_add_u32 m0, s31, 12288
    s_add_u32 s28, s30, 12288
    buffer_load_dwordx4 v7, s[12:15], s28 offen offset:0 nt lds
    buffer_load_dwordx4 v7, s[12:15], s28 offen offset:1024 nt lds
    buffer_load_dwordx4 v7, s[12:15], s28 offen offset:2048 nt lds
    buffer_load_dwordx4 v7, s[12:15], s28 offen offset:3072 nt lds
    s_xor_b32 s31, s31, 65536
    s_add_u32 s30, s30, 65536
    s_and_b32 s30, s30, 0x7fffff
    s_waitcnt vmcnt(16)
M_wt_loop:
    s_barrier
    ds_read_b128 v[16:19], v10 offset:0
    ds_read_b128 v[20:23], v11 offset:0
    ds_read_b128 v[24:27], v12 offset:0
    ds_read_b128 v[28:31], v13 offset:0
    ds_read_b128 v[32:35], v10 offset:256
    ds_read_b128 v[36:39], v11 offset:256
    ds_read_b128 v[40:43], v12 offset:256
    ds_read_b128 v[44:47], v13 offset:256
    ds_read_b128 v[48:51], v10 offset:512
    ds_read_b128 v[52:55], v11 offset:512
    ds_read_b128 v[56:59], v12 offset:512
    ds_read_b128 v[60:63], v13 offset:512
    ds_read_b128 v[64:67], v10 offset:768
    ds_read_b128 v[68:71], v11 offset:768
    ds_read_b128 v[72:75], v12 offset:768
    ds_read_b128 v[76:79], v13 offset:768
    s_lshr_b32 s28, s32, 1
    s_lshl_b32 s33, s28, 20
    s_and_b32 s28, s28, 15
    s_lshl_b32 s28, s28, 11
    s_add_u32 s33, s33, s28
    s_and_b32 s28, s32, 1
    s_mul_i32 s28, s28, 66560
    s_add_u32 s33, s33, s28
    s_lshl_b32 s28, s21, 14
    s_add_u32 s33, s33, s28
    s_add_u32 s33, s33, 0xc0d0000
    v_xor_b32 v10, 65536, v10
    v_xor_b32 v11, 65536, v11
    v_xor_b32 v12, 65536, v12
    v_xor_b32 v13, 65536, v13
    s_waitcnt lgkmcnt(0)
    s_barrier
    s_add_u32 m0, s31, 0
    s_add_u32 s28, s30, 0
    buffer_load_dwordx4 v4, s[12:15], s28 offen offset:0 nt lds
    buffer_load_dwordx4 v4, s[12:15], s28 offen offset:1024 nt lds
    buffer_load_dwordx4 v4, s[12:15], s28 offen offset:2048 nt lds
    buffer_load_dwordx4 v4, s[12:15], s28 offen offset:3072 nt lds
    s_add_u32 m0, s31, 4096
    s_add_u32 s28, s30, 4096
    buffer_load_dwordx4 v5, s[12:15], s28 offen offset:0 nt lds
    buffer_load_dwordx4 v5, s[12:15], s28 offen offset:1024 nt lds
    buffer_load_dwordx4 v5, s[12:15], s28 offen offset:2048 nt lds
    buffer_load_dwordx4 v5, s[12:15], s28 offen offset:3072 nt lds
    s_add_u32 m0, s31, 8192
    s_add_u32 s28, s30, 8192
    buffer_load_dwordx4 v6, s[12:15], s28 offen offset:0 nt lds
    buffer_load_dwordx4 v6, s[12:15], s28 offen offset:1024 nt lds
    buffer_load_dwordx4 v6, s[12:15], s28 offen offset:2048 nt lds
    buffer_load_dwordx4 v6, s[12:15], s28 offen offset:3072 nt lds
    s_add_u32 m0, s31, 12288
    s_add_u32 s28, s30, 12288
    buffer_load_dwordx4 v7, s[12:15], s28 offen offset:0 nt lds
    buffer_load_dwordx4 v7, s[12:15], s28 offen offset:1024 nt lds
    buffer_load_dwordx4 v7, s[12:15], s28 offen offset:2048 nt lds
    buffer_load_dwordx4 v7, s[12:15], s28 offen offset:3072 nt lds
    s_xor_b32 s31, s31, 65536
    s_add_u32 s30, s30, 65536
    s_and_b32 s30, s30, 0x7fffff
    buffer_store_dwordx4 v[16:19], v2, s[8:11], s33 offen offset:0 sc1
    buffer_store_dwordx4 v[20:23], v2, s[8:11], s33 offen offset:1024 sc1
    buffer_store_dwordx4 v[24:27], v2, s[8:11], s33 offen offset:2048 sc1
    buffer_store_dwordx4 v[28:31], v2, s[8:11], s33 offen offset:3072 sc1
    s_add_u32 s33, s33, 4096
    buffer_store_dwordx4 v[32:35], v2, s[8:11], s33 offen offset:0 sc1
    buffer_store_dwordx4 v[36:39], v2, s[8:11], s33 offen offset:1024 sc1
    buffer_store_dwordx4 v[40:43], v2, s[8:11], s33 offen offset:2048 sc1
    buffer_store_dwordx4 v[44:47], v2, s[8:11], s33 offen offset:3072 sc1
    s_add_u32 s33, s33, 4096
    buffer_store_dwordx4 v[48:51], v2, s[8:11], s33 offen offset:0 sc1
    buffer_store_dwordx4 v[52:55], v2, s[8:11], s33 offen offset:1024 sc1
    buffer_store_dwordx4 v[56:59], v2, s[8:11], s33 offen offset:2048 sc1
    buffer_store_dwordx4 v[60:63], v2, s[8:11], s33 offen offset:3072 sc1
    s_add_u32 s33, s33, 4096
    buffer_store_dwordx4 v[64:67], v2, s[8:11], s33 offen offset:0 sc1
    buffer_store_dwordx4 v[68:71], v2, s[8:11], s33 offen offset:1024 sc1
    buffer_store_dwordx4 v[72:75], v2, s[8:11], s33 offen offset:2048 sc1
    buffer_store_dwordx4 v[76:79], v2, s[8:11], s33 offen offset:3072 sc1
    s_add_u32 s33, s33, 4096
    s_add_u32 s32, s32, 1
    s_cmp_lt_u32 s32, s35
    s_waitcnt vmcnt(32)
    s_cbranch_scc1 M_wt_loop
    v_mov_b32 v6, 0x7ff00000
    v_lshlrev_b32 v7, 7, v0
    v_cmp_gt_u32 vcc, s26, v0
    s_lshl_b32 s28, s27, 7
    s_add_u32 s28, s28, 0x9a8000
    v_cndmask_b32 v6, v6, v7, vcc
    v_mov_b32 v7, 1
    s_waitcnt vmcnt(0)
    s_barrier
    buffer_store_dword v7, v6, s[8:11], s28 offen sc1
    s_branch M_wo
M_wo:
    s_and_b32 s20, s25, 1
M_wol:
    s_load_dwordx2 s[28:29], s[0:1], 88
    v_lshrrev_b32 v4, 2, v1
    v_and_b32 v5, 3, v1
    v_mul_u32_u24 v6, 1280, v4
    v_lshl_add_u32 v6, v5, 4, v6
    v_lshlrev_b32 v7, 6, v4
    v_lshl_add_u32 v7, v5, 3, v7
    s_mul_i32 s32, s21, 24576
    v_add_u32 v7, s32, v7
    s_lshl_b32 s34, s20, 2
    s_add_u32 s34, s34, s21
    s_lshl_b32 s33, s34, 6
    s_mul_i32 s34, s34, 49152
    s_add_u32 s34, s34, 0xa000000
    s_mov_b32 s35, 2
    s_waitcnt lgkmcnt(0)
    s_mov_b32 s12, s28
    s_and_b32 s13, s29, 0xffff
    s_mov_b32 s14, 0xf0000
    s_mov_b32 s15, 0x20000
M_wo_r:
    s_add_u32 m0, s32, 0
    s_add_u32 s28, s33, 0
    buffer_load_dwordx4 v6, s[12:15], s28 offen lds
    s_add_u32 m0, s32, 1024
    s_add_u32 s28, s33, 20480
    buffer_load_dwordx4 v6, s[12:15], s28 offen lds
    s_add_u32 m0, s32, 2048
    s_add_u32 s28, s33, 40960
    buffer_load_dwordx4 v6, s[12:15], s28 offen lds
    s_add_u32 m0, s32, 3072
    s_add_u32 s28, s33, 61440
    buffer_load_dwordx4 v6, s[12:15], s28 offen lds
    s_add_u32 m0, s32, 4096
    s_add_u32 s28, s33, 81920
    buffer_load_dwordx4 v6, s[12:15], s28 offen lds
    s_add_u32 m0, s32, 5120
    s_add_u32 s28, s33, 102400
    buffer_load_dwordx4 v6, s[12:15], s28 offen lds
    s_add_u32 m0, s32, 6144
    s_add_u32 s28, s33, 122880
    buffer_load_dwordx4 v6, s[12:15], s28 offen lds
    s_add_u32 m0, s32, 7168
    s_add_u32 s28, s33, 143360
    buffer_load_dwordx4 v6, s[12:15], s28 offen lds
    s_add_u32 m0, s32, 8192
    s_add_u32 s28, s33, 163840
    buffer_load_dwordx4 v6, s[12:15], s28 offen lds
    s_add_u32 m0, s32, 9216
    s_add_u32 s28, s33, 184320
    buffer_load_dwordx4 v6, s[12:15], s28 offen lds
    s_add_u32 m0, s32, 10240
    s_add_u32 s28, s33, 204800
    buffer_load_dwordx4 v6, s[12:15], s28 offen lds
    s_add_u32 m0, s32, 11264
    s_add_u32 s28, s33, 225280
    buffer_load_dwordx4 v6, s[12:15], s28 offen lds
    s_add_u32 m0, s32, 12288
    s_add_u32 s28, s33, 245760
    buffer_load_dwordx4 v6, s[12:15], s28 offen lds
    s_add_u32 m0, s32, 13312
    s_add_u32 s28, s33, 266240
    buffer_load_dwordx4 v6, s[12:15], s28 offen lds
    s_add_u32 m0, s32, 14336
    s_add_u32 s28, s33, 286720
    buffer_load_dwordx4 v6, s[12:15], s28 offen lds
    s_add_u32 m0, s32, 15360
    s_add_u32 s28, s33, 307200
    buffer_load_dwordx4 v6, s[12:15], s28 offen lds
    s_add_u32 m0, s32, 16384
    s_add_u32 s28, s33, 327680
    buffer_load_dwordx4 v6, s[12:15], s28 offen lds
    s_add_u32 m0, s32, 17408
    s_add_u32 s28, s33, 348160
    buffer_load_dwordx4 v6, s[12:15], s28 offen lds
    s_add_u32 m0, s32, 18432
    s_add_u32 s28, s33, 368640
    buffer_load_dwordx4 v6, s[12:15], s28 offen lds
    s_add_u32 m0, s32, 19456
    s_add_u32 s28, s33, 389120
    buffer_load_dwordx4 v6, s[12:15], s28 offen lds
    s_add_u32 m0, s32, 20480
    s_add_u32 s28, s33, 409600
    buffer_load_dwordx4 v6, s[12:15], s28 offen lds
    s_add_u32 m0, s32, 21504
    s_add_u32 s28, s33, 430080
    buffer_load_dwordx4 v6, s[12:15], s28 offen lds
    s_add_u32 m0, s32, 22528
    s_add_u32 s28, s33, 450560
    buffer_load_dwordx4 v6, s[12:15], s28 offen lds
    s_add_u32 m0, s32, 23552
    s_add_u32 s28, s33, 471040
    buffer_load_dwordx4 v6, s[12:15], s28 offen lds
    s_waitcnt vmcnt(0)
    ds_read_b64_tr_b16 v[16:17], v7 offset:0
    ds_read_b64_tr_b16 v[18:19], v7 offset:1024
    ds_read_b64_tr_b16 v[20:21], v7 offset:32
    ds_read_b64_tr_b16 v[22:23], v7 offset:1056
    ds_read_b64_tr_b16 v[24:25], v7 offset:2048
    ds_read_b64_tr_b16 v[26:27], v7 offset:3072
    ds_read_b64_tr_b16 v[28:29], v7 offset:2080
    ds_read_b64_tr_b16 v[30:31], v7 offset:3104
    ds_read_b64_tr_b16 v[32:33], v7 offset:4096
    ds_read_b64_tr_b16 v[34:35], v7 offset:5120
    ds_read_b64_tr_b16 v[36:37], v7 offset:4128
    ds_read_b64_tr_b16 v[38:39], v7 offset:5152
    ds_read_b64_tr_b16 v[40:41], v7 offset:6144
    ds_read_b64_tr_b16 v[42:43], v7 offset:7168
    ds_read_b64_tr_b16 v[44:45], v7 offset:6176
    ds_read_b64_tr_b16 v[46:47], v7 offset:7200
    ds_read_b64_tr_b16 v[48:49], v7 offset:8192
    ds_read_b64_tr_b16 v[50:51], v7 offset:9216
    ds_read_b64_tr_b16 v[52:53], v7 offset:8224
    ds_read_b64_tr_b16 v[54:55], v7 offset:9248
    ds_read_b64_tr_b16 v[56:57], v7 offset:10240
    ds_read_b64_tr_b16 v[58:59], v7 offset:11264
    ds_read_b64_tr_b16 v[60:61], v7 offset:10272
    ds_read_b64_tr_b16 v[62:63], v7 offset:11296
    ds_read_b64_tr_b16 v[64:65], v7 offset:12288
    ds_read_b64_tr_b16 v[66:67], v7 offset:13312
    ds_read_b64_tr_b16 v[68:69], v7 offset:12320
    ds_read_b64_tr_b16 v[70:71], v7 offset:13344
    ds_read_b64_tr_b16 v[72:73], v7 offset:14336
    ds_read_b64_tr_b16 v[74:75], v7 offset:15360
    ds_read_b64_tr_b16 v[76:77], v7 offset:14368
    ds_read_b64_tr_b16 v[78:79], v7 offset:15392
    ds_read_b64_tr_b16 v[80:81], v7 offset:16384
    ds_read_b64_tr_b16 v[82:83], v7 offset:17408
    ds_read_b64_tr_b16 v[84:85], v7 offset:16416
    ds_read_b64_tr_b16 v[86:87], v7 offset:17440
    ds_read_b64_tr_b16 v[88:89], v7 offset:18432
    ds_read_b64_tr_b16 v[90:91], v7 offset:19456
    ds_read_b64_tr_b16 v[92:93], v7 offset:18464
    ds_read_b64_tr_b16 v[94:95], v7 offset:19488
    ds_read_b64_tr_b16 v[96:97], v7 offset:20480
    ds_read_b64_tr_b16 v[98:99], v7 offset:21504
    ds_read_b64_tr_b16 v[100:101], v7 offset:20512
    ds_read_b64_tr_b16 v[102:103], v7 offset:21536
    ds_read_b64_tr_b16 v[104:105], v7 offset:22528
    ds_read_b64_tr_b16 v[106:107], v7 offset:23552
    ds_read_b64_tr_b16 v[108:109], v7 offset:22560
    ds_read_b64_tr_b16 v[110:111], v7 offset:23584
    s_waitcnt lgkmcnt(0)
    buffer_store_dwordx4 v[16:19], v2, s[8:11], s34 offen offset:0 sc1
    buffer_store_dwordx4 v[20:23], v2, s[8:11], s34 offen offset:1024 sc1
    buffer_store_dwordx4 v[24:27], v2, s[8:11], s34 offen offset:2048 sc1
    buffer_store_dwordx4 v[28:31], v2, s[8:11], s34 offen offset:3072 sc1
    s_add_u32 s34, s34, 4096
    buffer_store_dwordx4 v[32:35], v2, s[8:11], s34 offen offset:0 sc1
    buffer_store_dwordx4 v[36:39], v2, s[8:11], s34 offen offset:1024 sc1
    buffer_store_dwordx4 v[40:43], v2, s[8:11], s34 offen offset:2048 sc1
    buffer_store_dwordx4 v[44:47], v2, s[8:11], s34 offen offset:3072 sc1
    s_add_u32 s34, s34, 4096
    buffer_store_dwordx4 v[48:51], v2, s[8:11], s34 offen offset:0 sc1
    buffer_store_dwordx4 v[52:55], v2, s[8:11], s34 offen offset:1024 sc1
    buffer_store_dwordx4 v[56:59], v2, s[8:11], s34 offen offset:2048 sc1
    buffer_store_dwordx4 v[60:63], v2, s[8:11], s34 offen offset:3072 sc1
    s_add_u32 s34, s34, 4096
    buffer_store_dwordx4 v[64:67], v2, s[8:11], s34 offen offset:0 sc1
    buffer_store_dwordx4 v[68:71], v2, s[8:11], s34 offen offset:1024 sc1
    buffer_store_dwordx4 v[72:75], v2, s[8:11], s34 offen offset:2048 sc1
    buffer_store_dwordx4 v[76:79], v2, s[8:11], s34 offen offset:3072 sc1
    s_add_u32 s34, s34, 4096
    buffer_store_dwordx4 v[80:83], v2, s[8:11], s34 offen offset:0 sc1
    buffer_store_dwordx4 v[84:87], v2, s[8:11], s34 offen offset:1024 sc1
    buffer_store_dwordx4 v[88:91], v2, s[8:11], s34 offen offset:2048 sc1
    buffer_store_dwordx4 v[92:95], v2, s[8:11], s34 offen offset:3072 sc1
    s_add_u32 s34, s34, 4096
    buffer_store_dwordx4 v[96:99], v2, s[8:11], s34 offen offset:0 sc1
    buffer_store_dwordx4 v[100:103], v2, s[8:11], s34 offen offset:1024 sc1
    buffer_store_dwordx4 v[104:107], v2, s[8:11], s34 offen offset:2048 sc1
    buffer_store_dwordx4 v[108:111], v2, s[8:11], s34 offen offset:3072 sc1
    s_add_u32 s34, s34, 4096
    s_add_u32 s33, s33, 491520
    s_sub_u32 s35, s35, 1
    s_cmp_lg_u32 s35, 0
    s_cbranch_scc1 M_wo_r
    s_lshl_b32 s28, s20, 7
    v_mov_b32 v6, 0x7ff00000
    v_lshl_add_u32 v7, v0, 2, s28
    v_cmp_gt_u32 vcc, 32, v0
    s_nop 1
    v_cndmask_b32 v6, v6, v7, vcc
    v_mov_b32 v7, 1
    s_mov_b32 s28, 0x9b4000
    s_waitcnt vmcnt(0)
    s_barrier
    buffer_store_dword v7, v6, s[8:11], s28 offen sc1
    s_add_u32 s20, s20, 2
    s_cmp_lt_u32 s20, 5
    s_cbranch_scc1 M_wol
    s_branch M_g3
M_g10:
    v_and_b32 v16, 31, v1
    v_lshlrev_b32 v16, 7, v16
    s_add_u32 s44, s56, 0x8c0000
    s_mov_b32 s39, 0
M_wf:
    buffer_load_dword v17, v16, s[8:11], s44 offen sc1
    s_add_u32 s39, s39, 1
    s_cmp_gt_u32 s39, 400000
    s_cbranch_scc1 M_fail
    s_waitcnt vmcnt(0)
    v_cmp_eq_u32 vcc, 0, v17
    s_cbranch_vccz M_wf_ok
    s_sleep 8
    s_branch M_wf
M_wf_ok:
    v_lshlrev_b32 v2, 4, v1
    s_and_b32 s20, s25, 3
    s_bfe_u32 s22, s25, 0x20002
    s_cmp_eq_u32 s22, 3
    s_cselect_b32 s22, 0, s22
    s_cselect_b32 s28, 0, 4
    s_cselect_b32 s24, 1, 3
    s_cselect_b32 s26, 52, 64
    s_add_u32 s20, s20, s28
M_g1e:
    s_load_dwordx2 s[28:29], s[0:1], 64
    s_waitcnt lgkmcnt(0)
    s_mov_b32 s12, s28
    s_and_b32 s13, s29, 0xffff
    s_mov_b32 s14, 0x1e0000
    s_mov_b32 s15, 0x20000
    v_add_u32 v8, 0, v1
    v_mul_u32_u24 v9, 2731, v8
    v_lshrrev_b32 v9, 16, v9
    v_mul_u32_u24 v10, 24, v9
    v_sub_u32 v10, v8, v10
    v_mul_u32_u24 v9, 3072, v9
    v_lshl_add_u32 v144, v10, 4, v9
    v_add_u32 v8, 64, v1
    v_mul_u32_u24 v9, 2731, v8
    v_lshrrev_b32 v9, 16, v9
    v_mul_u32_u24 v10, 24, v9
    v_sub_u32 v10, v8, v10
    v_mul_u32_u24 v9, 3072, v9
    v_lshl_add_u32 v145, v10, 4, v9
    v_add_u32 v8, 128, v1
    v_mul_u32_u24 v9, 2731, v8
    v_lshrrev_b32 v9, 16, v9
    v_mul_u32_u24 v10, 24, v9
    v_sub_u32 v10, v8, v10
    v_mul_u32_u24 v9, 3072, v9
    v_lshl_add_u32 v146, v10, 4, v9
    v_lshrrev_b32 v11, 2, v1
    v_mul_u32_u24 v11, 384, v11
    v_and_b32 v10, 3, v1
    v_lshl_add_u32 v11, v10, 3, v11
    s_mul_i32 s28, s21, 96
    v_add_u32 v11, s28, v11
    s_mul_i32 s30, s20, 384
    s_mul_i32 s28, s21, 49152
    s_add_u32 s30, s30, s28
    s_mul_i32 s32, s21, 6144
    s_add_u32 m0, s32, 0
    s_add_u32 s33, s30, 0
    buffer_load_dwordx4 v144, s[12:15], s33 offen lds
    s_add_u32 m0, s32, 1024
    s_add_u32 s33, s30, 0
    buffer_load_dwordx4 v145, s[12:15], s33 offen lds
    s_add_u32 m0, s32, 2048
    s_add_u32 s33, s30, 0
    buffer_load_dwordx4 v146, s[12:15], s33 offen lds
    s_add_u32 m0, s32, 3072
    s_add_u32 s33, s30, 24576
    buffer_load_dwordx4 v144, s[12:15], s33 offen lds
    s_add_u32 m0, s32, 4096
    s_add_u32 s33, s30, 24576
    buffer_load_dwordx4 v145, s[12:15], s33 offen lds
    s_add_u32 m0, s32, 5120
    s_add_u32 s33, s30, 24576
    buffer_load_dwordx4 v146, s[12:15], s33 offen lds
    s_add_u32 m0, s32, 24576
    s_add_u32 s33, s30, 196608
    buffer_load_dwordx4 v144, s[12:15], s33 offen lds
    s_add_u32 m0, s32, 25600
    s_add_u32 s33, s30, 196608
    buffer_load_dwordx4 v145, s[12:15], s33 offen lds
    s_add_u32 m0, s32, 26624
    s_add_u32 s33, s30, 196608
    buffer_load_dwordx4 v146, s[12:15], s33 offen lds
    s_add_u32 m0, s32, 27648
    s_add_u32 s33, s30, 221184
    buffer_load_dwordx4 v144, s[12:15], s33 offen lds
    s_add_u32 m0, s32, 28672
    s_add_u32 s33, s30, 221184
    buffer_load_dwordx4 v145, s[12:15], s33 offen lds
    s_add_u32 m0, s32, 29696
    s_add_u32 s33, s30, 221184
    buffer_load_dwordx4 v146, s[12:15], s33 offen lds
    s_add_u32 m0, s32, 49152
    s_add_u32 s33, s30, 393216
    buffer_load_dwordx4 v144, s[12:15], s33 offen lds
    s_add_u32 m0, s32, 50176
    s_add_u32 s33, s30, 393216
    buffer_load_dwordx4 v145, s[12:15], s33 offen lds
    s_add_u32 m0, s32, 51200
    s_add_u32 s33, s30, 393216
    buffer_load_dwordx4 v146, s[12:15], s33 offen lds
    s_add_u32 m0, s32, 52224
    s_add_u32 s33, s30, 417792
    buffer_load_dwordx4 v144, s[12:15], s33 offen lds
    s_add_u32 m0, s32, 53248
    s_add_u32 s33, s30, 417792
    buffer_load_dwordx4 v145, s[12:15], s33 offen lds
    s_add_u32 m0, s32, 54272
    s_add_u32 s33, s30, 417792
    buffer_load_dwordx4 v146, s[12:15], s33 offen lds
    s_add_u32 m0, s32, 73728
    s_add_u32 s33, s30, 589824
    buffer_load_dwordx4 v144, s[12:15], s33 offen lds
    s_add_u32 m0, s32, 74752
    s_add_u32 s33, s30, 589824
    buffer_load_dwordx4 v145, s[12:15], s33 offen lds
    s_add_u32 m0, s32, 75776
    s_add_u32 s33, s30, 589824
    buffer_load_dwordx4 v146, s[12:15], s33 offen lds
    s_add_u32 m0, s32, 76800
    s_add_u32 s33, s30, 614400
    buffer_load_dwordx4 v144, s[12:15], s33 offen lds
    s_add_u32 m0, s32, 77824
    s_add_u32 s33, s30, 614400
    buffer_load_dwordx4 v145, s[12:15], s33 offen lds
    s_add_u32 m0, s32, 78848
    s_add_u32 s33, s30, 614400
    buffer_load_dwordx4 v146, s[12:15], s33 offen lds
    s_add_u32 m0, s32, 98304
    s_add_u32 s33, s30, 786432
    buffer_load_dwordx4 v144, s[12:15], s33 offen lds
    s_add_u32 m0, s32, 99328
    s_add_u32 s33, s30, 786432
    buffer_load_dwordx4 v145, s[12:15], s33 offen lds
    s_add_u32 m0, s32, 100352
    s_add_u32 s33, s30, 786432
    buffer_load_dwordx4 v146, s[12:15], s33 offen lds
    s_add_u32 m0, s32, 101376
    s_add_u32 s33, s30, 811008
    buffer_load_dwordx4 v144, s[12:15], s33 offen lds
    s_add_u32 m0, s32, 102400
    s_add_u32 s33, s30, 811008
    buffer_load_dwordx4 v145, s[12:15], s33 offen lds
    s_add_u32 m0, s32, 103424
    s_add_u32 s33, s30, 811008
    buffer_load_dwordx4 v146, s[12:15], s33 offen lds
    s_add_u32 m0, s32, 122880
    s_add_u32 s33, s30, 983040
    buffer_load_dwordx4 v144, s[12:15], s33 offen lds
    s_add_u32 m0, s32, 123904
    s_add_u32 s33, s30, 983040
    buffer_load_dwordx4 v145, s[12:15], s33 offen lds
    s_add_u32 m0, s32, 124928
    s_add_u32 s33, s30, 983040
    buffer_load_dwordx4 v146, s[12:15], s33 offen lds
    s_add_u32 m0, s32, 125952
    s_add_u32 s33, s30, 1007616
    buffer_load_dwordx4 v144, s[12:15], s33 offen lds
    s_add_u32 m0, s32, 126976
    s_add_u32 s33, s30, 1007616
    buffer_load_dwordx4 v145, s[12:15], s33 offen lds
    s_add_u32 m0, s32, 128000
    s_add_u32 s33, s30, 1007616
    buffer_load_dwordx4 v146, s[12:15], s33 offen lds
    s_waitcnt vmcnt(30)
    s_barrier
    v_add_u32 v13, 0, v11
    ds_read_b64_tr_b16 a[0:1], v13 offset:0
    ds_read_b64_tr_b16 a[2:3], v13 offset:6144
    ds_read_b64_tr_b16 a[12:13], v13 offset:12288
    ds_read_b64_tr_b16 a[14:15], v13 offset:18432
    ds_read_b64_tr_b16 a[4:5], v13 offset:32
    ds_read_b64_tr_b16 a[6:7], v13 offset:6176
    ds_read_b64_tr_b16 a[16:17], v13 offset:12320
    ds_read_b64_tr_b16 a[18:19], v13 offset:18464
    ds_read_b64_tr_b16 a[8:9], v13 offset:64
    ds_read_b64_tr_b16 a[10:11], v13 offset:6208
    ds_read_b64_tr_b16 a[20:21], v13 offset:12352
    ds_read_b64_tr_b16 a[22:23], v13 offset:18496
    s_waitcnt lgkmcnt(0)
    s_barrier
    s_add_u32 m0, s32, 0
    s_add_u32 s33, s30, 1179648
    buffer_load_dwordx4 v144, s[12:15], s33 offen lds
    s_add_u32 m0, s32, 1024
    s_add_u32 s33, s30, 1179648
    buffer_load_dwordx4 v145, s[12:15], s33 offen lds
    s_add_u32 m0, s32, 2048
    s_add_u32 s33, s30, 1179648
    buffer_load_dwordx4 v146, s[12:15], s33 offen lds
    s_add_u32 m0, s32, 3072
    s_add_u32 s33, s30, 1204224
    buffer_load_dwordx4 v144, s[12:15], s33 offen lds
    s_add_u32 m0, s32, 4096
    s_add_u32 s33, s30, 1204224
    buffer_load_dwordx4 v145, s[12:15], s33 offen lds
    s_add_u32 m0, s32, 5120
    s_add_u32 s33, s30, 1204224
    buffer_load_dwordx4 v146, s[12:15], s33 offen lds
    s_waitcnt vmcnt(30)
    s_barrier
    v_add_u32 v13, 24576, v11
    ds_read_b64_tr_b16 a[24:25], v13 offset:0
    ds_read_b64_tr_b16 a[26:27], v13 offset:6144
    ds_read_b64_tr_b16 a[36:37], v13 offset:12288
    ds_read_b64_tr_b16 a[38:39], v13 offset:18432
    ds_read_b64_tr_b16 a[28:29], v13 offset:32
    ds_read_b64_tr_b16 a[30:31], v13 offset:6176
    ds_read_b64_tr_b16 a[40:41], v13 offset:12320
    ds_read_b64_tr_b16 a[42:43], v13 offset:18464
    ds_read_b64_tr_b16 a[32:33], v13 offset:64
    ds_read_b64_tr_b16 a[34:35], v13 offset:6208
    ds_read_b64_tr_b16 a[44:45], v13 offset:12352
    ds_read_b64_tr_b16 a[46:47], v13 offset:18496
    s_waitcnt lgkmcnt(0)
    s_barrier
    s_add_u32 m0, s32, 24576
    s_add_u32 s33, s30, 1376256
    buffer_load_dwordx4 v144, s[12:15], s33 offen lds
    s_add_u32 m0, s32, 25600
    s_add_u32 s33, s30, 1376256
    buffer_load_dwordx4 v145, s[12:15], s33 offen lds
    s_add_u32 m0, s32, 26624
    s_add_u32 s33, s30, 1376256
    buffer_load_dwordx4 v146, s[12:15], s33 offen lds
    s_add_u32 m0, s32, 27648
    s_add_u32 s33, s30, 1400832
    buffer_load_dwordx4 v144, s[12:15], s33 offen lds
    s_add_u32 m0, s32, 28672
    s_add_u32 s33, s30, 1400832
    buffer_load_dwordx4 v145, s[12:15], s33 offen lds
    s_add_u32 m0, s32, 29696
    s_add_u32 s33, s30, 1400832
    buffer_load_dwordx4 v146, s[12:15], s33 offen lds
    s_waitcnt vmcnt(30)
    s_barrier
    v_add_u32 v13, 49152, v11
    ds_read_b64_tr_b16 a[48:49], v13 offset:0
    ds_read_b64_tr_b16 a[50:51], v13 offset:6144
    ds_read_b64_tr_b16 a[60:61], v13 offset:12288
    ds_read_b64_tr_b16 a[62:63], v13 offset:18432
    ds_read_b64_tr_b16 a[52:53], v13 offset:32
    ds_read_b64_tr_b16 a[54:55], v13 offset:6176
    ds_read_b64_tr_b16 a[64:65], v13 offset:12320
    ds_read_b64_tr_b16 a[66:67], v13 offset:18464
    ds_read_b64_tr_b16 a[56:57], v13 offset:64
    ds_read_b64_tr_b16 a[58:59], v13 offset:6208
    ds_read_b64_tr_b16 a[68:69], v13 offset:12352
    ds_read_b64_tr_b16 a[70:71], v13 offset:18496
    s_waitcnt lgkmcnt(0)
    s_barrier
    s_add_u32 m0, s32, 49152
    s_add_u32 s33, s30, 1572864
    buffer_load_dwordx4 v144, s[12:15], s33 offen lds
    s_add_u32 m0, s32, 50176
    s_add_u32 s33, s30, 1572864
    buffer_load_dwordx4 v145, s[12:15], s33 offen lds
    s_add_u32 m0, s32, 51200
    s_add_u32 s33, s30, 1572864
    buffer_load_dwordx4 v146, s[12:15], s33 offen lds
    s_add_u32 m0, s32, 52224
    s_add_u32 s33, s30, 1597440
    buffer_load_dwordx4 v144, s[12:15], s33 offen lds
    s_add_u32 m0, s32, 53248
    s_add_u32 s33, s30, 1597440
    buffer_load_dwordx4 v145, s[12:15], s33 offen lds
    s_add_u32 m0, s32, 54272
    s_add_u32 s33, s30, 1597440
    buffer_load_dwordx4 v146, s[12:15], s33 offen lds
    s_waitcnt vmcnt(30)
    s_barrier
    v_add_u32 v13, 73728, v11
    ds_read_b64_tr_b16 a[72:73], v13 offset:0
    ds_read_b64_tr_b16 a[74:75], v13 offset:6144
    ds_read_b64_tr_b16 a[84:85], v13 offset:12288
    ds_read_b64_tr_b16 a[86:87], v13 offset:18432
    ds_read_b64_tr_b16 a[76:77], v13 offset:32
    ds_read_b64_tr_b16 a[78:79], v13 offset:6176
    ds_read_b64_tr_b16 a[88:89], v13 offset:12320
    ds_read_b64_tr_b16 a[90:91], v13 offset:18464
    ds_read_b64_tr_b16 a[80:81], v13 offset:64
    ds_read_b64_tr_b16 a[82:83], v13 offset:6208
    ds_read_b64_tr_b16 a[92:93], v13 offset:12352
    ds_read_b64_tr_b16 a[94:95], v13 offset:18496
    s_waitcnt lgkmcnt(0)
    s_barrier
    s_add_u32 m0, s32, 73728
    s_add_u32 s33, s30, 1769472
    buffer_load_dwordx4 v144, s[12:15], s33 offen lds
    s_add_u32 m0, s32, 74752
    s_add_u32 s33, s30, 1769472
    buffer_load_dwordx4 v145, s[12:15], s33 offen lds
    s_add_u32 m0, s32, 75776
    s_add_u32 s33, s30, 1769472
    buffer_load_dwordx4 v146, s[12:15], s33 offen lds
    s_add_u32 m0, s32, 76800
    s_add_u32 s33, s30, 1794048
    buffer_load_dwordx4 v144, s[12:15], s33 offen lds
    s_add_u32 m0, s32, 77824
    s_add_u32 s33, s30, 1794048
    buffer_load_dwordx4 v145, s[12:15], s33 offen lds
    s_add_u32 m0, s32, 78848
    s_add_u32 s33, s30, 1794048
    buffer_load_dwordx4 v146, s[12:15], s33 offen lds
    s_waitcnt vmcnt(30)
    s_barrier
    v_add_u32 v13, 98304, v11
    ds_read_b64_tr_b16 a[96:97], v13 offset:0
    ds_read_b64_tr_b16 a[98:99], v13 offset:6144
    ds_read_b64_tr_b16 a[108:109], v13 offset:12288
    ds_read_b64_tr_b16 a[110:111], v13 offset:18432
    ds_read_b64_tr_b16 a[100:101], v13 offset:32
    ds_read_b64_tr_b16 a[102:103], v13 offset:6176
    ds_read_b64_tr_b16 a[112:113], v13 offset:12320
    ds_read_b64_tr_b16 a[114:115], v13 offset:18464
    ds_read_b64_tr_b16 a[104:105], v13 offset:64
    ds_read_b64_tr_b16 a[106:107], v13 offset:6208
    ds_read_b64_tr_b16 a[116:117], v13 offset:12352
    ds_read_b64_tr_b16 a[118:119], v13 offset:18496
    s_waitcnt lgkmcnt(0)
    s_waitcnt vmcnt(24)
    s_barrier
    v_add_u32 v13, 122880, v11
    ds_read_b64_tr_b16 a[120:121], v13 offset:0
    ds_read_b64_tr_b16 a[122:123], v13 offset:6144
    ds_read_b64_tr_b16 a[132:133], v13 offset:12288
    ds_read_b64_tr_b16 a[134:135], v13 offset:18432
    ds_read_b64_tr_b16 a[124:125], v13 offset:32
    ds_read_b64_tr_b16 a[126:127], v13 offset:6176
    ds_read_b64_tr_b16 a[136:137], v13 offset:12320
    ds_read_b64_tr_b16 a[138:139], v13 offset:18464
    ds_read_b64_tr_b16 a[128:129], v13 offset:64
    ds_read_b64_tr_b16 a[130:131], v13 offset:6208
    ds_read_b64_tr_b16 a[140:141], v13 offset:12352
    ds_read_b64_tr_b16 a[142:143], v13 offset:18496
    s_waitcnt lgkmcnt(0)
    s_waitcnt vmcnt(18)
    s_barrier
    v_add_u32 v13, 0, v11
    ds_read_b64_tr_b16 a[144:145], v13 offset:0
    ds_read_b64_tr_b16 a[146:147], v13 offset:6144
    ds_read_b64_tr_b16 a[156:157], v13 offset:12288
    ds_read_b64_tr_b16 a[158:159], v13 offset:18432
    ds_read_b64_tr_b16 a[148:149], v13 offset:32
    ds_read_b64_tr_b16 a[150:151], v13 offset:6176
    ds_read_b64_tr_b16 a[160:161], v13 offset:12320
    ds_read_b64_tr_b16 a[162:163], v13 offset:18464
    ds_read_b64_tr_b16 a[152:153], v13 offset:64
    ds_read_b64_tr_b16 a[154:155], v13 offset:6208
    ds_read_b64_tr_b16 a[164:165], v13 offset:12352
    ds_read_b64_tr_b16 a[166:167], v13 offset:18496
    s_waitcnt lgkmcnt(0)
    s_waitcnt vmcnt(12)
    s_barrier
    v_add_u32 v13, 24576, v11
    ds_read_b64_tr_b16 a[168:169], v13 offset:0
    ds_read_b64_tr_b16 a[170:171], v13 offset:6144
    ds_read_b64_tr_b16 a[180:181], v13 offset:12288
    ds_read_b64_tr_b16 a[182:183], v13 offset:18432
    ds_read_b64_tr_b16 a[172:173], v13 offset:32
    ds_read_b64_tr_b16 a[174:175], v13 offset:6176
    ds_read_b64_tr_b16 a[184:185], v13 offset:12320
    ds_read_b64_tr_b16 a[186:187], v13 offset:18464
    ds_read_b64_tr_b16 a[176:177], v13 offset:64
    ds_read_b64_tr_b16 a[178:179], v13 offset:6208
    ds_read_b64_tr_b16 a[188:189], v13 offset:12352
    ds_read_b64_tr_b16 a[190:191], v13 offset:18496
    s_waitcnt lgkmcnt(0)
    s_waitcnt vmcnt(6)
    s_barrier
    v_add_u32 v13, 49152, v11
    ds_read_b64_tr_b16 a[192:193], v13 offset:0
    ds_read_b64_tr_b16 a[194:195], v13 offset:6144
    ds_read_b64_tr_b16 a[204:205], v13 offset:12288
    ds_read_b64_tr_b16 a[206:207], v13 offset:18432
    ds_read_b64_tr_b16 a[196:197], v13 offset:32
    ds_read_b64_tr_b16 a[198:199], v13 offset:6176
    ds_read_b64_tr_b16 a[208:209], v13 offset:12320
    ds_read_b64_tr_b16 a[210:211], v13 offset:18464
    ds_read_b64_tr_b16 a[200:201], v13 offset:64
    ds_read_b64_tr_b16 a[202:203], v13 offset:6208
    ds_read_b64_tr_b16 a[212:213], v13 offset:12352
    ds_read_b64_tr_b16 a[214:215], v13 offset:18496
    s_waitcnt lgkmcnt(0)
    s_waitcnt vmcnt(0)
    s_barrier
    v_add_u32 v13, 73728, v11
    ds_read_b64_tr_b16 a[216:217], v13 offset:0
    ds_read_b64_tr_b16 a[218:219], v13 offset:6144
    ds_read_b64_tr_b16 a[228:229], v13 offset:12288
    ds_read_b64_tr_b16 a[230:231], v13 offset:18432
    ds_read_b64_tr_b16 a[220:221], v13 offset:32
    ds_read_b64_tr_b16 a[222:223], v13 offset:6176
    ds_read_b64_tr_b16 a[232:233], v13 offset:12320
    ds_read_b64_tr_b16 a[234:235], v13 offset:18464
    ds_read_b64_tr_b16 a[224:225], v13 offset:64
    ds_read_b64_tr_b16 a[226:227], v13 offset:6208
    ds_read_b64_tr_b16 a[236:237], v13 offset:12352
    ds_read_b64_tr_b16 a[238:239], v13 offset:18496
    s_waitcnt lgkmcnt(0)
    s_barrier
    v_mov_b32 v3, 9
    v_min_u32 v3, v3, v1
    v_lshlrev_b32 v3, 7, v3
    v_and_b32 v10, 15, v1
    v_lshrrev_b32 v11, 4, v1
    s_lshr_b32 s29, s21, 1
    s_mul_i32 s28, s29, 20480
    v_add_u32 v4, s28, v2
    v_lshrrev_b32 v12, 3, v10
    v_mul_u32_u24 v12, 20480, v12
    v_lshl_add_u32 v12, v11, 8, v12
    v_bfe_u32 v13, v10, 2, 1
    v_lshl_add_u32 v12, v13, 7, v12
    v_and_b32 v13, 3, v10
    v_lshl_add_u32 v12, v13, 4, v12
    s_lshl_b32 s28, s29, 6
    v_add_u32 v12, s28, v12
    s_cmp_ge_u32 s20, 4
    s_cselect_b64 vcc, -1, 0
    v_cndmask_b32 v4, v4, v12, vcc
    v_mov_b32 v5, v2
    s_mul_i32 s34, s21, 10240
    v_add_u32 v8, s34, v2
    s_and_b32 s35, s21, 1
    s_mul_i32 s35, s35, 10240
    s_add_u32 s35, s35, 0xb000000
    v_mov_b32 v6, 0x7ff00000
    v_cmp_gt_u32 vcc, 32, v0
    v_lshlrev_b32 v7, 2, v0
    s_nop 0
    v_cndmask_b32 v6, v6, v7, vcc
    v_mov_b32 v7, 1
    s_lshl_b32 s28, s21, 7
    s_add_u32 s28, s28, 81920
    v_lshlrev_b32 v9, 3, v10
    v_add_u32 v14, 81920, v9
    v_add_u32 v9, s28, v9
    v_lshrrev_b32 v12, 2, v10
    v_cmp_eq_u32 vcc, v12, v11
    v_mov_b32 v12, 83968
    v_and_b32 v13, 1, v1
    v_cndmask_b32 v9, v12, v9, vcc
    v_cmp_ne_u32 s[48:49], 0, v13
    v_and_b32 v13, 2, v1
    v_cmp_ne_u32 s[50:51], 0, v13
    s_mov_b32 s45, 0x9c0000
    v_lshlrev_b32 v15, 5, v11
    v_add_u32 v15, 81920, v15
    s_mov_b32 s36, 0x3f803f80
    v_mov_b32 v16, s36
    v_mov_b32 v17, s36
    v_mov_b32 v18, s36
    v_mov_b32 v19, s36
    v_mov_b32 v20, -2.302208198144325
    v_mov_b32 v22, -0.1029432395800235
    v_mov_b32 v24, 1.0
    s_mov_b32 s40, 0
    s_mov_b32 s41, 0
    s_cmp_ge_u32 s20, 4
    s_cbranch_scc1 M_g1p_z2
    v_mfma_f32_16x16x32_bf16 v[28:31], a[0:3], v[16:19], 0
    v_mfma_f32_16x16x32_bf16 v[32:35], a[4:7], v[16:19], 0
    v_mfma_f32_16x16x32_bf16 v[36:39], a[8:11], v[16:19], 0
    v_mfma_f32_16x16x32_bf16 v[28:31], a[12:15], v[16:19], v[28:31]
    v_mfma_f32_16x16x32_bf16 v[32:35], a[16:19], v[16:19], v[32:35]
    v_mfma_f32_16x16x32_bf16 v[36:39], a[20:23], v[16:19], v[36:39]
    v_mfma_f32_16x16x32_bf16 v[28:31], a[24:27], v[16:19], v[28:31]
    v_mfma_f32_16x16x32_bf16 v[32:35], a[28:31], v[16:19], v[32:35]
    v_mfma_f32_16x16x32_bf16 v[36:39], a[32:35], v[16:19], v[36:39]
    v_mfma_f32_16x16x32_bf16 v[28:31], a[36:39], v[16:19], v[28:31]
    v_mfma_f32_16x16x32_bf16 v[32:35], a[40:43], v[16:19], v[32:35]
    v_mfma_f32_16x16x32_bf16 v[36:39], a[44:47], v[16:19], v[36:39]
    v_mfma_f32_16x16x32_bf16 v[28:31], a[48:51], v[16:19], v[28:31]
    v_mfma_f32_16x16x32_bf16 v[32:35], a[52:55], v[16:19], v[32:35]
    v_mfma_f32_16x16x32_bf16 v[36:39], a[56:59], v[16:19], v[36:39]
    v_mfma_f32_16x16x32_bf16 v[28:31], a[60:63], v[16:19], v[28:31]
    v_mfma_f32_16x16x32_bf16 v[32:35], a[64:67], v[16:19], v[32:35]
    v_mfma_f32_16x16x32_bf16 v[36:39], a[68:71], v[16:19], v[36:39]
    v_mfma_f32_16x16x32_bf16 v[28:31], a[72:75], v[16:19], v[28:31]
    v_mfma_f32_16x16x32_bf16 v[32:35], a[76:79], v[16:19], v[32:35]
    v_mfma_f32_16x16x32_bf16 v[36:39], a[80:83], v[16:19], v[36:39]
    v_mfma_f32_16x16x32_bf16 v[28:31], a[84:87], v[16:19], v[28:31]
    v_mfma_f32_16x16x32_bf16 v[32:35], a[88:91], v[16:19], v[32:35]
    v_mfma_f32_16x16x32_bf16 v[36:39], a[92:95], v[16:19], v[36:39]
    v_mfma_f32_16x16x32_bf16 v[28:31], a[96:99], v[16:19], v[28:31]
    v_mfma_f32_16x16x32_bf16 v[32:35], a[100:103], v[16:19], v[32:35]
    v_mfma_f32_16x16x32_bf16 v[36:39], a[104:107], v[16:19], v[36:39]
    v_mfma_f32_16x16x32_bf16 v[28:31], a[108:111], v[16:19], v[28:31]
    v_mfma_f32_16x16x32_bf16 v[32:35], a[112:115], v[16:19], v[32:35]
    v_mfma_f32_16x16x32_bf16 v[36:39], a[116:119], v[16:19], v[36:39]
    v_mfma_f32_16x16x32_bf16 v[28:31], a[120:123], v[16:19], v[28:31]
    v_mfma_f32_16x16x32_bf16 v[32:35], a[124:127], v[16:19], v[32:35]
    v_mfma_f32_16x16x32_bf16 v[36:39], a[128:131], v[16:19], v[36:39]
    v_mfma_f32_16x16x32_bf16 v[28:31], a[132:135], v[16:19], v[28:31]
    v_mfma_f32_16x16x32_bf16 v[32:35], a[136:139], v[16:19], v[32:35]
    v_mfma_f32_16x16x32_bf16 v[36:39], a[140:143], v[16:19], v[36:39]
    v_mfma_f32_16x16x32_bf16 v[28:31], a[144:147], v[16:19], v[28:31]
    v_mfma_f32_16x16x32_bf16 v[32:35], a[148:151], v[16:19], v[32:35]
    v_mfma_f32_16x16x32_bf16 v[36:39], a[152:155], v[16:19], v[36:39]
    v_mfma_f32_16x16x32_bf16 v[28:31], a[156:159], v[16:19], v[28:31]
    v_mfma_f32_16x16x32_bf16 v[32:35], a[160:163], v[16:19], v[32:35]
    v_mfma_f32_16x16x32_bf16 v[36:39], a[164:167], v[16:19], v[36:39]
    v_mfma_f32_16x16x32_bf16 v[28:31], a[168:171], v[16:19], v[28:31]
    v_mfma_f32_16x16x32_bf16 v[32:35], a[172:175], v[16:19], v[32:35]
    v_mfma_f32_16x16x32_bf16 v[36:39], a[176:179], v[16:19], v[36:39]
    v_mfma_f32_16x16x32_bf16 v[28:31], a[180:183], v[16:19], v[28:31]
    v_mfma_f32_16x16x32_bf16 v[32:35], a[184:187], v[16:19], v[32:35]
    v_mfma_f32_16x16x32_bf16 v[36:39], a[188:191], v[16:19], v[36:39]
    v_mfma_f32_16x16x32_bf16 v[28:31], a[192:195], v[16:19], v[28:31]
    v_mfma_f32_16x16x32_bf16 v[32:35], a[196:199], v[16:19], v[32:35]
    v_mfma_f32_16x16x32_bf16 v[36:39], a[200:203], v[16:19], v[36:39]
    v_mfma_f32_16x16x32_bf16 v[28:31], a[204:207], v[16:19], v[28:31]
    v_mfma_f32_16x16x32_bf16 v[32:35], a[208:211], v[16:19], v[32:35]
    v_mfma_f32_16x16x32_bf16 v[36:39], a[212:215], v[16:19], v[36:39]
    v_mfma_f32_16x16x32_bf16 v[28:31], a[216:219], v[16:19], v[28:31]
    v_mfma_f32_16x16x32_bf16 v[32:35], a[220:223], v[16:19], v[32:35]
    v_mfma_f32_16x16x32_bf16 v[36:39], a[224:227], v[16:19], v[36:39]
    v_mfma_f32_16x16x32_bf16 v[28:31], a[228:231], v[16:19], v[28:31]
    v_mfma_f32_16x16x32_bf16 v[32:35], a[232:235], v[16:19], v[32:35]
    v_mfma_f32_16x16x32_bf16 v[36:39], a[236:239], v[16:19], v[36:39]
M_g1p_a_loop:
    s_cmp_lg_u32 s41, 0
    s_cbranch_scc1 M_g1p_a_have
    s_lshl_b32 s42, s22, 12
    s_add_u32 s42, s42, 0x940000
    s_add_u32 s42, s42, s56
    s_mov_b32 s39, 0
M_g1p_a_f:
    buffer_load_dword v26, v3, s[8:11], s42 offen sc1
    s_add_u32 s39, s39, 1
    s_cmp_gt_u32 s39, 400000
    s_cbranch_scc1 M_fail
    s_waitcnt vmcnt(0)
    v_cmp_eq_u32 vcc, 0, v26
    s_cbranch_vccz M_g1p_a_f_ok
    s_sleep 1
    s_cmp_ge_i32 s22, 58
    s_cbranch_scc1 M_g1p_a_f
    s_sleep 12
    s_branch M_g1p_a_f
M_g1p_a_f_ok:
    s_mul_i32 s29, s22, 40960
    s_add_u32 s29, s29, s35
    s_add_u32 s28, s34, s40
    s_add_u32 m0, s28, 0
    s_add_u32 s33, s29, 0
    buffer_load_dwordx4 v4, s[8:11], s33 offen offset:0 sc1 lds
    buffer_load_dwordx4 v4, s[8:11], s33 offen offset:1024 sc1 lds
    buffer_load_dwordx4 v4, s[8:11], s33 offen offset:2048 sc1 lds
    buffer_load_dwordx4 v4, s[8:11], s33 offen offset:3072 sc1 lds
    s_add_u32 m0, s28, 4096
    s_add_u32 s33, s29, 4096
    buffer_load_dwordx4 v4, s[8:11], s33 offen offset:0 sc1 lds
    buffer_load_dwordx4 v4, s[8:11], s33 offen offset:1024 sc1 lds
    buffer_load_dwordx4 v4, s[8:11], s33 offen offset:2048 sc1 lds
    buffer_load_dwordx4 v4, s[8:11], s33 offen offset:3072 sc1 lds
    s_add_u32 m0, s28, 8192
    s_add_u32 s33, s29, 8192
    buffer_load_dwordx4 v4, s[8:11], s33 offen offset:0 sc1 lds
    buffer_load_dwordx4 v4, s[8:11], s33 offen offset:1024 sc1 lds
    s_xor_b32 s40, s40, 40960
    s_waitcnt vmcnt(0)
M_g1p_a_have:
    s_add_u32 s43, s22, s24
    s_min_u32 s42, s43, 63
    s_lshl_b32 s42, s42, 12
    s_add_u32 s42, s42, 0x940000
    s_add_u32 s42, s42, s56
    s_waitcnt vmcnt(6)
    s_barrier
    buffer_load_dword v26, v3, s[8:11], s42 offen sc1
    s_mov_b32 s46, 0.0015625
    s_mov_b32 s47, s46
    ds_read_b128 v[64:67], v5 offset:0
    ds_read_b128 v[68:71], v5 offset:20480
    ds_read_b128 v[72:75], v5 offset:1024
    s_waitcnt lgkmcnt(2)
    v_mfma_f32_16x16x32_bf16 v[40:43], a[0:3], v[64:67], 0
    ds_read_b128 v[76:79], v5 offset:21504
    ds_read_b128 v[80:83], v5 offset:2048
    v_mfma_f32_16x16x32_bf16 v[44:47], a[4:7], v[64:67], 0
    ds_read_b128 v[84:87], v5 offset:22528
    ds_read_b128 v[96:99], v8 offset:0
    v_mfma_f32_16x16x32_bf16 v[48:51], a[8:11], v[64:67], 0
    s_waitcnt lgkmcnt(5)
    v_mfma_f32_16x16x32_bf16 v[52:55], a[0:3], v[68:71], 0
    ds_read_b128 v[88:91], v5 offset:3072
    v_mfma_f32_16x16x32_bf16 v[56:59], a[4:7], v[68:71], 0
    ds_read_b128 v[100:103], v8 offset:1024
    v_mfma_f32_16x16x32_bf16 v[60:63], a[8:11], v[68:71], 0
    s_waitcnt lgkmcnt(6)
    v_mfma_f32_16x16x32_bf16 v[40:43], a[12:15], v[72:75], v[40:43]
    ds_read_b128 v[92:95], v5 offset:23552
    v_mfma_f32_16x16x32_bf16 v[44:47], a[16:19], v[72:75], v[44:47]
    ds_read_b128 v[104:107], v8 offset:2048
    v_mfma_f32_16x16x32_bf16 v[48:51], a[20:23], v[72:75], v[48:51]
    s_waitcnt lgkmcnt(7)
    v_mfma_f32_16x16x32_bf16 v[52:55], a[12:15], v[76:79], v[52:55]
    ds_read_b128 v[64:67], v5 offset:4096
    v_mfma_f32_16x16x32_bf16 v[56:59], a[16:19], v[76:79], v[56:59]
    ds_read_b128 v[108:111], v8 offset:3072
    v_mfma_f32_16x16x32_bf16 v[60:63], a[20:23], v[76:79], v[60:63]
    s_waitcnt lgkmcnt(8)
    v_mfma_f32_16x16x32_bf16 v[40:43], a[24:27], v[80:83], v[40:43]
    ds_read_b128 v[68:71], v5 offset:24576
    v_mfma_f32_16x16x32_bf16 v[44:47], a[28:31], v[80:83], v[44:47]
    ds_read_b128 v[112:115], v8 offset:4096
    v_mfma_f32_16x16x32_bf16 v[48:51], a[32:35], v[80:83], v[48:51]
    s_waitcnt lgkmcnt(9)
    v_mfma_f32_16x16x32_bf16 v[52:55], a[24:27], v[84:87], v[52:55]
    ds_read_b128 v[72:75], v5 offset:5120
    v_mfma_f32_16x16x32_bf16 v[56:59], a[28:31], v[84:87], v[56:59]
    ds_read_b128 v[116:119], v8 offset:5120
    v_mfma_f32_16x16x32_bf16 v[60:63], a[32:35], v[84:87], v[60:63]
    s_waitcnt lgkmcnt(9)
    v_mfma_f32_16x16x32_bf16 v[40:43], a[36:39], v[88:91], v[40:43]
    ds_read_b128 v[76:79], v5 offset:25600
    v_mfma_f32_16x16x32_bf16 v[44:47], a[40:43], v[88:91], v[44:47]
    ds_read_b128 v[120:123], v8 offset:6144
    v_mfma_f32_16x16x32_bf16 v[48:51], a[44:47], v[88:91], v[48:51]
    s_waitcnt lgkmcnt(9)
    v_mfma_f32_16x16x32_bf16 v[52:55], a[36:39], v[92:95], v[52:55]
    ds_read_b128 v[80:83], v5 offset:6144
    v_mfma_f32_16x16x32_bf16 v[56:59], a[40:43], v[92:95], v[56:59]
    ds_read_b128 v[124:127], v8 offset:7168
    v_mfma_f32_16x16x32_bf16 v[60:63], a[44:47], v[92:95], v[60:63]
    s_waitcnt lgkmcnt(9)
    v_mfma_f32_16x16x32_bf16 v[40:43], a[48:51], v[64:67], v[40:43]
    ds_read_b128 v[84:87], v5 offset:26624
    v_mfma_f32_16x16x32_bf16 v[44:47], a[52:55], v[64:67], v[44:47]
    ds_read_b128 v[128:131], v8 offset:8192
    v_mfma_f32_16x16x32_bf16 v[48:51], a[56:59], v[64:67], v[48:51]
    s_waitcnt lgkmcnt(9)
    v_mfma_f32_16x16x32_bf16 v[52:55], a[48:51], v[68:71], v[52:55]
    ds_read_b128 v[88:91], v5 offset:7168
    v_mfma_f32_16x16x32_bf16 v[56:59], a[52:55], v[68:71], v[56:59]
    ds_read_b128 v[132:135], v8 offset:9216
    v_mfma_f32_16x16x32_bf16 v[60:63], a[56:59], v[68:71], v[60:63]
    s_waitcnt lgkmcnt(9)
    v_mfma_f32_16x16x32_bf16 v[40:43], a[60:63], v[72:75], v[40:43]
    ds_read_b128 v[92:95], v5 offset:27648
    v_mfma_f32_16x16x32_bf16 v[44:47], a[64:67], v[72:75], v[44:47]
    v_mfma_f32_16x16x32_bf16 v[48:51], a[68:71], v[72:75], v[48:51]
    s_waitcnt lgkmcnt(8)
    v_mfma_f32_16x16x32_bf16 v[52:55], a[60:63], v[76:79], v[52:55]
    ds_read_b128 v[64:67], v5 offset:8192
    v_mfma_f32_16x16x32_bf16 v[56:59], a[64:67], v[76:79], v[56:59]
    v_mfma_f32_16x16x32_bf16 v[60:63], a[68:71], v[76:79], v[60:63]
    s_waitcnt lgkmcnt(7)
    v_mfma_f32_16x16x32_bf16 v[40:43], a[72:75], v[80:83], v[40:43]
    ds_read_b128 v[68:71], v5 offset:28672
    v_mfma_f32_16x16x32_bf16 v[44:47], a[76:79], v[80:83], v[44:47]
    v_mfma_f32_16x16x32_bf16 v[48:51], a[80:83], v[80:83], v[48:51]
    s_waitcnt lgkmcnt(6)
    v_mfma_f32_16x16x32_bf16 v[52:55], a[72:75], v[84:87], v[52:55]
    ds_read_b128 v[72:75], v5 offset:9216
    v_mfma_f32_16x16x32_bf16 v[56:59], a[76:79], v[84:87], v[56:59]
    v_mfma_f32_16x16x32_bf16 v[60:63], a[80:83], v[84:87], v[60:63]
    v_mfma_f32_16x16x32_bf16 v[156:159], v[16:19], v[96:99], 0
    v_mfma_f32_16x16x32_bf16 v[160:163], v[96:99], v[96:99], 0
    v_mfma_f32_16x16x32_bf16 v[156:159], v[16:19], v[100:103], v[156:159]
    v_mfma_f32_16x16x32_bf16 v[160:163], v[100:103], v[100:103], v[160:163]
    v_mfma_f32_16x16x32_bf16 v[156:159], v[16:19], v[104:107], v[156:159]
    v_mfma_f32_16x16x32_bf16 v[160:163], v[104:107], v[104:107], v[160:163]
    v_mfma_f32_16x16x32_bf16 v[156:159], v[16:19], v[108:111], v[156:159]
    v_mfma_f32_16x16x32_bf16 v[160:163], v[108:111], v[108:111], v[160:163]
    v_mfma_f32_16x16x32_bf16 v[156:159], v[16:19], v[112:115], v[156:159]
    v_mfma_f32_16x16x32_bf16 v[160:163], v[112:115], v[112:115], v[160:163]
    v_mfma_f32_16x16x32_bf16 v[156:159], v[16:19], v[116:119], v[156:159]
    v_mfma_f32_16x16x32_bf16 v[160:163], v[116:119], v[116:119], v[160:163]
    v_mfma_f32_16x16x32_bf16 v[156:159], v[16:19], v[120:123], v[156:159]
    v_mfma_f32_16x16x32_bf16 v[160:163], v[120:123], v[120:123], v[160:163]
    v_mfma_f32_16x16x32_bf16 v[156:159], v[16:19], v[124:127], v[156:159]
    v_mfma_f32_16x16x32_bf16 v[160:163], v[124:127], v[124:127], v[160:163]
    s_waitcnt lgkmcnt(4)
    v_mfma_f32_16x16x32_bf16 v[156:159], v[16:19], v[128:131], v[156:159]
    v_mfma_f32_16x16x32_bf16 v[160:163], v[128:131], v[128:131], v[160:163]
    v_mfma_f32_16x16x32_bf16 v[156:159], v[16:19], v[132:135], v[156:159]
    v_mfma_f32_16x16x32_bf16 v[160:163], v[132:135], v[132:135], v[160:163]
    s_nop 1
    v_mfma_f32_16x16x32_bf16 v[40:43], a[84:87], v[88:91], v[40:43]
    ds_read_b128 v[76:79], v5 offset:29696
    s_nop 0
    v_mfma_f32_16x16x32_bf16 v[44:47], a[88:91], v[88:91], v[44:47]
    s_nop 1
    v_mfma_f32_16x16x32_bf16 v[48:51], a[92:95], v[88:91], v[48:51]
    s_waitcnt lgkmcnt(4)
    v_cndmask_b32 v160, v160, v161, s[48:49]
    v_mfma_f32_16x16x32_bf16 v[52:55], a[84:87], v[92:95], v[52:55]
    ds_read_b128 v[80:83], v5 offset:10240
    v_cndmask_b32 v162, v162, v163, s[48:49]
    v_mfma_f32_16x16x32_bf16 v[56:59], a[88:91], v[92:95], v[56:59]
    v_cndmask_b32 v157, v160, v162, s[50:51]
    v_mfma_f32_16x16x32_bf16 v[60:63], a[92:95], v[92:95], v[60:63]
    s_waitcnt lgkmcnt(4)
    v_mfma_f32_16x16x32_bf16 v[40:43], a[96:99], v[64:67], v[40:43]
    ds_read_b128 v[84:87], v5 offset:30720
    ds_write_b64 v9, v[156:157]
    v_mfma_f32_16x16x32_bf16 v[44:47], a[100:103], v[64:67], v[44:47]
    v_mfma_f32_16x16x32_bf16 v[48:51], a[104:107], v[64:67], v[48:51]
    s_waitcnt lgkmcnt(5)
    v_mfma_f32_16x16x32_bf16 v[52:55], a[96:99], v[68:71], v[52:55]
    ds_read_b128 v[88:91], v5 offset:11264
    v_mfma_f32_16x16x32_bf16 v[56:59], a[100:103], v[68:71], v[56:59]
    v_mfma_f32_16x16x32_bf16 v[60:63], a[104:107], v[68:71], v[60:63]
    s_waitcnt lgkmcnt(5)
    s_waitcnt vmcnt(0)
    v_cmp_eq_u32 vcc, 0, v26
    v_mfma_f32_16x16x32_bf16 v[40:43], a[108:111], v[72:75], v[40:43]
    ds_read_b128 v[92:95], v5 offset:31744
    s_waitcnt lgkmcnt(2)
    s_barrier
    v_mfma_f32_16x16x32_bf16 v[44:47], a[112:115], v[72:75], v[44:47]
    buffer_store_dword v7, v6, s[8:11], s45 offen sc1
    ds_read_b64 v[96:97], v14 offset:0
    v_mfma_f32_16x16x32_bf16 v[48:51], a[116:119], v[72:75], v[48:51]
    ds_read_b64 v[98:99], v14 offset:128
    v_mfma_f32_16x16x32_bf16 v[52:55], a[108:111], v[76:79], v[52:55]
    ds_read_b128 v[64:67], v5 offset:12288
    ds_read_b64 v[100:101], v14 offset:256
    v_mfma_f32_16x16x32_bf16 v[56:59], a[112:115], v[76:79], v[56:59]
    ds_read_b64 v[102:103], v14 offset:384
    v_mfma_f32_16x16x32_bf16 v[60:63], a[116:119], v[76:79], v[60:63]
    v_mfma_f32_16x16x32_bf16 v[40:43], a[120:123], v[80:83], v[40:43]
    ds_read_b128 v[68:71], v5 offset:32768
    v_mfma_f32_16x16x32_bf16 v[44:47], a[124:127], v[80:83], v[44:47]
    v_mfma_f32_16x16x32_bf16 v[48:51], a[128:131], v[80:83], v[48:51]
    v_mfma_f32_16x16x32_bf16 v[52:55], a[120:123], v[84:87], v[52:55]
    ds_read_b128 v[72:75], v5 offset:13312
    v_mfma_f32_16x16x32_bf16 v[56:59], a[124:127], v[84:87], v[56:59]
    s_mov_b32 s41, 0
    s_cmp_ge_u32 s43, s26
    s_cbranch_scc1 M_g1p_a_nop
    s_cbranch_vccnz M_g1p_a_nop
    s_mov_b32 s41, 1
    s_mul_i32 s29, s43, 40960
    s_add_u32 s29, s29, s35
    s_add_u32 s28, s34, s40
    s_add_u32 m0, s28, 0
    s_add_u32 s33, s29, 0
    buffer_load_dwordx4 v4, s[8:11], s33 offen offset:0 sc1 lds
    buffer_load_dwordx4 v4, s[8:11], s33 offen offset:1024 sc1 lds
    buffer_load_dwordx4 v4, s[8:11], s33 offen offset:2048 sc1 lds
    buffer_load_dwordx4 v4, s[8:11], s33 offen offset:3072 sc1 lds
    s_add_u32 m0, s28, 4096
    s_add_u32 s33, s29, 4096
    buffer_load_dwordx4 v4, s[8:11], s33 offen offset:0 sc1 lds
    buffer_load_dwordx4 v4, s[8:11], s33 offen offset:1024 sc1 lds
    buffer_load_dwordx4 v4, s[8:11], s33 offen offset:2048 sc1 lds
    buffer_load_dwordx4 v4, s[8:11], s33 offen offset:3072 sc1 lds
    s_add_u32 m0, s28, 8192
    s_add_u32 s33, s29, 8192
    buffer_load_dwordx4 v4, s[8:11], s33 offen offset:0 sc1 lds
    buffer_load_dwordx4 v4, s[8:11], s33 offen offset:1024 sc1 lds
    s_xor_b32 s40, s40, 40960
M_g1p_a_nop:
    v_mfma_f32_16x16x32_bf16 v[60:63], a[128:131], v[84:87], v[60:63]
    s_waitcnt lgkmcnt(8)
    v_mfma_f32_16x16x32_bf16 v[40:43], a[132:135], v[88:91], v[40:43]
    ds_read_b128 v[76:79], v5 offset:33792
    v_mfma_f32_16x16x32_bf16 v[44:47], a[136:139], v[88:91], v[44:47]
    v_mfma_f32_16x16x32_bf16 v[48:51], a[140:143], v[88:91], v[48:51]
    s_waitcnt lgkmcnt(8)
    s_waitcnt lgkmcnt(3)
    v_pk_add_f32 v[96:97], v[96:97], v[98:99]
    v_mfma_f32_16x16x32_bf16 v[52:55], a[132:135], v[92:95], v[52:55]
    ds_read_b128 v[80:83], v5 offset:14336
    v_pk_add_f32 v[100:101], v[100:101], v[102:103]
    v_mfma_f32_16x16x32_bf16 v[56:59], a[136:139], v[92:95], v[56:59]
    v_pk_mul_f32 v[96:97], v[96:97], s[46:47]
    v_pk_mul_f32 v[100:101], v[100:101], s[46:47]
    v_mfma_f32_16x16x32_bf16 v[60:63], a[140:143], v[92:95], v[60:63]
    v_fma_f32 v97, -v96, v96, v97
    v_fma_f32 v101, -v100, v100, v101
    v_mfma_f32_16x16x32_bf16 v[40:43], a[144:147], v[64:67], v[40:43]
    ds_read_b128 v[84:87], v5 offset:34816
    v_max_f32 v97, 0, v97
    v_mfma_f32_16x16x32_bf16 v[44:47], a[148:151], v[64:67], v[44:47]
    v_max_f32 v101, 0, v101
    v_add_f32 v97, 1e-5, v97
    v_mfma_f32_16x16x32_bf16 v[48:51], a[152:155], v[64:67], v[48:51]
    s_waitcnt lgkmcnt(4)
    v_add_f32 v101, 1e-5, v101
    v_mfma_f32_16x16x32_bf16 v[52:55], a[144:147], v[68:71], v[52:55]
    ds_read_b128 v[88:91], v5 offset:15360
    v_rsq_f32 v140, v97
    v_mfma_f32_16x16x32_bf16 v[56:59], a[148:151], v[68:71], v[56:59]
    v_rsq_f32 v142, v101
    v_nop
    v_mfma_f32_16x16x32_bf16 v[60:63], a[152:155], v[68:71], v[60:63]
    s_waitcnt lgkmcnt(4)
    v_mul_f32_e64 v148, -v96, v140
    v_mfma_f32_16x16x32_bf16 v[40:43], a[156:159], v[72:75], v[40:43]
    ds_read_b128 v[92:95], v5 offset:35840
    v_mul_f32_e64 v150, -v100, v142
    v_mfma_f32_16x16x32_bf16 v[44:47], a[160:163], v[72:75], v[44:47]
    v_mfma_f32_16x16x32_bf16 v[48:51], a[164:167], v[72:75], v[48:51]
    s_waitcnt lgkmcnt(4)
    v_mfma_f32_16x16x32_bf16 v[52:55], a[156:159], v[76:79], v[52:55]
    ds_read_b128 v[64:67], v5 offset:16384
    v_mfma_f32_16x16x32_bf16 v[56:59], a[160:163], v[76:79], v[56:59]
    v_mfma_f32_16x16x32_bf16 v[60:63], a[164:167], v[76:79], v[60:63]
    s_waitcnt lgkmcnt(4)
    v_mfma_f32_16x16x32_bf16 v[40:43], a[168:171], v[80:83], v[40:43]
    ds_read_b128 v[68:71], v5 offset:36864
    v_mfma_f32_16x16x32_bf16 v[44:47], a[172:175], v[80:83], v[44:47]
    v_mfma_f32_16x16x32_bf16 v[48:51], a[176:179], v[80:83], v[48:51]
    s_waitcnt lgkmcnt(4)
    v_mfma_f32_16x16x32_bf16 v[52:55], a[168:171], v[84:87], v[52:55]
    ds_read_b128 v[72:75], v5 offset:17408
    v_mfma_f32_16x16x32_bf16 v[56:59], a[172:175], v[84:87], v[56:59]
    v_mfma_f32_16x16x32_bf16 v[60:63], a[176:179], v[84:87], v[60:63]
    s_waitcnt lgkmcnt(4)
    v_mfma_f32_16x16x32_bf16 v[40:43], a[180:183], v[88:91], v[40:43]
    ds_read_b128 v[76:79], v5 offset:37888
    v_mfma_f32_16x16x32_bf16 v[44:47], a[184:187], v[88:91], v[44:47]
    v_mfma_f32_16x16x32_bf16 v[48:51], a[188:191], v[88:91], v[48:51]
    s_waitcnt lgkmcnt(4)
    v_mfma_f32_16x16x32_bf16 v[52:55], a[180:183], v[92:95], v[52:55]
    ds_read_b128 v[80:83], v5 offset:18432
    v_mfma_f32_16x16x32_bf16 v[56:59], a[184:187], v[92:95], v[56:59]
    v_mfma_f32_16x16x32_bf16 v[60:63], a[188:191], v[92:95], v[60:63]
    s_waitcnt lgkmcnt(4)
    v_mfma_f32_16x16x32_bf16 v[40:43], a[192:195], v[64:67], v[40:43]
    ds_read_b128 v[84:87], v5 offset:38912
    v_mfma_f32_16x16x32_bf16 v[44:47], a[196:199], v[64:67], v[44:47]
    v_mfma_f32_16x16x32_bf16 v[48:51], a[200:203], v[64:67], v[48:51]
    s_waitcnt lgkmcnt(4)
    v_mfma_f32_16x16x32_bf16 v[52:55], a[192:195], v[68:71], v[52:55]
    ds_read_b128 v[88:91], v5 offset:19456
    v_mfma_f32_16x16x32_bf16 v[56:59], a[196:199], v[68:71], v[56:59]
    v_mfma_f32_16x16x32_bf16 v[60:63], a[200:203], v[68:71], v[60:63]
    s_waitcnt lgkmcnt(4)
    v_mfma_f32_16x16x32_bf16 v[40:43], a[204:207], v[72:75], v[40:43]
    ds_read_b128 v[92:95], v5 offset:39936
    v_mfma_f32_16x16x32_bf16 v[44:47], a[208:211], v[72:75], v[44:47]
    v_mfma_f32_16x16x32_bf16 v[48:51], a[212:215], v[72:75], v[48:51]
    s_waitcnt lgkmcnt(4)
    v_mfma_f32_16x16x32_bf16 v[52:55], a[204:207], v[76:79], v[52:55]
    v_mfma_f32_16x16x32_bf16 v[56:59], a[208:211], v[76:79], v[56:59]
    v_mfma_f32_16x16x32_bf16 v[60:63], a[212:215], v[76:79], v[60:63]
    s_waitcnt lgkmcnt(3)
    v_mfma_f32_16x16x32_bf16 v[40:43], a[216:219], v[80:83], v[40:43]
    v_mfma_f32_16x16x32_bf16 v[44:47], a[220:223], v[80:83], v[44:47]
    v_mfma_f32_16x16x32_bf16 v[48:51], a[224:227], v[80:83], v[48:51]
    s_waitcnt lgkmcnt(2)
    v_mfma_f32_16x16x32_bf16 v[52:55], a[216:219], v[84:87], v[52:55]
    v_mfma_f32_16x16x32_bf16 v[56:59], a[220:223], v[84:87], v[56:59]
    v_mfma_f32_16x16x32_bf16 v[60:63], a[224:227], v[84:87], v[60:63]
    s_waitcnt lgkmcnt(1)
    v_mfma_f32_16x16x32_bf16 v[40:43], a[228:231], v[88:91], v[40:43]
    v_mfma_f32_16x16x32_bf16 v[44:47], a[232:235], v[88:91], v[44:47]
    v_mfma_f32_16x16x32_bf16 v[48:51], a[236:239], v[88:91], v[48:51]
    s_waitcnt lgkmcnt(0)
    v_mfma_f32_16x16x32_bf16 v[52:55], a[228:231], v[92:95], v[52:55]
    v_mfma_f32_16x16x32_bf16 v[56:59], a[232:235], v[92:95], v[56:59]
    v_mfma_f32_16x16x32_bf16 v[60:63], a[236:239], v[92:95], v[60:63]
    v_xor_b32 v5, 40960, v5
    s_nop 0
    v_add_u32 v8, s34, v5
    v_pk_mul_f32 v[40:41], v[40:41], v[140:141] op_sel_hi:[1,0]
    v_pk_fma_f32 v[40:41], v[28:29], v[148:149], v[40:41] op_sel_hi:[1,0,1]
    v_pk_mul_f32 v[42:43], v[42:43], v[140:141] op_sel_hi:[1,0]
    v_pk_fma_f32 v[42:43], v[30:31], v[148:149], v[42:43] op_sel_hi:[1,0,1]
    v_pk_mul_f32 v[44:45], v[44:45], v[140:141] op_sel_hi:[1,0]
    v_pk_fma_f32 v[44:45], v[32:33], v[148:149], v[44:45] op_sel_hi:[1,0,1]
    v_pk_mul_f32 v[46:47], v[46:47], v[140:141] op_sel_hi:[1,0]
    v_pk_fma_f32 v[46:47], v[34:35], v[148:149], v[46:47] op_sel_hi:[1,0,1]
    v_pk_mul_f32 v[48:49], v[48:49], v[140:141] op_sel_hi:[1,0]
    v_pk_fma_f32 v[48:49], v[36:37], v[148:149], v[48:49] op_sel_hi:[1,0,1]
    v_pk_mul_f32 v[50:51], v[50:51], v[140:141] op_sel_hi:[1,0]
    v_pk_fma_f32 v[50:51], v[38:39], v[148:149], v[50:51] op_sel_hi:[1,0,1]
    v_pk_mul_f32 v[52:53], v[52:53], v[142:143] op_sel_hi:[1,0]
    v_pk_fma_f32 v[52:53], v[28:29], v[150:151], v[52:53] op_sel_hi:[1,0,1]
    v_pk_mul_f32 v[54:55], v[54:55], v[142:143] op_sel_hi:[1,0]
    v_pk_fma_f32 v[54:55], v[30:31], v[150:151], v[54:55] op_sel_hi:[1,0,1]
    v_pk_mul_f32 v[56:57], v[56:57], v[142:143] op_sel_hi:[1,0]
    v_pk_fma_f32 v[56:57], v[32:33], v[150:151], v[56:57] op_sel_hi:[1,0,1]
    v_pk_mul_f32 v[58:59], v[58:59], v[142:143] op_sel_hi:[1,0]
    v_pk_fma_f32 v[58:59], v[34:35], v[150:151], v[58:59] op_sel_hi:[1,0,1]
    v_pk_mul_f32 v[60:61], v[60:61], v[142:143] op_sel_hi:[1,0]
    v_pk_fma_f32 v[60:61], v[36:37], v[150:151], v[60:61] op_sel_hi:[1,0,1]
    v_pk_mul_f32 v[62:63], v[62:63], v[142:143] op_sel_hi:[1,0]
    v_pk_fma_f32 v[62:63], v[38:39], v[150:151], v[62:63] op_sel_hi:[1,0,1]
    v_pk_mul_f32 v[64:65], v[40:41], v[40:41]
    v_pk_mul_f32 v[66:67], v[42:43], v[42:43]
    v_pk_mul_f32 v[68:69], v[44:45], v[44:45]
    v_pk_mul_f32 v[70:71], v[46:47], v[46:47]
    v_pk_fma_f32 v[64:65], v[64:65], v[22:23], v[20:21] op_sel_hi:[1,0,0]
    v_pk_fma_f32 v[66:67], v[66:67], v[22:23], v[20:21] op_sel_hi:[1,0,0]
    v_pk_fma_f32 v[68:69], v[68:69], v[22:23], v[20:21] op_sel_hi:[1,0,0]
    v_pk_fma_f32 v[70:71], v[70:71], v[22:23], v[20:21] op_sel_hi:[1,0,0]
    v_pk_mul_f32 v[64:65], v[64:65], v[40:41]
    v_pk_mul_f32 v[66:67], v[66:67], v[42:43]
    v_pk_mul_f32 v[68:69], v[68:69], v[44:45]
    v_pk_mul_f32 v[70:71], v[70:71], v[46:47]
    v_exp_f32 v64, v64
    v_exp_f32 v65, v65
    v_exp_f32 v66, v66
    v_exp_f32 v67, v67
    v_exp_f32 v68, v68
    v_exp_f32 v69, v69
    v_exp_f32 v70, v70
    v_exp_f32 v71, v71
    v_pk_add_f32 v[64:65], v[64:65], v[24:25] op_sel_hi:[1,0]
    v_pk_add_f32 v[66:67], v[66:67], v[24:25] op_sel_hi:[1,0]
    v_pk_add_f32 v[68:69], v[68:69], v[24:25] op_sel_hi:[1,0]
    v_pk_add_f32 v[70:71], v[70:71], v[24:25] op_sel_hi:[1,0]
    v_rcp_f32 v64, v64
    v_rcp_f32 v65, v65
    v_rcp_f32 v66, v66
    v_rcp_f32 v67, v67
    v_rcp_f32 v68, v68
    v_rcp_f32 v69, v69
    v_rcp_f32 v70, v70
    v_rcp_f32 v71, v71
    v_pk_mul_f32 v[40:41], v[40:41], v[64:65]
    v_pk_mul_f32 v[42:43], v[42:43], v[66:67]
    v_pk_mul_f32 v[44:45], v[44:45], v[68:69]
    v_pk_mul_f32 v[46:47], v[46:47], v[70:71]
    v_pk_mul_f32 v[64:65], v[48:49], v[48:49]
    v_pk_mul_f32 v[66:67], v[50:51], v[50:51]
    v_pk_mul_f32 v[68:69], v[52:53], v[52:53]
    v_pk_mul_f32 v[70:71], v[54:55], v[54:55]
    v_pk_fma_f32 v[64:65], v[64:65], v[22:23], v[20:21] op_sel_hi:[1,0,0]
    v_pk_fma_f32 v[66:67], v[66:67], v[22:23], v[20:21] op_sel_hi:[1,0,0]
    v_pk_fma_f32 v[68:69], v[68:69], v[22:23], v[20:21] op_sel_hi:[1,0,0]
    v_pk_fma_f32 v[70:71], v[70:71], v[22:23], v[20:21] op_sel_hi:[1,0,0]
    v_pk_mul_f32 v[64:65], v[64:65], v[48:49]
    v_pk_mul_f32 v[66:67], v[66:67], v[50:51]
    v_pk_mul_f32 v[68:69], v[68:69], v[52:53]
    v_pk_mul_f32 v[70:71], v[70:71], v[54:55]
    v_exp_f32 v64, v64
    v_exp_f32 v65, v65
    v_exp_f32 v66, v66
    v_exp_f32 v67, v67
    v_exp_f32 v68, v68
    v_exp_f32 v69, v69
    v_exp_f32 v70, v70
    v_exp_f32 v71, v71
    v_pk_add_f32 v[64:65], v[64:65], v[24:25] op_sel_hi:[1,0]
    v_pk_add_f32 v[66:67], v[66:67], v[24:25] op_sel_hi:[1,0]
    v_pk_add_f32 v[68:69], v[68:69], v[24:25] op_sel_hi:[1,0]
    v_pk_add_f32 v[70:71], v[70:71], v[24:25] op_sel_hi:[1,0]
    v_rcp_f32 v64, v64
    v_rcp_f32 v65, v65
    v_rcp_f32 v66, v66
    v_rcp_f32 v67, v67
    v_rcp_f32 v68, v68
    v_rcp_f32 v69, v69
    v_rcp_f32 v70, v70
    v_rcp_f32 v71, v71
    v_pk_mul_f32 v[48:49], v[48:49], v[64:65]
    v_pk_mul_f32 v[50:51], v[50:51], v[66:67]
    v_pk_mul_f32 v[52:53], v[52:53], v[68:69]
    v_pk_mul_f32 v[54:55], v[54:55], v[70:71]
    v_pk_mul_f32 v[64:65], v[56:57], v[56:57]
    v_pk_mul_f32 v[66:67], v[58:59], v[58:59]
    v_pk_mul_f32 v[68:69], v[60:61], v[60:61]
    v_pk_mul_f32 v[70:71], v[62:63], v[62:63]
    v_pk_fma_f32 v[64:65], v[64:65], v[22:23], v[20:21] op_sel_hi:[1,0,0]
    v_pk_fma_f32 v[66:67], v[66:67], v[22:23], v[20:21] op_sel_hi:[1,0,0]
    v_pk_fma_f32 v[68:69], v[68:69], v[22:23], v[20:21] op_sel_hi:[1,0,0]
    v_pk_fma_f32 v[70:71], v[70:71], v[22:23], v[20:21] op_sel_hi:[1,0,0]
    v_pk_mul_f32 v[64:65], v[64:65], v[56:57]
    v_pk_mul_f32 v[66:67], v[66:67], v[58:59]
    v_pk_mul_f32 v[68:69], v[68:69], v[60:61]
    v_pk_mul_f32 v[70:71], v[70:71], v[62:63]
    v_exp_f32 v64, v64
    v_exp_f32 v65, v65
    v_exp_f32 v66, v66
    v_exp_f32 v67, v67
    v_exp_f32 v68, v68
    v_exp_f32 v69, v69
    v_exp_f32 v70, v70
    v_exp_f32 v71, v71
    v_pk_add_f32 v[64:65], v[64:65], v[24:25] op_sel_hi:[1,0]
    v_pk_add_f32 v[66:67], v[66:67], v[24:25] op_sel_hi:[1,0]
    v_pk_add_f32 v[68:69], v[68:69], v[24:25] op_sel_hi:[1,0]
    v_pk_add_f32 v[70:71], v[70:71], v[24:25] op_sel_hi:[1,0]
    v_rcp_f32 v64, v64
    v_rcp_f32 v65, v65
    v_rcp_f32 v66, v66
    v_rcp_f32 v67, v67
    v_rcp_f32 v68, v68
    v_rcp_f32 v69, v69
    v_rcp_f32 v70, v70
    v_rcp_f32 v71, v71
    v_pk_mul_f32 v[56:57], v[56:57], v[64:65]
    v_pk_mul_f32 v[58:59], v[58:59], v[66:67]
    v_pk_mul_f32 v[60:61], v[60:61], v[68:69]
    v_pk_mul_f32 v[62:63], v[62:63], v[70:71]
    s_mul_i32 s28, s20, 6144
    s_mul_i32 s29, s21, 1536
    s_add_u32 s28, s28, s29
    s_mul_i32 s29, s22, 49152
    s_add_u32 s28, s28, s29
    s_add_u32 s28, s28, 0xb400000
    s_add_u32 s29, s28, 24576
    v_lshlrev_b32 v12, 3, v1
    v_cvt_pk_bf16_f32 v72, v40, v41
    v_cvt_pk_bf16_f32 v73, v42, v43
    buffer_store_dwordx2 v[72:73], v12, s[8:11], s28 offen offset:0 sc1
    v_cvt_pk_bf16_f32 v76, v44, v45
    v_cvt_pk_bf16_f32 v77, v46, v47
    buffer_store_dwordx2 v[76:77], v12, s[8:11], s28 offen offset:512 sc1
    v_cvt_pk_bf16_f32 v80, v48, v49
    v_cvt_pk_bf16_f32 v81, v50, v51
    buffer_store_dwordx2 v[80:81], v12, s[8:11], s28 offen offset:1024 sc1
    v_cvt_pk_bf16_f32 v74, v52, v53
    v_cvt_pk_bf16_f32 v75, v54, v55
    buffer_store_dwordx2 v[74:75], v12, s[8:11], s29 offen offset:0 sc1
    v_cvt_pk_bf16_f32 v78, v56, v57
    v_cvt_pk_bf16_f32 v79, v58, v59
    buffer_store_dwordx2 v[78:79], v12, s[8:11], s29 offen offset:512 sc1
    v_cvt_pk_bf16_f32 v82, v60, v61
    v_cvt_pk_bf16_f32 v83, v62, v63
    buffer_store_dwordx2 v[82:83], v12, s[8:11], s29 offen offset:1024 sc1
    s_lshl_b32 s28, s20, 7
    s_add_u32 s28, s28, s22
    s_lshl_b32 s28, s28, 7
    s_add_u32 s28, s28, s56
    s_add_u32 s28, s28, 0x986000
    s_mov_b32 s45, s28
    s_cmp_lt_u32 s43, s26
    s_cbranch_scc1 M_g1p_a_df
    s_waitcnt vmcnt(0)
    s_barrier
    buffer_store_dword v7, v6, s[8:11], s28 offen sc1
M_g1p_a_df:
    s_mov_b32 s22, s43
    s_cmp_lt_u32 s22, s26
    s_cbranch_scc1 M_g1p_a_loop
    s_branch M_end
M_g1p_z2:
    v_mfma_f32_16x16x32_bf16 v[28:31], v[16:19], a[0:3], 0
    v_mfma_f32_16x16x32_bf16 v[32:35], v[16:19], a[4:7], 0
    v_mfma_f32_16x16x32_bf16 v[36:39], v[16:19], a[8:11], 0
    v_mfma_f32_16x16x32_bf16 v[28:31], v[16:19], a[12:15], v[28:31]
    v_mfma_f32_16x16x32_bf16 v[32:35], v[16:19], a[16:19], v[32:35]
    v_mfma_f32_16x16x32_bf16 v[36:39], v[16:19], a[20:23], v[36:39]
    v_mfma_f32_16x16x32_bf16 v[28:31], v[16:19], a[24:27], v[28:31]
    v_mfma_f32_16x16x32_bf16 v[32:35], v[16:19], a[28:31], v[32:35]
    v_mfma_f32_16x16x32_bf16 v[36:39], v[16:19], a[32:35], v[36:39]
    v_mfma_f32_16x16x32_bf16 v[28:31], v[16:19], a[36:39], v[28:31]
    v_mfma_f32_16x16x32_bf16 v[32:35], v[16:19], a[40:43], v[32:35]
    v_mfma_f32_16x16x32_bf16 v[36:39], v[16:19], a[44:47], v[36:39]
    v_mfma_f32_16x16x32_bf16 v[28:31], v[16:19], a[48:51], v[28:31]
    v_mfma_f32_16x16x32_bf16 v[32:35], v[16:19], a[52:55], v[32:35]
    v_mfma_f32_16x16x32_bf16 v[36:39], v[16:19], a[56:59], v[36:39]
    v_mfma_f32_16x16x32_bf16 v[28:31], v[16:19], a[60:63], v[28:31]
    v_mfma_f32_16x16x32_bf16 v[32:35], v[16:19], a[64:67], v[32:35]
    v_mfma_f32_16x16x32_bf16 v[36:39], v[16:19], a[68:71], v[36:39]
    v_mfma_f32_16x16x32_bf16 v[28:31], v[16:19], a[72:75], v[28:31]
    v_mfma_f32_16x16x32_bf16 v[32:35], v[16:19], a[76:79], v[32:35]
    v_mfma_f32_16x16x32_bf16 v[36:39], v[16:19], a[80:83], v[36:39]
    v_mfma_f32_16x16x32_bf16 v[28:31], v[16:19], a[84:87], v[28:31]
    v_mfma_f32_16x16x32_bf16 v[32:35], v[16:19], a[88:91], v[32:35]
    v_mfma_f32_16x16x32_bf16 v[36:39], v[16:19], a[92:95], v[36:39]
    v_mfma_f32_16x16x32_bf16 v[28:31], v[16:19], a[96:99], v[28:31]
    v_mfma_f32_16x16x32_bf16 v[32:35], v[16:19], a[100:103], v[32:35]
    v_mfma_f32_16x16x32_bf16 v[36:39], v[16:19], a[104:107], v[36:39]
    v_mfma_f32_16x16x32_bf16 v[28:31], v[16:19], a[108:111], v[28:31]
    v_mfma_f32_16x16x32_bf16 v[32:35], v[16:19], a[112:115], v[32:35]
    v_mfma_f32_16x16x32_bf16 v[36:39], v[16:19], a[116:119], v[36:39]
    v_mfma_f32_16x16x32_bf16 v[28:31], v[16:19], a[120:123], v[28:31]
    v_mfma_f32_16x16x32_bf16 v[32:35], v[16:19], a[124:127], v[32:35]
    v_mfma_f32_16x16x32_bf16 v[36:39], v[16:19], a[128:131], v[36:39]
    v_mfma_f32_16x16x32_bf16 v[28:31], v[16:19], a[132:135], v[28:31]
    v_mfma_f32_16x16x32_bf16 v[32:35], v[16:19], a[136:139], v[32:35]
    v_mfma_f32_16x16x32_bf16 v[36:39], v[16:19], a[140:143], v[36:39]
    v_mfma_f32_16x16x32_bf16 v[28:31], v[16:19], a[144:147], v[28:31]
    v_mfma_f32_16x16x32_bf16 v[32:35], v[16:19], a[148:151], v[32:35]
    v_mfma_f32_16x16x32_bf16 v[36:39], v[16:19], a[152:155], v[36:39]
    v_mfma_f32_16x16x32_bf16 v[28:31], v[16:19], a[156:159], v[28:31]
    v_mfma_f32_16x16x32_bf16 v[32:35], v[16:19], a[160:163], v[32:35]
    v_mfma_f32_16x16x32_bf16 v[36:39], v[16:19], a[164:167], v[36:39]
    v_mfma_f32_16x16x32_bf16 v[28:31], v[16:19], a[168:171], v[28:31]
    v_mfma_f32_16x16x32_bf16 v[32:35], v[16:19], a[172:175], v[32:35]
    v_mfma_f32_16x16x32_bf16 v[36:39], v[16:19], a[176:179], v[36:39]
    v_mfma_f32_16x16x32_bf16 v[28:31], v[16:19], a[180:183], v[28:31]
    v_mfma_f32_16x16x32_bf16 v[32:35], v[16:19], a[184:187], v[32:35]
    v_mfma_f32_16x16x32_bf16 v[36:39], v[16:19], a[188:191], v[36:39]
    v_mfma_f32_16x16x32_bf16 v[28:31], v[16:19], a[192:195], v[28:31]
    v_mfma_f32_16x16x32_bf16 v[32:35], v[16:19], a[196:199], v[32:35]
    v_mfma_f32_16x16x32_bf16 v[36:39], v[16:19], a[200:203], v[36:39]
    v_mfma_f32_16x16x32_bf16 v[28:31], v[16:19], a[204:207], v[28:31]
    v_mfma_f32_16x16x32_bf16 v[32:35], v[16:19], a[208:211], v[32:35]
    v_mfma_f32_16x16x32_bf16 v[36:39], v[16:19], a[212:215], v[36:39]
    v_mfma_f32_16x16x32_bf16 v[28:31], v[16:19], a[216:219], v[28:31]
    v_mfma_f32_16x16x32_bf16 v[32:35], v[16:19], a[220:223], v[32:35]
    v_mfma_f32_16x16x32_bf16 v[36:39], v[16:19], a[224:227], v[36:39]
    v_mfma_f32_16x16x32_bf16 v[28:31], v[16:19], a[228:231], v[28:31]
    v_mfma_f32_16x16x32_bf16 v[32:35], v[16:19], a[232:235], v[32:35]
    v_mfma_f32_16x16x32_bf16 v[36:39], v[16:19], a[236:239], v[36:39]
M_g1p_b_loop:
    s_cmp_lg_u32 s41, 0
    s_cbranch_scc1 M_g1p_b_have
    s_lshl_b32 s42, s22, 12
    s_add_u32 s42, s42, 0x940000
    s_add_u32 s42, s42, s56
    s_mov_b32 s39, 0
M_g1p_b_f:
    buffer_load_dword v26, v3, s[8:11], s42 offen sc1
    s_add_u32 s39, s39, 1
    s_cmp_gt_u32 s39, 400000
    s_cbranch_scc1 M_fail
    s_waitcnt vmcnt(0)
    v_cmp_eq_u32 vcc, 0, v26
    s_cbranch_vccz M_g1p_b_f_ok
    s_sleep 1
    s_cmp_ge_i32 s22, 58
    s_cbranch_scc1 M_g1p_b_f
    s_sleep 12
    s_branch M_g1p_b_f
M_g1p_b_f_ok:
    s_mul_i32 s29, s22, 40960
    s_add_u32 s29, s29, s35
    s_add_u32 s28, s34, s40
    s_add_u32 m0, s28, 0
    s_add_u32 s33, s29, 0
    buffer_load_dwordx4 v4, s[8:11], s33 offen offset:0 sc1 lds
    buffer_load_dwordx4 v4, s[8:11], s33 offen offset:1024 sc1 lds
    buffer_load_dwordx4 v4, s[8:11], s33 offen offset:2048 sc1 lds
    buffer_load_dwordx4 v4, s[8:11], s33 offen offset:3072 sc1 lds
    s_add_u32 m0, s28, 4096
    s_add_u32 s33, s29, 4096
    buffer_load_dwordx4 v4, s[8:11], s33 offen offset:0 sc1 lds
    buffer_load_dwordx4 v4, s[8:11], s33 offen offset:1024 sc1 lds
    buffer_load_dwordx4 v4, s[8:11], s33 offen offset:2048 sc1 lds
    buffer_load_dwordx4 v4, s[8:11], s33 offen offset:3072 sc1 lds
    s_add_u32 m0, s28, 8192
    s_add_u32 s33, s29, 8192
    buffer_load_dwordx4 v4, s[8:11], s33 offen offset:0 sc1 lds
    buffer_load_dwordx4 v4, s[8:11], s33 offen offset:1024 sc1 lds
    s_xor_b32 s40, s40, 40960
    s_waitcnt vmcnt(0)
M_g1p_b_have:
    s_add_u32 s43, s22, s24
    s_min_u32 s42, s43, 63
    s_lshl_b32 s42, s42, 12
    s_add_u32 s42, s42, 0x940000
    s_add_u32 s42, s42, s56
    s_waitcnt vmcnt(1)
    s_barrier
    buffer_load_dword v26, v3, s[8:11], s42 offen sc1
    s_mov_b32 s46, 0.0015625
    s_mov_b32 s47, s46
    ds_read_b128 v[64:67], v5 offset:0
    ds_read_b128 v[68:71], v5 offset:20480
    ds_read_b128 v[72:75], v5 offset:1024
    s_waitcnt lgkmcnt(2)
    v_mfma_f32_16x16x32_bf16 v[40:43], v[64:67], a[0:3], 0
    ds_read_b128 v[76:79], v5 offset:21504
    ds_read_b128 v[80:83], v5 offset:2048
    v_mfma_f32_16x16x32_bf16 v[44:47], v[64:67], a[4:7], 0
    ds_read_b128 v[84:87], v5 offset:22528
    ds_read_b128 v[96:99], v8 offset:0
    v_mfma_f32_16x16x32_bf16 v[48:51], v[64:67], a[8:11], 0
    s_waitcnt lgkmcnt(5)
    v_mfma_f32_16x16x32_bf16 v[52:55], v[68:71], a[0:3], 0
    ds_read_b128 v[88:91], v5 offset:3072
    v_mfma_f32_16x16x32_bf16 v[56:59], v[68:71], a[4:7], 0
    ds_read_b128 v[100:103], v8 offset:1024
    v_mfma_f32_16x16x32_bf16 v[60:63], v[68:71], a[8:11], 0
    s_waitcnt lgkmcnt(6)
    v_mfma_f32_16x16x32_bf16 v[40:43], v[72:75], a[12:15], v[40:43]
    ds_read_b128 v[92:95], v5 offset:23552
    v_mfma_f32_16x16x32_bf16 v[44:47], v[72:75], a[16:19], v[44:47]
    ds_read_b128 v[104:107], v8 offset:2048
    v_mfma_f32_16x16x32_bf16 v[48:51], v[72:75], a[20:23], v[48:51]
    s_waitcnt lgkmcnt(7)
    v_mfma_f32_16x16x32_bf16 v[52:55], v[76:79], a[12:15], v[52:55]
    ds_read_b128 v[64:67], v5 offset:4096
    v_mfma_f32_16x16x32_bf16 v[56:59], v[76:79], a[16:19], v[56:59]
    ds_read_b128 v[108:111], v8 offset:3072
    v_mfma_f32_16x16x32_bf16 v[60:63], v[76:79], a[20:23], v[60:63]
    s_waitcnt lgkmcnt(8)
    v_mfma_f32_16x16x32_bf16 v[40:43], v[80:83], a[24:27], v[40:43]
    ds_read_b128 v[68:71], v5 offset:24576
    v_mfma_f32_16x16x32_bf16 v[44:47], v[80:83], a[28:31], v[44:47]
    ds_read_b128 v[112:115], v8 offset:4096
    v_mfma_f32_16x16x32_bf16 v[48:51], v[80:83], a[32:35], v[48:51]
    s_waitcnt lgkmcnt(9)
    v_mfma_f32_16x16x32_bf16 v[52:55], v[84:87], a[24:27], v[52:55]
    ds_read_b128 v[72:75], v5 offset:5120
    v_mfma_f32_16x16x32_bf16 v[56:59], v[84:87], a[28:31], v[56:59]
    ds_read_b128 v[116:119], v8 offset:5120
    v_mfma_f32_16x16x32_bf16 v[60:63], v[84:87], a[32:35], v[60:63]
    s_waitcnt lgkmcnt(9)
    v_mfma_f32_16x16x32_bf16 v[40:43], v[88:91], a[36:39], v[40:43]
    ds_read_b128 v[76:79], v5 offset:25600
    v_mfma_f32_16x16x32_bf16 v[44:47], v[88:91], a[40:43], v[44:47]
    ds_read_b128 v[120:123], v8 offset:6144
    v_mfma_f32_16x16x32_bf16 v[48:51], v[88:91], a[44:47], v[48:51]
    s_waitcnt lgkmcnt(9)
    v_mfma_f32_16x16x32_bf16 v[52:55], v[92:95], a[36:39], v[52:55]
    ds_read_b128 v[80:83], v5 offset:6144
    v_mfma_f32_16x16x32_bf16 v[56:59], v[92:95], a[40:43], v[56:59]
    ds_read_b128 v[124:127], v8 offset:7168
    v_mfma_f32_16x16x32_bf16 v[60:63], v[92:95], a[44:47], v[60:63]
    s_waitcnt lgkmcnt(9)
    v_mfma_f32_16x16x32_bf16 v[40:43], v[64:67], a[48:51], v[40:43]
    ds_read_b128 v[84:87], v5 offset:26624
    v_mfma_f32_16x16x32_bf16 v[44:47], v[64:67], a[52:55], v[44:47]
    ds_read_b128 v[128:131], v8 offset:8192
    v_mfma_f32_16x16x32_bf16 v[48:51], v[64:67], a[56:59], v[48:51]
    s_waitcnt lgkmcnt(9)
    v_mfma_f32_16x16x32_bf16 v[52:55], v[68:71], a[48:51], v[52:55]
    ds_read_b128 v[88:91], v5 offset:7168
    v_mfma_f32_16x16x32_bf16 v[56:59], v[68:71], a[52:55], v[56:59]
    ds_read_b128 v[132:135], v8 offset:9216
    v_mfma_f32_16x16x32_bf16 v[60:63], v[68:71], a[56:59], v[60:63]
    s_waitcnt lgkmcnt(9)
    v_mfma_f32_16x16x32_bf16 v[40:43], v[72:75], a[60:63], v[40:43]
    ds_read_b128 v[92:95], v5 offset:27648
    v_mfma_f32_16x16x32_bf16 v[44:47], v[72:75], a[64:67], v[44:47]
    v_mfma_f32_16x16x32_bf16 v[48:51], v[72:75], a[68:71], v[48:51]
    s_waitcnt lgkmcnt(8)
    v_mfma_f32_16x16x32_bf16 v[52:55], v[76:79], a[60:63], v[52:55]
    ds_read_b128 v[64:67], v5 offset:8192
    v_mfma_f32_16x16x32_bf16 v[56:59], v[76:79], a[64:67], v[56:59]
    v_mfma_f32_16x16x32_bf16 v[60:63], v[76:79], a[68:71], v[60:63]
    s_waitcnt lgkmcnt(7)
    v_mfma_f32_16x16x32_bf16 v[40:43], v[80:83], a[72:75], v[40:43]
    ds_read_b128 v[68:71], v5 offset:28672
    v_mfma_f32_16x16x32_bf16 v[44:47], v[80:83], a[76:79], v[44:47]
    v_mfma_f32_16x16x32_bf16 v[48:51], v[80:83], a[80:83], v[48:51]
    s_waitcnt lgkmcnt(6)
    v_mfma_f32_16x16x32_bf16 v[52:55], v[84:87], a[72:75], v[52:55]
    ds_read_b128 v[72:75], v5 offset:9216
    v_mfma_f32_16x16x32_bf16 v[56:59], v[84:87], a[76:79], v[56:59]
    v_mfma_f32_16x16x32_bf16 v[60:63], v[84:87], a[80:83], v[60:63]
    v_mfma_f32_16x16x32_bf16 v[156:159], v[16:19], v[96:99], 0
    v_mfma_f32_16x16x32_bf16 v[160:163], v[96:99], v[96:99], 0
    v_mfma_f32_16x16x32_bf16 v[156:159], v[16:19], v[100:103], v[156:159]
    v_mfma_f32_16x16x32_bf16 v[160:163], v[100:103], v[100:103], v[160:163]
    v_mfma_f32_16x16x32_bf16 v[156:159], v[16:19], v[104:107], v[156:159]
    v_mfma_f32_16x16x32_bf16 v[160:163], v[104:107], v[104:107], v[160:163]
    v_mfma_f32_16x16x32_bf16 v[156:159], v[16:19], v[108:111], v[156:159]
    v_mfma_f32_16x16x32_bf16 v[160:163], v[108:111], v[108:111], v[160:163]
    v_mfma_f32_16x16x32_bf16 v[156:159], v[16:19], v[112:115], v[156:159]
    v_mfma_f32_16x16x32_bf16 v[160:163], v[112:115], v[112:115], v[160:163]
    v_mfma_f32_16x16x32_bf16 v[156:159], v[16:19], v[116:119], v[156:159]
    v_mfma_f32_16x16x32_bf16 v[160:163], v[116:119], v[116:119], v[160:163]
    v_mfma_f32_16x16x32_bf16 v[156:159], v[16:19], v[120:123], v[156:159]
    v_mfma_f32_16x16x32_bf16 v[160:163], v[120:123], v[120:123], v[160:163]
    v_mfma_f32_16x16x32_bf16 v[156:159], v[16:19], v[124:127], v[156:159]
    v_mfma_f32_16x16x32_bf16 v[160:163], v[124:127], v[124:127], v[160:163]
    s_waitcnt lgkmcnt(4)
    v_mfma_f32_16x16x32_bf16 v[156:159], v[16:19], v[128:131], v[156:159]
    v_mfma_f32_16x16x32_bf16 v[160:163], v[128:131], v[128:131], v[160:163]
    v_mfma_f32_16x16x32_bf16 v[156:159], v[16:19], v[132:135], v[156:159]
    v_mfma_f32_16x16x32_bf16 v[160:163], v[132:135], v[132:135], v[160:163]
    s_nop 1
    v_mfma_f32_16x16x32_bf16 v[40:43], v[88:91], a[84:87], v[40:43]
    ds_read_b128 v[76:79], v5 offset:29696
    s_nop 0
    v_mfma_f32_16x16x32_bf16 v[44:47], v[88:91], a[88:91], v[44:47]
    s_nop 1
    v_mfma_f32_16x16x32_bf16 v[48:51], v[88:91], a[92:95], v[48:51]
    s_waitcnt lgkmcnt(4)
    v_cndmask_b32 v160, v160, v161, s[48:49]
    v_mfma_f32_16x16x32_bf16 v[52:55], v[92:95], a[84:87], v[52:55]
    ds_read_b128 v[80:83], v5 offset:10240
    v_cndmask_b32 v162, v162, v163, s[48:49]
    v_mfma_f32_16x16x32_bf16 v[56:59], v[92:95], a[88:91], v[56:59]
    v_cndmask_b32 v157, v160, v162, s[50:51]
    v_mfma_f32_16x16x32_bf16 v[60:63], v[92:95], a[92:95], v[60:63]
    s_waitcnt lgkmcnt(4)
    v_mfma_f32_16x16x32_bf16 v[40:43], v[64:67], a[96:99], v[40:43]
    ds_read_b128 v[84:87], v5 offset:30720
    ds_write_b64 v9, v[156:157]
    v_mfma_f32_16x16x32_bf16 v[44:47], v[64:67], a[100:103], v[44:47]
    v_mfma_f32_16x16x32_bf16 v[48:51], v[64:67], a[104:107], v[48:51]
    s_waitcnt lgkmcnt(5)
    v_mfma_f32_16x16x32_bf16 v[52:55], v[68:71], a[96:99], v[52:55]
    ds_read_b128 v[88:91], v5 offset:11264
    v_mfma_f32_16x16x32_bf16 v[56:59], v[68:71], a[100:103], v[56:59]
    v_mfma_f32_16x16x32_bf16 v[60:63], v[68:71], a[104:107], v[60:63]
    s_waitcnt lgkmcnt(5)
    s_waitcnt vmcnt(0)
    v_cmp_eq_u32 vcc, 0, v26
    v_mfma_f32_16x16x32_bf16 v[40:43], v[72:75], a[108:111], v[40:43]
    ds_read_b128 v[92:95], v5 offset:31744
    s_waitcnt lgkmcnt(2)
    s_barrier
    v_mfma_f32_16x16x32_bf16 v[44:47], v[72:75], a[112:115], v[44:47]
    ds_read_b128 v[96:99], v15 offset:0
    v_mfma_f32_16x16x32_bf16 v[48:51], v[72:75], a[116:119], v[48:51]
    ds_read_b128 v[100:103], v15 offset:16
    v_mfma_f32_16x16x32_bf16 v[52:55], v[76:79], a[108:111], v[52:55]
    ds_read_b128 v[64:67], v5 offset:12288
    ds_read_b128 v[104:107], v15 offset:128
    v_mfma_f32_16x16x32_bf16 v[56:59], v[76:79], a[112:115], v[56:59]
    ds_read_b128 v[108:111], v15 offset:144
    v_mfma_f32_16x16x32_bf16 v[60:63], v[76:79], a[116:119], v[60:63]
    ds_read_b128 v[112:115], v15 offset:256
    v_mfma_f32_16x16x32_bf16 v[40:43], v[80:83], a[120:123], v[40:43]
    ds_read_b128 v[68:71], v5 offset:32768
    ds_read_b128 v[116:119], v15 offset:272
    v_mfma_f32_16x16x32_bf16 v[44:47], v[80:83], a[124:127], v[44:47]
    ds_read_b128 v[120:123], v15 offset:384
    v_mfma_f32_16x16x32_bf16 v[48:51], v[80:83], a[128:131], v[48:51]
    ds_read_b128 v[124:127], v15 offset:400
    v_mfma_f32_16x16x32_bf16 v[52:55], v[84:87], a[120:123], v[52:55]
    ds_read_b128 v[72:75], v5 offset:13312
    v_mfma_f32_16x16x32_bf16 v[56:59], v[84:87], a[124:127], v[56:59]
    s_mov_b32 s41, 0
    s_cmp_ge_u32 s43, s26
    s_cbranch_scc1 M_g1p_b_nop
    s_cbranch_vccnz M_g1p_b_nop
    s_mov_b32 s41, 1
    s_mul_i32 s29, s43, 40960
    s_add_u32 s29, s29, s35
    s_add_u32 s28, s34, s40
    s_add_u32 m0, s28, 0
    s_add_u32 s33, s29, 0
    buffer_load_dwordx4 v4, s[8:11], s33 offen offset:0 sc1 lds
    buffer_load_dwordx4 v4, s[8:11], s33 offen offset:1024 sc1 lds
    buffer_load_dwordx4 v4, s[8:11], s33 offen offset:2048 sc1 lds
    buffer_load_dwordx4 v4, s[8:11], s33 offen offset:3072 sc1 lds
    s_add_u32 m0, s28, 4096
    s_add_u32 s33, s29, 4096
    buffer_load_dwordx4 v4, s[8:11], s33 offen offset:0 sc1 lds
    buffer_load_dwordx4 v4, s[8:11], s33 offen offset:1024 sc1 lds
    buffer_load_dwordx4 v4, s[8:11], s33 offen offset:2048 sc1 lds
    buffer_load_dwordx4 v4, s[8:11], s33 offen offset:3072 sc1 lds
    s_add_u32 m0, s28, 8192
    s_add_u32 s33, s29, 8192
    buffer_load_dwordx4 v4, s[8:11], s33 offen offset:0 sc1 lds
    buffer_load_dwordx4 v4, s[8:11], s33 offen offset:1024 sc1 lds
    s_xor_b32 s40, s40, 40960
M_g1p_b_nop:
    v_mfma_f32_16x16x32_bf16 v[60:63], v[84:87], a[128:131], v[60:63]
    s_waitcnt lgkmcnt(12)
    v_mfma_f32_16x16x32_bf16 v[40:43], v[88:91], a[132:135], v[40:43]
    ds_read_b128 v[76:79], v5 offset:33792
    v_mfma_f32_16x16x32_bf16 v[44:47], v[88:91], a[136:139], v[44:47]
    v_mfma_f32_16x16x32_bf16 v[48:51], v[88:91], a[140:143], v[48:51]
    s_waitcnt lgkmcnt(12)
    s_waitcnt lgkmcnt(2)
    v_pk_add_f32 v[96:97], v[96:97], v[104:105]
    v_mfma_f32_16x16x32_bf16 v[52:55], v[92:95], a[132:135], v[52:55]
    ds_read_b128 v[80:83], v5 offset:14336
    v_pk_add_f32 v[98:99], v[98:99], v[106:107]
    v_mfma_f32_16x16x32_bf16 v[56:59], v[92:95], a[136:139], v[56:59]
    v_pk_add_f32 v[100:101], v[100:101], v[108:109]
    v_pk_add_f32 v[102:103], v[102:103], v[110:111]
    v_mfma_f32_16x16x32_bf16 v[60:63], v[92:95], a[140:143], v[60:63]
    v_pk_add_f32 v[112:113], v[112:113], v[120:121]
    v_pk_add_f32 v[114:115], v[114:115], v[122:123]
    v_mfma_f32_16x16x32_bf16 v[40:43], v[64:67], a[144:147], v[40:43]
    ds_read_b128 v[84:87], v5 offset:34816
    v_pk_add_f32 v[116:117], v[116:117], v[124:125]
    v_mfma_f32_16x16x32_bf16 v[44:47], v[64:67], a[148:151], v[44:47]
    v_pk_add_f32 v[118:119], v[118:119], v[126:127]
    v_pk_mul_f32 v[96:97], v[96:97], s[46:47]
    v_mfma_f32_16x16x32_bf16 v[48:51], v[64:67], a[152:155], v[48:51]
    v_pk_mul_f32 v[98:99], v[98:99], s[46:47]
    v_pk_mul_f32 v[100:101], v[100:101], s[46:47]
    v_mfma_f32_16x16x32_bf16 v[52:55], v[68:71], a[144:147], v[52:55]
    ds_read_b128 v[88:91], v5 offset:15360
    v_pk_mul_f32 v[102:103], v[102:103], s[46:47]
    v_mfma_f32_16x16x32_bf16 v[56:59], v[68:71], a[148:151], v[56:59]
    v_pk_mul_f32 v[112:113], v[112:113], s[46:47]
    v_pk_mul_f32 v[114:115], v[114:115], s[46:47]
    v_mfma_f32_16x16x32_bf16 v[60:63], v[68:71], a[152:155], v[60:63]
    s_waitcnt lgkmcnt(4)
    v_pk_mul_f32 v[116:117], v[116:117], s[46:47]
    v_mfma_f32_16x16x32_bf16 v[40:43], v[72:75], a[156:159], v[40:43]
    ds_read_b128 v[92:95], v5 offset:35840
    v_pk_mul_f32 v[118:119], v[118:119], s[46:47]
    v_mfma_f32_16x16x32_bf16 v[44:47], v[72:75], a[160:163], v[44:47]
    v_fma_f32 v97, -v96, v96, v97
    v_fma_f32 v99, -v98, v98, v99
    v_mfma_f32_16x16x32_bf16 v[48:51], v[72:75], a[164:167], v[48:51]
    s_waitcnt lgkmcnt(4)
    v_fma_f32 v101, -v100, v100, v101
    v_mfma_f32_16x16x32_bf16 v[52:55], v[76:79], a[156:159], v[52:55]
    ds_read_b128 v[64:67], v5 offset:16384
    v_fma_f32 v103, -v102, v102, v103
    v_mfma_f32_16x16x32_bf16 v[56:59], v[76:79], a[160:163], v[56:59]
    v_fma_f32 v113, -v112, v112, v113
    v_fma_f32 v115, -v114, v114, v115
    v_mfma_f32_16x16x32_bf16 v[60:63], v[76:79], a[164:167], v[60:63]
    s_waitcnt lgkmcnt(4)
    v_fma_f32 v117, -v116, v116, v117
    v_mfma_f32_16x16x32_bf16 v[40:43], v[80:83], a[168:171], v[40:43]
    ds_read_b128 v[68:71], v5 offset:36864
    v_fma_f32 v119, -v118, v118, v119
    v_mfma_f32_16x16x32_bf16 v[44:47], v[80:83], a[172:175], v[44:47]
    v_max_f32 v97, 0, v97
    v_max_f32 v99, 0, v99
    v_mfma_f32_16x16x32_bf16 v[48:51], v[80:83], a[176:179], v[48:51]
    s_waitcnt lgkmcnt(4)
    v_max_f32 v101, 0, v101
    v_mfma_f32_16x16x32_bf16 v[52:55], v[84:87], a[168:171], v[52:55]
    ds_read_b128 v[72:75], v5 offset:17408
    v_max_f32 v103, 0, v103
    v_mfma_f32_16x16x32_bf16 v[56:59], v[84:87], a[172:175], v[56:59]
    v_max_f32 v113, 0, v113
    v_max_f32 v115, 0, v115
    v_mfma_f32_16x16x32_bf16 v[60:63], v[84:87], a[176:179], v[60:63]
    s_waitcnt lgkmcnt(4)
    v_max_f32 v117, 0, v117
    v_mfma_f32_16x16x32_bf16 v[40:43], v[88:91], a[180:183], v[40:43]
    ds_read_b128 v[76:79], v5 offset:37888
    v_max_f32 v119, 0, v119
    v_mfma_f32_16x16x32_bf16 v[44:47], v[88:91], a[184:187], v[44:47]
    v_add_f32 v97, 1e-5, v97
    v_add_f32 v99, 1e-5, v99
    v_mfma_f32_16x16x32_bf16 v[48:51], v[88:91], a[188:191], v[48:51]
    s_waitcnt lgkmcnt(4)
    v_add_f32 v101, 1e-5, v101
    v_mfma_f32_16x16x32_bf16 v[52:55], v[92:95], a[180:183], v[52:55]
    ds_read_b128 v[80:83], v5 offset:18432
    v_add_f32 v103, 1e-5, v103
    v_mfma_f32_16x16x32_bf16 v[56:59], v[92:95], a[184:187], v[56:59]
    v_add_f32 v113, 1e-5, v113
    v_add_f32 v115, 1e-5, v115
    v_mfma_f32_16x16x32_bf16 v[60:63], v[92:95], a[188:191], v[60:63]
    s_waitcnt lgkmcnt(4)
    v_add_f32 v117, 1e-5, v117
    v_mfma_f32_16x16x32_bf16 v[40:43], v[64:67], a[192:195], v[40:43]
    ds_read_b128 v[84:87], v5 offset:38912
    v_add_f32 v119, 1e-5, v119
    v_mfma_f32_16x16x32_bf16 v[44:47], v[64:67], a[196:199], v[44:47]
    v_rsq_f32 v140, v97
    v_rsq_f32 v141, v99
    v_mfma_f32_16x16x32_bf16 v[48:51], v[64:67], a[200:203], v[48:51]
    s_waitcnt lgkmcnt(4)
    v_rsq_f32 v142, v101
    v_mfma_f32_16x16x32_bf16 v[52:55], v[68:71], a[192:195], v[52:55]
    ds_read_b128 v[88:91], v5 offset:19456
    v_rsq_f32 v143, v103
    v_mfma_f32_16x16x32_bf16 v[56:59], v[68:71], a[196:199], v[56:59]
    v_rsq_f32 v144, v113
    v_rsq_f32 v145, v115
    v_mfma_f32_16x16x32_bf16 v[60:63], v[68:71], a[200:203], v[60:63]
    s_waitcnt lgkmcnt(4)
    v_rsq_f32 v146, v117
    v_mfma_f32_16x16x32_bf16 v[40:43], v[72:75], a[204:207], v[40:43]
    ds_read_b128 v[92:95], v5 offset:39936
    v_rsq_f32 v147, v119
    v_mfma_f32_16x16x32_bf16 v[44:47], v[72:75], a[208:211], v[44:47]
    v_nop
    v_mul_f32_e64 v148, -v96, v140
    v_mfma_f32_16x16x32_bf16 v[48:51], v[72:75], a[212:215], v[48:51]
    s_waitcnt lgkmcnt(4)
    v_mul_f32_e64 v149, -v98, v141
    v_mfma_f32_16x16x32_bf16 v[52:55], v[76:79], a[204:207], v[52:55]
    v_mul_f32_e64 v150, -v100, v142
    v_mul_f32_e64 v151, -v102, v143
    v_mfma_f32_16x16x32_bf16 v[56:59], v[76:79], a[208:211], v[56:59]
    v_mul_f32_e64 v152, -v112, v144
    v_mul_f32_e64 v153, -v114, v145
    v_mfma_f32_16x16x32_bf16 v[60:63], v[76:79], a[212:215], v[60:63]
    s_waitcnt lgkmcnt(3)
    v_mul_f32_e64 v154, -v116, v146
    v_mfma_f32_16x16x32_bf16 v[40:43], v[80:83], a[216:219], v[40:43]
    v_mul_f32_e64 v155, -v118, v147
    v_mfma_f32_16x16x32_bf16 v[44:47], v[80:83], a[220:223], v[44:47]
    v_mfma_f32_16x16x32_bf16 v[48:51], v[80:83], a[224:227], v[48:51]
    s_waitcnt lgkmcnt(2)
    v_mfma_f32_16x16x32_bf16 v[52:55], v[84:87], a[216:219], v[52:55]
    v_mfma_f32_16x16x32_bf16 v[56:59], v[84:87], a[220:223], v[56:59]
    v_mfma_f32_16x16x32_bf16 v[60:63], v[84:87], a[224:227], v[60:63]
    s_waitcnt lgkmcnt(1)
    v_mfma_f32_16x16x32_bf16 v[40:43], v[88:91], a[228:231], v[40:43]
    v_mfma_f32_16x16x32_bf16 v[44:47], v[88:91], a[232:235], v[44:47]
    v_mfma_f32_16x16x32_bf16 v[48:51], v[88:91], a[236:239], v[48:51]
    s_waitcnt lgkmcnt(0)
    v_mfma_f32_16x16x32_bf16 v[52:55], v[92:95], a[228:231], v[52:55]
    v_mfma_f32_16x16x32_bf16 v[56:59], v[92:95], a[232:235], v[56:59]
    v_mfma_f32_16x16x32_bf16 v[60:63], v[92:95], a[236:239], v[60:63]
    v_xor_b32 v5, 40960, v5
    s_nop 0
    v_add_u32 v8, s34, v5
    v_pk_mul_f32 v[40:41], v[40:41], v[140:141]
    v_pk_fma_f32 v[40:41], v[28:29], v[148:149], v[40:41]
    v_pk_mul_f32 v[42:43], v[42:43], v[142:143]
    v_pk_fma_f32 v[42:43], v[30:31], v[150:151], v[42:43]
    v_pk_mul_f32 v[44:45], v[44:45], v[140:141]
    v_pk_fma_f32 v[44:45], v[32:33], v[148:149], v[44:45]
    v_pk_mul_f32 v[46:47], v[46:47], v[142:143]
    v_pk_fma_f32 v[46:47], v[34:35], v[150:151], v[46:47]
    v_pk_mul_f32 v[48:49], v[48:49], v[140:141]
    v_pk_fma_f32 v[48:49], v[36:37], v[148:149], v[48:49]
    v_pk_mul_f32 v[50:51], v[50:51], v[142:143]
    v_pk_fma_f32 v[50:51], v[38:39], v[150:151], v[50:51]
    v_pk_mul_f32 v[52:53], v[52:53], v[144:145]
    v_pk_fma_f32 v[52:53], v[28:29], v[152:153], v[52:53]
    v_pk_mul_f32 v[54:55], v[54:55], v[146:147]
    v_pk_fma_f32 v[54:55], v[30:31], v[154:155], v[54:55]
    v_pk_mul_f32 v[56:57], v[56:57], v[144:145]
    v_pk_fma_f32 v[56:57], v[32:33], v[152:153], v[56:57]
    v_pk_mul_f32 v[58:59], v[58:59], v[146:147]
    v_pk_fma_f32 v[58:59], v[34:35], v[154:155], v[58:59]
    v_pk_mul_f32 v[60:61], v[60:61], v[144:145]
    v_pk_fma_f32 v[60:61], v[36:37], v[152:153], v[60:61]
    v_pk_mul_f32 v[62:63], v[62:63], v[146:147]
    v_pk_fma_f32 v[62:63], v[38:39], v[154:155], v[62:63]
    v_pk_mul_f32 v[64:65], v[40:41], v[40:41]
    v_pk_mul_f32 v[66:67], v[42:43], v[42:43]
    v_pk_mul_f32 v[68:69], v[44:45], v[44:45]
    v_pk_mul_f32 v[70:71], v[46:47], v[46:47]
    v_pk_fma_f32 v[64:65], v[64:65], v[22:23], v[20:21] op_sel_hi:[1,0,0]
    v_pk_fma_f32 v[66:67], v[66:67], v[22:23], v[20:21] op_sel_hi:[1,0,0]
    v_pk_fma_f32 v[68:69], v[68:69], v[22:23], v[20:21] op_sel_hi:[1,0,0]
    v_pk_fma_f32 v[70:71], v[70:71], v[22:23], v[20:21] op_sel_hi:[1,0,0]
    v_pk_mul_f32 v[64:65], v[64:65], v[40:41]
    v_pk_mul_f32 v[66:67], v[66:67], v[42:43]
    v_pk_mul_f32 v[68:69], v[68:69], v[44:45]
    v_pk_mul_f32 v[70:71], v[70:71], v[46:47]
    v_exp_f32 v64, v64
    v_exp_f32 v65, v65
    v_exp_f32 v66, v66
    v_exp_f32 v67, v67
    v_exp_f32 v68, v68
    v_exp_f32 v69, v69
    v_exp_f32 v70, v70
    v_exp_f32 v71, v71
    v_pk_add_f32 v[64:65], v[64:65], v[24:25] op_sel_hi:[1,0]
    v_pk_add_f32 v[66:67], v[66:67], v[24:25] op_sel_hi:[1,0]
    v_pk_add_f32 v[68:69], v[68:69], v[24:25] op_sel_hi:[1,0]
    v_pk_add_f32 v[70:71], v[70:71], v[24:25] op_sel_hi:[1,0]
    v_rcp_f32 v64, v64
    v_rcp_f32 v65, v65
    v_rcp_f32 v66, v66
    v_rcp_f32 v67, v67
    v_rcp_f32 v68, v68
    v_rcp_f32 v69, v69
    v_rcp_f32 v70, v70
    v_rcp_f32 v71, v71
    v_pk_mul_f32 v[40:41], v[40:41], v[64:65]
    v_pk_mul_f32 v[42:43], v[42:43], v[66:67]
    v_pk_mul_f32 v[44:45], v[44:45], v[68:69]
    v_pk_mul_f32 v[46:47], v[46:47], v[70:71]
    v_pk_mul_f32 v[64:65], v[48:49], v[48:49]
    v_pk_mul_f32 v[66:67], v[50:51], v[50:51]
    v_pk_mul_f32 v[68:69], v[52:53], v[52:53]
    v_pk_mul_f32 v[70:71], v[54:55], v[54:55]
    v_pk_fma_f32 v[64:65], v[64:65], v[22:23], v[20:21] op_sel_hi:[1,0,0]
    v_pk_fma_f32 v[66:67], v[66:67], v[22:23], v[20:21] op_sel_hi:[1,0,0]
    v_pk_fma_f32 v[68:69], v[68:69], v[22:23], v[20:21] op_sel_hi:[1,0,0]
    v_pk_fma_f32 v[70:71], v[70:71], v[22:23], v[20:21] op_sel_hi:[1,0,0]
    v_pk_mul_f32 v[64:65], v[64:65], v[48:49]
    v_pk_mul_f32 v[66:67], v[66:67], v[50:51]
    v_pk_mul_f32 v[68:69], v[68:69], v[52:53]
    v_pk_mul_f32 v[70:71], v[70:71], v[54:55]
    v_exp_f32 v64, v64
    v_exp_f32 v65, v65
    v_exp_f32 v66, v66
    v_exp_f32 v67, v67
    v_exp_f32 v68, v68
    v_exp_f32 v69, v69
    v_exp_f32 v70, v70
    v_exp_f32 v71, v71
    v_pk_add_f32 v[64:65], v[64:65], v[24:25] op_sel_hi:[1,0]
    v_pk_add_f32 v[66:67], v[66:67], v[24:25] op_sel_hi:[1,0]
    v_pk_add_f32 v[68:69], v[68:69], v[24:25] op_sel_hi:[1,0]
    v_pk_add_f32 v[70:71], v[70:71], v[24:25] op_sel_hi:[1,0]
    v_rcp_f32 v64, v64
    v_rcp_f32 v65, v65
    v_rcp_f32 v66, v66
    v_rcp_f32 v67, v67
    v_rcp_f32 v68, v68
    v_rcp_f32 v69, v69
    v_rcp_f32 v70, v70
    v_rcp_f32 v71, v71
    v_pk_mul_f32 v[48:49], v[48:49], v[64:65]
    v_pk_mul_f32 v[50:51], v[50:51], v[66:67]
    v_pk_mul_f32 v[52:53], v[52:53], v[68:69]
    v_pk_mul_f32 v[54:55], v[54:55], v[70:71]
    v_pk_mul_f32 v[64:65], v[56:57], v[56:57]
    v_pk_mul_f32 v[66:67], v[58:59], v[58:59]
    v_pk_mul_f32 v[68:69], v[60:61], v[60:61]
    v_pk_mul_f32 v[70:71], v[62:63], v[62:63]
    v_pk_fma_f32 v[64:65], v[64:65], v[22:23], v[20:21] op_sel_hi:[1,0,0]
    v_pk_fma_f32 v[66:67], v[66:67], v[22:23], v[20:21] op_sel_hi:[1,0,0]
    v_pk_fma_f32 v[68:69], v[68:69], v[22:23], v[20:21] op_sel_hi:[1,0,0]
    v_pk_fma_f32 v[70:71], v[70:71], v[22:23], v[20:21] op_sel_hi:[1,0,0]
    v_pk_mul_f32 v[64:65], v[64:65], v[56:57]
    v_pk_mul_f32 v[66:67], v[66:67], v[58:59]
    v_pk_mul_f32 v[68:69], v[68:69], v[60:61]
    v_pk_mul_f32 v[70:71], v[70:71], v[62:63]
    v_exp_f32 v64, v64
    v_exp_f32 v65, v65
    v_exp_f32 v66, v66
    v_exp_f32 v67, v67
    v_exp_f32 v68, v68
    v_exp_f32 v69, v69
    v_exp_f32 v70, v70
    v_exp_f32 v71, v71
    v_pk_add_f32 v[64:65], v[64:65], v[24:25] op_sel_hi:[1,0]
    v_pk_add_f32 v[66:67], v[66:67], v[24:25] op_sel_hi:[1,0]
    v_pk_add_f32 v[68:69], v[68:69], v[24:25] op_sel_hi:[1,0]
    v_pk_add_f32 v[70:71], v[70:71], v[24:25] op_sel_hi:[1,0]
    v_rcp_f32 v64, v64
    v_rcp_f32 v65, v65
    v_rcp_f32 v66, v66
    v_rcp_f32 v67, v67
    v_rcp_f32 v68, v68
    v_rcp_f32 v69, v69
    v_rcp_f32 v70, v70
    v_rcp_f32 v71, v71
    v_pk_mul_f32 v[56:57], v[56:57], v[64:65]
    v_pk_mul_f32 v[58:59], v[58:59], v[66:67]
    v_pk_mul_f32 v[60:61], v[60:61], v[68:69]
    v_pk_mul_f32 v[62:63], v[62:63], v[70:71]
    v_add_f32 v96, v40, v44
    v_mul_f32 v97, v40, v40
    v_add_f32 v96, v96, v48
    v_fmac_f32 v97, v44, v44
    v_fmac_f32 v97, v48, v48
    v_add_f32 v98, v41, v45
    v_mul_f32 v99, v41, v41
    v_add_f32 v98, v98, v49
    v_fmac_f32 v99, v45, v45
    v_fmac_f32 v99, v49, v49
    v_add_f32 v100, v42, v46
    v_mul_f32 v101, v42, v42
    v_add_f32 v100, v100, v50
    v_fmac_f32 v101, v46, v46
    v_fmac_f32 v101, v50, v50
    v_add_f32 v102, v43, v47
    v_mul_f32 v103, v43, v43
    v_add_f32 v102, v102, v51
    v_fmac_f32 v103, v47, v47
    v_fmac_f32 v103, v51, v51
    v_add_f32 v104, v52, v56
    v_mul_f32 v105, v52, v52
    v_add_f32 v104, v104, v60
    v_fmac_f32 v105, v56, v56
    v_fmac_f32 v105, v60, v60
    v_add_f32 v106, v53, v57
    v_mul_f32 v107, v53, v53
    v_add_f32 v106, v106, v61
    v_fmac_f32 v107, v57, v57
    v_fmac_f32 v107, v61, v61
    v_add_f32 v108, v54, v58
    v_mul_f32 v109, v54, v54
    v_add_f32 v108, v108, v62
    v_fmac_f32 v109, v58, v58
    v_fmac_f32 v109, v62, v62
    v_add_f32 v110, v55, v59
    v_mul_f32 v111, v55, v55
    v_add_f32 v110, v110, v63
    v_fmac_f32 v111, v59, v59
    v_fmac_f32 v111, v63, v63
    v_add_f32_dpp v96, v96, v96 row_ror:8 row_mask:0xf bank_mask:0xf
    v_add_f32_dpp v97, v97, v97 row_ror:8 row_mask:0xf bank_mask:0xf
    v_add_f32_dpp v98, v98, v98 row_ror:8 row_mask:0xf bank_mask:0xf
    v_add_f32_dpp v99, v99, v99 row_ror:8 row_mask:0xf bank_mask:0xf
    v_add_f32_dpp v100, v100, v100 row_ror:8 row_mask:0xf bank_mask:0xf
    v_add_f32_dpp v101, v101, v101 row_ror:8 row_mask:0xf bank_mask:0xf
    v_add_f32_dpp v102, v102, v102 row_ror:8 row_mask:0xf bank_mask:0xf
    v_add_f32_dpp v103, v103, v103 row_ror:8 row_mask:0xf bank_mask:0xf
    v_add_f32_dpp v104, v104, v104 row_ror:8 row_mask:0xf bank_mask:0xf
    v_add_f32_dpp v105, v105, v105 row_ror:8 row_mask:0xf bank_mask:0xf
    v_add_f32_dpp v106, v106, v106 row_ror:8 row_mask:0xf bank_mask:0xf
    v_add_f32_dpp v107, v107, v107 row_ror:8 row_mask:0xf bank_mask:0xf
    v_add_f32_dpp v108, v108, v108 row_ror:8 row_mask:0xf bank_mask:0xf
    v_add_f32_dpp v109, v109, v109 row_ror:8 row_mask:0xf bank_mask:0xf
    v_add_f32_dpp v110, v110, v110 row_ror:8 row_mask:0xf bank_mask:0xf
    v_add_f32_dpp v111, v111, v111 row_ror:8 row_mask:0xf bank_mask:0xf
    v_add_f32_dpp v96, v96, v96 row_ror:4 row_mask:0xf bank_mask:0xf
    v_add_f32_dpp v97, v97, v97 row_ror:4 row_mask:0xf bank_mask:0xf
    v_add_f32_dpp v98, v98, v98 row_ror:4 row_mask:0xf bank_mask:0xf
    v_add_f32_dpp v99, v99, v99 row_ror:4 row_mask:0xf bank_mask:0xf
    v_add_f32_dpp v100, v100, v100 row_ror:4 row_mask:0xf bank_mask:0xf
    v_add_f32_dpp v101, v101, v101 row_ror:4 row_mask:0xf bank_mask:0xf
    v_add_f32_dpp v102, v102, v102 row_ror:4 row_mask:0xf bank_mask:0xf
    v_add_f32_dpp v103, v103, v103 row_ror:4 row_mask:0xf bank_mask:0xf
    v_add_f32_dpp v104, v104, v104 row_ror:4 row_mask:0xf bank_mask:0xf
    v_add_f32_dpp v105, v105, v105 row_ror:4 row_mask:0xf bank_mask:0xf
    v_add_f32_dpp v106, v106, v106 row_ror:4 row_mask:0xf bank_mask:0xf
    v_add_f32_dpp v107, v107, v107 row_ror:4 row_mask:0xf bank_mask:0xf
    v_add_f32_dpp v108, v108, v108 row_ror:4 row_mask:0xf bank_mask:0xf
    v_add_f32_dpp v109, v109, v109 row_ror:4 row_mask:0xf bank_mask:0xf
    v_add_f32_dpp v110, v110, v110 row_ror:4 row_mask:0xf bank_mask:0xf
    v_add_f32_dpp v111, v111, v111 row_ror:4 row_mask:0xf bank_mask:0xf
    v_add_f32_dpp v96, v96, v96 row_ror:2 row_mask:0xf bank_mask:0xf
    v_add_f32_dpp v97, v97, v97 row_ror:2 row_mask:0xf bank_mask:0xf
    v_add_f32_dpp v98, v98, v98 row_ror:2 row_mask:0xf bank_mask:0xf
    v_add_f32_dpp v99, v99, v99 row_ror:2 row_mask:0xf bank_mask:0xf
    v_add_f32_dpp v100, v100, v100 row_ror:2 row_mask:0xf bank_mask:0xf
    v_add_f32_dpp v101, v101, v101 row_ror:2 row_mask:0xf bank_mask:0xf
    v_add_f32_dpp v102, v102, v102 row_ror:2 row_mask:0xf bank_mask:0xf
    v_add_f32_dpp v103, v103, v103 row_ror:2 row_mask:0xf bank_mask:0xf
    v_add_f32_dpp v104, v104, v104 row_ror:2 row_mask:0xf bank_mask:0xf
    v_add_f32_dpp v105, v105, v105 row_ror:2 row_mask:0xf bank_mask:0xf
    v_add_f32_dpp v106, v106, v106 row_ror:2 row_mask:0xf bank_mask:0xf
    v_add_f32_dpp v107, v107, v107 row_ror:2 row_mask:0xf bank_mask:0xf
    v_add_f32_dpp v108, v108, v108 row_ror:2 row_mask:0xf bank_mask:0xf
    v_add_f32_dpp v109, v109, v109 row_ror:2 row_mask:0xf bank_mask:0xf
    v_add_f32_dpp v110, v110, v110 row_ror:2 row_mask:0xf bank_mask:0xf
    v_add_f32_dpp v111, v111, v111 row_ror:2 row_mask:0xf bank_mask:0xf
    v_add_f32_dpp v96, v96, v96 row_ror:1 row_mask:0xf bank_mask:0xf
    v_add_f32_dpp v97, v97, v97 row_ror:1 row_mask:0xf bank_mask:0xf
    v_add_f32_dpp v98, v98, v98 row_ror:1 row_mask:0xf bank_mask:0xf
    v_add_f32_dpp v99, v99, v99 row_ror:1 row_mask:0xf bank_mask:0xf
    v_add_f32_dpp v100, v100, v100 row_ror:1 row_mask:0xf bank_mask:0xf
    v_add_f32_dpp v101, v101, v101 row_ror:1 row_mask:0xf bank_mask:0xf
    v_add_f32_dpp v102, v102, v102 row_ror:1 row_mask:0xf bank_mask:0xf
    v_add_f32_dpp v103, v103, v103 row_ror:1 row_mask:0xf bank_mask:0xf
    v_add_f32_dpp v104, v104, v104 row_ror:1 row_mask:0xf bank_mask:0xf
    v_add_f32_dpp v105, v105, v105 row_ror:1 row_mask:0xf bank_mask:0xf
    v_add_f32_dpp v106, v106, v106 row_ror:1 row_mask:0xf bank_mask:0xf
    v_add_f32_dpp v107, v107, v107 row_ror:1 row_mask:0xf bank_mask:0xf
    v_add_f32_dpp v108, v108, v108 row_ror:1 row_mask:0xf bank_mask:0xf
    v_add_f32_dpp v109, v109, v109 row_ror:1 row_mask:0xf bank_mask:0xf
    v_add_f32_dpp v110, v110, v110 row_ror:1 row_mask:0xf bank_mask:0xf
    v_add_f32_dpp v111, v111, v111 row_ror:1 row_mask:0xf bank_mask:0xf
    s_lshl_b32 s28, s21, 8
    v_add_u32 v13, s28, v15
    ds_write_b128 v13, v[96:99] offset:512
    ds_write_b128 v13, v[100:103] offset:528
    ds_write_b128 v13, v[104:107] offset:640
    ds_write_b128 v13, v[108:111] offset:656
    s_waitcnt lgkmcnt(0)
    s_barrier
    s_cmp_lg_u32 s21, 0
    s_cbranch_scc1 M_g1p_b_w
    v_and_b32 v12, 31, v1
    v_lshlrev_b32 v12, 3, v12
    v_add_u32 v13, 82432, v12
    ds_read_b64 v[96:97], v13
    ds_read_b64 v[98:99], v13 offset:256
    ds_read_b64 v[100:101], v13 offset:512
    ds_read_b64 v[102:103], v13 offset:768
    s_lshl_b32 s44, s22, 10
    s_add_u32 s44, s44, 0xc00000
    s_add_u32 s44, s44, s56
    s_and_b32 s28, s20, 3
    s_lshl_b32 s28, s28, 8
    s_add_u32 s28, s28, s44
    s_waitcnt lgkmcnt(0)
    v_pk_add_f32 v[96:97], v[96:97], v[98:99]
    v_pk_add_f32 v[100:101], v[100:101], v[102:103]
    v_pk_add_f32 v[96:97], v[96:97], v[100:101]
    v_min_u32 v96, -2, v96
    v_min_u32 v97, -2, v97
    buffer_store_dwordx2 v[96:97], v12, s[8:11], s28 offen sc1
    s_mov_b32 s39, 0
    s_waitcnt vmcnt(0)
M_g1p_b_sp:
    buffer_load_dwordx2 v[98:99], v12, s[8:11], s44 offen offset:0 sc1
    buffer_load_dwordx2 v[100:101], v12, s[8:11], s44 offen offset:256 sc1
    buffer_load_dwordx2 v[102:103], v12, s[8:11], s44 offen offset:512 sc1
    buffer_load_dwordx2 v[104:105], v12, s[8:11], s44 offen offset:768 sc1
    s_add_u32 s39, s39, 1
    s_cmp_gt_u32 s39, 400000
    s_cbranch_scc1 M_fail
    s_waitcnt vmcnt(0)
    v_max3_u32 v10, v98, v99, v100
    v_max3_u32 v10, v10, v101, v102
    v_max3_u32 v10, v10, v103, v104
    v_max_u32 v10, v10, v105
    v_cmp_eq_u32 vcc, -1, v10
    s_cbranch_vccnz M_g1p_b_sp
    v_pk_add_f32 v[98:99], v[98:99], v[100:101]
    v_pk_add_f32 v[102:103], v[102:103], v[104:105]
    v_pk_add_f32 v[98:99], v[98:99], v[102:103]
    v_mul_f32 v98, 0.0013020833333333333, v98
    v_mul_f32 v99, 0.0013020833333333333, v99
    v_fma_f32 v99, -v98, v98, v99
    v_max_f32 v99, 0, v99
    v_add_f32 v99, 1e-5, v99
    v_rsq_f32 v100, v99
    s_nop 0
    v_mul_f32_e64 v101, -v98, v100
    ds_write_b64 v13, v[100:101] offset:1024
    s_waitcnt lgkmcnt(0)
M_g1p_b_w:
    s_barrier
    ds_read_b128 v[96:99], v15 offset:1536
    ds_read_b128 v[100:103], v15 offset:1552
    ds_read_b128 v[104:107], v15 offset:1664
    ds_read_b128 v[108:111], v15 offset:1680
    s_sub_u32 s28, s20, 4
    s_mul_i32 s28, s28, 12
    s_mul_i32 s29, s21, 3
    s_add_u32 s28, s28, s29
    s_lshl_b32 s28, s28, 10
    s_mul_i32 s29, s22, 49152
    s_add_u32 s28, s28, s29
    s_add_u32 s28, s28, 0xb800000
    s_waitcnt lgkmcnt(0)
    v_fma_f32 v40, v40, v96, v97
    v_fma_f32 v41, v41, v98, v99
    v_fma_f32 v42, v42, v100, v101
    v_fma_f32 v43, v43, v102, v103
    v_cvt_pk_bf16_f32 v72, v40, v41
    v_cvt_pk_bf16_f32 v73, v42, v43
    v_fma_f32 v52, v52, v104, v105
    v_fma_f32 v53, v53, v106, v107
    v_fma_f32 v54, v54, v108, v109
    v_fma_f32 v55, v55, v110, v111
    v_cvt_pk_bf16_f32 v74, v52, v53
    v_cvt_pk_bf16_f32 v75, v54, v55
    buffer_store_dwordx4 v[72:75], v2, s[8:11], s28 offen offset:0 sc1
    v_fma_f32 v44, v44, v96, v97
    v_fma_f32 v45, v45, v98, v99
    v_fma_f32 v46, v46, v100, v101
    v_fma_f32 v47, v47, v102, v103
    v_cvt_pk_bf16_f32 v76, v44, v45
    v_cvt_pk_bf16_f32 v77, v46, v47
    v_fma_f32 v56, v56, v104, v105
    v_fma_f32 v57, v57, v106, v107
    v_fma_f32 v58, v58, v108, v109
    v_fma_f32 v59, v59, v110, v111
    v_cvt_pk_bf16_f32 v78, v56, v57
    v_cvt_pk_bf16_f32 v79, v58, v59
    buffer_store_dwordx4 v[76:79], v2, s[8:11], s28 offen offset:1024 sc1
    v_fma_f32 v48, v48, v96, v97
    v_fma_f32 v49, v49, v98, v99
    v_fma_f32 v50, v50, v100, v101
    v_fma_f32 v51, v51, v102, v103
    v_cvt_pk_bf16_f32 v80, v48, v49
    v_cvt_pk_bf16_f32 v81, v50, v51
    v_fma_f32 v60, v60, v104, v105
    v_fma_f32 v61, v61, v106, v107
    v_fma_f32 v62, v62, v108, v109
    v_fma_f32 v63, v63, v110, v111
    v_cvt_pk_bf16_f32 v82, v60, v61
    v_cvt_pk_bf16_f32 v83, v62, v63
    buffer_store_dwordx4 v[80:83], v2, s[8:11], s28 offen offset:2048 sc1
    s_lshl_b32 s28, s20, 7
    s_add_u32 s28, s28, s22
    s_lshl_b32 s28, s28, 7
    s_add_u32 s28, s28, s56
    s_add_u32 s28, s28, 0x986000
    s_waitcnt vmcnt(0)
    s_barrier
    buffer_store_dword v7, v6, s[8:11], s28 offen sc1
M_g1p_b_df:
    s_mov_b32 s22, s43
    s_cmp_lt_u32 s22, s26
    s_cbranch_scc1 M_g1p_b_loop
    s_branch M_end
M_x:
    s_mov_b32 s26, 63
M_xe:
    s_and_b32 s31, s20, 4
    s_add_u32 s31, s31, s21
    s_and_b32 s32, s20, 3
    s_lshl_b32 s30, s31, 2
    s_add_u32 s30, s30, s32
    v_lshlrev_b32 v2, 4, v1
    v_and_b32 v4, 15, v1
    v_lshrrev_b32 v5, 4, v1
    s_lshl_b32 s28, s30, 7
    v_mov_b32 v6, s28
    v_mov_b32 v7, 0x7ff00000
    v_cmp_gt_u32 vcc, 32, v1
    v_lshl_add_u32 v8, v1, 2, v6
    s_nop 0
    v_cndmask_b32 v8, v7, v8, vcc
    v_mov_b32 v9, 1
    v_and_b32 v10, 7, v1
    v_lshlrev_b32 v10, 4, v10
    v_lshl_add_u32 v10, v5, 7, v10
    v_lshlrev_b32 v11, 4, v4
    v_lshl_add_u32 v11, v5, 3, v11
    v_cmp_gt_u32 vcc, 2, v5
    s_nop 1
    v_cndmask_b32 v11, v7, v11, vcc
    v_mov_b32 v7, 0xff800000
    v_cndmask_b32_e64 v16, v7, 0, vcc
    v_mov_b32 v17, v16
    v_mov_b32 v18, v16
    v_mov_b32 v19, v16
    v_lshlrev_b32 v3, 2, v5
    v_add_u32 v20, 0, v3
    v_cmp_le_u32 vcc, v20, v4
    s_nop 1
    v_cndmask_b32_e64 v12, v7, 0, vcc
    v_add_u32 v20, 1, v3
    v_cmp_le_u32 vcc, v20, v4
    s_nop 1
    v_cndmask_b32_e64 v13, v7, 0, vcc
    v_add_u32 v20, 2, v3
    v_cmp_le_u32 vcc, v20, v4
    s_nop 1
    v_cndmask_b32_e64 v14, v7, 0, vcc
    v_add_u32 v20, 3, v3
    v_cmp_le_u32 vcc, v20, v4
    s_nop 1
    v_cndmask_b32_e64 v15, v7, 0, vcc
    v_and_b32 v23, 1, v1
    v_mul_u32_u24 v23, 0x40000, v23
    v_add_u32 v23, v23, v6
    v_add_u32 v22, 4096, v23
    v_add_u32 v21, 0x80000, v6
    v_add_u32 v21, s56, v21
    v_cmp_gt_u32 vcc, 32, v1
    s_mul_i32 s45, s30, 3072
    s_add_u32 s45, s45, 0xa400000
    v_cndmask_b32 v22, v21, v22, vcc
    v_mov_b32 v62, v21
    s_mul_i32 s33, s30, 24576
    s_add_u32 s33, s33, 0x1000000
    s_lshl_b32 s47, s30, 11
    s_add_u32 s47, s47, 0xaa00000
    s_lshl_b32 s46, s31, 11
    s_lshl_b32 s28, s32, 8
    s_add_u32 s46, s46, s28
    s_add_u32 s46, s46, 0xaa10000
    s_lshl_b32 s44, s22, 12
    s_add_u32 s44, s44, 0x840000
    s_mul_i32 s28, s22, 98304
    s_add_u32 s45, s45, s28
    s_and_b32 s28, s22, 63
    s_mul_i32 s28, s28, 786432
    s_add_u32 s33, s33, s28
    s_mul_i32 s28, s22, 81920
    s_add_u32 s46, s46, s28
    s_add_u32 s47, s47, s28
    s_sub_u32 s27, s26, 1
    s_cmp_eq_u32 s22, s27
    s_cselect_b64 vcc, -1, 0
    v_cndmask_b32 v22, v22, v62, vcc
    s_mov_b32 s42, 0.10411754627697264
    v_mov_b32 v50, 0
    v_mov_b32 v51, 0
    s_mov_b32 s39, 0
M_x_f1:
    buffer_load_dword v20, v23, s[8:11], s44 offen sc1
    s_add_u32 s39, s39, 1
    s_cmp_gt_u32 s39, 400000
    s_cbranch_scc1 M_fail
    s_waitcnt vmcnt(0)
    v_cmp_eq_u32 vcc, 0, v20
    s_cbranch_vccz M_x_f1_ok
    s_sleep 4
    s_branch M_x_f1
M_x_f1_ok:
    s_add_u32 s28, s33, 0
    buffer_load_dwordx4 v[64:67], v2, s[8:11], s28 offen offset:0 sc1
    buffer_load_dwordx4 v[68:71], v2, s[8:11], s28 offen offset:1024 sc1
    buffer_load_dwordx4 v[72:75], v2, s[8:11], s28 offen offset:2048 sc1
    buffer_load_dwordx4 v[76:79], v2, s[8:11], s28 offen offset:3072 sc1
    s_add_u32 s28, s33, 4096
    buffer_load_dwordx4 v[80:83], v2, s[8:11], s28 offen offset:0 sc1
    buffer_load_dwordx4 v[84:87], v2, s[8:11], s28 offen offset:1024 sc1
    buffer_load_dwordx4 v[88:91], v2, s[8:11], s28 offen offset:2048 sc1
    buffer_load_dwordx4 v[92:95], v2, s[8:11], s28 offen offset:3072 sc1
    s_add_u32 s28, s33, 8192
    buffer_load_dwordx4 v[96:99], v2, s[8:11], s28 offen offset:0 sc1
    buffer_load_dwordx4 v[100:103], v2, s[8:11], s28 offen offset:1024 sc1
    buffer_load_dwordx4 v[104:107], v2, s[8:11], s28 offen offset:2048 sc1
    buffer_load_dwordx4 v[108:111], v2, s[8:11], s28 offen offset:3072 sc1
    s_add_u32 s28, s33, 12288
    buffer_load_dwordx4 v[112:115], v2, s[8:11], s28 offen offset:0 sc1
    buffer_load_dwordx4 v[116:119], v2, s[8:11], s28 offen offset:1024 sc1
    buffer_load_dwordx4 v[120:123], v2, s[8:11], s28 offen offset:2048 sc1
    buffer_load_dwordx4 v[124:127], v2, s[8:11], s28 offen offset:3072 sc1
    s_add_u32 s28, s33, 16384
    buffer_load_dwordx4 v[128:131], v2, s[8:11], s28 offen offset:0 sc1
    buffer_load_dwordx4 v[132:135], v2, s[8:11], s28 offen offset:1024 sc1
    buffer_load_dwordx4 v[136:139], v2, s[8:11], s28 offen offset:2048 sc1
    buffer_load_dwordx4 v[140:143], v2, s[8:11], s28 offen offset:3072 sc1
    s_add_u32 s28, s33, 20480
    buffer_load_dwordx4 v[144:147], v2, s[8:11], s28 offen offset:0 sc1
    buffer_load_dwordx4 v[148:151], v2, s[8:11], s28 offen offset:1024 sc1
    buffer_load_dwordx4 v[152:155], v2, s[8:11], s28 offen offset:2048 sc1
    buffer_load_dwordx4 v[156:159], v2, s[8:11], s28 offen offset:3072 sc1
    s_add_u32 s33, s33, 786432
    s_nop 0
    v_mov_b32 v63, 0
    s_waitcnt vmcnt(0)
M_x_loop0:
    v_cmp_eq_u32 vcc, 0, v63
    v_mfma_f32_16x16x32_bf16 v[24:27], v[112:115], v[64:67], v[12:15]
    v_mfma_f32_16x16x32_bf16 v[32:35], v[112:115], v[88:91], 0
    v_mfma_f32_16x16x32_bf16 v[36:39], v[136:139], v[88:91], v[12:15]
    v_mfma_f32_16x16x32_bf16 v[24:27], v[116:119], v[68:71], v[24:27]
    v_mfma_f32_16x16x32_bf16 v[32:35], v[116:119], v[92:95], v[32:35]
    v_mfma_f32_16x16x32_bf16 v[36:39], v[140:143], v[92:95], v[36:39]
    v_mfma_f32_16x16x32_bf16 v[24:27], v[120:123], v[72:75], v[24:27]
    v_mfma_f32_16x16x32_bf16 v[32:35], v[120:123], v[96:99], v[32:35]
    v_mfma_f32_16x16x32_bf16 v[36:39], v[144:147], v[96:99], v[36:39]
    v_mfma_f32_16x16x32_bf16 v[24:27], v[124:127], v[76:79], v[24:27]
    v_mfma_f32_16x16x32_bf16 v[32:35], v[124:127], v[100:103], v[32:35]
    v_mfma_f32_16x16x32_bf16 v[36:39], v[148:151], v[100:103], v[36:39]
    v_mfma_f32_16x16x32_bf16 v[24:27], v[128:131], v[80:83], v[24:27]
    v_mfma_f32_16x16x32_bf16 v[32:35], v[128:131], v[104:107], v[32:35]
    v_mfma_f32_16x16x32_bf16 v[36:39], v[152:155], v[104:107], v[36:39]
    v_mfma_f32_16x16x32_bf16 v[24:27], v[132:135], v[84:87], v[24:27]
    v_mfma_f32_16x16x32_bf16 v[32:35], v[132:135], v[108:111], v[32:35]
    v_mfma_f32_16x16x32_bf16 v[36:39], v[156:159], v[108:111], v[36:39]
    s_cbranch_vccz M_x_go0
    s_mov_b32 s39, 0
M_x_f20:
    buffer_load_dword v20, v22, s[8:11], s44 offen sc1
    s_add_u32 s39, s39, 1
    s_cmp_gt_u32 s39, 400000
    s_cbranch_scc1 M_fail
    s_waitcnt vmcnt(0)
    v_cmp_eq_u32 vcc, 0, v20
    s_cbranch_vccz M_x_f20_ok
    s_sleep 1
    s_cmp_ge_i32 s22, 58
    s_cbranch_scc1 M_x_f20
    s_sleep 3
    s_branch M_x_f20
M_x_f20_ok:
M_x_go0:
    buffer_load_dwordx4 v[160:163], v10, s[8:11], s45 offen offset:0 sc1
    buffer_load_dwordx4 v[164:167], v10, s[8:11], s45 offen offset:512 sc1
    buffer_load_dwordx4 v[168:171], v10, s[8:11], s45 offen offset:1024 sc1
    buffer_load_dwordx4 v[172:175], v10, s[8:11], s45 offen offset:1536 sc1
    buffer_load_dwordx4 v[176:179], v10, s[8:11], s45 offen offset:2048 sc1
    buffer_load_dwordx4 v[180:183], v10, s[8:11], s45 offen offset:2560 sc1
    s_cmp_lg_u32 s22, s27
    s_cbranch_scc1 M_x_nq
    s_waitcnt vmcnt(5)
    v_mfma_f32_16x16x32_bf16 v[40:43], v[160:163], v[88:91], v[16:19]
    v_mfma_f32_16x16x32_bf16 v[28:31], v[160:163], v[64:67], v[16:19]
    s_waitcnt vmcnt(4)
    v_mfma_f32_16x16x32_bf16 v[40:43], v[164:167], v[92:95], v[40:43]
    v_mfma_f32_16x16x32_bf16 v[28:31], v[164:167], v[68:71], v[28:31]
    s_waitcnt vmcnt(3)
    v_mfma_f32_16x16x32_bf16 v[40:43], v[168:171], v[96:99], v[40:43]
    v_mfma_f32_16x16x32_bf16 v[28:31], v[168:171], v[72:75], v[28:31]
    s_waitcnt vmcnt(2)
    v_mfma_f32_16x16x32_bf16 v[40:43], v[172:175], v[100:103], v[40:43]
    v_mfma_f32_16x16x32_bf16 v[28:31], v[172:175], v[76:79], v[28:31]
    s_waitcnt vmcnt(1)
    v_mfma_f32_16x16x32_bf16 v[40:43], v[176:179], v[104:107], v[40:43]
    v_mfma_f32_16x16x32_bf16 v[28:31], v[176:179], v[80:83], v[28:31]
    s_waitcnt vmcnt(0)
    v_mfma_f32_16x16x32_bf16 v[40:43], v[180:183], v[108:111], v[40:43]
    v_mfma_f32_16x16x32_bf16 v[28:31], v[180:183], v[84:87], v[28:31]
    s_branch M_x_nq2
M_x_nq:
    s_add_u32 s28, s33, 0
    buffer_load_dwordx4 a[0:3], v2, s[8:11], s28 offen offset:0 sc1
    buffer_load_dwordx4 a[4:7], v2, s[8:11], s28 offen offset:1024 sc1
    buffer_load_dwordx4 a[8:11], v2, s[8:11], s28 offen offset:2048 sc1
    buffer_load_dwordx4 a[12:15], v2, s[8:11], s28 offen offset:3072 sc1
    s_add_u32 s28, s33, 4096
    buffer_load_dwordx4 a[16:19], v2, s[8:11], s28 offen offset:0 sc1
    buffer_load_dwordx4 a[20:23], v2, s[8:11], s28 offen offset:1024 sc1
    buffer_load_dwordx4 a[24:27], v2, s[8:11], s28 offen offset:2048 sc1
    buffer_load_dwordx4 a[28:31], v2, s[8:11], s28 offen offset:3072 sc1
    s_add_u32 s28, s33, 8192
    buffer_load_dwordx4 a[32:35], v2, s[8:11], s28 offen offset:0 sc1
    buffer_load_dwordx4 a[36:39], v2, s[8:11], s28 offen offset:1024 sc1
    buffer_load_dwordx4 a[40:43], v2, s[8:11], s28 offen offset:2048 sc1
    buffer_load_dwordx4 a[44:47], v2, s[8:11], s28 offen offset:3072 sc1
    s_add_u32 s28, s33, 12288
    buffer_load_dwordx4 a[48:51], v2, s[8:11], s28 offen offset:0 sc1
    buffer_load_dwordx4 a[52:55], v2, s[8:11], s28 offen offset:1024 sc1
    buffer_load_dwordx4 a[56:59], v2, s[8:11], s28 offen offset:2048 sc1
    buffer_load_dwordx4 a[60:63], v2, s[8:11], s28 offen offset:3072 sc1
    s_add_u32 s28, s33, 16384
    buffer_load_dwordx4 a[64:67], v2, s[8:11], s28 offen offset:0 sc1
    buffer_load_dwordx4 a[68:71], v2, s[8:11], s28 offen offset:1024 sc1
    buffer_load_dwordx4 a[72:75], v2, s[8:11], s28 offen offset:2048 sc1
    buffer_load_dwordx4 a[76:79], v2, s[8:11], s28 offen offset:3072 sc1
    s_add_u32 s28, s33, 20480
    buffer_load_dwordx4 a[80:83], v2, s[8:11], s28 offen offset:0 sc1
    buffer_load_dwordx4 a[84:87], v2, s[8:11], s28 offen offset:1024 sc1
    buffer_load_dwordx4 a[88:91], v2, s[8:11], s28 offen offset:2048 sc1
    buffer_load_dwordx4 a[92:95], v2, s[8:11], s28 offen offset:3072 sc1
    s_add_u32 s33, s33, 786432
    s_nop 0
    s_waitcnt vmcnt(29)
    v_mfma_f32_16x16x32_bf16 v[40:43], v[160:163], v[88:91], v[16:19]
    v_mfma_f32_16x16x32_bf16 v[28:31], v[160:163], v[64:67], v[16:19]
    s_waitcnt vmcnt(28)
    v_mfma_f32_16x16x32_bf16 v[40:43], v[164:167], v[92:95], v[40:43]
    v_mfma_f32_16x16x32_bf16 v[28:31], v[164:167], v[68:71], v[28:31]
    s_waitcnt vmcnt(27)
    v_mfma_f32_16x16x32_bf16 v[40:43], v[168:171], v[96:99], v[40:43]
    v_mfma_f32_16x16x32_bf16 v[28:31], v[168:171], v[72:75], v[28:31]
    s_waitcnt vmcnt(26)
    v_mfma_f32_16x16x32_bf16 v[40:43], v[172:175], v[100:103], v[40:43]
    v_mfma_f32_16x16x32_bf16 v[28:31], v[172:175], v[76:79], v[28:31]
    s_waitcnt vmcnt(25)
    v_mfma_f32_16x16x32_bf16 v[40:43], v[176:179], v[104:107], v[40:43]
    v_mfma_f32_16x16x32_bf16 v[28:31], v[176:179], v[80:83], v[28:31]
    s_waitcnt vmcnt(24)
    v_mfma_f32_16x16x32_bf16 v[40:43], v[180:183], v[108:111], v[40:43]
    v_mfma_f32_16x16x32_bf16 v[28:31], v[180:183], v[84:87], v[28:31]
M_x_nq2:
    s_nop 6
    v_max3_f32 v20, v32, v33, v34
    v_max3_f32 v20, v20, v35, v36
    v_max3_f32 v20, v20, v37, v38
    v_max3_f32 v20, v20, v39, v40
    v_max3_f32 v20, v20, v41, v42
    v_max_f32 v20, v20, v43
    v_mov_b32 v21, v20
    s_nop 1
    v_permlane32_swap_b32 v20, v21
    v_max_f32 v20, v20, v21
    v_mov_b32 v21, v20
    s_nop 1
    v_permlane16_swap_b32 v20, v21
    v_max_f32 v20, v20, v21
    v_mul_f32 v20, s42, v20
    v_fma_f32 v32, v32, s42, -v20
    v_fma_f32 v33, v33, s42, -v20
    v_fma_f32 v34, v34, s42, -v20
    v_fma_f32 v35, v35, s42, -v20
    v_fma_f32 v36, v36, s42, -v20
    v_fma_f32 v37, v37, s42, -v20
    v_fma_f32 v38, v38, s42, -v20
    v_fma_f32 v39, v39, s42, -v20
    v_fma_f32 v40, v40, s42, -v20
    v_fma_f32 v41, v41, s42, -v20
    v_fma_f32 v42, v42, s42, -v20
    v_fma_f32 v43, v43, s42, -v20
    v_exp_f32 v32, v32
    v_exp_f32 v33, v33
    v_exp_f32 v34, v34
    v_exp_f32 v35, v35
    v_exp_f32 v36, v36
    v_exp_f32 v37, v37
    v_exp_f32 v38, v38
    v_exp_f32 v39, v39
    v_exp_f32 v40, v40
    v_exp_f32 v41, v41
    v_exp_f32 v42, v42
    v_exp_f32 v43, v43
    v_pk_add_f32 v[20:21], v[32:33], v[34:35]
    v_pk_add_f32 v[20:21], v[20:21], v[36:37]
    v_pk_add_f32 v[20:21], v[20:21], v[38:39]
    v_pk_add_f32 v[20:21], v[20:21], v[40:41]
    v_pk_add_f32 v[20:21], v[20:21], v[42:43]
    v_add_f32 v20, v20, v21
    v_mov_b32 v21, v20
    s_nop 1
    v_permlane32_swap_b32 v20, v21
    v_add_f32 v20, v20, v21
    v_mov_b32 v21, v20
    s_nop 1
    v_permlane16_swap_b32 v20, v21
    v_add_f32 v20, v20, v21
    v_rcp_f32 v20, v20
    s_nop 0
    v_pk_mul_f32 v[32:33], v[32:33], v[20:21] op_sel_hi:[1,0]
    v_pk_mul_f32 v[34:35], v[34:35], v[20:21] op_sel_hi:[1,0]
    v_pk_mul_f32 v[36:37], v[36:37], v[20:21] op_sel_hi:[1,0]
    v_pk_mul_f32 v[38:39], v[38:39], v[20:21] op_sel_hi:[1,0]
    v_pk_mul_f32 v[40:41], v[40:41], v[20:21] op_sel_hi:[1,0]
    v_pk_mul_f32 v[42:43], v[42:43], v[20:21] op_sel_hi:[1,0]
    v_cvt_pk_bf16_f32 v56, v32, v33
    v_cvt_pk_bf16_f32 v57, v34, v35
    v_cvt_pk_bf16_f32 v58, v36, v37
    v_cvt_pk_bf16_f32 v59, v38, v39
    v_cvt_pk_bf16_f32 v60, v40, v41
    v_cvt_pk_bf16_f32 v61, v42, v43
    buffer_store_dwordx4 v[56:59], v2, s[8:11], s47 offen offset:1024 sc1
    buffer_store_dwordx2 v[60:61], v11, s[8:11], s46 offen offset:1024 sc1
    v_max3_f32 v44, v24, v25, v26
    v_max3_f32 v44, v44, v27, v28
    v_max3_f32 v44, v44, v29, v30
    v_max_f32 v44, v44, v31
    v_mov_b32 v45, v44
    s_nop 1
    v_permlane32_swap_b32 v44, v45
    v_max_f32 v44, v44, v45
    v_mov_b32 v45, v44
    s_nop 1
    v_permlane16_swap_b32 v44, v45
    v_max_f32 v44, v44, v45
    v_mul_f32 v44, s42, v44
    v_fma_f32 v24, v24, s42, -v44
    v_fma_f32 v25, v25, s42, -v44
    v_fma_f32 v26, v26, s42, -v44
    v_fma_f32 v27, v27, s42, -v44
    v_fma_f32 v28, v28, s42, -v44
    v_fma_f32 v29, v29, s42, -v44
    v_fma_f32 v30, v30, s42, -v44
    v_fma_f32 v31, v31, s42, -v44
    v_exp_f32 v24, v24
    v_exp_f32 v25, v25
    v_exp_f32 v26, v26
    v_exp_f32 v27, v27
    v_exp_f32 v28, v28
    v_exp_f32 v29, v29
    v_exp_f32 v30, v30
    v_exp_f32 v31, v31
    v_pk_add_f32 v[44:45], v[24:25], v[26:27]
    v_pk_add_f32 v[44:45], v[44:45], v[28:29]
    v_pk_add_f32 v[44:45], v[44:45], v[30:31]
    v_add_f32 v44, v44, v45
    v_mov_b32 v45, v44
    s_nop 1
    v_permlane32_swap_b32 v44, v45
    v_add_f32 v44, v44, v45
    v_mov_b32 v45, v44
    s_nop 1
    v_permlane16_swap_b32 v44, v45
    v_add_f32 v44, v44, v45
    v_rcp_f32 v44, v44
    s_nop 0
    v_pk_mul_f32 v[24:25], v[24:25], v[44:45] op_sel_hi:[1,0]
    v_pk_mul_f32 v[26:27], v[26:27], v[44:45] op_sel_hi:[1,0]
    v_pk_mul_f32 v[28:29], v[28:29], v[44:45] op_sel_hi:[1,0]
    v_pk_mul_f32 v[30:31], v[30:31], v[44:45] op_sel_hi:[1,0]
    v_cvt_pk_bf16_f32 v48, v24, v25
    v_cvt_pk_bf16_f32 v49, v26, v27
    v_cvt_pk_bf16_f32 v52, v28, v29
    v_cvt_pk_bf16_f32 v53, v30, v31
    buffer_store_dwordx4 v[48:51], v2, s[8:11], s47 offen sc1
    buffer_store_dwordx2 v[52:53], v11, s[8:11], s46 offen sc1
    s_add_u32 s28, s44, 0xc0000
    s_add_u32 s28, s28, s56
    s_add_u32 s44, s44, 4096
    buffer_load_dword v63, v22, s[8:11], s44 offen sc1
    s_add_u32 s45, s45, 98304
    s_add_u32 s46, s46, 81920
    s_add_u32 s47, s47, 81920
    s_waitcnt vmcnt(1)
    buffer_store_dword v9, v8, s[8:11], s28 offen sc1
    s_add_u32 s22, s22, 1
    s_waitcnt vmcnt(1)
    s_cmp_ge_u32 s22, s26
    s_cbranch_scc1 M_xd
M_x_loop1:
    v_cmp_eq_u32 vcc, 0, v63
    v_mfma_f32_16x16x32_bf16 v[24:27], a[48:51], a[0:3], v[12:15]
    v_mfma_f32_16x16x32_bf16 v[32:35], a[48:51], a[24:27], 0
    v_mfma_f32_16x16x32_bf16 v[36:39], a[72:75], a[24:27], v[12:15]
    v_mfma_f32_16x16x32_bf16 v[24:27], a[52:55], a[4:7], v[24:27]
    v_mfma_f32_16x16x32_bf16 v[32:35], a[52:55], a[28:31], v[32:35]
    v_mfma_f32_16x16x32_bf16 v[36:39], a[76:79], a[28:31], v[36:39]
    v_mfma_f32_16x16x32_bf16 v[24:27], a[56:59], a[8:11], v[24:27]
    v_mfma_f32_16x16x32_bf16 v[32:35], a[56:59], a[32:35], v[32:35]
    v_mfma_f32_16x16x32_bf16 v[36:39], a[80:83], a[32:35], v[36:39]
    v_mfma_f32_16x16x32_bf16 v[24:27], a[60:63], a[12:15], v[24:27]
    v_mfma_f32_16x16x32_bf16 v[32:35], a[60:63], a[36:39], v[32:35]
    v_mfma_f32_16x16x32_bf16 v[36:39], a[84:87], a[36:39], v[36:39]
    v_mfma_f32_16x16x32_bf16 v[24:27], a[64:67], a[16:19], v[24:27]
    v_mfma_f32_16x16x32_bf16 v[32:35], a[64:67], a[40:43], v[32:35]
    v_mfma_f32_16x16x32_bf16 v[36:39], a[88:91], a[40:43], v[36:39]
    v_mfma_f32_16x16x32_bf16 v[24:27], a[68:71], a[20:23], v[24:27]
    v_mfma_f32_16x16x32_bf16 v[32:35], a[68:71], a[44:47], v[32:35]
    v_mfma_f32_16x16x32_bf16 v[36:39], a[92:95], a[44:47], v[36:39]
    s_cbranch_vccz M_x_go1
    s_mov_b32 s39, 0
M_x_f21:
    buffer_load_dword v20, v22, s[8:11], s44 offen sc1
    s_add_u32 s39, s39, 1
    s_cmp_gt_u32 s39, 400000
    s_cbranch_scc1 M_fail
    s_waitcnt vmcnt(0)
    v_cmp_eq_u32 vcc, 0, v20
    s_cbranch_vccz M_x_f21_ok
    s_sleep 1
    s_cmp_ge_i32 s22, 58
    s_cbranch_scc1 M_x_f21
    s_sleep 3
    s_branch M_x_f21
M_x_f21_ok:
M_x_go1:
    buffer_load_dwordx4 v[160:163], v10, s[8:11], s45 offen offset:0 sc1
    buffer_load_dwordx4 v[164:167], v10, s[8:11], s45 offen offset:512 sc1
    buffer_load_dwordx4 v[168:171], v10, s[8:11], s45 offen offset:1024 sc1
    buffer_load_dwordx4 v[172:175], v10, s[8:11], s45 offen offset:1536 sc1
    buffer_load_dwordx4 v[176:179], v10, s[8:11], s45 offen offset:2048 sc1
    buffer_load_dwordx4 v[180:183], v10, s[8:11], s45 offen offset:2560 sc1
    s_add_u32 s28, s33, 0
    buffer_load_dwordx4 v[64:67], v2, s[8:11], s28 offen offset:0 sc1
    buffer_load_dwordx4 v[68:71], v2, s[8:11], s28 offen offset:1024 sc1
    buffer_load_dwordx4 v[72:75], v2, s[8:11], s28 offen offset:2048 sc1
    buffer_load_dwordx4 v[76:79], v2, s[8:11], s28 offen offset:3072 sc1
    s_add_u32 s28, s33, 4096
    buffer_load_dwordx4 v[80:83], v2, s[8:11], s28 offen offset:0 sc1
    buffer_load_dwordx4 v[84:87], v2, s[8:11], s28 offen offset:1024 sc1
    buffer_load_dwordx4 v[88:91], v2, s[8:11], s28 offen offset:2048 sc1
    buffer_load_dwordx4 v[92:95], v2, s[8:11], s28 offen offset:3072 sc1
    s_add_u32 s28, s33, 8192
    buffer_load_dwordx4 v[96:99], v2, s[8:11], s28 offen offset:0 sc1
    buffer_load_dwordx4 v[100:103], v2, s[8:11], s28 offen offset:1024 sc1
    buffer_load_dwordx4 v[104:107], v2, s[8:11], s28 offen offset:2048 sc1
    buffer_load_dwordx4 v[108:111], v2, s[8:11], s28 offen offset:3072 sc1
    s_add_u32 s28, s33, 12288
    buffer_load_dwordx4 v[112:115], v2, s[8:11], s28 offen offset:0 sc1
    buffer_load_dwordx4 v[116:119], v2, s[8:11], s28 offen offset:1024 sc1
    buffer_load_dwordx4 v[120:123], v2, s[8:11], s28 offen offset:2048 sc1
    buffer_load_dwordx4 v[124:127], v2, s[8:11], s28 offen offset:3072 sc1
    s_add_u32 s28, s33, 16384
    buffer_load_dwordx4 v[128:131], v2, s[8:11], s28 offen offset:0 sc1
    buffer_load_dwordx4 v[132:135], v2, s[8:11], s28 offen offset:1024 sc1
    buffer_load_dwordx4 v[136:139], v2, s[8:11], s28 offen offset:2048 sc1
    buffer_load_dwordx4 v[140:143], v2, s[8:11], s28 offen offset:3072 sc1
    s_add_u32 s28, s33, 20480
    buffer_load_dwordx4 v[144:147], v2, s[8:11], s28 offen offset:0 sc1
    buffer_load_dwordx4 v[148:151], v2, s[8:11], s28 offen offset:1024 sc1
    buffer_load_dwordx4 v[152:155], v2, s[8:11], s28 offen offset:2048 sc1
    buffer_load_dwordx4 v[156:159], v2, s[8:11], s28 offen offset:3072 sc1
    s_add_u32 s33, s33, 786432
    s_nop 0
    s_waitcnt vmcnt(29)
    v_mfma_f32_16x16x32_bf16 v[40:43], v[160:163], a[24:27], v[16:19]
    v_mfma_f32_16x16x32_bf16 v[28:31], v[160:163], a[0:3], v[16:19]
    s_waitcnt vmcnt(28)
    v_mfma_f32_16x16x32_bf16 v[40:43], v[164:167], a[28:31], v[40:43]
    v_mfma_f32_16x16x32_bf16 v[28:31], v[164:167], a[4:7], v[28:31]
    s_waitcnt vmcnt(27)
    v_mfma_f32_16x16x32_bf16 v[40:43], v[168:171], a[32:35], v[40:43]
    v_mfma_f32_16x16x32_bf16 v[28:31], v[168:171], a[8:11], v[28:31]
    s_waitcnt vmcnt(26)
    v_mfma_f32_16x16x32_bf16 v[40:43], v[172:175], a[36:39], v[40:43]
    v_mfma_f32_16x16x32_bf16 v[28:31], v[172:175], a[12:15], v[28:31]
    s_waitcnt vmcnt(25)
    v_mfma_f32_16x16x32_bf16 v[40:43], v[176:179], a[40:43], v[40:43]
    v_mfma_f32_16x16x32_bf16 v[28:31], v[176:179], a[16:19], v[28:31]
    s_waitcnt vmcnt(24)
    v_mfma_f32_16x16x32_bf16 v[40:43], v[180:183], a[44:47], v[40:43]
    v_mfma_f32_16x16x32_bf16 v[28:31], v[180:183], a[20:23], v[28:31]
    s_nop 6
    v_max3_f32 v20, v32, v33, v34
    v_max3_f32 v20, v20, v35, v36
    v_max3_f32 v20, v20, v37, v38
    v_max3_f32 v20, v20, v39, v40
    v_max3_f32 v20, v20, v41, v42
    v_max_f32 v20, v20, v43
    v_mov_b32 v21, v20
    s_nop 1
    v_permlane32_swap_b32 v20, v21
    v_max_f32 v20, v20, v21
    v_mov_b32 v21, v20
    s_nop 1
    v_permlane16_swap_b32 v20, v21
    v_max_f32 v20, v20, v21
    v_mul_f32 v20, s42, v20
    v_fma_f32 v32, v32, s42, -v20
    v_fma_f32 v33, v33, s42, -v20
    v_fma_f32 v34, v34, s42, -v20
    v_fma_f32 v35, v35, s42, -v20
    v_fma_f32 v36, v36, s42, -v20
    v_fma_f32 v37, v37, s42, -v20
    v_fma_f32 v38, v38, s42, -v20
    v_fma_f32 v39, v39, s42, -v20
    v_fma_f32 v40, v40, s42, -v20
    v_fma_f32 v41, v41, s42, -v20
    v_fma_f32 v42, v42, s42, -v20
    v_fma_f32 v43, v43, s42, -v20
    v_exp_f32 v32, v32
    v_exp_f32 v33, v33
    v_exp_f32 v34, v34
    v_exp_f32 v35, v35
    v_exp_f32 v36, v36
    v_exp_f32 v37, v37
    v_exp_f32 v38, v38
    v_exp_f32 v39, v39
    v_exp_f32 v40, v40
    v_exp_f32 v41, v41
    v_exp_f32 v42, v42
    v_exp_f32 v43, v43
    v_pk_add_f32 v[20:21], v[32:33], v[34:35]
    v_pk_add_f32 v[20:21], v[20:21], v[36:37]
    v_pk_add_f32 v[20:21], v[20:21], v[38:39]
    v_pk_add_f32 v[20:21], v[20:21], v[40:41]
    v_pk_add_f32 v[20:21], v[20:21], v[42:43]
    v_add_f32 v20, v20, v21
    v_mov_b32 v21, v20
    s_nop 1
    v_permlane32_swap_b32 v20, v21
    v_add_f32 v20, v20, v21
    v_mov_b32 v21, v20
    s_nop 1
    v_permlane16_swap_b32 v20, v21
    v_add_f32 v20, v20, v21
    v_rcp_f32 v20, v20
    s_nop 0
    v_pk_mul_f32 v[32:33], v[32:33], v[20:21] op_sel_hi:[1,0]
    v_pk_mul_f32 v[34:35], v[34:35], v[20:21] op_sel_hi:[1,0]
    v_pk_mul_f32 v[36:37], v[36:37], v[20:21] op_sel_hi:[1,0]
    v_pk_mul_f32 v[38:39], v[38:39], v[20:21] op_sel_hi:[1,0]
    v_pk_mul_f32 v[40:41], v[40:41], v[20:21] op_sel_hi:[1,0]
    v_pk_mul_f32 v[42:43], v[42:43], v[20:21] op_sel_hi:[1,0]
    v_cvt_pk_bf16_f32 v56, v32, v33
    v_cvt_pk_bf16_f32 v57, v34, v35
    v_cvt_pk_bf16_f32 v58, v36, v37
    v_cvt_pk_bf16_f32 v59, v38, v39
    v_cvt_pk_bf16_f32 v60, v40, v41
    v_cvt_pk_bf16_f32 v61, v42, v43
    buffer_store_dwordx4 v[56:59], v2, s[8:11], s47 offen offset:1024 sc1
    buffer_store_dwordx2 v[60:61], v11, s[8:11], s46 offen offset:1024 sc1
    v_max3_f32 v44, v24, v25, v26
    v_max3_f32 v44, v44, v27, v28
    v_max3_f32 v44, v44, v29, v30
    v_max_f32 v44, v44, v31
    v_mov_b32 v45, v44
    s_nop 1
    v_permlane32_swap_b32 v44, v45
    v_max_f32 v44, v44, v45
    v_mov_b32 v45, v44
    s_nop 1
    v_permlane16_swap_b32 v44, v45
    v_max_f32 v44, v44, v45
    v_mul_f32 v44, s42, v44
    v_fma_f32 v24, v24, s42, -v44
    v_fma_f32 v25, v25, s42, -v44
    v_fma_f32 v26, v26, s42, -v44
    v_fma_f32 v27, v27, s42, -v44
    v_fma_f32 v28, v28, s42, -v44
    v_fma_f32 v29, v29, s42, -v44
    v_fma_f32 v30, v30, s42, -v44
    v_fma_f32 v31, v31, s42, -v44
    v_exp_f32 v24, v24
    v_exp_f32 v25, v25
    v_exp_f32 v26, v26
    v_exp_f32 v27, v27
    v_exp_f32 v28, v28
    v_exp_f32 v29, v29
    v_exp_f32 v30, v30
    v_exp_f32 v31, v31
    v_pk_add_f32 v[44:45], v[24:25], v[26:27]
    v_pk_add_f32 v[44:45], v[44:45], v[28:29]
    v_pk_add_f32 v[44:45], v[44:45], v[30:31]
    v_add_f32 v44, v44, v45
    v_mov_b32 v45, v44
    s_nop 1
    v_permlane32_swap_b32 v44, v45
    v_add_f32 v44, v44, v45
    v_mov_b32 v45, v44
    s_nop 1
    v_permlane16_swap_b32 v44, v45
    v_add_f32 v44, v44, v45
    v_rcp_f32 v44, v44
    s_nop 0
    v_pk_mul_f32 v[24:25], v[24:25], v[44:45] op_sel_hi:[1,0]
    v_pk_mul_f32 v[26:27], v[26:27], v[44:45] op_sel_hi:[1,0]
    v_pk_mul_f32 v[28:29], v[28:29], v[44:45] op_sel_hi:[1,0]
    v_pk_mul_f32 v[30:31], v[30:31], v[44:45] op_sel_hi:[1,0]
    v_cvt_pk_bf16_f32 v48, v24, v25
    v_cvt_pk_bf16_f32 v49, v26, v27
    v_cvt_pk_bf16_f32 v52, v28, v29
    v_cvt_pk_bf16_f32 v53, v30, v31
    buffer_store_dwordx4 v[48:51], v2, s[8:11], s47 offen sc1
    buffer_store_dwordx2 v[52:53], v11, s[8:11], s46 offen sc1
    s_add_u32 s28, s44, 0xc0000
    s_add_u32 s28, s28, s56
    s_add_u32 s44, s44, 4096
    buffer_load_dword v63, v22, s[8:11], s44 offen sc1
    s_add_u32 s45, s45, 98304
    s_add_u32 s46, s46, 81920
    s_add_u32 s47, s47, 81920
    s_waitcnt vmcnt(1)
    buffer_store_dword v9, v8, s[8:11], s28 offen sc1
    s_add_u32 s22, s22, 1
    s_waitcnt vmcnt(1)
    s_branch M_x_loop0
M_xd:
    s_cmp_eq_u32 s26, 64
    s_cbranch_scc1 M_g3
    s_branch M_end
M_c:
    v_mov_b32 v16, 128
    s_mov_b32 s39, 0
L_go_4:
    buffer_load_dword v17, v16, s[88:91], 0 offen sc1
    buffer_load_dword v18, v16, s[88:91], 0 offen offset:12 sc1
    s_add_u32 s39, s39, 1
    s_cmp_gt_u32 s39, 400000
    s_cbranch_scc1 M_fail
    s_waitcnt vmcnt(0)
    v_cmp_eq_u32 vcc, 0, v18
    s_cbranch_vccnz L_go_4
    v_readfirstlane_b32 s28, v18
    s_cmp_lg_u32 s28, s23
    s_cbranch_scc1 M_redo
    v_cmp_ne_u32 vcc, 0, v17
    s_cbranch_vccnz L_go_4k
    s_sleep 3
    s_branch L_go_4
L_go_4k:
    v_readfirstlane_b32 s53, v17
    s_sub_u32 s53, s53, 1
    s_and_b32 s53, s53, 1
    s_lshl_b32 s52, s53, 13
    s_add_u32 s52, s52, 0xa00000
    s_xor_b32 s56, s53, 1
    s_lshl_b32 s56, s56, 13
    s_lshr_b32 s55, s25, 2
    s_and_b32 s55, s55, 15
    s_mul_i32 s55, s55, 256
    s_mov_b32 s58, 0
    v_lshlrev_b32 v2, 4, v1
    v_and_b32 v4, 7, v1
    v_bfe_u32 v5, v1, 3, 1
    v_lshrrev_b32 v6, 4, v1
    s_mul_i32 s28, s21, 5120
    v_mul_u32_u24 v7, 640, v5
    v_lshl_add_u32 v7, v6, 7, v7
    v_lshl_add_u32 v7, v4, 4, v7
    v_add_u32 v7, s28, v7
    v_add_u32 v16, 0, v7
    v_add_u32 v17, 1280, v7
    v_add_u32 v18, 2560, v7
    v_add_u32 v19, 3840, v7
    v_lshl_add_u32 v7, v5, 2, v6
    v_mul_u32_u24 v7, 640, v7
    v_lshl_add_u32 v7, v4, 4, v7
    s_add_u32 s28, s28, 512
    v_add_u32 v20, s28, v7
    v_lshrrev_b32 v7, 13, v16
    v_lshlrev_b32 v7, 13, v7
    v_add_u32 v16, v16, v7
    v_lshrrev_b32 v7, 13, v17
    v_lshlrev_b32 v7, 13, v7
    v_add_u32 v17, v17, v7
    v_lshrrev_b32 v7, 13, v18
    v_lshlrev_b32 v7, 13, v7
    v_add_u32 v18, v18, v7
    v_lshrrev_b32 v7, 13, v19
    v_lshlrev_b32 v7, 13, v7
    v_add_u32 v19, v19, v7
    v_lshrrev_b32 v7, 13, v20
    v_lshlrev_b32 v7, 13, v7
    v_add_u32 v20, v20, v7
    s_lshl_b32 s28, s21, 10
    v_lshlrev_b32 v21, 7, v4
    v_add_u32 v21, s28, v21
    v_lshlrev_b32 v28, 5, v6
    v_bfe_u32 v7, v1, 2, 1
    v_lshl_add_u32 v28, v7, 4, v28
    v_lshl_add_u32 v28, v5, 9, v28
    v_bfe_u32 v7, v1, 1, 1
    v_lshl_add_u32 v28, v7, 8, v28
    v_and_b32 v7, 1, v1
    v_lshl_add_u32 v28, v7, 3, v28
    v_lshlrev_b32 v22, 2, v1
    s_lshl_b32 s28, s20, 8
    s_add_u32 s28, s28, 20480
    v_add_u32 v22, s28, v22
    v_lshrrev_b32 v7, 13, v22
    v_lshlrev_b32 v7, 13, v7
    v_add_u32 v22, v22, v7
    v_mov_b32 v7, 0x7ff00000
    v_cmp_ne_u32 s[44:45], 0, v5
    s_nop 1
    s_lshl_b32 s28, s21, 10
    v_add_u32 v23, s28, v2
    s_lshl_b32 s42, s20, 15
    s_lshl_b32 s28, s21, 13
    s_add_u32 s42, s42, s28
    s_add_u32 s42, s42, 0x4000000
    s_lshl_b32 s48, s20, 14
    s_lshl_b32 s28, s21, 11
    s_add_u32 s48, s48, s28
    s_add_u32 s48, s48, 0xc000000
    v_mul_u32_u24 v26, 256, v1
    v_add_u32 v26, 0xa4000, v26
    s_cmp_eq_u32 s20, 0
    s_cselect_b32 s28, 16, 0
    s_cmp_eq_u32 s21, 1
    s_cselect_b32 s28, s28, 0
    v_cmp_gt_u32 vcc, s28, v1
    s_nop 1
    v_cndmask_b32 v26, v7, v26, vcc
    s_mov_b32 s46, 0x800000
    s_mov_b32 s22, 0
    v_and_b32 v21, 31, v1
    v_lshlrev_b32 v21, 7, v21
    v_mov_b32 v25, 0
    s_lshl_b32 s28, s21, 13
    s_sub_u32 s42, s42, s28
    s_add_u32 s28, s28, 8192
    v_add_u32 v3, s28, v2
    s_mul_i32 s50, s21, 11264
    s_min_u32 s50, s50, 21504
    s_add_u32 s42, s42, s50
    s_add_u32 s50, s50, 8192
M_c_loop:
    s_lshr_b32 s28, s22, 1
    s_xor_b32 s28, s28, s53
    s_and_b32 s28, s28, 1
    s_xor_b32 s28, s28, 1
    s_lshl_b32 s28, s28, 13
    s_lshl_b32 s43, s22, 20
    s_add_u32 s43, s43, s28
    s_add_u32 s43, s43, s48
    s_lshr_b32 s28, s22, 1
    s_xor_b32 s28, s28, s53
    s_and_b32 s28, s28, 1
    s_xor_b32 s28, s28, 1
    s_lshl_b32 s28, s28, 13
    s_lshl_b32 s40, s22, 20
    s_add_u32 s40, s40, s28
    s_add_u32 s40, s40, 0xc0c0000
    v_mov_b32 v27, s22
    s_cmp_eq_u32 s21, 3
    s_cbranch_scc1 M_c_w3
    s_barrier
    s_add_u32 m0, s50, 0
    s_add_u32 s28, s42, 0
    buffer_load_dwordx4 v2, s[8:11], s28 offen offset:0 sc1 lds
    buffer_load_dwordx4 v2, s[8:11], s28 offen offset:1024 sc1 lds
    buffer_load_dwordx4 v2, s[8:11], s28 offen offset:2048 sc1 lds
    buffer_load_dwordx4 v2, s[8:11], s28 offen offset:3072 sc1 lds
    s_add_u32 m0, s50, 4096
    s_add_u32 s28, s42, 4096
    buffer_load_dwordx4 v2, s[8:11], s28 offen offset:0 sc1 lds
    buffer_load_dwordx4 v2, s[8:11], s28 offen offset:1024 sc1 lds
    buffer_load_dwordx4 v2, s[8:11], s28 offen offset:2048 sc1 lds
    buffer_load_dwordx4 v2, s[8:11], s28 offen offset:3072 sc1 lds
    s_add_u32 m0, s50, 8192
    s_add_u32 s28, s42, 8192
    buffer_load_dwordx4 v2, s[8:11], s28 offen offset:0 sc1 lds
    buffer_load_dwordx4 v2, s[8:11], s28 offen offset:1024 sc1 lds
    buffer_load_dwordx4 v2, s[8:11], s28 offen offset:2048 sc1 lds
    s_add_u32 s42, s42, 1310720
    s_nop 0
    s_waitcnt vmcnt(0)
    s_branch M_c_go
M_c_w3:
    s_cmp_lg_u32 s22, 0
    s_cbranch_scc1 M_c_n0
    s_mov_b32 s39, 0
M_c_f00:
    buffer_load_dword v24, v21, s[8:11], s46 offen sc1
    s_add_u32 s39, s39, 1
    s_cmp_gt_u32 s39, 400000
    s_cbranch_scc1 M_fail
    s_waitcnt vmcnt(0)
    v_cmp_eq_u32 vcc, 0, v24
    s_cbranch_vccz M_c_f00_ok
    s_sleep 1
    s_branch M_c_f00
M_c_f00_ok:
    s_add_u32 s47, s56, 0x8c0000
    buffer_load_dword v24, v21, s[8:11], s47 offen sc1
    s_barrier
    s_add_u32 s46, s46, 4096
    s_waitcnt vmcnt(0)
    v_cmp_eq_u32 vcc, 0, v24
    s_cbranch_vccz M_c_go
    s_mov_b32 s39, 0
M_c_f0:
    buffer_load_dword v24, v21, s[8:11], s47 offen sc1
    s_add_u32 s39, s39, 1
    s_cmp_gt_u32 s39, 400000
    s_cbranch_scc1 M_fail
    s_waitcnt vmcnt(0)
    v_cmp_eq_u32 vcc, 0, v24
    s_cbranch_vccz M_c_f0_ok
    s_sleep 1
    s_branch M_c_f0
M_c_f0_ok:
    s_branch M_c_go
M_c_n0:
    s_sub_u32 s47, s22, 1
    s_add_u32 s28, s55, 0xa4000
    v_mov_b32 v108, s28
    s_mov_b32 s39, 0
    s_waitcnt vmcnt(0)
    buffer_load_dword v109, v108, s[8:11], s52 offen sc1
    s_nop 15
    buffer_load_dword v110, v108, s[8:11], s52 offen sc1
M_c_g_hu:
    s_waitcnt vmcnt(1)
    v_cmp_gt_i32 vcc, s47, v109
    s_cbranch_vccz M_c_g_hud
    buffer_load_dword v109, v108, s[8:11], s52 offen sc1
    s_waitcnt vmcnt(1)
    v_cmp_gt_i32 vcc, s47, v110
    s_cbranch_vccz M_c_g_hud
    buffer_load_dword v110, v108, s[8:11], s52 offen sc1
    s_add_u32 s39, s39, 1
    s_cmp_gt_u32 s39, 400000
    s_cbranch_scc1 M_fail
    s_branch M_c_g_hu
M_c_g_hud:
    v_cmp_eq_u32 vcc, 0, v25
    s_cbranch_vccz M_c_fk
    s_mov_b32 s39, 0
M_c_fl:
    buffer_load_dword v24, v21, s[8:11], s46 offen sc1
    s_add_u32 s39, s39, 1
    s_cmp_gt_u32 s39, 400000
    s_cbranch_scc1 M_fail
    s_waitcnt vmcnt(0)
    v_cmp_eq_u32 vcc, 0, v24
    s_cbranch_vccz M_c_fl_ok
    s_sleep 2
    s_branch M_c_fl
M_c_fl_ok:
    s_branch M_c_tg
M_c_fk:
    buffer_load_dword v109, v108, s[8:11], s52 offen sc1
    s_waitcnt vmcnt(0)
M_c_tg:
    s_barrier
    s_add_u32 s46, s46, 4096
    buffer_load_dword v25, v21, s[8:11], s46 offen sc1
    s_add_u32 s28, s40, 0xe0000
    s_add_u32 s28, s55, 0xa0000
    v_mov_b32 v108, s28
    s_mov_b32 s39, 0
    s_waitcnt vmcnt(0)
    buffer_load_dword v109, v108, s[8:11], s52 offen sc1
    s_nop 15
    buffer_load_dword v110, v108, s[8:11], s52 offen sc1
    s_nop 15
    buffer_load_dword v111, v108, s[8:11], s52 offen sc1
M_c_hu:
    s_waitcnt vmcnt(2)
    v_cmp_gt_i32 vcc, s22, v109
    s_cbranch_vccz M_c_hud
    buffer_load_dword v109, v108, s[8:11], s52 offen sc1
    s_waitcnt vmcnt(2)
    v_cmp_gt_i32 vcc, s22, v110
    s_cbranch_vccz M_c_hud
    buffer_load_dword v110, v108, s[8:11], s52 offen sc1
    s_waitcnt vmcnt(2)
    v_cmp_gt_i32 vcc, s22, v111
    s_cbranch_vccz M_c_hud
    buffer_load_dword v111, v108, s[8:11], s52 offen sc1
    s_add_u32 s39, s39, 1
    s_cmp_gt_u32 s39, 400000
    s_cbranch_scc1 M_fail
    s_branch M_c_hu
M_c_hud:
M_c_go:
    s_barrier
    s_mov_b32 s39, 1
    buffer_load_dwordx4 v[64:67], v2, s[8:11], s43 offen offset:0 sc1
    buffer_load_dwordx4 v[68:71], v2, s[8:11], s43 offen offset:1024 sc1
    s_barrier
    buffer_load_dwordx4 v[72:75], v16, s[8:11], s40 offen sc1
    s_barrier
    buffer_load_dwordx4 v[76:79], v17, s[8:11], s40 offen sc1
    s_barrier
    buffer_load_dwordx4 v[80:83], v18, s[8:11], s40 offen sc1
    s_barrier
    buffer_load_dwordx4 v[84:87], v19, s[8:11], s40 offen sc1
    s_barrier
    buffer_load_dwordx4 v[88:91], v20, s[8:11], s40 offen sc1
    ds_read_b128 v[32:35], v3 offset:0
    ds_read_b128 v[36:39], v3 offset:1024
    ds_read_b128 v[40:43], v3 offset:2048
    ds_read_b128 v[44:47], v3 offset:3072
    ds_read_b128 v[48:51], v3 offset:4096
    ds_read_b128 v[52:55], v3 offset:5120
    ds_read_b128 v[56:59], v3 offset:6144
    ds_read_b128 v[60:63], v3 offset:7168
    s_waitcnt vmcnt(5) lgkmcnt(0)
    v_max3_u32 v24, v64, v65, v66
    v_max3_u32 v24, v24, v67, v68
    v_max3_u32 v24, v24, v69, v70
    v_max_u32 v24, v24, v71
    s_waitcnt vmcnt(4)
    v_mfma_f32_16x16x32_bf16 v[8:11], v[32:35], v[72:75], 0
    v_max3_u32 v24, v24, v72, v73
    v_mfma_f32_16x16x32_bf16 v[12:15], v[36:39], v[72:75], 0
    v_max3_u32 v24, v24, v74, v75
    s_waitcnt vmcnt(3)
    v_mfma_f32_16x16x32_bf16 v[8:11], v[40:43], v[76:79], v[8:11]
    v_max3_u32 v24, v24, v76, v77
    v_mfma_f32_16x16x32_bf16 v[12:15], v[44:47], v[76:79], v[12:15]
    v_max3_u32 v24, v24, v78, v79
    s_waitcnt vmcnt(2)
    v_mfma_f32_16x16x32_bf16 v[8:11], v[48:51], v[80:83], v[8:11]
    v_max3_u32 v24, v24, v80, v81
    v_mfma_f32_16x16x32_bf16 v[12:15], v[52:55], v[80:83], v[12:15]
    v_max3_u32 v24, v24, v82, v83
    s_waitcnt vmcnt(1)
    v_mfma_f32_16x16x32_bf16 v[8:11], v[56:59], v[84:87], v[8:11]
    v_max3_u32 v24, v24, v84, v85
    v_mfma_f32_16x16x32_bf16 v[12:15], v[60:63], v[84:87], v[12:15]
    v_max3_u32 v24, v24, v86, v87
    s_waitcnt vmcnt(0)
    v_mfma_f32_16x16x32_bf16 v[8:11], v[64:67], v[88:91], v[8:11]
    v_max3_u32 v24, v24, v88, v89
    v_mfma_f32_16x16x32_bf16 v[12:15], v[68:71], v[88:91], v[12:15]
    v_max3_u32 v24, v24, v90, v91
    v_cmp_eq_u32 vcc, -1, v24
    s_nop 5
    v_add_f32_dpp v8, v12, v8 row_ror:8 row_mask:0xf bank_mask:0xf
    v_add_f32_dpp v9, v13, v9 row_ror:8 row_mask:0xf bank_mask:0xf
    v_add_f32_dpp v10, v14, v10 row_ror:8 row_mask:0xf bank_mask:0xf
    v_add_f32_dpp v11, v15, v11 row_ror:8 row_mask:0xf bank_mask:0xf
    ds_write_b128 v23, v[8:11] offset:0
    s_cbranch_vccnz M_c_retry
M_c_ok:
    s_barrier
    buffer_store_dword v27, v26, s[8:11], s52 offen sc1
    s_cmp_lg_u32 s21, 0
    s_waitcnt lgkmcnt(0)
    s_barrier
    s_cbranch_scc1 M_c_nx
    ds_read_b64 v[96:97], v28 offset:0
    ds_read_b64 v[98:99], v28 offset:1024
    ds_read_b64 v[100:101], v28 offset:2048
    ds_read_b64 v[102:103], v28 offset:3072
    s_waitcnt lgkmcnt(2)
    v_pk_add_f32 v[96:97], v[96:97], v[98:99]
    s_waitcnt lgkmcnt(0)
    v_pk_add_f32 v[100:101], v[100:101], v[102:103]
    v_pk_add_f32 v[96:97], v[96:97], v[100:101]
    v_cvt_pk_bf16_f32 v8, v96, v97
    buffer_store_dword v8, v22, s[8:11], s40 offen sc1
M_c_nx:
    s_add_u32 s22, s22, 1
    s_cmp_lt_u32 s22, 63
    s_cbranch_scc1 M_c_loop
    s_branch M_g3
M_c_retry:
    s_mov_b64 exec, vcc
    buffer_load_dwordx4 v[64:67], v2, s[8:11], s43 offen offset:0 sc1
    buffer_load_dwordx4 v[68:71], v2, s[8:11], s43 offen offset:1024 sc1
    buffer_load_dwordx4 v[72:75], v16, s[8:11], s40 offen sc1
    buffer_load_dwordx4 v[76:79], v17, s[8:11], s40 offen sc1
    buffer_load_dwordx4 v[80:83], v18, s[8:11], s40 offen sc1
    buffer_load_dwordx4 v[84:87], v19, s[8:11], s40 offen sc1
    buffer_load_dwordx4 v[88:91], v20, s[8:11], s40 offen sc1
    s_mov_b64 exec, -1
    s_add_u32 s39, s39, 1
    s_cmp_gt_u32 s39, 400000
    s_cbranch_scc1 M_fail
    s_waitcnt vmcnt(5) lgkmcnt(0)
    v_max3_u32 v24, v64, v65, v66
    v_max3_u32 v24, v24, v67, v68
    v_max3_u32 v24, v24, v69, v70
    v_max_u32 v24, v24, v71
    s_waitcnt vmcnt(4)
    v_mfma_f32_16x16x32_bf16 v[8:11], v[32:35], v[72:75], 0
    v_max3_u32 v24, v24, v72, v73
    v_mfma_f32_16x16x32_bf16 v[12:15], v[36:39], v[72:75], 0
    v_max3_u32 v24, v24, v74, v75
    s_waitcnt vmcnt(3)
    v_mfma_f32_16x16x32_bf16 v[8:11], v[40:43], v[76:79], v[8:11]
    v_max3_u32 v24, v24, v76, v77
    v_mfma_f32_16x16x32_bf16 v[12:15], v[44:47], v[76:79], v[12:15]
    v_max3_u32 v24, v24, v78, v79
    s_waitcnt vmcnt(2)
    v_mfma_f32_16x16x32_bf16 v[8:11], v[48:51], v[80:83], v[8:11]
    v_max3_u32 v24, v24, v80, v81
    v_mfma_f32_16x16x32_bf16 v[12:15], v[52:55], v[80:83], v[12:15]
    v_max3_u32 v24, v24, v82, v83
    s_waitcnt vmcnt(1)
    v_mfma_f32_16x16x32_bf16 v[8:11], v[56:59], v[84:87], v[8:11]
    v_max3_u32 v24, v24, v84, v85
    v_mfma_f32_16x16x32_bf16 v[12:15], v[60:63], v[84:87], v[12:15]
    v_max3_u32 v24, v24, v86, v87
    s_waitcnt vmcnt(0)
    v_mfma_f32_16x16x32_bf16 v[8:11], v[64:67], v[88:91], v[8:11]
    v_max3_u32 v24, v24, v88, v89
    v_mfma_f32_16x16x32_bf16 v[12:15], v[68:71], v[88:91], v[12:15]
    v_max3_u32 v24, v24, v90, v91
    v_cmp_eq_u32 vcc, -1, v24
    s_cbranch_vccnz M_c_retry
    s_nop 5
    v_add_f32_dpp v8, v12, v8 row_ror:8 row_mask:0xf bank_mask:0xf
    v_add_f32_dpp v9, v13, v9 row_ror:8 row_mask:0xf bank_mask:0xf
    v_add_f32_dpp v10, v14, v10 row_ror:8 row_mask:0xf bank_mask:0xf
    v_add_f32_dpp v11, v15, v11 row_ror:8 row_mask:0xf bank_mask:0xf
    ds_write_b128 v23, v[8:11] offset:0
    s_branch M_c_ok
M_g3:
    s_cmp_lt_u32 s25, 224
    s_cselect_b32 s28, 8, 0
    s_add_u32 s28, s28, s25
    s_sub_u32 s28, s28, 96
    s_cmp_lt_u32 s25, 128
    s_cselect_b32 s20, s25, s28
    s_load_dwordx2 s[28:29], s[0:1], 96
    v_mbcnt_lo_u32_b32 v1, -1, 0
    v_mbcnt_hi_u32_b32 v1, -1, v1
    s_and_b32 s22, s20, 31
    s_lshr_b32 s20, s20, 5
    v_lshlrev_b32 v2, 4, v1
    v_mov_b32 v9, 0
    s_lshl_b32 s42, s20, 7
    s_add_u32 s42, s42, 0x9b4000
    s_waitcnt vmcnt(0) lgkmcnt(0)
    s_barrier
    s_mov_b32 s16, s28
    s_and_b32 s17, s29, 0xffff
    s_mov_b32 s18, 0x280000
    s_mov_b32 s19, 0x20000
    s_mov_b32 s39, 0
M_g3p_fw:
    buffer_load_dword v11, v9, s[8:11], s42 offen sc1
    s_add_u32 s39, s39, 1
    s_cmp_gt_u32 s39, 400000
    s_cbranch_scc1 M_fail
    s_waitcnt vmcnt(0)
    v_cmp_eq_u32 vcc, 0, v11
    s_cbranch_vccz M_g3p_fw_ok
    s_sleep 8
    s_branch M_g3p_fw
M_g3p_fw_ok:
    s_lshl_b32 s33, s20, 2
    s_add_u32 s33, s33, s21
    s_mul_i32 s34, s33, 49152
    s_add_u32 s34, s34, 0xa000000
    buffer_load_dwordx4 a[0:3], v2, s[8:11], s34 offen offset:0 sc1
    buffer_load_dwordx4 a[4:7], v2, s[8:11], s34 offen offset:1024 sc1
    buffer_load_dwordx4 a[8:11], v2, s[8:11], s34 offen offset:2048 sc1
    buffer_load_dwordx4 a[12:15], v2, s[8:11], s34 offen offset:3072 sc1
    s_add_u32 s34, s34, 4096
    buffer_load_dwordx4 a[16:19], v2, s[8:11], s34 offen offset:0 sc1
    buffer_load_dwordx4 a[20:23], v2, s[8:11], s34 offen offset:1024 sc1
    buffer_load_dwordx4 a[24:27], v2, s[8:11], s34 offen offset:2048 sc1
    buffer_load_dwordx4 a[28:31], v2, s[8:11], s34 offen offset:3072 sc1
    s_add_u32 s34, s34, 4096
    buffer_load_dwordx4 a[32:35], v2, s[8:11], s34 offen offset:0 sc1
    buffer_load_dwordx4 a[36:39], v2, s[8:11], s34 offen offset:1024 sc1
    buffer_load_dwordx4 a[40:43], v2, s[8:11], s34 offen offset:2048 sc1
    buffer_load_dwordx4 a[44:47], v2, s[8:11], s34 offen offset:3072 sc1
    s_add_u32 s34, s34, 4096
    buffer_load_dwordx4 a[48:51], v2, s[8:11], s34 offen offset:0 sc1
    buffer_load_dwordx4 a[52:55], v2, s[8:11], s34 offen offset:1024 sc1
    buffer_load_dwordx4 a[56:59], v2, s[8:11], s34 offen offset:2048 sc1
    buffer_load_dwordx4 a[60:63], v2, s[8:11], s34 offen offset:3072 sc1
    s_add_u32 s34, s34, 4096
    buffer_load_dwordx4 a[64:67], v2, s[8:11], s34 offen offset:0 sc1
    buffer_load_dwordx4 a[68:71], v2, s[8:11], s34 offen offset:1024 sc1
    buffer_load_dwordx4 a[72:75], v2, s[8:11], s34 offen offset:2048 sc1
    buffer_load_dwordx4 a[76:79], v2, s[8:11], s34 offen offset:3072 sc1
    s_add_u32 s34, s34, 4096
    buffer_load_dwordx4 a[80:83], v2, s[8:11], s34 offen offset:0 sc1
    buffer_load_dwordx4 a[84:87], v2, s[8:11], s34 offen offset:1024 sc1
    buffer_load_dwordx4 a[88:91], v2, s[8:11], s34 offen offset:2048 sc1
    buffer_load_dwordx4 a[92:95], v2, s[8:11], s34 offen offset:3072 sc1
    s_add_u32 s34, s34, 4096
    buffer_load_dwordx4 a[96:99], v2, s[8:11], s34 offen offset:0 sc1
    buffer_load_dwordx4 a[100:103], v2, s[8:11], s34 offen offset:1024 sc1
    buffer_load_dwordx4 a[104:107], v2, s[8:11], s34 offen offset:2048 sc1
    buffer_load_dwordx4 a[108:111], v2, s[8:11], s34 offen offset:3072 sc1
    s_add_u32 s34, s34, 4096
    buffer_load_dwordx4 a[112:115], v2, s[8:11], s34 offen offset:0 sc1
    buffer_load_dwordx4 a[116:119], v2, s[8:11], s34 offen offset:1024 sc1
    buffer_load_dwordx4 a[120:123], v2, s[8:11], s34 offen offset:2048 sc1
    buffer_load_dwordx4 a[124:127], v2, s[8:11], s34 offen offset:3072 sc1
    s_add_u32 s34, s34, 4096
    buffer_load_dwordx4 a[128:131], v2, s[8:11], s34 offen offset:0 sc1
    buffer_load_dwordx4 a[132:135], v2, s[8:11], s34 offen offset:1024 sc1
    buffer_load_dwordx4 a[136:139], v2, s[8:11], s34 offen offset:2048 sc1
    buffer_load_dwordx4 a[140:143], v2, s[8:11], s34 offen offset:3072 sc1
    s_add_u32 s34, s34, 4096
    buffer_load_dwordx4 a[144:147], v2, s[8:11], s34 offen offset:0 sc1
    buffer_load_dwordx4 a[148:151], v2, s[8:11], s34 offen offset:1024 sc1
    buffer_load_dwordx4 a[152:155], v2, s[8:11], s34 offen offset:2048 sc1
    buffer_load_dwordx4 a[156:159], v2, s[8:11], s34 offen offset:3072 sc1
    s_add_u32 s34, s34, 4096
    buffer_load_dwordx4 a[160:163], v2, s[8:11], s34 offen offset:0 sc1
    buffer_load_dwordx4 a[164:167], v2, s[8:11], s34 offen offset:1024 sc1
    buffer_load_dwordx4 a[168:171], v2, s[8:11], s34 offen offset:2048 sc1
    buffer_load_dwordx4 a[172:175], v2, s[8:11], s34 offen offset:3072 sc1
    s_add_u32 s34, s34, 4096
    buffer_load_dwordx4 a[176:179], v2, s[8:11], s34 offen offset:0 sc1
    buffer_load_dwordx4 a[180:183], v2, s[8:11], s34 offen offset:1024 sc1
    buffer_load_dwordx4 a[184:187], v2, s[8:11], s34 offen offset:2048 sc1
    buffer_load_dwordx4 a[188:191], v2, s[8:11], s34 offen offset:3072 sc1
    s_add_u32 s34, s34, 4096
    s_mul_i32 s32, s21, 24576
    v_and_b32 v8, 15, v1
    v_lshrrev_b32 v9, 4, v1
    v_mul_u32_u24 v8, 1280, v8
    v_and_b32 v10, 1, v9
    v_lshl_add_u32 v8, v10, 5, v8
    v_lshrrev_b32 v10, 1, v9
    v_lshl_add_u32 v8, v10, 4, v8
    s_mul_i32 s36, s22, 81920
    s_lshl_b32 s37, s33, 10
    s_add_u32 s37, s37, s36
    s_add_u32 s37, s37, 0xb000000
    s_lshl_b32 s28, s33, 6
    s_add_u32 s36, s36, s28
    v_and_b32 v9, 7, v1
    v_lshlrev_b32 v9, 7, v9
    s_lshl_b32 s42, s22, 10
    s_add_u32 s42, s42, 0x9ac000
    s_mul_i32 s34, s22, 98304
    s_add_u32 s34, s34, s32
    s_add_u32 s34, s34, 0xbc00000
    v_add_u32 v10, 49152, v2
    s_waitcnt vmcnt(0)
    s_cmp_lg_u32 s21, 0
    s_cbranch_scc1 M_g3p_go
    v_mov_b32 v12, 0
    s_add_u32 s43, s56, 0x997f00
    s_mov_b32 s39, 0
M_g3p_fe:
    buffer_load_dword v11, v12, s[8:11], s43 offen sc1
    s_add_u32 s39, s39, 1
    s_cmp_gt_u32 s39, 400000
    s_cbranch_scc1 M_fail
    s_waitcnt vmcnt(0)
    v_cmp_eq_u32 vcc, 0, v11
    s_cbranch_vccz M_g3p_fe_ok
    s_sleep 16
    s_branch M_g3p_fe
M_g3p_fe_ok:
    s_mov_b32 s39, 0
M_g3p_fy:
    buffer_load_dword v11, v9, s[8:11], s42 offen sc1
    s_add_u32 s39, s39, 1
    s_cmp_gt_u32 s39, 400000
    s_cbranch_scc1 M_fail
    s_waitcnt vmcnt(0)
    v_cmp_eq_u32 vcc, 0, v11
    s_cbranch_vccz M_g3p_fy_ok
    s_sleep 2
    s_branch M_g3p_fy
M_g3p_fy_ok:
M_g3p_go:
    s_barrier
    s_add_u32 m0, s32, 0
    s_add_u32 s28, s34, 0
    buffer_load_dwordx4 v2, s[8:11], s28 offen offset:0 sc1 lds
    buffer_load_dwordx4 v2, s[8:11], s28 offen offset:1024 sc1 lds
    buffer_load_dwordx4 v2, s[8:11], s28 offen offset:2048 sc1 lds
    buffer_load_dwordx4 v2, s[8:11], s28 offen offset:3072 sc1 lds
    s_add_u32 m0, s32, 4096
    s_add_u32 s28, s34, 4096
    buffer_load_dwordx4 v2, s[8:11], s28 offen offset:0 sc1 lds
    buffer_load_dwordx4 v2, s[8:11], s28 offen offset:1024 sc1 lds
    buffer_load_dwordx4 v2, s[8:11], s28 offen offset:2048 sc1 lds
    buffer_load_dwordx4 v2, s[8:11], s28 offen offset:3072 sc1 lds
    s_add_u32 m0, s32, 8192
    s_add_u32 s28, s34, 8192
    buffer_load_dwordx4 v2, s[8:11], s28 offen offset:0 sc1 lds
    buffer_load_dwordx4 v2, s[8:11], s28 offen offset:1024 sc1 lds
    buffer_load_dwordx4 v2, s[8:11], s28 offen offset:2048 sc1 lds
    buffer_load_dwordx4 v2, s[8:11], s28 offen offset:3072 sc1 lds
    s_waitcnt vmcnt(10)
    s_barrier
    ds_read_b128 v[64:67], v2 offset:0
    ds_read_b128 v[68:71], v2 offset:24576
    ds_read_b128 v[72:75], v10 offset:0
    ds_read_b128 v[76:79], v10 offset:24576
    ds_read_b128 v[80:83], v2 offset:1024
    ds_read_b128 v[84:87], v2 offset:25600
    s_waitcnt lgkmcnt(5)
    v_mfma_f32_16x16x32_bf16 v[32:35], a[0:3], v[64:67], 0
    ds_read_b128 v[88:91], v10 offset:1024
    v_mfma_f32_16x16x32_bf16 v[36:39], a[4:7], v[64:67], 0
    s_waitcnt lgkmcnt(4)
    s_add_u32 m0, s32, 12288
    s_add_u32 s28, s34, 12288
    v_mfma_f32_16x16x32_bf16 v[40:43], a[0:3], v[68:71], 0
    ds_read_b128 v[92:95], v10 offset:25600
    v_mfma_f32_16x16x32_bf16 v[44:47], a[4:7], v[68:71], 0
    buffer_load_dwordx4 v2, s[8:11], s28 offen offset:0 sc1 lds
    v_mfma_f32_16x16x32_bf16 v[48:51], a[0:3], v[72:75], 0
    s_waitcnt vmcnt(9)
    s_barrier
    v_mfma_f32_16x16x32_bf16 v[52:55], a[4:7], v[72:75], 0
    s_waitcnt lgkmcnt(3)
    ds_read_b128 v[96:99], v2 offset:2048
    v_mfma_f32_16x16x32_bf16 v[56:59], a[0:3], v[76:79], 0
    ds_read_b128 v[100:103], v2 offset:26624
    v_mfma_f32_16x16x32_bf16 v[60:63], a[4:7], v[76:79], 0
    buffer_load_dwordx4 v2, s[8:11], s28 offen offset:1024 sc1 lds
    v_mfma_f32_16x16x32_bf16 v[32:35], a[8:11], v[80:83], v[32:35]
    ds_read_b128 v[104:107], v10 offset:2048
    v_mfma_f32_16x16x32_bf16 v[36:39], a[12:15], v[80:83], v[36:39]
    s_waitcnt lgkmcnt(4)
    v_mfma_f32_16x16x32_bf16 v[40:43], a[8:11], v[84:87], v[40:43]
    ds_read_b128 v[108:111], v10 offset:26624
    v_mfma_f32_16x16x32_bf16 v[44:47], a[12:15], v[84:87], v[44:47]
    buffer_load_dwordx4 v2, s[8:11], s28 offen offset:2048 sc1 lds
    v_mfma_f32_16x16x32_bf16 v[48:51], a[8:11], v[88:91], v[48:51]
    ds_read_b128 v[64:67], v2 offset:3072
    v_mfma_f32_16x16x32_bf16 v[52:55], a[12:15], v[88:91], v[52:55]
    s_waitcnt lgkmcnt(4)
    v_mfma_f32_16x16x32_bf16 v[56:59], a[8:11], v[92:95], v[56:59]
    ds_read_b128 v[68:71], v2 offset:27648
    v_mfma_f32_16x16x32_bf16 v[60:63], a[12:15], v[92:95], v[60:63]
    buffer_load_dwordx4 v2, s[8:11], s28 offen offset:3072 sc1 lds
    v_mfma_f32_16x16x32_bf16 v[32:35], a[16:19], v[96:99], v[32:35]
    ds_read_b128 v[72:75], v10 offset:3072
    v_mfma_f32_16x16x32_bf16 v[36:39], a[20:23], v[96:99], v[36:39]
    s_waitcnt lgkmcnt(4)
    v_mfma_f32_16x16x32_bf16 v[40:43], a[16:19], v[100:103], v[40:43]
    ds_read_b128 v[76:79], v10 offset:27648
    v_mfma_f32_16x16x32_bf16 v[44:47], a[20:23], v[100:103], v[44:47]
    s_add_u32 m0, s32, 16384
    s_add_u32 s28, s34, 16384
    v_mfma_f32_16x16x32_bf16 v[48:51], a[16:19], v[104:107], v[48:51]
    s_waitcnt vmcnt(8)
    s_barrier
    v_mfma_f32_16x16x32_bf16 v[52:55], a[20:23], v[104:107], v[52:55]
    s_waitcnt lgkmcnt(3)
    ds_read_b128 v[80:83], v2 offset:4096
    v_mfma_f32_16x16x32_bf16 v[56:59], a[16:19], v[108:111], v[56:59]
    buffer_load_dwordx4 v2, s[8:11], s28 offen offset:0 sc1 lds
    ds_read_b128 v[84:87], v2 offset:28672
    v_mfma_f32_16x16x32_bf16 v[60:63], a[20:23], v[108:111], v[60:63]
    v_mfma_f32_16x16x32_bf16 v[32:35], a[24:27], v[64:67], v[32:35]
    ds_read_b128 v[88:91], v10 offset:4096
    v_mfma_f32_16x16x32_bf16 v[36:39], a[28:31], v[64:67], v[36:39]
    s_waitcnt lgkmcnt(4)
    buffer_load_dwordx4 v2, s[8:11], s28 offen offset:1024 sc1 lds
    v_mfma_f32_16x16x32_bf16 v[40:43], a[24:27], v[68:71], v[40:43]
    ds_read_b128 v[92:95], v10 offset:28672
    v_mfma_f32_16x16x32_bf16 v[44:47], a[28:31], v[68:71], v[44:47]
    v_mfma_f32_16x16x32_bf16 v[48:51], a[24:27], v[72:75], v[48:51]
    ds_read_b128 v[96:99], v2 offset:5120
    v_mfma_f32_16x16x32_bf16 v[52:55], a[28:31], v[72:75], v[52:55]
    s_waitcnt lgkmcnt(4)
    buffer_load_dwordx4 v2, s[8:11], s28 offen offset:2048 sc1 lds
    v_mfma_f32_16x16x32_bf16 v[56:59], a[24:27], v[76:79], v[56:59]
    ds_read_b128 v[100:103], v2 offset:29696
    v_mfma_f32_16x16x32_bf16 v[60:63], a[28:31], v[76:79], v[60:63]
    v_mfma_f32_16x16x32_bf16 v[32:35], a[32:35], v[80:83], v[32:35]
    ds_read_b128 v[104:107], v10 offset:5120
    v_mfma_f32_16x16x32_bf16 v[36:39], a[36:39], v[80:83], v[36:39]
    s_waitcnt lgkmcnt(4)
    buffer_load_dwordx4 v2, s[8:11], s28 offen offset:3072 sc1 lds
    v_mfma_f32_16x16x32_bf16 v[40:43], a[32:35], v[84:87], v[40:43]
    ds_read_b128 v[108:111], v10 offset:29696
    v_mfma_f32_16x16x32_bf16 v[44:47], a[36:39], v[84:87], v[44:47]
    v_mfma_f32_16x16x32_bf16 v[48:51], a[32:35], v[88:91], v[48:51]
    ds_read_b128 v[64:67], v2 offset:6144
    v_mfma_f32_16x16x32_bf16 v[52:55], a[36:39], v[88:91], v[52:55]
    s_waitcnt lgkmcnt(4)
    s_add_u32 m0, s32, 20480
    s_add_u32 s28, s34, 20480
    v_mfma_f32_16x16x32_bf16 v[56:59], a[32:35], v[92:95], v[56:59]
    ds_read_b128 v[68:71], v2 offset:30720
    v_mfma_f32_16x16x32_bf16 v[60:63], a[36:39], v[92:95], v[60:63]
    buffer_load_dwordx4 v2, s[8:11], s28 offen offset:0 sc1 lds
    v_mfma_f32_16x16x32_bf16 v[32:35], a[40:43], v[96:99], v[32:35]
    ds_read_b128 v[72:75], v10 offset:6144
    v_mfma_f32_16x16x32_bf16 v[36:39], a[44:47], v[96:99], v[36:39]
    s_waitcnt lgkmcnt(4)
    v_mfma_f32_16x16x32_bf16 v[40:43], a[40:43], v[100:103], v[40:43]
    ds_read_b128 v[76:79], v10 offset:30720
    v_mfma_f32_16x16x32_bf16 v[44:47], a[44:47], v[100:103], v[44:47]
    buffer_load_dwordx4 v2, s[8:11], s28 offen offset:1024 sc1 lds
    v_mfma_f32_16x16x32_bf16 v[48:51], a[40:43], v[104:107], v[48:51]
    ds_read_b128 v[80:83], v2 offset:7168
    v_mfma_f32_16x16x32_bf16 v[52:55], a[44:47], v[104:107], v[52:55]
    s_waitcnt lgkmcnt(4)
    v_mfma_f32_16x16x32_bf16 v[56:59], a[40:43], v[108:111], v[56:59]
    ds_read_b128 v[84:87], v2 offset:31744
    v_mfma_f32_16x16x32_bf16 v[60:63], a[44:47], v[108:111], v[60:63]
    buffer_load_dwordx4 v2, s[8:11], s28 offen offset:2048 sc1 lds
    v_mfma_f32_16x16x32_bf16 v[32:35], a[48:51], v[64:67], v[32:35]
    ds_read_b128 v[88:91], v10 offset:7168
    v_mfma_f32_16x16x32_bf16 v[36:39], a[52:55], v[64:67], v[36:39]
    s_waitcnt lgkmcnt(4)
    v_mfma_f32_16x16x32_bf16 v[40:43], a[48:51], v[68:71], v[40:43]
    ds_read_b128 v[92:95], v10 offset:31744
    v_mfma_f32_16x16x32_bf16 v[44:47], a[52:55], v[68:71], v[44:47]
    buffer_load_dwordx4 v2, s[8:11], s28 offen offset:3072 sc1 lds
    v_mfma_f32_16x16x32_bf16 v[48:51], a[48:51], v[72:75], v[48:51]
    s_waitcnt vmcnt(12)
    s_barrier
    v_mfma_f32_16x16x32_bf16 v[52:55], a[52:55], v[72:75], v[52:55]
    s_waitcnt lgkmcnt(3)
    ds_read_b128 v[96:99], v2 offset:8192
    v_mfma_f32_16x16x32_bf16 v[56:59], a[48:51], v[76:79], v[56:59]
    ds_read_b128 v[100:103], v2 offset:32768
    v_mfma_f32_16x16x32_bf16 v[60:63], a[52:55], v[76:79], v[60:63]
    v_mfma_f32_16x16x32_bf16 v[32:35], a[56:59], v[80:83], v[32:35]
    ds_read_b128 v[104:107], v10 offset:8192
    v_mfma_f32_16x16x32_bf16 v[36:39], a[60:63], v[80:83], v[36:39]
    s_waitcnt lgkmcnt(4)
    v_mfma_f32_16x16x32_bf16 v[40:43], a[56:59], v[84:87], v[40:43]
    ds_read_b128 v[108:111], v10 offset:32768
    v_mfma_f32_16x16x32_bf16 v[44:47], a[60:63], v[84:87], v[44:47]
    v_mfma_f32_16x16x32_bf16 v[48:51], a[56:59], v[88:91], v[48:51]
    ds_read_b128 v[64:67], v2 offset:9216
    v_mfma_f32_16x16x32_bf16 v[52:55], a[60:63], v[88:91], v[52:55]
    s_waitcnt lgkmcnt(4)
    v_mfma_f32_16x16x32_bf16 v[56:59], a[56:59], v[92:95], v[56:59]
    ds_read_b128 v[68:71], v2 offset:33792
    v_mfma_f32_16x16x32_bf16 v[60:63], a[60:63], v[92:95], v[60:63]
    v_mfma_f32_16x16x32_bf16 v[32:35], a[64:67], v[96:99], v[32:35]
    ds_read_b128 v[72:75], v10 offset:9216
    v_mfma_f32_16x16x32_bf16 v[36:39], a[68:71], v[96:99], v[36:39]
    s_waitcnt lgkmcnt(4)
    v_mfma_f32_16x16x32_bf16 v[40:43], a[64:67], v[100:103], v[40:43]
    ds_read_b128 v[76:79], v10 offset:33792
    v_mfma_f32_16x16x32_bf16 v[44:47], a[68:71], v[100:103], v[44:47]
    v_mfma_f32_16x16x32_bf16 v[48:51], a[64:67], v[104:107], v[48:51]
    ds_read_b128 v[80:83], v2 offset:10240
    v_mfma_f32_16x16x32_bf16 v[52:55], a[68:71], v[104:107], v[52:55]
    s_waitcnt lgkmcnt(4)
    v_mfma_f32_16x16x32_bf16 v[56:59], a[64:67], v[108:111], v[56:59]
    ds_read_b128 v[84:87], v2 offset:34816
    v_mfma_f32_16x16x32_bf16 v[60:63], a[68:71], v[108:111], v[60:63]
    v_mfma_f32_16x16x32_bf16 v[32:35], a[72:75], v[64:67], v[32:35]
    ds_read_b128 v[88:91], v10 offset:10240
    v_mfma_f32_16x16x32_bf16 v[36:39], a[76:79], v[64:67], v[36:39]
    s_waitcnt lgkmcnt(4)
    v_mfma_f32_16x16x32_bf16 v[40:43], a[72:75], v[68:71], v[40:43]
    ds_read_b128 v[92:95], v10 offset:34816
    v_mfma_f32_16x16x32_bf16 v[44:47], a[76:79], v[68:71], v[44:47]
    v_mfma_f32_16x16x32_bf16 v[48:51], a[72:75], v[72:75], v[48:51]
    ds_read_b128 v[96:99], v2 offset:11264
    v_mfma_f32_16x16x32_bf16 v[52:55], a[76:79], v[72:75], v[52:55]
    s_waitcnt lgkmcnt(4)
    v_mfma_f32_16x16x32_bf16 v[56:59], a[72:75], v[76:79], v[56:59]
    ds_read_b128 v[100:103], v2 offset:35840
    v_mfma_f32_16x16x32_bf16 v[60:63], a[76:79], v[76:79], v[60:63]
    v_mfma_f32_16x16x32_bf16 v[32:35], a[80:83], v[80:83], v[32:35]
    ds_read_b128 v[104:107], v10 offset:11264
    v_mfma_f32_16x16x32_bf16 v[36:39], a[84:87], v[80:83], v[36:39]
    s_waitcnt lgkmcnt(4)
    s_add_u32 s28, s37, 0
    buffer_load_dwordx4 v[16:19], v2, s[8:11], s28 offen sc1
    v_mfma_f32_16x16x32_bf16 v[40:43], a[80:83], v[84:87], v[40:43]
    ds_read_b128 v[108:111], v10 offset:35840
    v_mfma_f32_16x16x32_bf16 v[44:47], a[84:87], v[84:87], v[44:47]
    v_mfma_f32_16x16x32_bf16 v[48:51], a[80:83], v[88:91], v[48:51]
    s_waitcnt vmcnt(9)
    s_barrier
    v_mfma_f32_16x16x32_bf16 v[52:55], a[84:87], v[88:91], v[52:55]
    s_waitcnt lgkmcnt(3)
    ds_read_b128 v[64:67], v2 offset:12288
    v_mfma_f32_16x16x32_bf16 v[56:59], a[80:83], v[92:95], v[56:59]
    s_add_u32 s28, s37, 20480
    buffer_load_dwordx4 v[20:23], v2, s[8:11], s28 offen sc1
    v_mfma_f32_16x16x32_bf16 v[60:63], a[84:87], v[92:95], v[60:63]
    ds_read_b128 v[68:71], v2 offset:36864
    v_mfma_f32_16x16x32_bf16 v[32:35], a[88:91], v[96:99], v[32:35]
    ds_read_b128 v[72:75], v10 offset:12288
    v_mfma_f32_16x16x32_bf16 v[36:39], a[92:95], v[96:99], v[36:39]
    s_waitcnt lgkmcnt(4)
    s_add_u32 s28, s37, 40960
    buffer_load_dwordx4 v[24:27], v2, s[8:11], s28 offen sc1
    v_mfma_f32_16x16x32_bf16 v[40:43], a[88:91], v[100:103], v[40:43]
    ds_read_b128 v[76:79], v10 offset:36864
    v_mfma_f32_16x16x32_bf16 v[44:47], a[92:95], v[100:103], v[44:47]
    v_mfma_f32_16x16x32_bf16 v[48:51], a[88:91], v[104:107], v[48:51]
    ds_read_b128 v[80:83], v2 offset:13312
    v_mfma_f32_16x16x32_bf16 v[52:55], a[92:95], v[104:107], v[52:55]
    s_waitcnt lgkmcnt(4)
    s_add_u32 s28, s37, 61440
    buffer_load_dwordx4 v[28:31], v2, s[8:11], s28 offen sc1
    v_mfma_f32_16x16x32_bf16 v[56:59], a[88:91], v[108:111], v[56:59]
    ds_read_b128 v[84:87], v2 offset:37888
    v_mfma_f32_16x16x32_bf16 v[60:63], a[92:95], v[108:111], v[60:63]
    v_mfma_f32_16x16x32_bf16 v[32:35], a[96:99], v[64:67], v[32:35]
    ds_read_b128 v[88:91], v10 offset:13312
    v_mfma_f32_16x16x32_bf16 v[36:39], a[100:103], v[64:67], v[36:39]
    s_waitcnt lgkmcnt(4)
    v_mfma_f32_16x16x32_bf16 v[40:43], a[96:99], v[68:71], v[40:43]
    ds_read_b128 v[92:95], v10 offset:37888
    v_mfma_f32_16x16x32_bf16 v[44:47], a[100:103], v[68:71], v[44:47]
    v_mfma_f32_16x16x32_bf16 v[48:51], a[96:99], v[72:75], v[48:51]
    ds_read_b128 v[96:99], v2 offset:14336
    v_mfma_f32_16x16x32_bf16 v[52:55], a[100:103], v[72:75], v[52:55]
    s_waitcnt lgkmcnt(4)
    v_mfma_f32_16x16x32_bf16 v[56:59], a[96:99], v[76:79], v[56:59]
    ds_read_b128 v[100:103], v2 offset:38912
    v_mfma_f32_16x16x32_bf16 v[60:63], a[100:103], v[76:79], v[60:63]
    v_mfma_f32_16x16x32_bf16 v[32:35], a[104:107], v[80:83], v[32:35]
    ds_read_b128 v[104:107], v10 offset:14336
    v_mfma_f32_16x16x32_bf16 v[36:39], a[108:111], v[80:83], v[36:39]
    s_waitcnt lgkmcnt(4)
    v_mfma_f32_16x16x32_bf16 v[40:43], a[104:107], v[84:87], v[40:43]
    ds_read_b128 v[108:111], v10 offset:38912
    v_mfma_f32_16x16x32_bf16 v[44:47], a[108:111], v[84:87], v[44:47]
    v_mfma_f32_16x16x32_bf16 v[48:51], a[104:107], v[88:91], v[48:51]
    ds_read_b128 v[64:67], v2 offset:15360
    v_mfma_f32_16x16x32_bf16 v[52:55], a[108:111], v[88:91], v[52:55]
    s_waitcnt lgkmcnt(4)
    v_mfma_f32_16x16x32_bf16 v[56:59], a[104:107], v[92:95], v[56:59]
    ds_read_b128 v[68:71], v2 offset:39936
    v_mfma_f32_16x16x32_bf16 v[60:63], a[108:111], v[92:95], v[60:63]
    v_mfma_f32_16x16x32_bf16 v[32:35], a[112:115], v[96:99], v[32:35]
    ds_read_b128 v[72:75], v10 offset:15360
    v_mfma_f32_16x16x32_bf16 v[36:39], a[116:119], v[96:99], v[36:39]
    s_waitcnt lgkmcnt(4)
    v_mfma_f32_16x16x32_bf16 v[40:43], a[112:115], v[100:103], v[40:43]
    ds_read_b128 v[76:79], v10 offset:39936
    v_mfma_f32_16x16x32_bf16 v[44:47], a[116:119], v[100:103], v[44:47]
    v_mfma_f32_16x16x32_bf16 v[48:51], a[112:115], v[104:107], v[48:51]
    s_waitcnt vmcnt(8)
    s_barrier
    v_mfma_f32_16x16x32_bf16 v[52:55], a[116:119], v[104:107], v[52:55]
    s_waitcnt lgkmcnt(3)
    ds_read_b128 v[80:83], v2 offset:16384
    v_mfma_f32_16x16x32_bf16 v[56:59], a[112:115], v[108:111], v[56:59]
    ds_read_b128 v[84:87], v2 offset:40960
    v_mfma_f32_16x16x32_bf16 v[60:63], a[116:119], v[108:111], v[60:63]
    v_mfma_f32_16x16x32_bf16 v[32:35], a[120:123], v[64:67], v[32:35]
    ds_read_b128 v[88:91], v10 offset:16384
    v_mfma_f32_16x16x32_bf16 v[36:39], a[124:127], v[64:67], v[36:39]
    s_waitcnt lgkmcnt(4)
    v_mfma_f32_16x16x32_bf16 v[40:43], a[120:123], v[68:71], v[40:43]
    ds_read_b128 v[92:95], v10 offset:40960
    v_mfma_f32_16x16x32_bf16 v[44:47], a[124:127], v[68:71], v[44:47]
    v_mfma_f32_16x16x32_bf16 v[48:51], a[120:123], v[72:75], v[48:51]
    ds_read_b128 v[96:99], v2 offset:17408
    v_mfma_f32_16x16x32_bf16 v[52:55], a[124:127], v[72:75], v[52:55]
    s_waitcnt lgkmcnt(4)
    v_mfma_f32_16x16x32_bf16 v[56:59], a[120:123], v[76:79], v[56:59]
    ds_read_b128 v[100:103], v2 offset:41984
    v_mfma_f32_16x16x32_bf16 v[60:63], a[124:127], v[76:79], v[60:63]
    v_mfma_f32_16x16x32_bf16 v[32:35], a[128:131], v[80:83], v[32:35]
    ds_read_b128 v[104:107], v10 offset:17408
    v_mfma_f32_16x16x32_bf16 v[36:39], a[132:135], v[80:83], v[36:39]
    s_waitcnt lgkmcnt(4)
    v_mfma_f32_16x16x32_bf16 v[40:43], a[128:131], v[84:87], v[40:43]
    ds_read_b128 v[108:111], v10 offset:41984
    v_mfma_f32_16x16x32_bf16 v[44:47], a[132:135], v[84:87], v[44:47]
    v_mfma_f32_16x16x32_bf16 v[48:51], a[128:131], v[88:91], v[48:51]
    ds_read_b128 v[64:67], v2 offset:18432
    v_mfma_f32_16x16x32_bf16 v[52:55], a[132:135], v[88:91], v[52:55]
    s_waitcnt lgkmcnt(4)
    v_mfma_f32_16x16x32_bf16 v[56:59], a[128:131], v[92:95], v[56:59]
    ds_read_b128 v[68:71], v2 offset:43008
    v_mfma_f32_16x16x32_bf16 v[60:63], a[132:135], v[92:95], v[60:63]
    v_mfma_f32_16x16x32_bf16 v[32:35], a[136:139], v[96:99], v[32:35]
    ds_read_b128 v[72:75], v10 offset:18432
    v_mfma_f32_16x16x32_bf16 v[36:39], a[140:143], v[96:99], v[36:39]
    s_waitcnt lgkmcnt(4)
    v_mfma_f32_16x16x32_bf16 v[40:43], a[136:139], v[100:103], v[40:43]
    ds_read_b128 v[76:79], v10 offset:43008
    v_mfma_f32_16x16x32_bf16 v[44:47], a[140:143], v[100:103], v[44:47]
    v_mfma_f32_16x16x32_bf16 v[48:51], a[136:139], v[104:107], v[48:51]
    ds_read_b128 v[80:83], v2 offset:19456
    v_mfma_f32_16x16x32_bf16 v[52:55], a[140:143], v[104:107], v[52:55]
    s_waitcnt lgkmcnt(4)
    v_mfma_f32_16x16x32_bf16 v[56:59], a[136:139], v[108:111], v[56:59]
    ds_read_b128 v[84:87], v2 offset:44032
    v_mfma_f32_16x16x32_bf16 v[60:63], a[140:143], v[108:111], v[60:63]
    v_mfma_f32_16x16x32_bf16 v[32:35], a[144:147], v[64:67], v[32:35]
    ds_read_b128 v[88:91], v10 offset:19456
    v_mfma_f32_16x16x32_bf16 v[36:39], a[148:151], v[64:67], v[36:39]
    s_waitcnt lgkmcnt(4)
    v_mfma_f32_16x16x32_bf16 v[40:43], a[144:147], v[68:71], v[40:43]
    ds_read_b128 v[92:95], v10 offset:44032
    v_mfma_f32_16x16x32_bf16 v[44:47], a[148:151], v[68:71], v[44:47]
    v_mfma_f32_16x16x32_bf16 v[48:51], a[144:147], v[72:75], v[48:51]
    s_waitcnt vmcnt(4)
    s_barrier
    v_mfma_f32_16x16x32_bf16 v[52:55], a[148:151], v[72:75], v[52:55]
    s_waitcnt lgkmcnt(3)
    ds_read_b128 v[96:99], v2 offset:20480
    v_mfma_f32_16x16x32_bf16 v[56:59], a[144:147], v[76:79], v[56:59]
    ds_read_b128 v[100:103], v2 offset:45056
    v_mfma_f32_16x16x32_bf16 v[60:63], a[148:151], v[76:79], v[60:63]
    v_mfma_f32_16x16x32_bf16 v[32:35], a[152:155], v[80:83], v[32:35]
    ds_read_b128 v[104:107], v10 offset:20480
    v_mfma_f32_16x16x32_bf16 v[36:39], a[156:159], v[80:83], v[36:39]
    s_waitcnt lgkmcnt(4)
    v_mfma_f32_16x16x32_bf16 v[40:43], a[152:155], v[84:87], v[40:43]
    ds_read_b128 v[108:111], v10 offset:45056
    v_mfma_f32_16x16x32_bf16 v[44:47], a[156:159], v[84:87], v[44:47]
    v_mfma_f32_16x16x32_bf16 v[48:51], a[152:155], v[88:91], v[48:51]
    ds_read_b128 v[64:67], v2 offset:21504
    v_mfma_f32_16x16x32_bf16 v[52:55], a[156:159], v[88:91], v[52:55]
    s_waitcnt lgkmcnt(4)
    v_mfma_f32_16x16x32_bf16 v[56:59], a[152:155], v[92:95], v[56:59]
    ds_read_b128 v[68:71], v2 offset:46080
    v_mfma_f32_16x16x32_bf16 v[60:63], a[156:159], v[92:95], v[60:63]
    v_mfma_f32_16x16x32_bf16 v[32:35], a[160:163], v[96:99], v[32:35]
    ds_read_b128 v[72:75], v10 offset:21504
    v_mfma_f32_16x16x32_bf16 v[36:39], a[164:167], v[96:99], v[36:39]
    s_waitcnt lgkmcnt(4)
    v_mfma_f32_16x16x32_bf16 v[40:43], a[160:163], v[100:103], v[40:43]
    ds_read_b128 v[76:79], v10 offset:46080
    v_mfma_f32_16x16x32_bf16 v[44:47], a[164:167], v[100:103], v[44:47]
    v_mfma_f32_16x16x32_bf16 v[48:51], a[160:163], v[104:107], v[48:51]
    ds_read_b128 v[80:83], v2 offset:22528
    v_mfma_f32_16x16x32_bf16 v[52:55], a[164:167], v[104:107], v[52:55]
    s_waitcnt lgkmcnt(4)
    v_mfma_f32_16x16x32_bf16 v[56:59], a[160:163], v[108:111], v[56:59]
    ds_read_b128 v[84:87], v2 offset:47104
    v_mfma_f32_16x16x32_bf16 v[60:63], a[164:167], v[108:111], v[60:63]
    v_mfma_f32_16x16x32_bf16 v[32:35], a[168:171], v[64:67], v[32:35]
    ds_read_b128 v[88:91], v10 offset:22528
    v_mfma_f32_16x16x32_bf16 v[36:39], a[172:175], v[64:67], v[36:39]
    s_waitcnt lgkmcnt(4)
    v_mfma_f32_16x16x32_bf16 v[40:43], a[168:171], v[68:71], v[40:43]
    ds_read_b128 v[92:95], v10 offset:47104
    v_mfma_f32_16x16x32_bf16 v[44:47], a[172:175], v[68:71], v[44:47]
    v_mfma_f32_16x16x32_bf16 v[48:51], a[168:171], v[72:75], v[48:51]
    ds_read_b128 v[96:99], v2 offset:23552
    v_mfma_f32_16x16x32_bf16 v[52:55], a[172:175], v[72:75], v[52:55]
    s_waitcnt lgkmcnt(4)
    v_mfma_f32_16x16x32_bf16 v[56:59], a[168:171], v[76:79], v[56:59]
    ds_read_b128 v[100:103], v2 offset:48128
    v_mfma_f32_16x16x32_bf16 v[60:63], a[172:175], v[76:79], v[60:63]
    v_mfma_f32_16x16x32_bf16 v[32:35], a[176:179], v[80:83], v[32:35]
    ds_read_b128 v[104:107], v10 offset:23552
    v_mfma_f32_16x16x32_bf16 v[36:39], a[180:183], v[80:83], v[36:39]
    s_waitcnt lgkmcnt(4)
    v_mfma_f32_16x16x32_bf16 v[40:43], a[176:179], v[84:87], v[40:43]
    ds_read_b128 v[108:111], v10 offset:48128
    v_mfma_f32_16x16x32_bf16 v[44:47], a[180:183], v[84:87], v[44:47]
    v_mfma_f32_16x16x32_bf16 v[48:51], a[176:179], v[88:91], v[48:51]
    v_mfma_f32_16x16x32_bf16 v[52:55], a[180:183], v[88:91], v[52:55]
    s_waitcnt lgkmcnt(3)
    v_mfma_f32_16x16x32_bf16 v[56:59], a[176:179], v[92:95], v[56:59]
    v_mfma_f32_16x16x32_bf16 v[60:63], a[180:183], v[92:95], v[60:63]
    v_mfma_f32_16x16x32_bf16 v[32:35], a[184:187], v[96:99], v[32:35]
    v_mfma_f32_16x16x32_bf16 v[36:39], a[188:191], v[96:99], v[36:39]
    s_waitcnt lgkmcnt(2)
    v_mfma_f32_16x16x32_bf16 v[40:43], a[184:187], v[100:103], v[40:43]
    v_mfma_f32_16x16x32_bf16 v[44:47], a[188:191], v[100:103], v[44:47]
    s_waitcnt lgkmcnt(1)
    v_mfma_f32_16x16x32_bf16 v[48:51], a[184:187], v[104:107], v[48:51]
    v_mfma_f32_16x16x32_bf16 v[52:55], a[188:191], v[104:107], v[52:55]
    s_waitcnt lgkmcnt(0)
    v_mfma_f32_16x16x32_bf16 v[56:59], a[184:187], v[108:111], v[56:59]
    v_mfma_f32_16x16x32_bf16 v[60:63], a[188:191], v[108:111], v[60:63]
    s_mov_b32 s46, 0xffff0000
    s_waitcnt vmcnt(0)
    v_lshlrev_b32 v64, 16, v16
    v_and_b32 v65, s46, v16
    v_lshlrev_b32 v66, 16, v17
    v_and_b32 v67, s46, v17
    v_lshlrev_b32 v68, 16, v18
    v_and_b32 v69, s46, v18
    v_lshlrev_b32 v70, 16, v19
    v_and_b32 v71, s46, v19
    v_pk_add_f32 v[32:33], v[32:33], v[64:65]
    v_pk_add_f32 v[34:35], v[34:35], v[66:67]
    v_pk_add_f32 v[36:37], v[36:37], v[68:69]
    v_pk_add_f32 v[38:39], v[38:39], v[70:71]
    v_cvt_pk_bf16_f32 v16, v32, v33
    v_cvt_pk_bf16_f32 v17, v34, v35
    v_cvt_pk_bf16_f32 v18, v36, v37
    v_cvt_pk_bf16_f32 v19, v38, v39
    s_add_u32 s28, s36, 0
    v_permlane16_swap_b32 v16, v18
    v_permlane16_swap_b32 v17, v19
    buffer_store_dwordx4 v[16:19], v8, s[16:19], s28 offen sc1
    v_lshlrev_b32 v64, 16, v20
    v_and_b32 v65, s46, v20
    v_lshlrev_b32 v66, 16, v21
    v_and_b32 v67, s46, v21
    v_lshlrev_b32 v68, 16, v22
    v_and_b32 v69, s46, v22
    v_lshlrev_b32 v70, 16, v23
    v_and_b32 v71, s46, v23
    v_pk_add_f32 v[40:41], v[40:41], v[64:65]
    v_pk_add_f32 v[42:43], v[42:43], v[66:67]
    v_pk_add_f32 v[44:45], v[44:45], v[68:69]
    v_pk_add_f32 v[46:47], v[46:47], v[70:71]
    v_cvt_pk_bf16_f32 v20, v40, v41
    v_cvt_pk_bf16_f32 v21, v42, v43
    v_cvt_pk_bf16_f32 v22, v44, v45
    v_cvt_pk_bf16_f32 v23, v46, v47
    s_add_u32 s28, s36, 20480
    v_permlane16_swap_b32 v20, v22
    v_permlane16_swap_b32 v21, v23
    buffer_store_dwordx4 v[20:23], v8, s[16:19], s28 offen sc1
    v_lshlrev_b32 v64, 16, v24
    v_and_b32 v65, s46, v24
    v_lshlrev_b32 v66, 16, v25
    v_and_b32 v67, s46, v25
    v_lshlrev_b32 v68, 16, v26
    v_and_b32 v69, s46, v26
    v_lshlrev_b32 v70, 16, v27
    v_and_b32 v71, s46, v27
    v_pk_add_f32 v[48:49], v[48:49], v[64:65]
    v_pk_add_f32 v[50:51], v[50:51], v[66:67]
    v_pk_add_f32 v[52:53], v[52:53], v[68:69]
    v_pk_add_f32 v[54:55], v[54:55], v[70:71]
    v_cvt_pk_bf16_f32 v24, v48, v49
    v_cvt_pk_bf16_f32 v25, v50, v51
    v_cvt_pk_bf16_f32 v26, v52, v53
    v_cvt_pk_bf16_f32 v27, v54, v55
    s_add_u32 s28, s36, 40960
    v_permlane16_swap_b32 v24, v26
    v_permlane16_swap_b32 v25, v27
    buffer_store_dwordx4 v[24:27], v8, s[16:19], s28 offen sc1
    v_lshlrev_b32 v64, 16, v28
    v_and_b32 v65, s46, v28
    v_lshlrev_b32 v66, 16, v29
    v_and_b32 v67, s46, v29
    v_lshlrev_b32 v68, 16, v30
    v_and_b32 v69, s46, v30
    v_lshlrev_b32 v70, 16, v31
    v_and_b32 v71, s46, v31
    v_pk_add_f32 v[56:57], v[56:57], v[64:65]
    v_pk_add_f32 v[58:59], v[58:59], v[66:67]
    v_pk_add_f32 v[60:61], v[60:61], v[68:69]
    v_pk_add_f32 v[62:63], v[62:63], v[70:71]
    v_cvt_pk_bf16_f32 v28, v56, v57
    v_cvt_pk_bf16_f32 v29, v58, v59
    v_cvt_pk_bf16_f32 v30, v60, v61
    v_cvt_pk_bf16_f32 v31, v62, v63
    s_add_u32 s28, s36, 61440
    v_permlane16_swap_b32 v28, v30
    v_permlane16_swap_b32 v29, v31
    buffer_store_dwordx4 v[28:31], v8, s[16:19], s28 offen sc1
    s_branch M_end
M_z:
    s_mov_b32 s12, s96
    s_and_b32 s13, s97, 0xffff
    s_mov_b32 s14, 0x780000
    s_mov_b32 s15, 0x20000
    s_mov_b32 s16, s98
    s_and_b32 s17, s99, 0xffff
    s_mov_b32 s18, 0x780000
    s_mov_b32 s19, 0x20000
    v_add_u32 v8, 0, v1
    v_mul_u32_u24 v9, 2731, v8
    v_lshrrev_b32 v9, 16, v9
    v_mul_u32_u24 v10, 24, v9
    v_sub_u32 v10, v8, v10
    v_mul_u32_u24 v9, 12288, v9
    v_lshl_add_u32 v4, v10, 4, v9
    v_add_u32 v8, 64, v1
    v_mul_u32_u24 v9, 2731, v8
    v_lshrrev_b32 v9, 16, v9
    v_mul_u32_u24 v10, 24, v9
    v_sub_u32 v10, v8, v10
    v_mul_u32_u24 v9, 12288, v9
    v_lshl_add_u32 v5, v10, 4, v9
    v_add_u32 v8, 128, v1
    v_mul_u32_u24 v9, 2731, v8
    v_lshrrev_b32 v9, 16, v9
    v_mul_u32_u24 v10, 24, v9
    v_sub_u32 v10, v8, v10
    v_mul_u32_u24 v9, 12288, v9
    v_lshl_add_u32 v6, v10, 4, v9
    v_lshrrev_b32 v8, 3, v1
    v_mul_u32_u24 v8, 1280, v8
    v_and_b32 v9, 7, v1
    v_lshl_add_u32 v7, v9, 4, v8
    v_lshrrev_b32 v8, 4, v1
    v_bfe_u32 v9, v1, 2, 2
    v_and_b32 v10, 3, v1
    v_lshrrev_b32 v11, 1, v8
    v_lshlrev_b32 v11, 4, v11
    v_and_b32 v12, 1, v8
    v_lshl_add_u32 v11, v12, 2, v11
    v_and_b32 v12, 1, v9
    v_add_u32 v11, v11, v12
    v_lshrrev_b32 v12, 1, v9
    v_lshl_add_u32 v11, v12, 3, v11
    v_mul_u32_u24 v11, 384, v11
    v_lshl_add_u32 v11, v10, 3, v11
    s_mul_i32 s28, s21, 96
    v_add_u32 v11, s28, v11
    v_and_b32 v12, 1, v9
    v_lshrrev_b32 v13, 1, v9
    v_lshl_add_u32 v12, v12, 1, v13
    v_lshl_add_u32 v12, v8, 3, v12
    v_lshlrev_b32 v12, 7, v12
    v_lshl_add_u32 v12, v10, 3, v12
    s_lshl_b32 s28, s21, 5
    s_add_u32 s28, s28, 24576
    v_add_u32 v12, s28, v12
    s_mul_i32 s30, s20, 384
    s_mul_i32 s28, s21, 196608
    s_add_u32 s30, s30, s28
    s_mul_i32 s31, s20, 245760
    s_mul_i32 s28, s21, 61440
    s_add_u32 s31, s31, s28
    s_mul_i32 s32, s21, 6144
    s_add_u32 m0, s32, 98304
    s_add_u32 s33, s30, 0
    buffer_load_dwordx4 v4, s[12:15], s33 offen nt lds
    s_add_u32 m0, s32, 99328
    s_add_u32 s33, s30, 0
    buffer_load_dwordx4 v5, s[12:15], s33 offen nt lds
    s_add_u32 m0, s32, 100352
    s_add_u32 s33, s30, 0
    buffer_load_dwordx4 v6, s[12:15], s33 offen nt lds
    s_add_u32 m0, s32, 101376
    s_add_u32 s33, s30, 98304
    buffer_load_dwordx4 v4, s[12:15], s33 offen nt lds
    s_add_u32 m0, s32, 102400
    s_add_u32 s33, s30, 98304
    buffer_load_dwordx4 v5, s[12:15], s33 offen nt lds
    s_add_u32 m0, s32, 103424
    s_add_u32 s33, s30, 98304
    buffer_load_dwordx4 v6, s[12:15], s33 offen nt lds
    s_add_u32 m0, s32, 122880
    s_add_u32 s33, s31, 0
    buffer_load_dwordx4 v7, s[16:19], s33 offen nt lds
    s_add_u32 m0, s32, 123904
    s_add_u32 s33, s31, 10240
    buffer_load_dwordx4 v7, s[16:19], s33 offen nt lds
    s_add_u32 m0, s32, 124928
    s_add_u32 s33, s31, 20480
    buffer_load_dwordx4 v7, s[16:19], s33 offen nt lds
    s_add_u32 m0, s32, 125952
    s_add_u32 s33, s31, 30720
    buffer_load_dwordx4 v7, s[16:19], s33 offen nt lds
    s_add_u32 m0, s32, 126976
    s_add_u32 s33, s31, 40960
    buffer_load_dwordx4 v7, s[16:19], s33 offen nt lds
    s_add_u32 m0, s32, 128000
    s_add_u32 s33, s31, 51200
    buffer_load_dwordx4 v7, s[16:19], s33 offen nt lds
    s_add_u32 m0, s32, 0
    s_add_u32 s33, s30, 786432
    buffer_load_dwordx4 v4, s[12:15], s33 offen nt lds
    s_add_u32 m0, s32, 1024
    s_add_u32 s33, s30, 786432
    buffer_load_dwordx4 v5, s[12:15], s33 offen nt lds
    s_add_u32 m0, s32, 2048
    s_add_u32 s33, s30, 786432
    buffer_load_dwordx4 v6, s[12:15], s33 offen nt lds
    s_add_u32 m0, s32, 3072
    s_add_u32 s33, s30, 884736
    buffer_load_dwordx4 v4, s[12:15], s33 offen nt lds
    s_add_u32 m0, s32, 4096
    s_add_u32 s33, s30, 884736
    buffer_load_dwordx4 v5, s[12:15], s33 offen nt lds
    s_add_u32 m0, s32, 5120
    s_add_u32 s33, s30, 884736
    buffer_load_dwordx4 v6, s[12:15], s33 offen nt lds
    s_add_u32 m0, s32, 24576
    s_add_u32 s33, s31, 128
    buffer_load_dwordx4 v7, s[16:19], s33 offen nt lds
    s_add_u32 m0, s32, 25600
    s_add_u32 s33, s31, 10368
    buffer_load_dwordx4 v7, s[16:19], s33 offen nt lds
    s_add_u32 m0, s32, 26624
    s_add_u32 s33, s31, 20608
    buffer_load_dwordx4 v7, s[16:19], s33 offen nt lds
    s_add_u32 m0, s32, 27648
    s_add_u32 s33, s31, 30848
    buffer_load_dwordx4 v7, s[16:19], s33 offen nt lds
    s_add_u32 m0, s32, 28672
    s_add_u32 s33, s31, 41088
    buffer_load_dwordx4 v7, s[16:19], s33 offen nt lds
    s_add_u32 m0, s32, 29696
    s_add_u32 s33, s31, 51328
    buffer_load_dwordx4 v7, s[16:19], s33 offen nt lds
    s_add_u32 m0, s32, 49152
    s_add_u32 s33, s30, 1572864
    buffer_load_dwordx4 v4, s[12:15], s33 offen nt lds
    s_add_u32 m0, s32, 50176
    s_add_u32 s33, s30, 1572864
    buffer_load_dwordx4 v5, s[12:15], s33 offen nt lds
    s_add_u32 m0, s32, 51200
    s_add_u32 s33, s30, 1572864
    buffer_load_dwordx4 v6, s[12:15], s33 offen nt lds
    s_add_u32 m0, s32, 52224
    s_add_u32 s33, s30, 1671168
    buffer_load_dwordx4 v4, s[12:15], s33 offen nt lds
    s_add_u32 m0, s32, 53248
    s_add_u32 s33, s30, 1671168
    buffer_load_dwordx4 v5, s[12:15], s33 offen nt lds
    s_add_u32 m0, s32, 54272
    s_add_u32 s33, s30, 1671168
    buffer_load_dwordx4 v6, s[12:15], s33 offen nt lds
    s_add_u32 m0, s32, 73728
    s_add_u32 s33, s31, 256
    buffer_load_dwordx4 v7, s[16:19], s33 offen nt lds
    s_add_u32 m0, s32, 74752
    s_add_u32 s33, s31, 10496
    buffer_load_dwordx4 v7, s[16:19], s33 offen nt lds
    s_add_u32 m0, s32, 75776
    s_add_u32 s33, s31, 20736
    buffer_load_dwordx4 v7, s[16:19], s33 offen nt lds
    s_add_u32 m0, s32, 76800
    s_add_u32 s33, s31, 30976
    buffer_load_dwordx4 v7, s[16:19], s33 offen nt lds
    s_add_u32 m0, s32, 77824
    s_add_u32 s33, s31, 41216
    buffer_load_dwordx4 v7, s[16:19], s33 offen nt lds
    s_add_u32 m0, s32, 78848
    s_add_u32 s33, s31, 51456
    buffer_load_dwordx4 v7, s[16:19], s33 offen nt lds
    s_waitcnt vmcnt(24)
    s_barrier
    v_add_u32 v13, 98304, v11
    v_add_u32 v14, 98304, v12
    ds_read_b64_tr_b16 a[0:1], v13 offset:0
    ds_read_b64_tr_b16 a[2:3], v13 offset:768
    ds_read_b64_tr_b16 a[4:5], v13 offset:12288
    ds_read_b64_tr_b16 a[6:7], v13 offset:13056
    ds_read_b64_tr_b16 a[8:9], v13 offset:32
    ds_read_b64_tr_b16 a[10:11], v13 offset:800
    ds_read_b64_tr_b16 a[12:13], v13 offset:12320
    ds_read_b64_tr_b16 a[14:15], v13 offset:13088
    ds_read_b64_tr_b16 a[16:17], v13 offset:64
    ds_read_b64_tr_b16 a[18:19], v13 offset:832
    ds_read_b64_tr_b16 a[20:21], v13 offset:12352
    ds_read_b64_tr_b16 a[22:23], v13 offset:13120
    ds_read_b64_tr_b16 a[200:201], v14 offset:0
    ds_read_b64_tr_b16 a[202:203], v14 offset:512
    ds_read_b64_tr_b16 a[204:205], v14 offset:4096
    ds_read_b64_tr_b16 a[206:207], v14 offset:4608
    ds_read_b64_tr_b16 a[208:209], v14 offset:8192
    ds_read_b64_tr_b16 a[210:211], v14 offset:8704
    ds_read_b64_tr_b16 a[212:213], v14 offset:12288
    ds_read_b64_tr_b16 a[214:215], v14 offset:12800
    ds_read_b64_tr_b16 a[216:217], v14 offset:16384
    ds_read_b64_tr_b16 a[218:219], v14 offset:16896
    ds_read_b64_tr_b16 a[220:221], v14 offset:20480
    ds_read_b64_tr_b16 a[222:223], v14 offset:20992
    s_waitcnt lgkmcnt(0)
    s_barrier
    s_add_u32 m0, s32, 98304
    s_add_u32 s33, s30, 2359296
    buffer_load_dwordx4 v4, s[12:15], s33 offen nt lds
    s_add_u32 m0, s32, 99328
    s_add_u32 s33, s30, 2359296
    buffer_load_dwordx4 v5, s[12:15], s33 offen nt lds
    s_add_u32 m0, s32, 100352
    s_add_u32 s33, s30, 2359296
    buffer_load_dwordx4 v6, s[12:15], s33 offen nt lds
    s_add_u32 m0, s32, 101376
    s_add_u32 s33, s30, 2457600
    buffer_load_dwordx4 v4, s[12:15], s33 offen nt lds
    s_add_u32 m0, s32, 102400
    s_add_u32 s33, s30, 2457600
    buffer_load_dwordx4 v5, s[12:15], s33 offen nt lds
    s_add_u32 m0, s32, 103424
    s_add_u32 s33, s30, 2457600
    buffer_load_dwordx4 v6, s[12:15], s33 offen nt lds
    s_add_u32 m0, s32, 122880
    s_add_u32 s33, s31, 384
    buffer_load_dwordx4 v7, s[16:19], s33 offen nt lds
    s_add_u32 m0, s32, 123904
    s_add_u32 s33, s31, 10624
    buffer_load_dwordx4 v7, s[16:19], s33 offen nt lds
    s_add_u32 m0, s32, 124928
    s_add_u32 s33, s31, 20864
    buffer_load_dwordx4 v7, s[16:19], s33 offen nt lds
    s_add_u32 m0, s32, 125952
    s_add_u32 s33, s31, 31104
    buffer_load_dwordx4 v7, s[16:19], s33 offen nt lds
    s_add_u32 m0, s32, 126976
    s_add_u32 s33, s31, 41344
    buffer_load_dwordx4 v7, s[16:19], s33 offen nt lds
    s_add_u32 m0, s32, 128000
    s_add_u32 s33, s31, 51584
    buffer_load_dwordx4 v7, s[16:19], s33 offen nt lds
    s_waitcnt vmcnt(24)
    s_barrier
    v_add_u32 v13, 0, v11
    v_add_u32 v14, 0, v12
    ds_read_b64_tr_b16 a[24:25], v13 offset:0
    ds_read_b64_tr_b16 a[26:27], v13 offset:768
    ds_read_b64_tr_b16 a[28:29], v13 offset:12288
    ds_read_b64_tr_b16 a[30:31], v13 offset:13056
    ds_read_b64_tr_b16 a[32:33], v13 offset:32
    ds_read_b64_tr_b16 a[34:35], v13 offset:800
    ds_read_b64_tr_b16 a[36:37], v13 offset:12320
    ds_read_b64_tr_b16 a[38:39], v13 offset:13088
    ds_read_b64_tr_b16 a[40:41], v13 offset:64
    ds_read_b64_tr_b16 a[42:43], v13 offset:832
    ds_read_b64_tr_b16 a[44:45], v13 offset:12352
    ds_read_b64_tr_b16 a[46:47], v13 offset:13120
    ds_read_b64_tr_b16 a[224:225], v14 offset:0
    ds_read_b64_tr_b16 a[226:227], v14 offset:512
    ds_read_b64_tr_b16 a[228:229], v14 offset:4096
    ds_read_b64_tr_b16 a[230:231], v14 offset:4608
    ds_read_b64_tr_b16 a[232:233], v14 offset:8192
    ds_read_b64_tr_b16 a[234:235], v14 offset:8704
    ds_read_b64_tr_b16 a[236:237], v14 offset:12288
    ds_read_b64_tr_b16 a[238:239], v14 offset:12800
    ds_read_b64_tr_b16 v[72:73], v14 offset:16384
    ds_read_b64_tr_b16 v[74:75], v14 offset:16896
    ds_read_b64_tr_b16 v[76:77], v14 offset:20480
    ds_read_b64_tr_b16 v[78:79], v14 offset:20992
    s_waitcnt lgkmcnt(0)
    s_barrier
    s_add_u32 m0, s32, 0
    s_add_u32 s33, s30, 3145728
    buffer_load_dwordx4 v4, s[12:15], s33 offen nt lds
    s_add_u32 m0, s32, 1024
    s_add_u32 s33, s30, 3145728
    buffer_load_dwordx4 v5, s[12:15], s33 offen nt lds
    s_add_u32 m0, s32, 2048
    s_add_u32 s33, s30, 3145728
    buffer_load_dwordx4 v6, s[12:15], s33 offen nt lds
    s_add_u32 m0, s32, 3072
    s_add_u32 s33, s30, 3244032
    buffer_load_dwordx4 v4, s[12:15], s33 offen nt lds
    s_add_u32 m0, s32, 4096
    s_add_u32 s33, s30, 3244032
    buffer_load_dwordx4 v5, s[12:15], s33 offen nt lds
    s_add_u32 m0, s32, 5120
    s_add_u32 s33, s30, 3244032
    buffer_load_dwordx4 v6, s[12:15], s33 offen nt lds
    s_add_u32 m0, s32, 24576
    s_add_u32 s33, s31, 512
    buffer_load_dwordx4 v7, s[16:19], s33 offen nt lds
    s_add_u32 m0, s32, 25600
    s_add_u32 s33, s31, 10752
    buffer_load_dwordx4 v7, s[16:19], s33 offen nt lds
    s_add_u32 m0, s32, 26624
    s_add_u32 s33, s31, 20992
    buffer_load_dwordx4 v7, s[16:19], s33 offen nt lds
    s_add_u32 m0, s32, 27648
    s_add_u32 s33, s31, 31232
    buffer_load_dwordx4 v7, s[16:19], s33 offen nt lds
    s_add_u32 m0, s32, 28672
    s_add_u32 s33, s31, 41472
    buffer_load_dwordx4 v7, s[16:19], s33 offen nt lds
    s_add_u32 m0, s32, 29696
    s_add_u32 s33, s31, 51712
    buffer_load_dwordx4 v7, s[16:19], s33 offen nt lds
    s_waitcnt vmcnt(24)
    s_barrier
    v_add_u32 v13, 49152, v11
    v_add_u32 v14, 49152, v12
    ds_read_b64_tr_b16 a[48:49], v13 offset:0
    ds_read_b64_tr_b16 a[50:51], v13 offset:768
    ds_read_b64_tr_b16 a[52:53], v13 offset:12288
    ds_read_b64_tr_b16 a[54:55], v13 offset:13056
    ds_read_b64_tr_b16 a[56:57], v13 offset:32
    ds_read_b64_tr_b16 a[58:59], v13 offset:800
    ds_read_b64_tr_b16 a[60:61], v13 offset:12320
    ds_read_b64_tr_b16 a[62:63], v13 offset:13088
    ds_read_b64_tr_b16 a[64:65], v13 offset:64
    ds_read_b64_tr_b16 a[66:67], v13 offset:832
    ds_read_b64_tr_b16 a[68:69], v13 offset:12352
    ds_read_b64_tr_b16 a[70:71], v13 offset:13120
    ds_read_b64_tr_b16 a[240:241], v14 offset:0
    ds_read_b64_tr_b16 a[242:243], v14 offset:512
    ds_read_b64_tr_b16 a[244:245], v14 offset:4096
    ds_read_b64_tr_b16 a[246:247], v14 offset:4608
    ds_read_b64_tr_b16 a[248:249], v14 offset:8192
    ds_read_b64_tr_b16 a[250:251], v14 offset:8704
    ds_read_b64_tr_b16 a[252:253], v14 offset:12288
    ds_read_b64_tr_b16 a[254:255], v14 offset:12800
    ds_read_b64_tr_b16 v[128:129], v14 offset:16384
    ds_read_b64_tr_b16 v[130:131], v14 offset:16896
    ds_read_b64_tr_b16 v[132:133], v14 offset:20480
    ds_read_b64_tr_b16 v[134:135], v14 offset:20992
    s_waitcnt lgkmcnt(0)
    s_barrier
    s_add_u32 m0, s32, 49152
    s_add_u32 s33, s30, 3932160
    buffer_load_dwordx4 v4, s[12:15], s33 offen nt lds
    s_add_u32 m0, s32, 50176
    s_add_u32 s33, s30, 3932160
    buffer_load_dwordx4 v5, s[12:15], s33 offen nt lds
    s_add_u32 m0, s32, 51200
    s_add_u32 s33, s30, 3932160
    buffer_load_dwordx4 v6, s[12:15], s33 offen nt lds
    s_add_u32 m0, s32, 52224
    s_add_u32 s33, s30, 4030464
    buffer_load_dwordx4 v4, s[12:15], s33 offen nt lds
    s_add_u32 m0, s32, 53248
    s_add_u32 s33, s30, 4030464
    buffer_load_dwordx4 v5, s[12:15], s33 offen nt lds
    s_add_u32 m0, s32, 54272
    s_add_u32 s33, s30, 4030464
    buffer_load_dwordx4 v6, s[12:15], s33 offen nt lds
    s_add_u32 m0, s32, 73728
    s_add_u32 s33, s31, 640
    buffer_load_dwordx4 v7, s[16:19], s33 offen nt lds
    s_add_u32 m0, s32, 74752
    s_add_u32 s33, s31, 10880
    buffer_load_dwordx4 v7, s[16:19], s33 offen nt lds
    s_add_u32 m0, s32, 75776
    s_add_u32 s33, s31, 21120
    buffer_load_dwordx4 v7, s[16:19], s33 offen nt lds
    s_add_u32 m0, s32, 76800
    s_add_u32 s33, s31, 31360
    buffer_load_dwordx4 v7, s[16:19], s33 offen nt lds
    s_add_u32 m0, s32, 77824
    s_add_u32 s33, s31, 41600
    buffer_load_dwordx4 v7, s[16:19], s33 offen nt lds
    s_add_u32 m0, s32, 78848
    s_add_u32 s33, s31, 51840
    buffer_load_dwordx4 v7, s[16:19], s33 offen nt lds
    s_waitcnt vmcnt(24)
    s_barrier
    v_add_u32 v13, 98304, v11
    v_add_u32 v14, 98304, v12
    ds_read_b64_tr_b16 a[72:73], v13 offset:0
    ds_read_b64_tr_b16 a[74:75], v13 offset:768
    ds_read_b64_tr_b16 a[76:77], v13 offset:12288
    ds_read_b64_tr_b16 a[78:79], v13 offset:13056
    ds_read_b64_tr_b16 a[80:81], v13 offset:32
    ds_read_b64_tr_b16 a[82:83], v13 offset:800
    ds_read_b64_tr_b16 a[84:85], v13 offset:12320
    ds_read_b64_tr_b16 a[86:87], v13 offset:13088
    ds_read_b64_tr_b16 a[88:89], v13 offset:64
    ds_read_b64_tr_b16 a[90:91], v13 offset:832
    ds_read_b64_tr_b16 a[92:93], v13 offset:12352
    ds_read_b64_tr_b16 a[94:95], v13 offset:13120
    ds_read_b64_tr_b16 v[80:81], v14 offset:0
    ds_read_b64_tr_b16 v[82:83], v14 offset:512
    ds_read_b64_tr_b16 v[84:85], v14 offset:4096
    ds_read_b64_tr_b16 v[86:87], v14 offset:4608
    ds_read_b64_tr_b16 v[136:137], v14 offset:8192
    ds_read_b64_tr_b16 v[138:139], v14 offset:8704
    ds_read_b64_tr_b16 v[140:141], v14 offset:12288
    ds_read_b64_tr_b16 v[142:143], v14 offset:12800
    ds_read_b64_tr_b16 v[144:145], v14 offset:16384
    ds_read_b64_tr_b16 v[146:147], v14 offset:16896
    ds_read_b64_tr_b16 v[148:149], v14 offset:20480
    ds_read_b64_tr_b16 v[150:151], v14 offset:20992
    s_waitcnt lgkmcnt(0)
    s_barrier
    s_add_u32 m0, s32, 98304
    s_add_u32 s33, s30, 5505024
    buffer_load_dwordx4 v4, s[12:15], s33 offen nt lds
    s_add_u32 m0, s32, 99328
    s_add_u32 s33, s30, 5505024
    buffer_load_dwordx4 v5, s[12:15], s33 offen nt lds
    s_add_u32 m0, s32, 100352
    s_add_u32 s33, s30, 5505024
    buffer_load_dwordx4 v6, s[12:15], s33 offen nt lds
    s_add_u32 m0, s32, 101376
    s_add_u32 s33, s30, 5603328
    buffer_load_dwordx4 v4, s[12:15], s33 offen nt lds
    s_add_u32 m0, s32, 102400
    s_add_u32 s33, s30, 5603328
    buffer_load_dwordx4 v5, s[12:15], s33 offen nt lds
    s_add_u32 m0, s32, 103424
    s_add_u32 s33, s30, 5603328
    buffer_load_dwordx4 v6, s[12:15], s33 offen nt lds
    s_add_u32 m0, s32, 122880
    s_add_u32 s33, s31, 896
    buffer_load_dwordx4 v7, s[16:19], s33 offen nt lds
    s_add_u32 m0, s32, 123904
    s_add_u32 s33, s31, 11136
    buffer_load_dwordx4 v7, s[16:19], s33 offen nt lds
    s_add_u32 m0, s32, 124928
    s_add_u32 s33, s31, 21376
    buffer_load_dwordx4 v7, s[16:19], s33 offen nt lds
    s_add_u32 m0, s32, 125952
    s_add_u32 s33, s31, 31616
    buffer_load_dwordx4 v7, s[16:19], s33 offen nt lds
    s_add_u32 m0, s32, 126976
    s_add_u32 s33, s31, 41856
    buffer_load_dwordx4 v7, s[16:19], s33 offen nt lds
    s_add_u32 m0, s32, 128000
    s_add_u32 s33, s31, 52096
    buffer_load_dwordx4 v7, s[16:19], s33 offen nt lds
    s_waitcnt vmcnt(24)
    s_barrier
    v_add_u32 v13, 0, v11
    v_add_u32 v14, 0, v12
    ds_read_b64_tr_b16 a[96:97], v13 offset:0
    ds_read_b64_tr_b16 a[98:99], v13 offset:768
    ds_read_b64_tr_b16 a[100:101], v13 offset:12288
    ds_read_b64_tr_b16 a[102:103], v13 offset:13056
    ds_read_b64_tr_b16 a[104:105], v13 offset:32
    ds_read_b64_tr_b16 a[106:107], v13 offset:800
    ds_read_b64_tr_b16 a[108:109], v13 offset:12320
    ds_read_b64_tr_b16 a[110:111], v13 offset:13088
    ds_read_b64_tr_b16 a[112:113], v13 offset:64
    ds_read_b64_tr_b16 a[114:115], v13 offset:832
    ds_read_b64_tr_b16 a[116:117], v13 offset:12352
    ds_read_b64_tr_b16 a[118:119], v13 offset:13120
    ds_read_b64_tr_b16 v[152:153], v14 offset:0
    ds_read_b64_tr_b16 v[154:155], v14 offset:512
    ds_read_b64_tr_b16 v[156:157], v14 offset:4096
    ds_read_b64_tr_b16 v[158:159], v14 offset:4608
    ds_read_b64_tr_b16 v[88:89], v14 offset:8192
    ds_read_b64_tr_b16 v[90:91], v14 offset:8704
    ds_read_b64_tr_b16 v[92:93], v14 offset:12288
    ds_read_b64_tr_b16 v[94:95], v14 offset:12800
    ds_read_b64_tr_b16 v[160:161], v14 offset:16384
    ds_read_b64_tr_b16 v[162:163], v14 offset:16896
    ds_read_b64_tr_b16 v[164:165], v14 offset:20480
    ds_read_b64_tr_b16 v[166:167], v14 offset:20992
    s_waitcnt lgkmcnt(0)
    s_barrier
    s_add_u32 m0, s32, 0
    s_add_u32 s33, s30, 6291456
    buffer_load_dwordx4 v4, s[12:15], s33 offen nt lds
    s_add_u32 m0, s32, 1024
    s_add_u32 s33, s30, 6291456
    buffer_load_dwordx4 v5, s[12:15], s33 offen nt lds
    s_add_u32 m0, s32, 2048
    s_add_u32 s33, s30, 6291456
    buffer_load_dwordx4 v6, s[12:15], s33 offen nt lds
    s_add_u32 m0, s32, 3072
    s_add_u32 s33, s30, 6389760
    buffer_load_dwordx4 v4, s[12:15], s33 offen nt lds
    s_add_u32 m0, s32, 4096
    s_add_u32 s33, s30, 6389760
    buffer_load_dwordx4 v5, s[12:15], s33 offen nt lds
    s_add_u32 m0, s32, 5120
    s_add_u32 s33, s30, 6389760
    buffer_load_dwordx4 v6, s[12:15], s33 offen nt lds
    s_add_u32 m0, s32, 24576
    s_add_u32 s33, s31, 1024
    buffer_load_dwordx4 v7, s[16:19], s33 offen nt lds
    s_add_u32 m0, s32, 25600
    s_add_u32 s33, s31, 11264
    buffer_load_dwordx4 v7, s[16:19], s33 offen nt lds
    s_add_u32 m0, s32, 26624
    s_add_u32 s33, s31, 21504
    buffer_load_dwordx4 v7, s[16:19], s33 offen nt lds
    s_add_u32 m0, s32, 27648
    s_add_u32 s33, s31, 31744
    buffer_load_dwordx4 v7, s[16:19], s33 offen nt lds
    s_add_u32 m0, s32, 28672
    s_add_u32 s33, s31, 41984
    buffer_load_dwordx4 v7, s[16:19], s33 offen nt lds
    s_add_u32 m0, s32, 29696
    s_add_u32 s33, s31, 52224
    buffer_load_dwordx4 v7, s[16:19], s33 offen nt lds
    s_waitcnt vmcnt(24)
    s_barrier
    v_add_u32 v13, 49152, v11
    v_add_u32 v14, 49152, v12
    ds_read_b64_tr_b16 a[120:121], v13 offset:0
    ds_read_b64_tr_b16 a[122:123], v13 offset:768
    ds_read_b64_tr_b16 a[124:125], v13 offset:12288
    ds_read_b64_tr_b16 a[126:127], v13 offset:13056
    ds_read_b64_tr_b16 a[128:129], v13 offset:32
    ds_read_b64_tr_b16 a[130:131], v13 offset:800
    ds_read_b64_tr_b16 a[132:133], v13 offset:12320
    ds_read_b64_tr_b16 a[134:135], v13 offset:13088
    ds_read_b64_tr_b16 a[136:137], v13 offset:64
    ds_read_b64_tr_b16 a[138:139], v13 offset:832
    ds_read_b64_tr_b16 a[140:141], v13 offset:12352
    ds_read_b64_tr_b16 a[142:143], v13 offset:13120
    ds_read_b64_tr_b16 v[168:169], v14 offset:0
    ds_read_b64_tr_b16 v[170:171], v14 offset:512
    ds_read_b64_tr_b16 v[172:173], v14 offset:4096
    ds_read_b64_tr_b16 v[174:175], v14 offset:4608
    ds_read_b64_tr_b16 v[176:177], v14 offset:8192
    ds_read_b64_tr_b16 v[178:179], v14 offset:8704
    ds_read_b64_tr_b16 v[180:181], v14 offset:12288
    ds_read_b64_tr_b16 v[182:183], v14 offset:12800
    ds_read_b64_tr_b16 v[96:97], v14 offset:16384
    ds_read_b64_tr_b16 v[98:99], v14 offset:16896
    ds_read_b64_tr_b16 v[100:101], v14 offset:20480
    ds_read_b64_tr_b16 v[102:103], v14 offset:20992
    s_waitcnt lgkmcnt(0)
    s_barrier
    s_add_u32 m0, s32, 49152
    s_add_u32 s33, s30, 7077888
    buffer_load_dwordx4 v4, s[12:15], s33 offen nt lds
    s_add_u32 m0, s32, 50176
    s_add_u32 s33, s30, 7077888
    buffer_load_dwordx4 v5, s[12:15], s33 offen nt lds
    s_add_u32 m0, s32, 51200
    s_add_u32 s33, s30, 7077888
    buffer_load_dwordx4 v6, s[12:15], s33 offen nt lds
    s_add_u32 m0, s32, 52224
    s_add_u32 s33, s30, 7176192
    buffer_load_dwordx4 v4, s[12:15], s33 offen nt lds
    s_add_u32 m0, s32, 53248
    s_add_u32 s33, s30, 7176192
    buffer_load_dwordx4 v5, s[12:15], s33 offen nt lds
    s_add_u32 m0, s32, 54272
    s_add_u32 s33, s30, 7176192
    buffer_load_dwordx4 v6, s[12:15], s33 offen nt lds
    s_add_u32 m0, s32, 73728
    s_add_u32 s33, s31, 1152
    buffer_load_dwordx4 v7, s[16:19], s33 offen nt lds
    s_add_u32 m0, s32, 74752
    s_add_u32 s33, s31, 11392
    buffer_load_dwordx4 v7, s[16:19], s33 offen nt lds
    s_add_u32 m0, s32, 75776
    s_add_u32 s33, s31, 21632
    buffer_load_dwordx4 v7, s[16:19], s33 offen nt lds
    s_add_u32 m0, s32, 76800
    s_add_u32 s33, s31, 31872
    buffer_load_dwordx4 v7, s[16:19], s33 offen nt lds
    s_add_u32 m0, s32, 77824
    s_add_u32 s33, s31, 42112
    buffer_load_dwordx4 v7, s[16:19], s33 offen nt lds
    s_add_u32 m0, s32, 78848
    s_add_u32 s33, s31, 52352
    buffer_load_dwordx4 v7, s[16:19], s33 offen nt lds
    s_waitcnt vmcnt(24)
    s_barrier
    v_add_u32 v13, 98304, v11
    v_add_u32 v14, 98304, v12
    ds_read_b64_tr_b16 a[168:169], v13 offset:0
    ds_read_b64_tr_b16 a[170:171], v13 offset:768
    ds_read_b64_tr_b16 a[172:173], v13 offset:12288
    ds_read_b64_tr_b16 a[174:175], v13 offset:13056
    ds_read_b64_tr_b16 a[176:177], v13 offset:32
    ds_read_b64_tr_b16 a[178:179], v13 offset:800
    ds_read_b64_tr_b16 a[180:181], v13 offset:12320
    ds_read_b64_tr_b16 a[182:183], v13 offset:13088
    ds_read_b64_tr_b16 a[184:185], v13 offset:64
    ds_read_b64_tr_b16 a[186:187], v13 offset:832
    ds_read_b64_tr_b16 a[188:189], v13 offset:12352
    ds_read_b64_tr_b16 a[190:191], v13 offset:13120
    ds_read_b64_tr_b16 v[104:105], v14 offset:0
    ds_read_b64_tr_b16 v[106:107], v14 offset:512
    ds_read_b64_tr_b16 v[108:109], v14 offset:4096
    ds_read_b64_tr_b16 v[110:111], v14 offset:4608
    ds_read_b64_tr_b16 v[208:209], v14 offset:8192
    ds_read_b64_tr_b16 v[210:211], v14 offset:8704
    ds_read_b64_tr_b16 v[212:213], v14 offset:12288
    ds_read_b64_tr_b16 v[214:215], v14 offset:12800
    ds_read_b64_tr_b16 v[216:217], v14 offset:16384
    ds_read_b64_tr_b16 v[218:219], v14 offset:16896
    ds_read_b64_tr_b16 v[220:221], v14 offset:20480
    ds_read_b64_tr_b16 v[222:223], v14 offset:20992
    s_waitcnt lgkmcnt(0)
    s_barrier
    v_mov_b32 v16, 128
    buffer_load_dwordx4 v[20:23], v16, s[88:91], 0 offen sc1
    s_add_u32 m0, s32, 98304
    s_add_u32 s33, s30, 4718592
    buffer_load_dwordx4 v4, s[12:15], s33 offen nt lds
    s_add_u32 m0, s32, 99328
    s_add_u32 s33, s30, 4718592
    buffer_load_dwordx4 v5, s[12:15], s33 offen nt lds
    s_add_u32 m0, s32, 100352
    s_add_u32 s33, s30, 4718592
    buffer_load_dwordx4 v6, s[12:15], s33 offen nt lds
    s_add_u32 m0, s32, 101376
    s_add_u32 s33, s30, 4816896
    buffer_load_dwordx4 v4, s[12:15], s33 offen nt lds
    s_add_u32 m0, s32, 102400
    s_add_u32 s33, s30, 4816896
    buffer_load_dwordx4 v5, s[12:15], s33 offen nt lds
    s_add_u32 m0, s32, 103424
    s_add_u32 s33, s30, 4816896
    buffer_load_dwordx4 v6, s[12:15], s33 offen nt lds
    s_add_u32 m0, s32, 122880
    s_add_u32 s33, s31, 768
    buffer_load_dwordx4 v7, s[16:19], s33 offen nt lds
    s_add_u32 m0, s32, 123904
    s_add_u32 s33, s31, 11008
    buffer_load_dwordx4 v7, s[16:19], s33 offen nt lds
    s_add_u32 m0, s32, 124928
    s_add_u32 s33, s31, 21248
    buffer_load_dwordx4 v7, s[16:19], s33 offen nt lds
    s_add_u32 m0, s32, 125952
    s_add_u32 s33, s31, 31488
    buffer_load_dwordx4 v7, s[16:19], s33 offen nt lds
    s_add_u32 m0, s32, 126976
    s_add_u32 s33, s31, 41728
    buffer_load_dwordx4 v7, s[16:19], s33 offen nt lds
    s_add_u32 m0, s32, 128000
    s_add_u32 s33, s31, 51968
    buffer_load_dwordx4 v7, s[16:19], s33 offen nt lds
    s_waitcnt vmcnt(25)
    s_barrier
    v_add_u32 v13, 0, v11
    v_add_u32 v14, 0, v12
    ds_read_b64_tr_b16 v[32:33], v13 offset:0
    ds_read_b64_tr_b16 v[34:35], v13 offset:768
    ds_read_b64_tr_b16 v[36:37], v13 offset:12288
    ds_read_b64_tr_b16 v[38:39], v13 offset:13056
    ds_read_b64_tr_b16 v[40:41], v13 offset:32
    ds_read_b64_tr_b16 v[42:43], v13 offset:800
    ds_read_b64_tr_b16 v[44:45], v13 offset:12320
    ds_read_b64_tr_b16 v[46:47], v13 offset:13088
    ds_read_b64_tr_b16 v[48:49], v13 offset:64
    ds_read_b64_tr_b16 v[50:51], v13 offset:832
    ds_read_b64_tr_b16 v[52:53], v13 offset:12352
    ds_read_b64_tr_b16 v[54:55], v13 offset:13120
    ds_read_b64_tr_b16 v[224:225], v14 offset:0
    ds_read_b64_tr_b16 v[226:227], v14 offset:512
    ds_read_b64_tr_b16 v[228:229], v14 offset:4096
    ds_read_b64_tr_b16 v[230:231], v14 offset:4608
    ds_read_b64_tr_b16 v[112:113], v14 offset:8192
    ds_read_b64_tr_b16 v[114:115], v14 offset:8704
    ds_read_b64_tr_b16 v[116:117], v14 offset:12288
    ds_read_b64_tr_b16 v[118:119], v14 offset:12800
    ds_read_b64_tr_b16 v[232:233], v14 offset:16384
    ds_read_b64_tr_b16 v[234:235], v14 offset:16896
    ds_read_b64_tr_b16 v[236:237], v14 offset:20480
    ds_read_b64_tr_b16 v[238:239], v14 offset:20992
    s_waitcnt lgkmcnt(0)
    s_barrier
    s_waitcnt vmcnt(12)
    s_barrier
    v_add_u32 v13, 49152, v11
    v_add_u32 v14, 49152, v12
    ds_read_b64_tr_b16 v[56:57], v13 offset:0
    ds_read_b64_tr_b16 v[58:59], v13 offset:768
    ds_read_b64_tr_b16 v[60:61], v13 offset:12288
    ds_read_b64_tr_b16 v[62:63], v13 offset:13056
    ds_read_b64_tr_b16 v[64:65], v13 offset:32
    ds_read_b64_tr_b16 v[66:67], v13 offset:800
    ds_read_b64_tr_b16 v[68:69], v13 offset:12320
    ds_read_b64_tr_b16 v[70:71], v13 offset:13088
    ds_read_b64_tr_b16 a[192:193], v13 offset:64
    ds_read_b64_tr_b16 a[194:195], v13 offset:832
    ds_read_b64_tr_b16 a[196:197], v13 offset:12352
    ds_read_b64_tr_b16 a[198:199], v13 offset:13120
    ds_read_b64_tr_b16 v[240:241], v14 offset:0
    ds_read_b64_tr_b16 v[242:243], v14 offset:512
    ds_read_b64_tr_b16 v[244:245], v14 offset:4096
    ds_read_b64_tr_b16 v[246:247], v14 offset:4608
    ds_read_b64_tr_b16 v[248:249], v14 offset:8192
    ds_read_b64_tr_b16 v[250:251], v14 offset:8704
    ds_read_b64_tr_b16 v[252:253], v14 offset:12288
    ds_read_b64_tr_b16 v[254:255], v14 offset:12800
    ds_read_b64_tr_b16 v[120:121], v14 offset:16384
    ds_read_b64_tr_b16 v[122:123], v14 offset:16896
    ds_read_b64_tr_b16 v[124:125], v14 offset:20480
    ds_read_b64_tr_b16 v[126:127], v14 offset:20992
    s_waitcnt lgkmcnt(0)
    s_barrier
    v_lshlrev_b32 v2, 4, v1
    s_mul_i32 s28, s21, 24576
    v_add_u32 v3, s28, v2
    ds_write_b128 v3, v[32:35] offset:0
    ds_write_b128 v3, v[36:39] offset:1024
    ds_write_b128 v3, v[40:43] offset:2048
    ds_write_b128 v3, v[44:47] offset:3072
    ds_write_b128 v3, v[48:51] offset:4096
    ds_write_b128 v3, v[52:55] offset:5120
    ds_write_b128 v3, v[56:59] offset:6144
    ds_write_b128 v3, v[60:63] offset:7168
    ds_write_b128 v3, v[64:67] offset:8192
    ds_write_b128 v3, v[68:71] offset:9216
    ds_write_b128 v3, v[72:75] offset:10240
    ds_write_b128 v3, v[76:79] offset:11264
    ds_write_b128 v3, v[80:83] offset:12288
    ds_write_b128 v3, v[84:87] offset:13312
    ds_write_b128 v3, v[88:91] offset:14336
    ds_write_b128 v3, v[92:95] offset:15360
    ds_write_b128 v3, v[96:99] offset:16384
    ds_write_b128 v3, v[100:103] offset:17408
    ds_write_b128 v3, v[104:107] offset:18432
    ds_write_b128 v3, v[108:111] offset:19456
    ds_write_b128 v3, v[112:115] offset:20480
    ds_write_b128 v3, v[116:119] offset:21504
    ds_write_b128 v3, v[120:123] offset:22528
    ds_write_b128 v3, v[124:127] offset:23552
    s_waitcnt lgkmcnt(0)
    s_waitcnt vmcnt(0)
    s_barrier
    v_add_u32 v13, 98304, v11
    v_add_u32 v14, 98304, v12
    ds_read_b64_tr_b16 a[144:145], v13 offset:0
    ds_read_b64_tr_b16 a[146:147], v13 offset:768
    ds_read_b64_tr_b16 a[148:149], v13 offset:12288
    ds_read_b64_tr_b16 a[150:151], v13 offset:13056
    ds_read_b64_tr_b16 a[152:153], v13 offset:32
    ds_read_b64_tr_b16 a[154:155], v13 offset:800
    ds_read_b64_tr_b16 a[156:157], v13 offset:12320
    ds_read_b64_tr_b16 a[158:159], v13 offset:13088
    ds_read_b64_tr_b16 a[160:161], v13 offset:64
    ds_read_b64_tr_b16 a[162:163], v13 offset:832
    ds_read_b64_tr_b16 a[164:165], v13 offset:12352
    ds_read_b64_tr_b16 a[166:167], v13 offset:13120
    ds_read_b64_tr_b16 v[184:185], v14 offset:0
    ds_read_b64_tr_b16 v[186:187], v14 offset:512
    ds_read_b64_tr_b16 v[188:189], v14 offset:4096
    ds_read_b64_tr_b16 v[190:191], v14 offset:4608
    ds_read_b64_tr_b16 v[192:193], v14 offset:8192
    ds_read_b64_tr_b16 v[194:195], v14 offset:8704
    ds_read_b64_tr_b16 v[196:197], v14 offset:12288
    ds_read_b64_tr_b16 v[198:199], v14 offset:12800
    ds_read_b64_tr_b16 v[200:201], v14 offset:16384
    ds_read_b64_tr_b16 v[202:203], v14 offset:16896
    ds_read_b64_tr_b16 v[204:205], v14 offset:20480
    ds_read_b64_tr_b16 v[206:207], v14 offset:20992
    s_waitcnt lgkmcnt(0)
    s_barrier
    v_cmp_ne_u32 vcc, 0, v20
    s_cbranch_vccz M_z_sl
    v_readfirstlane_b32 s28, v23
    s_cmp_lg_u32 s28, s23
    s_cbranch_scc1 M_redo
    v_readfirstlane_b32 s53, v20
    s_sub_u32 s53, s53, 1
    s_and_b32 s53, s53, 1
    s_lshl_b32 s52, s53, 13
    s_add_u32 s52, s52, 0xa00000
    s_xor_b32 s56, s53, 1
    s_lshl_b32 s56, s56, 13
    s_lshr_b32 s55, s25, 2
    s_and_b32 s55, s55, 15
    s_mul_i32 s55, s55, 256
    s_mov_b32 s58, 0
    s_branch M_z_sk
M_z_sl:
    v_mov_b32 v16, 128
    s_mov_b32 s39, 0
L_go_5:
    buffer_load_dword v17, v16, s[88:91], 0 offen sc1
    buffer_load_dword v18, v16, s[88:91], 0 offen offset:12 sc1
    s_add_u32 s39, s39, 1
    s_cmp_gt_u32 s39, 400000
    s_cbranch_scc1 M_fail
    s_waitcnt vmcnt(0)
    v_cmp_eq_u32 vcc, 0, v18
    s_cbranch_vccnz L_go_5
    v_readfirstlane_b32 s28, v18
    s_cmp_lg_u32 s28, s23
    s_cbranch_scc1 M_redo
    v_cmp_ne_u32 vcc, 0, v17
    s_cbranch_vccnz L_go_5k
    s_sleep 3
    s_branch L_go_5
L_go_5k:
    v_readfirstlane_b32 s53, v17
    s_sub_u32 s53, s53, 1
    s_and_b32 s53, s53, 1
    s_lshl_b32 s52, s53, 13
    s_add_u32 s52, s52, 0xa00000
    s_xor_b32 s56, s53, 1
    s_lshl_b32 s56, s56, 13
    s_lshr_b32 s55, s25, 2
    s_and_b32 s55, s55, 15
    s_mul_i32 s55, s55, 256
    s_mov_b32 s58, 0
M_z_sk:
    s_lshl_b32 s28, s21, 10
    v_add_u32 v7, s28, v2
    v_add_u32 v4, 20480, v7
    v_add_u32 v5, 24576, v7
    v_add_u32 v7, 98304, v7
    v_add_u32 v6, 3072, v5
    v_add_u32 v9, 98304, v2
    v_lshrrev_b32 v11, 13, v4
    v_lshlrev_b32 v11, 13, v11
    v_add_u32 v4, v4, v11
    v_lshrrev_b32 v11, 13, v5
    v_lshlrev_b32 v11, 13, v11
    v_add_u32 v5, v5, v11
    v_lshrrev_b32 v11, 13, v6
    v_lshlrev_b32 v11, 13, v11
    v_add_u32 v6, v6, v11
    v_and_b32 v11, 2, v1
    v_mov_b32 v10, 0x4444
    v_mov_b32 v12, 0xeeee
    v_cmp_ne_u32 vcc, 0, v11
    s_nop 1
    v_cndmask_b32 v10, v10, v12, vcc
    v_and_b32 v11, 15, v1
    v_lshrrev_b32 v16, 4, v1
    v_and_b32 v17, 3, v1
    v_mul_u32_u24 v12, 768, v16
    v_and_b32 v18, 1, v16
    v_lshl_add_u32 v12, v18, 5, v12
    v_lshrrev_b32 v18, 1, v16
    v_lshl_add_u32 v12, v18, 7, v12
    v_mul_u32_u24 v14, 768, v17
    v_and_b32 v18, 1, v17
    v_lshl_add_u32 v14, v18, 5, v14
    v_lshrrev_b32 v18, 1, v17
    v_lshl_add_u32 v14, v18, 7, v14
    v_lshl_add_u32 v12, v11, 2, v12
    s_mul_i32 s28, s21, 192
    s_add_u32 s28, s28, 108544
    v_add_u32 v12, s28, v12
    v_lshl_add_u32 v14, v16, 6, v14
    v_bfe_u32 v18, v1, 2, 2
    v_lshl_add_u32 v14, v18, 3, v14
    v_add_u32 v14, 108544, v14
    v_lshlrev_b32 v15, 4, v11
    v_lshrrev_b32 v18, 1, v16
    v_lshl_add_u32 v15, v18, 3, v15
    v_and_b32 v18, 1, v16
    v_lshl_add_u32 v15, v18, 16, v15
    s_lshl_b32 s28, s20, 8
    s_lshl_b32 s42, s21, 14
    s_add_u32 s42, s42, s28
    s_add_u32 s42, s42, 0xc000000
    v_lshlrev_b32 v13, 7, v1
    s_add_u32 s30, s21, 15
    s_lshr_b32 s28, s20, 2
    s_and_b32 s54, s28, 3
    s_add_u32 s54, s54, 4
    s_mul_i32 s28, s28, 3
    s_add_u32 s28, s28, s30
    s_lshr_b32 s29, s28, 2
    s_lshl_b32 s29, s29, 17
    s_and_b32 s28, s28, 3
    s_lshl_b32 s28, s28, 13
    s_add_u32 s44, s28, s29
    s_and_b32 s28, s20, 3
    s_lshl_b32 s28, s28, 15
    s_add_u32 s44, s44, s28
    s_add_u32 s44, s44, 0x4140000
    s_mov_b32 s22, 0
    s_cmp_eq_u32 s21, 0
    s_cbranch_scc1 M_z_w0_loop
    s_cmp_eq_u32 s21, 1
    s_cbranch_scc1 M_z_w1_loop
    s_cmp_eq_u32 s21, 2
    s_cbranch_scc1 M_z_w2_loop
    s_branch M_z_w3_loop
M_z_w0_loop:
    v_mov_b32 v56, 0
    v_mov_b32 v57, 0
    v_mov_b32 v58, 0
    v_mov_b32 v59, 0
    v_mov_b32 v60, 0
    v_mov_b32 v61, 0
    v_mov_b32 v62, 0
    v_mov_b32 v63, 0
    v_mov_b32 v64, 0
    v_mov_b32 v65, 0
    v_mov_b32 v66, 0
    v_mov_b32 v67, 0
    v_mov_b32 v68, 0
    v_mov_b32 v69, 0
    v_mov_b32 v70, 0
    v_mov_b32 v71, 0
    v_mov_b32 v72, 0
    v_mov_b32 v73, 0
    v_mov_b32 v74, 0
    v_mov_b32 v75, 0
    v_mov_b32 v76, 0
    v_mov_b32 v77, 0
    v_mov_b32 v78, 0
    v_mov_b32 v79, 0
    v_mov_b32 v80, 0
    v_mov_b32 v81, 0
    v_mov_b32 v82, 0
    v_mov_b32 v83, 0
    v_mov_b32 v84, 0
    v_mov_b32 v85, 0
    v_mov_b32 v86, 0
    v_mov_b32 v87, 0
    v_mov_b32 v88, 0
    v_mov_b32 v89, 0
    v_mov_b32 v90, 0
    v_mov_b32 v91, 0
    v_mov_b32 v92, 0
    v_mov_b32 v93, 0
    v_mov_b32 v94, 0
    v_mov_b32 v95, 0
    v_mov_b32 v96, 0
    v_mov_b32 v97, 0
    v_mov_b32 v98, 0
    v_mov_b32 v99, 0
    v_mov_b32 v100, 0
    v_mov_b32 v101, 0
    v_mov_b32 v102, 0
    v_mov_b32 v103, 0
    v_mov_b32 v104, 0
    v_mov_b32 v105, 0
    v_mov_b32 v106, 0
    v_mov_b32 v107, 0
    ds_read_b128 v[108:111], v3 offset:0
    ds_read_b128 v[112:115], v3 offset:1024
    ds_read_b128 v[116:119], v3 offset:6144
    ds_read_b128 v[120:123], v3 offset:7168
    s_sub_u32 s46, s22, 1
    s_lshr_b32 s28, s46, 1
    s_xor_b32 s28, s28, s53
    s_and_b32 s28, s28, 1
    s_xor_b32 s28, s28, 1
    s_lshl_b32 s28, s28, 13
    s_lshl_b32 s40, s46, 20
    s_add_u32 s40, s40, s28
    s_add_u32 s40, s40, 0xc0c0000
    s_lshr_b32 s28, s22, 1
    s_xor_b32 s28, s28, s53
    s_and_b32 s28, s28, 1
    s_xor_b32 s28, s28, 1
    s_lshl_b32 s28, s28, 13
    s_lshl_b32 s43, s22, 20
    s_add_u32 s43, s43, s28
    s_add_u32 s43, s43, s42
    s_cmp_lt_u32 s22, s54
    s_cselect_b32 s45, 0x0, s44
    s_add_u32 s48, s43, 131072
    s_add_u32 s49, s43, 262144
    s_add_u32 s50, s43, 393216
    s_add_u32 s51, s43, 524288
    s_waitcnt lgkmcnt(0)
    s_sub_u32 s46, s22, 1
    s_add_u32 s28, s55, 0xa4000
    v_mov_b32 v20, s28
    s_mov_b32 s39, 0
    s_waitcnt vmcnt(0)
    buffer_load_dword v21, v20, s[8:11], s52 offen sc1
    s_nop 15
    buffer_load_dword v22, v20, s[8:11], s52 offen sc1
    s_nop 15
    buffer_load_dword v23, v20, s[8:11], s52 offen sc1
M_z_w0_hu:
    s_waitcnt vmcnt(2)
    v_cmp_gt_i32 vcc, s46, v21
    s_cbranch_vccz M_z_w0_hud
    buffer_load_dword v21, v20, s[8:11], s52 offen sc1
    s_waitcnt vmcnt(2)
    v_cmp_gt_i32 vcc, s46, v22
    s_cbranch_vccz M_z_w0_hud
    buffer_load_dword v22, v20, s[8:11], s52 offen sc1
    s_waitcnt vmcnt(2)
    v_cmp_gt_i32 vcc, s46, v23
    s_cbranch_vccz M_z_w0_hud
    buffer_load_dword v23, v20, s[8:11], s52 offen sc1
    s_add_u32 s39, s39, 1
    s_cmp_gt_u32 s39, 400000
    s_cbranch_scc1 M_fail
    s_branch M_z_w0_hu
M_z_w0_hud:
    s_barrier
    buffer_load_dwordx4 v[16:19], v4, s[8:11], s40 offen sc1
    s_barrier
    buffer_load_dwordx4 v[32:35], v5, s[8:11], s40 offen sc1
    s_barrier
    s_mov_b32 s39, 1
    s_waitcnt vmcnt(1)
    ds_write_b128 v7, v[16:19] offset:0
    v_max3_u32 v11, v16, v17, v18
    v_max_u32 v11, v11, v19
    v_cmp_eq_u32 vcc, -1, v11
    v_smfmac_f32_16x16x64_bf16 v[56:59], v[16:19], a[0:7], v10
    v_smfmac_f32_16x16x64_bf16 v[60:63], v[16:19], a[8:15], v10
    v_smfmac_f32_16x16x64_bf16 v[64:67], v[16:19], a[16:23], v10
    s_cbranch_vccnz M_z_w0_slow1
M_z_w0_back1:
    s_waitcnt lgkmcnt(0)
    s_barrier
    ds_read_b128 v[20:23], v9 offset:1024
    ds_read_b128 v[24:27], v9 offset:2048
    ds_read_b128 v[28:31], v9 offset:3072
    s_waitcnt vmcnt(0)
    ds_write_b128 v7, v[32:35] offset:4096
    v_smfmac_f32_16x16x64_bf16 v[56:59], v[32:35], a[96:103], v10
    v_max3_u32 v11, v32, v33, v34
    v_max_u32 v11, v11, v35
    v_smfmac_f32_16x16x64_bf16 v[60:63], v[32:35], a[104:111], v10
    v_cmp_eq_u32 vcc, -1, v11
    v_smfmac_f32_16x16x64_bf16 v[64:67], v[32:35], a[112:119], v10
    s_waitcnt lgkmcnt(3)
    v_smfmac_f32_16x16x64_bf16 v[56:59], v[20:23], a[24:31], v10
    v_smfmac_f32_16x16x64_bf16 v[60:63], v[20:23], a[32:39], v10
    s_cbranch_vccnz M_z_w0_slow2
M_z_w0_back2:
    s_waitcnt lgkmcnt(0)
    s_barrier
    v_smfmac_f32_16x16x64_bf16 v[64:67], v[20:23], a[40:47], v10
    ds_read_b128 v[48:51], v9 offset:8192
    v_smfmac_f32_16x16x64_bf16 v[56:59], v[24:27], a[48:55], v10
    ds_read_b128 v[36:39], v9 offset:5120
    ds_read_b128 v[52:55], v9 offset:9216
    v_smfmac_f32_16x16x64_bf16 v[60:63], v[24:27], a[56:63], v10
    ds_read_b128 v[40:43], v9 offset:6144
    ds_read_b128 v[44:47], v9 offset:7168
    v_smfmac_f32_16x16x64_bf16 v[64:67], v[24:27], a[64:71], v10
    v_smfmac_f32_16x16x64_bf16 v[56:59], v[28:31], a[72:79], v10
    v_smfmac_f32_16x16x64_bf16 v[60:63], v[28:31], a[80:87], v10
    v_smfmac_f32_16x16x64_bf16 v[64:67], v[28:31], a[88:95], v10
    s_waitcnt lgkmcnt(2)
    ds_read_b128 v[16:19], v3 offset:2048
    v_smfmac_f32_16x16x64_bf16 v[56:59], v[48:51], v[108:115], v10
    ds_read_b128 v[20:23], v3 offset:3072
    ds_read_b128 v[108:111], v3 offset:8192
    v_smfmac_f32_16x16x64_bf16 v[56:59], v[36:39], a[120:127], v10
    ds_read_b128 v[112:115], v3 offset:9216
    ds_read_b128 v[24:27], v3 offset:4096
    v_smfmac_f32_16x16x64_bf16 v[56:59], v[52:55], v[116:123], v10
    s_waitcnt lgkmcnt(5)
    ds_read_b128 v[28:31], v3 offset:5120
    v_smfmac_f32_16x16x64_bf16 v[56:59], v[40:43], a[144:151], v10
    ds_read_b128 v[116:119], v3 offset:10240
    ds_read_b128 v[120:123], v3 offset:11264
    v_smfmac_f32_16x16x64_bf16 v[56:59], v[44:47], a[168:175], v10
    s_nop 1
    v_smfmac_f32_16x16x64_bf16 v[60:63], v[36:39], a[128:135], v10
    s_nop 1
    v_smfmac_f32_16x16x64_bf16 v[64:67], v[36:39], a[136:143], v10
    ds_read_b128 v[32:35], v3 offset:12288
    ds_read_b128 v[36:39], v3 offset:13312
    v_smfmac_f32_16x16x64_bf16 v[60:63], v[40:43], a[152:159], v10
    v_add_f32 v56, v56, v58
    v_smfmac_f32_16x16x64_bf16 v[64:67], v[40:43], a[160:167], v10
    s_waitcnt lgkmcnt(6)
    v_add_f32 v57, v57, v59
    v_smfmac_f32_16x16x64_bf16 v[60:63], v[48:51], v[16:23], v10
    ds_read_b128 v[16:19], v3 offset:14336
    v_cvt_pk_bf16_f32 v124, v56, v57
    v_smfmac_f32_16x16x64_bf16 v[60:63], v[44:47], a[176:183], v10
    ds_read_b128 v[20:23], v3 offset:15360
    v_smfmac_f32_16x16x64_bf16 v[60:63], v[52:55], v[108:115], v10
    s_waitcnt lgkmcnt(6)
    ds_write_b32 v12, v124
    v_smfmac_f32_16x16x64_bf16 v[64:67], v[48:51], v[24:31], v10
    s_nop 1
    v_smfmac_f32_16x16x64_bf16 v[64:67], v[44:47], a[184:191], v10
    s_nop 1
    v_smfmac_f32_16x16x64_bf16 v[64:67], v[52:55], a[192:199], v10
    s_nop 1
    v_pk_add_f32 v[60:61], v[60:61], v[62:63]
    v_cvt_pk_bf16_f32 v125, v60, v61
    s_nop 0
    s_nop 0
    s_nop 0
    s_nop 0
    v_pk_add_f32 v[64:65], v[64:65], v[66:67]
    v_cvt_pk_bf16_f32 v126, v64, v65
    ds_write2_b32 v12, v125, v126 offset0:16 offset1:32
    s_waitcnt lgkmcnt(0)
    s_barrier
    ds_read_b64_tr_b16 v[56:57], v14 offset:0
    ds_read_b64_tr_b16 v[58:59], v14 offset:32
    ds_read_b64_tr_b16 v[60:61], v14 offset:256
    ds_read_b64_tr_b16 v[62:63], v14 offset:288
    ds_read_b64_tr_b16 v[64:65], v14 offset:512
    ds_read_b64_tr_b16 v[66:67], v14 offset:544
    s_waitcnt lgkmcnt(4)
    v_smfmac_f32_16x16x64_bf16 v[68:71], v[56:59], a[200:207], v10
    s_waitcnt lgkmcnt(2)
    v_smfmac_f32_16x16x64_bf16 v[68:71], v[60:63], a[208:215], v10
    s_waitcnt lgkmcnt(0)
    v_smfmac_f32_16x16x64_bf16 v[68:71], v[64:67], a[216:223], v10
    ds_read_b128 v[108:111], v3 offset:16384
    ds_read_b128 v[112:115], v3 offset:17408
    v_smfmac_f32_16x16x64_bf16 v[72:75], v[56:59], a[224:231], v10
    ds_read_b128 v[24:27], v3 offset:18432
    ds_read_b128 v[28:31], v3 offset:19456
    v_smfmac_f32_16x16x64_bf16 v[72:75], v[60:63], a[232:239], v10
    ds_read_b128 v[40:43], v3 offset:20480
    ds_read_b128 v[44:47], v3 offset:21504
    v_smfmac_f32_16x16x64_bf16 v[72:75], v[64:67], v[116:123], v10
    ds_read_b128 v[48:51], v3 offset:22528
    v_add_f32 v68, v68, v70
    v_smfmac_f32_16x16x64_bf16 v[76:79], v[56:59], a[240:247], v10
    ds_read_b128 v[52:55], v3 offset:23552
    v_add_f32 v69, v69, v71
    v_smfmac_f32_16x16x64_bf16 v[76:79], v[60:63], a[248:255], v10
    v_cvt_pk_bf16_f32 v70, v68, v69
    v_smfmac_f32_16x16x64_bf16 v[76:79], v[64:67], v[128:135], v10
    v_add_f32 v72, v72, v74
    v_smfmac_f32_16x16x64_bf16 v[80:83], v[56:59], v[32:39], v10
    v_add_f32 v73, v73, v75
    v_smfmac_f32_16x16x64_bf16 v[80:83], v[60:63], v[136:143], v10
    v_cvt_pk_bf16_f32 v71, v72, v73
    v_smfmac_f32_16x16x64_bf16 v[80:83], v[64:67], v[144:151], v10
    s_nop 1
    v_smfmac_f32_16x16x64_bf16 v[84:87], v[56:59], v[152:159], v10
    v_add_f32 v76, v76, v78
    v_smfmac_f32_16x16x64_bf16 v[84:87], v[60:63], v[16:23], v10
    v_permlane16_swap_b32 v70, v71
    v_smfmac_f32_16x16x64_bf16 v[84:87], v[64:67], v[160:167], v10
    buffer_store_dwordx2 v[70:71], v15, s[8:11], s43 offen sc1
    v_add_f32 v77, v77, v79
    v_smfmac_f32_16x16x64_bf16 v[88:91], v[56:59], v[168:175], v10
    v_cvt_pk_bf16_f32 v78, v76, v77
    v_smfmac_f32_16x16x64_bf16 v[88:91], v[60:63], v[176:183], v10
    s_waitcnt lgkmcnt(6)
    v_add_f32 v80, v80, v82
    v_smfmac_f32_16x16x64_bf16 v[88:91], v[64:67], v[108:115], v10
    v_add_f32 v81, v81, v83
    v_smfmac_f32_16x16x64_bf16 v[92:95], v[56:59], v[184:191], v10
    v_cvt_pk_bf16_f32 v79, v80, v81
    v_smfmac_f32_16x16x64_bf16 v[92:95], v[60:63], v[192:199], v10
    v_add_f32 v84, v84, v86
    v_smfmac_f32_16x16x64_bf16 v[92:95], v[64:67], v[200:207], v10
    s_waitcnt lgkmcnt(4)
    v_permlane16_swap_b32 v78, v79
    v_smfmac_f32_16x16x64_bf16 v[96:99], v[56:59], v[24:31], v10
    buffer_store_dwordx2 v[78:79], v15, s[8:11], s48 offen sc1
    v_add_f32 v85, v85, v87
    v_smfmac_f32_16x16x64_bf16 v[96:99], v[60:63], v[208:215], v10
    v_cvt_pk_bf16_f32 v86, v84, v85
    v_smfmac_f32_16x16x64_bf16 v[96:99], v[64:67], v[216:223], v10
    v_add_f32 v88, v88, v90
    v_smfmac_f32_16x16x64_bf16 v[100:103], v[56:59], v[224:231], v10
    s_waitcnt lgkmcnt(2)
    v_add_f32 v89, v89, v91
    v_smfmac_f32_16x16x64_bf16 v[100:103], v[60:63], v[40:47], v10
    v_cvt_pk_bf16_f32 v87, v88, v89
    v_smfmac_f32_16x16x64_bf16 v[100:103], v[64:67], v[232:239], v10
    v_add_f32 v92, v92, v94
    v_smfmac_f32_16x16x64_bf16 v[104:107], v[56:59], v[240:247], v10
    v_permlane16_swap_b32 v86, v87
    v_smfmac_f32_16x16x64_bf16 v[104:107], v[60:63], v[248:255], v10
    s_waitcnt lgkmcnt(0)
    v_add_f32 v93, v93, v95
    v_smfmac_f32_16x16x64_bf16 v[104:107], v[64:67], v[48:55], v10
    buffer_store_dwordx2 v[86:87], v15, s[8:11], s49 offen sc1
    v_cvt_pk_bf16_f32 v94, v92, v93
    v_add_f32 v96, v96, v98
    v_add_f32 v97, v97, v99
    v_cvt_pk_bf16_f32 v95, v96, v97
    v_pk_add_f32 v[100:101], v[100:101], v[102:103]
    s_nop 0
    v_permlane16_swap_b32 v94, v95
    v_cvt_pk_bf16_f32 v102, v100, v101
    v_pk_add_f32 v[104:105], v[104:105], v[106:107]
    v_cvt_pk_bf16_f32 v103, v104, v105
    buffer_store_dwordx2 v[94:95], v15, s[8:11], s50 offen sc1
    s_nop 0
    v_permlane16_swap_b32 v102, v103
    buffer_store_dwordx2 v[102:103], v15, s[8:11], s51 offen sc1
    s_add_u32 s22, s22, 1
    s_cmp_lt_u32 s22, 64
    s_cbranch_scc1 M_z_w0_loop
    s_branch M_g3
M_z_w1_loop:
    v_mov_b32 v56, 0
    v_mov_b32 v57, 0
    v_mov_b32 v58, 0
    v_mov_b32 v59, 0
    v_mov_b32 v60, 0
    v_mov_b32 v61, 0
    v_mov_b32 v62, 0
    v_mov_b32 v63, 0
    v_mov_b32 v64, 0
    v_mov_b32 v65, 0
    v_mov_b32 v66, 0
    v_mov_b32 v67, 0
    v_mov_b32 v68, 0
    v_mov_b32 v69, 0
    v_mov_b32 v70, 0
    v_mov_b32 v71, 0
    v_mov_b32 v72, 0
    v_mov_b32 v73, 0
    v_mov_b32 v74, 0
    v_mov_b32 v75, 0
    v_mov_b32 v76, 0
    v_mov_b32 v77, 0
    v_mov_b32 v78, 0
    v_mov_b32 v79, 0
    v_mov_b32 v80, 0
    v_mov_b32 v81, 0
    v_mov_b32 v82, 0
    v_mov_b32 v83, 0
    v_mov_b32 v84, 0
    v_mov_b32 v85, 0
    v_mov_b32 v86, 0
    v_mov_b32 v87, 0
    v_mov_b32 v88, 0
    v_mov_b32 v89, 0
    v_mov_b32 v90, 0
    v_mov_b32 v91, 0
    v_mov_b32 v92, 0
    v_mov_b32 v93, 0
    v_mov_b32 v94, 0
    v_mov_b32 v95, 0
    v_mov_b32 v96, 0
    v_mov_b32 v97, 0
    v_mov_b32 v98, 0
    v_mov_b32 v99, 0
    v_mov_b32 v100, 0
    v_mov_b32 v101, 0
    v_mov_b32 v102, 0
    v_mov_b32 v103, 0
    v_mov_b32 v104, 0
    v_mov_b32 v105, 0
    v_mov_b32 v106, 0
    v_mov_b32 v107, 0
    ds_read_b128 v[108:111], v3 offset:0
    ds_read_b128 v[112:115], v3 offset:1024
    ds_read_b128 v[116:119], v3 offset:6144
    ds_read_b128 v[120:123], v3 offset:7168
    s_sub_u32 s46, s22, 1
    s_lshr_b32 s28, s46, 1
    s_xor_b32 s28, s28, s53
    s_and_b32 s28, s28, 1
    s_xor_b32 s28, s28, 1
    s_lshl_b32 s28, s28, 13
    s_lshl_b32 s40, s46, 20
    s_add_u32 s40, s40, s28
    s_add_u32 s40, s40, 0xc0c0000
    s_lshr_b32 s28, s22, 1
    s_xor_b32 s28, s28, s53
    s_and_b32 s28, s28, 1
    s_xor_b32 s28, s28, 1
    s_lshl_b32 s28, s28, 13
    s_lshl_b32 s43, s22, 20
    s_add_u32 s43, s43, s28
    s_add_u32 s43, s43, s42
    s_cmp_lt_u32 s22, s54
    s_cselect_b32 s45, 0x0, s44
    s_add_u32 s48, s43, 131072
    s_add_u32 s49, s43, 262144
    s_add_u32 s50, s43, 393216
    s_add_u32 s51, s43, 524288
    s_waitcnt lgkmcnt(0)
    s_barrier
    buffer_load_dwordx4 v[20:23], v4, s[8:11], s40 offen sc1
    s_barrier
    buffer_load_dwordx4 v[36:39], v5, s[8:11], s40 offen sc1
    s_barrier
    buffer_load_dwordx4 v[48:51], v6, s[8:11], s40 offen sc1
    s_mov_b32 s39, 1
    s_waitcnt vmcnt(2)
    ds_write_b128 v7, v[20:23] offset:0
    v_max3_u32 v11, v20, v21, v22
    v_max_u32 v11, v11, v23
    v_cmp_eq_u32 vcc, -1, v11
    v_smfmac_f32_16x16x64_bf16 v[56:59], v[20:23], a[24:31], v10
    v_smfmac_f32_16x16x64_bf16 v[60:63], v[20:23], a[32:39], v10
    v_smfmac_f32_16x16x64_bf16 v[64:67], v[20:23], a[40:47], v10
    s_cbranch_vccnz M_z_w1_slow1
M_z_w1_back1:
    s_waitcnt lgkmcnt(0)
    s_barrier
    ds_read_b128 v[16:19], v9 offset:0
    ds_read_b128 v[24:27], v9 offset:2048
    ds_read_b128 v[28:31], v9 offset:3072
    s_waitcnt vmcnt(1)
    ds_write_b128 v7, v[36:39] offset:4096
    v_smfmac_f32_16x16x64_bf16 v[56:59], v[36:39], a[120:127], v10
    v_max3_u32 v11, v36, v37, v38
    v_max_u32 v11, v11, v39
    v_smfmac_f32_16x16x64_bf16 v[60:63], v[36:39], a[128:135], v10
    s_waitcnt vmcnt(0)
    ds_write_b128 v7, v[48:51] offset:7168
    v_max3_u32 v11, v11, v48, v49
    v_max3_u32 v11, v11, v50, v51
    v_cmp_eq_u32 vcc, -1, v11
    v_smfmac_f32_16x16x64_bf16 v[64:67], v[36:39], a[136:143], v10
    s_waitcnt lgkmcnt(4)
    v_smfmac_f32_16x16x64_bf16 v[56:59], v[16:19], a[0:7], v10
    v_smfmac_f32_16x16x64_bf16 v[60:63], v[16:19], a[8:15], v10
    s_cbranch_vccnz M_z_w1_slow2
M_z_w1_back2:
    s_waitcnt lgkmcnt(0)
    s_barrier
    v_smfmac_f32_16x16x64_bf16 v[64:67], v[16:19], a[16:23], v10
    ds_read_b128 v[32:35], v9 offset:4096
    v_smfmac_f32_16x16x64_bf16 v[56:59], v[24:27], a[48:55], v10
    ds_read_b128 v[52:55], v9 offset:9216
    ds_read_b128 v[40:43], v9 offset:6144
    v_smfmac_f32_16x16x64_bf16 v[60:63], v[24:27], a[56:63], v10
    ds_read_b128 v[44:47], v9 offset:7168
    v_smfmac_f32_16x16x64_bf16 v[64:67], v[24:27], a[64:71], v10
    v_smfmac_f32_16x16x64_bf16 v[56:59], v[28:31], a[72:79], v10
    buffer_load_dword v127, v13, s[8:11], s45 offen sc1
    s_add_u32 s44, s44, 1310720
    v_smfmac_f32_16x16x64_bf16 v[60:63], v[28:31], a[80:87], v10
    s_nop 0
    v_smfmac_f32_16x16x64_bf16 v[64:67], v[28:31], a[88:95], v10
    ds_read_b128 v[16:19], v3 offset:2048
    ds_read_b128 v[20:23], v3 offset:3072
    v_smfmac_f32_16x16x64_bf16 v[56:59], v[48:51], v[108:115], v10
    s_waitcnt lgkmcnt(3)
    ds_read_b128 v[108:111], v3 offset:8192
    v_smfmac_f32_16x16x64_bf16 v[56:59], v[32:35], a[96:103], v10
    ds_read_b128 v[112:115], v3 offset:9216
    ds_read_b128 v[24:27], v3 offset:4096
    v_smfmac_f32_16x16x64_bf16 v[56:59], v[52:55], v[116:123], v10
    ds_read_b128 v[28:31], v3 offset:5120
    ds_read_b128 v[116:119], v3 offset:10240
    v_smfmac_f32_16x16x64_bf16 v[56:59], v[40:43], a[144:151], v10
    s_waitcnt lgkmcnt(7)
    ds_read_b128 v[120:123], v3 offset:11264
    v_smfmac_f32_16x16x64_bf16 v[56:59], v[44:47], a[168:175], v10
    s_nop 1
    v_smfmac_f32_16x16x64_bf16 v[60:63], v[32:35], a[104:111], v10
    s_nop 1
    v_smfmac_f32_16x16x64_bf16 v[64:67], v[32:35], a[112:119], v10
    ds_read_b128 v[32:35], v3 offset:12288
    ds_read_b128 v[36:39], v3 offset:13312
    v_smfmac_f32_16x16x64_bf16 v[60:63], v[40:43], a[152:159], v10
    v_add_f32 v56, v56, v58
    v_smfmac_f32_16x16x64_bf16 v[64:67], v[40:43], a[160:167], v10
    s_waitcnt lgkmcnt(6)
    v_add_f32 v57, v57, v59
    v_smfmac_f32_16x16x64_bf16 v[60:63], v[48:51], v[16:23], v10
    ds_read_b128 v[16:19], v3 offset:14336
    v_cvt_pk_bf16_f32 v124, v56, v57
    v_smfmac_f32_16x16x64_bf16 v[60:63], v[44:47], a[176:183], v10
    ds_read_b128 v[20:23], v3 offset:15360
    v_smfmac_f32_16x16x64_bf16 v[60:63], v[52:55], v[108:115], v10
    s_waitcnt lgkmcnt(6)
    ds_write_b32 v12, v124
    v_smfmac_f32_16x16x64_bf16 v[64:67], v[48:51], v[24:31], v10
    s_nop 1
    v_smfmac_f32_16x16x64_bf16 v[64:67], v[44:47], a[184:191], v10
    s_nop 1
    v_smfmac_f32_16x16x64_bf16 v[64:67], v[52:55], a[192:199], v10
    s_nop 1
    v_pk_add_f32 v[60:61], v[60:61], v[62:63]
    v_cvt_pk_bf16_f32 v125, v60, v61
    s_nop 0
    s_nop 0
    s_nop 0
    s_nop 0
    v_pk_add_f32 v[64:65], v[64:65], v[66:67]
    v_cvt_pk_bf16_f32 v126, v64, v65
    ds_write2_b32 v12, v125, v126 offset0:16 offset1:32
    s_waitcnt lgkmcnt(0)
    s_barrier
    ds_read_b64_tr_b16 v[56:57], v14 offset:0
    ds_read_b64_tr_b16 v[58:59], v14 offset:32
    ds_read_b64_tr_b16 v[60:61], v14 offset:256
    ds_read_b64_tr_b16 v[62:63], v14 offset:288
    ds_read_b64_tr_b16 v[64:65], v14 offset:512
    ds_read_b64_tr_b16 v[66:67], v14 offset:544
    s_waitcnt lgkmcnt(4)
    v_smfmac_f32_16x16x64_bf16 v[68:71], v[56:59], a[200:207], v10
    s_waitcnt lgkmcnt(2)
    v_smfmac_f32_16x16x64_bf16 v[68:71], v[60:63], a[208:215], v10
    s_waitcnt lgkmcnt(0)
    v_smfmac_f32_16x16x64_bf16 v[68:71], v[64:67], a[216:223], v10
    ds_read_b128 v[108:111], v3 offset:16384
    ds_read_b128 v[112:115], v3 offset:17408
    v_smfmac_f32_16x16x64_bf16 v[72:75], v[56:59], a[224:231], v10
    ds_read_b128 v[24:27], v3 offset:18432
    ds_read_b128 v[28:31], v3 offset:19456
    v_smfmac_f32_16x16x64_bf16 v[72:75], v[60:63], a[232:239], v10
    ds_read_b128 v[40:43], v3 offset:20480
    ds_read_b128 v[44:47], v3 offset:21504
    v_smfmac_f32_16x16x64_bf16 v[72:75], v[64:67], v[116:123], v10
    ds_read_b128 v[48:51], v3 offset:22528
    v_add_f32 v68, v68, v70
    v_smfmac_f32_16x16x64_bf16 v[76:79], v[56:59], a[240:247], v10
    ds_read_b128 v[52:55], v3 offset:23552
    v_add_f32 v69, v69, v71
    v_smfmac_f32_16x16x64_bf16 v[76:79], v[60:63], a[248:255], v10
    v_cvt_pk_bf16_f32 v70, v68, v69
    v_smfmac_f32_16x16x64_bf16 v[76:79], v[64:67], v[128:135], v10
    v_add_f32 v72, v72, v74
    v_smfmac_f32_16x16x64_bf16 v[80:83], v[56:59], v[32:39], v10
    v_add_f32 v73, v73, v75
    v_smfmac_f32_16x16x64_bf16 v[80:83], v[60:63], v[136:143], v10
    v_cvt_pk_bf16_f32 v71, v72, v73
    v_smfmac_f32_16x16x64_bf16 v[80:83], v[64:67], v[144:151], v10
    s_nop 1
    v_smfmac_f32_16x16x64_bf16 v[84:87], v[56:59], v[152:159], v10
    v_add_f32 v76, v76, v78
    v_smfmac_f32_16x16x64_bf16 v[84:87], v[60:63], v[16:23], v10
    v_permlane16_swap_b32 v70, v71
    v_smfmac_f32_16x16x64_bf16 v[84:87], v[64:67], v[160:167], v10
    buffer_store_dwordx2 v[70:71], v15, s[8:11], s43 offen sc1
    v_add_f32 v77, v77, v79
    v_smfmac_f32_16x16x64_bf16 v[88:91], v[56:59], v[168:175], v10
    v_cvt_pk_bf16_f32 v78, v76, v77
    v_smfmac_f32_16x16x64_bf16 v[88:91], v[60:63], v[176:183], v10
    s_waitcnt lgkmcnt(6)
    v_add_f32 v80, v80, v82
    v_smfmac_f32_16x16x64_bf16 v[88:91], v[64:67], v[108:115], v10
    v_add_f32 v81, v81, v83
    v_smfmac_f32_16x16x64_bf16 v[92:95], v[56:59], v[184:191], v10
    v_cvt_pk_bf16_f32 v79, v80, v81
    v_smfmac_f32_16x16x64_bf16 v[92:95], v[60:63], v[192:199], v10
    v_add_f32 v84, v84, v86
    v_smfmac_f32_16x16x64_bf16 v[92:95], v[64:67], v[200:207], v10
    s_waitcnt lgkmcnt(4)
    v_permlane16_swap_b32 v78, v79
    v_smfmac_f32_16x16x64_bf16 v[96:99], v[56:59], v[24:31], v10
    buffer_store_dwordx2 v[78:79], v15, s[8:11], s48 offen sc1
    v_add_f32 v85, v85, v87
    v_smfmac_f32_16x16x64_bf16 v[96:99], v[60:63], v[208:215], v10
    v_cvt_pk_bf16_f32 v86, v84, v85
    v_smfmac_f32_16x16x64_bf16 v[96:99], v[64:67], v[216:223], v10
    v_add_f32 v88, v88, v90
    v_smfmac_f32_16x16x64_bf16 v[100:103], v[56:59], v[224:231], v10
    s_waitcnt lgkmcnt(2)
    v_add_f32 v89, v89, v91
    v_smfmac_f32_16x16x64_bf16 v[100:103], v[60:63], v[40:47], v10
    v_cvt_pk_bf16_f32 v87, v88, v89
    v_smfmac_f32_16x16x64_bf16 v[100:103], v[64:67], v[232:239], v10
    v_add_f32 v92, v92, v94
    v_smfmac_f32_16x16x64_bf16 v[104:107], v[56:59], v[240:247], v10
    v_permlane16_swap_b32 v86, v87
    v_smfmac_f32_16x16x64_bf16 v[104:107], v[60:63], v[248:255], v10
    s_waitcnt lgkmcnt(0)
    v_add_f32 v93, v93, v95
    v_smfmac_f32_16x16x64_bf16 v[104:107], v[64:67], v[48:55], v10
    buffer_store_dwordx2 v[86:87], v15, s[8:11], s49 offen sc1
    v_cvt_pk_bf16_f32 v94, v92, v93
    v_add_f32 v96, v96, v98
    v_add_f32 v97, v97, v99
    v_cvt_pk_bf16_f32 v95, v96, v97
    v_pk_add_f32 v[100:101], v[100:101], v[102:103]
    s_nop 0
    v_permlane16_swap_b32 v94, v95
    v_cvt_pk_bf16_f32 v102, v100, v101
    v_pk_add_f32 v[104:105], v[104:105], v[106:107]
    v_cvt_pk_bf16_f32 v103, v104, v105
    buffer_store_dwordx2 v[94:95], v15, s[8:11], s50 offen sc1
    s_nop 0
    v_permlane16_swap_b32 v102, v103
    buffer_store_dwordx2 v[102:103], v15, s[8:11], s51 offen sc1
    s_add_u32 s22, s22, 1
    s_cmp_lt_u32 s22, 64
    s_cbranch_scc1 M_z_w1_loop
    s_branch M_g3
M_z_w2_loop:
    v_mov_b32 v56, 0
    v_mov_b32 v57, 0
    v_mov_b32 v58, 0
    v_mov_b32 v59, 0
    v_mov_b32 v60, 0
    v_mov_b32 v61, 0
    v_mov_b32 v62, 0
    v_mov_b32 v63, 0
    v_mov_b32 v64, 0
    v_mov_b32 v65, 0
    v_mov_b32 v66, 0
    v_mov_b32 v67, 0
    v_mov_b32 v68, 0
    v_mov_b32 v69, 0
    v_mov_b32 v70, 0
    v_mov_b32 v71, 0
    v_mov_b32 v72, 0
    v_mov_b32 v73, 0
    v_mov_b32 v74, 0
    v_mov_b32 v75, 0
    v_mov_b32 v76, 0
    v_mov_b32 v77, 0
    v_mov_b32 v78, 0
    v_mov_b32 v79, 0
    v_mov_b32 v80, 0
    v_mov_b32 v81, 0
    v_mov_b32 v82, 0
    v_mov_b32 v83, 0
    v_mov_b32 v84, 0
    v_mov_b32 v85, 0
    v_mov_b32 v86, 0
    v_mov_b32 v87, 0
    v_mov_b32 v88, 0
    v_mov_b32 v89, 0
    v_mov_b32 v90, 0
    v_mov_b32 v91, 0
    v_mov_b32 v92, 0
    v_mov_b32 v93, 0
    v_mov_b32 v94, 0
    v_mov_b32 v95, 0
    v_mov_b32 v96, 0
    v_mov_b32 v97, 0
    v_mov_b32 v98, 0
    v_mov_b32 v99, 0
    v_mov_b32 v100, 0
    v_mov_b32 v101, 0
    v_mov_b32 v102, 0
    v_mov_b32 v103, 0
    v_mov_b32 v104, 0
    v_mov_b32 v105, 0
    v_mov_b32 v106, 0
    v_mov_b32 v107, 0
    ds_read_b128 v[108:111], v3 offset:0
    ds_read_b128 v[112:115], v3 offset:1024
    ds_read_b128 v[116:119], v3 offset:6144
    ds_read_b128 v[120:123], v3 offset:7168
    s_sub_u32 s46, s22, 1
    s_lshr_b32 s28, s46, 1
    s_xor_b32 s28, s28, s53
    s_and_b32 s28, s28, 1
    s_xor_b32 s28, s28, 1
    s_lshl_b32 s28, s28, 13
    s_lshl_b32 s40, s46, 20
    s_add_u32 s40, s40, s28
    s_add_u32 s40, s40, 0xc0c0000
    s_lshr_b32 s28, s22, 1
    s_xor_b32 s28, s28, s53
    s_and_b32 s28, s28, 1
    s_xor_b32 s28, s28, 1
    s_lshl_b32 s28, s28, 13
    s_lshl_b32 s43, s22, 20
    s_add_u32 s43, s43, s28
    s_add_u32 s43, s43, s42
    s_cmp_lt_u32 s22, s54
    s_cselect_b32 s45, 0x0, s44
    s_add_u32 s48, s43, 131072
    s_add_u32 s49, s43, 262144
    s_add_u32 s50, s43, 393216
    s_add_u32 s51, s43, 524288
    s_waitcnt lgkmcnt(0)
    s_barrier
    buffer_load_dwordx4 v[24:27], v4, s[8:11], s40 offen sc1
    s_barrier
    buffer_load_dwordx4 v[40:43], v5, s[8:11], s40 offen sc1
    s_barrier
    buffer_load_dwordx4 v[52:55], v6, s[8:11], s40 offen sc1
    s_mov_b32 s39, 1
    s_waitcnt vmcnt(2)
    ds_write_b128 v7, v[24:27] offset:0
    v_max3_u32 v11, v24, v25, v26
    v_max_u32 v11, v11, v27
    v_cmp_eq_u32 vcc, -1, v11
    v_smfmac_f32_16x16x64_bf16 v[56:59], v[24:27], a[48:55], v10
    v_smfmac_f32_16x16x64_bf16 v[60:63], v[24:27], a[56:63], v10
    v_smfmac_f32_16x16x64_bf16 v[64:67], v[24:27], a[64:71], v10
    s_cbranch_vccnz M_z_w2_slow1
M_z_w2_back1:
    s_waitcnt lgkmcnt(0)
    s_barrier
    ds_read_b128 v[16:19], v9 offset:0
    ds_read_b128 v[20:23], v9 offset:1024
    ds_read_b128 v[28:31], v9 offset:3072
    s_waitcnt vmcnt(1)
    ds_write_b128 v7, v[40:43] offset:4096
    v_smfmac_f32_16x16x64_bf16 v[56:59], v[40:43], a[144:151], v10
    v_max3_u32 v11, v40, v41, v42
    v_max_u32 v11, v11, v43
    v_smfmac_f32_16x16x64_bf16 v[60:63], v[40:43], a[152:159], v10
    s_waitcnt vmcnt(0)
    ds_write_b128 v7, v[52:55] offset:7168
    v_max3_u32 v11, v11, v52, v53
    v_max3_u32 v11, v11, v54, v55
    v_cmp_eq_u32 vcc, -1, v11
    v_smfmac_f32_16x16x64_bf16 v[64:67], v[40:43], a[160:167], v10
    s_waitcnt lgkmcnt(4)
    v_smfmac_f32_16x16x64_bf16 v[56:59], v[16:19], a[0:7], v10
    v_smfmac_f32_16x16x64_bf16 v[60:63], v[16:19], a[8:15], v10
    s_cbranch_vccnz M_z_w2_slow2
M_z_w2_back2:
    s_waitcnt lgkmcnt(0)
    s_barrier
    v_smfmac_f32_16x16x64_bf16 v[64:67], v[16:19], a[16:23], v10
    ds_read_b128 v[48:51], v9 offset:8192
    v_smfmac_f32_16x16x64_bf16 v[56:59], v[20:23], a[24:31], v10
    ds_read_b128 v[32:35], v9 offset:4096
    ds_read_b128 v[36:39], v9 offset:5120
    v_smfmac_f32_16x16x64_bf16 v[60:63], v[20:23], a[32:39], v10
    ds_read_b128 v[44:47], v9 offset:7168
    v_smfmac_f32_16x16x64_bf16 v[64:67], v[20:23], a[40:47], v10
    v_smfmac_f32_16x16x64_bf16 v[56:59], v[28:31], a[72:79], v10
    buffer_load_dword v127, v13, s[8:11], s45 offen sc1
    s_add_u32 s44, s44, 1310720
    v_smfmac_f32_16x16x64_bf16 v[60:63], v[28:31], a[80:87], v10
    s_nop 0
    v_smfmac_f32_16x16x64_bf16 v[64:67], v[28:31], a[88:95], v10
    s_waitcnt lgkmcnt(2)
    ds_read_b128 v[16:19], v3 offset:2048
    v_smfmac_f32_16x16x64_bf16 v[56:59], v[48:51], v[108:115], v10
    ds_read_b128 v[20:23], v3 offset:3072
    ds_read_b128 v[108:111], v3 offset:8192
    v_smfmac_f32_16x16x64_bf16 v[56:59], v[32:35], a[96:103], v10
    ds_read_b128 v[112:115], v3 offset:9216
    ds_read_b128 v[24:27], v3 offset:4096
    v_smfmac_f32_16x16x64_bf16 v[56:59], v[52:55], v[116:123], v10
    s_waitcnt lgkmcnt(5)
    ds_read_b128 v[28:31], v3 offset:5120
    v_smfmac_f32_16x16x64_bf16 v[56:59], v[36:39], a[120:127], v10
    ds_read_b128 v[116:119], v3 offset:10240
    ds_read_b128 v[120:123], v3 offset:11264
    v_smfmac_f32_16x16x64_bf16 v[56:59], v[44:47], a[168:175], v10
    s_nop 1
    v_smfmac_f32_16x16x64_bf16 v[60:63], v[32:35], a[104:111], v10
    s_nop 1
    v_smfmac_f32_16x16x64_bf16 v[64:67], v[32:35], a[112:119], v10
    s_nop 1
    v_smfmac_f32_16x16x64_bf16 v[60:63], v[36:39], a[128:135], v10
    v_add_f32 v56, v56, v58
    v_smfmac_f32_16x16x64_bf16 v[64:67], v[36:39], a[136:143], v10
    s_waitcnt lgkmcnt(4)
    v_add_f32 v57, v57, v59
    v_smfmac_f32_16x16x64_bf16 v[60:63], v[48:51], v[16:23], v10
    ds_read_b128 v[32:35], v3 offset:12288
    v_cvt_pk_bf16_f32 v124, v56, v57
    v_smfmac_f32_16x16x64_bf16 v[60:63], v[44:47], a[176:183], v10
    ds_read_b128 v[36:39], v3 offset:13312
    ds_read_b128 v[16:19], v3 offset:14336
    v_smfmac_f32_16x16x64_bf16 v[60:63], v[52:55], v[108:115], v10
    s_waitcnt lgkmcnt(5)
    ds_read_b128 v[20:23], v3 offset:15360
    v_smfmac_f32_16x16x64_bf16 v[64:67], v[48:51], v[24:31], v10
    ds_write_b32 v12, v124
    s_nop 0
    v_smfmac_f32_16x16x64_bf16 v[64:67], v[44:47], a[184:191], v10
    s_nop 1
    v_smfmac_f32_16x16x64_bf16 v[64:67], v[52:55], a[192:199], v10
    s_nop 1
    v_pk_add_f32 v[60:61], v[60:61], v[62:63]
    v_cvt_pk_bf16_f32 v125, v60, v61
    s_nop 0
    s_nop 0
    s_nop 0
    s_nop 0
    v_pk_add_f32 v[64:65], v[64:65], v[66:67]
    v_cvt_pk_bf16_f32 v126, v64, v65
    ds_write2_b32 v12, v125, v126 offset0:16 offset1:32
    s_waitcnt lgkmcnt(0)
    s_barrier
    ds_read_b64_tr_b16 v[56:57], v14 offset:0
    ds_read_b64_tr_b16 v[58:59], v14 offset:32
    ds_read_b64_tr_b16 v[60:61], v14 offset:256
    ds_read_b64_tr_b16 v[62:63], v14 offset:288
    ds_read_b64_tr_b16 v[64:65], v14 offset:512
    ds_read_b64_tr_b16 v[66:67], v14 offset:544
    s_waitcnt lgkmcnt(4)
    v_smfmac_f32_16x16x64_bf16 v[68:71], v[56:59], a[200:207], v10
    s_waitcnt lgkmcnt(2)
    v_smfmac_f32_16x16x64_bf16 v[68:71], v[60:63], a[208:215], v10
    s_waitcnt lgkmcnt(0)
    v_smfmac_f32_16x16x64_bf16 v[68:71], v[64:67], a[216:223], v10
    ds_read_b128 v[108:111], v3 offset:16384
    ds_read_b128 v[112:115], v3 offset:17408
    v_smfmac_f32_16x16x64_bf16 v[72:75], v[56:59], a[224:231], v10
    ds_read_b128 v[24:27], v3 offset:18432
    ds_read_b128 v[28:31], v3 offset:19456
    v_smfmac_f32_16x16x64_bf16 v[72:75], v[60:63], a[232:239], v10
    ds_read_b128 v[40:43], v3 offset:20480
    ds_read_b128 v[44:47], v3 offset:21504
    v_smfmac_f32_16x16x64_bf16 v[72:75], v[64:67], v[116:123], v10
    ds_read_b128 v[48:51], v3 offset:22528
    v_add_f32 v68, v68, v70
    v_smfmac_f32_16x16x64_bf16 v[76:79], v[56:59], a[240:247], v10
    ds_read_b128 v[52:55], v3 offset:23552
    v_add_f32 v69, v69, v71
    v_smfmac_f32_16x16x64_bf16 v[76:79], v[60:63], a[248:255], v10
    v_cvt_pk_bf16_f32 v70, v68, v69
    v_smfmac_f32_16x16x64_bf16 v[76:79], v[64:67], v[128:135], v10
    v_add_f32 v72, v72, v74
    v_smfmac_f32_16x16x64_bf16 v[80:83], v[56:59], v[32:39], v10
    v_add_f32 v73, v73, v75
    v_smfmac_f32_16x16x64_bf16 v[80:83], v[60:63], v[136:143], v10
    v_cvt_pk_bf16_f32 v71, v72, v73
    v_smfmac_f32_16x16x64_bf16 v[80:83], v[64:67], v[144:151], v10
    s_nop 1
    v_smfmac_f32_16x16x64_bf16 v[84:87], v[56:59], v[152:159], v10
    v_add_f32 v76, v76, v78
    v_smfmac_f32_16x16x64_bf16 v[84:87], v[60:63], v[16:23], v10
    v_permlane16_swap_b32 v70, v71
    v_smfmac_f32_16x16x64_bf16 v[84:87], v[64:67], v[160:167], v10
    buffer_store_dwordx2 v[70:71], v15, s[8:11], s43 offen sc1
    v_add_f32 v77, v77, v79
    v_smfmac_f32_16x16x64_bf16 v[88:91], v[56:59], v[168:175], v10
    v_cvt_pk_bf16_f32 v78, v76, v77
    v_smfmac_f32_16x16x64_bf16 v[88:91], v[60:63], v[176:183], v10
    s_waitcnt lgkmcnt(6)
    v_add_f32 v80, v80, v82
    v_smfmac_f32_16x16x64_bf16 v[88:91], v[64:67], v[108:115], v10
    v_add_f32 v81, v81, v83
    v_smfmac_f32_16x16x64_bf16 v[92:95], v[56:59], v[184:191], v10
    v_cvt_pk_bf16_f32 v79, v80, v81
    v_smfmac_f32_16x16x64_bf16 v[92:95], v[60:63], v[192:199], v10
    v_add_f32 v84, v84, v86
    v_smfmac_f32_16x16x64_bf16 v[92:95], v[64:67], v[200:207], v10
    s_waitcnt lgkmcnt(4)
    v_permlane16_swap_b32 v78, v79
    v_smfmac_f32_16x16x64_bf16 v[96:99], v[56:59], v[24:31], v10
    buffer_store_dwordx2 v[78:79], v15, s[8:11], s48 offen sc1
    v_add_f32 v85, v85, v87
    v_smfmac_f32_16x16x64_bf16 v[96:99], v[60:63], v[208:215], v10
    v_cvt_pk_bf16_f32 v86, v84, v85
    v_smfmac_f32_16x16x64_bf16 v[96:99], v[64:67], v[216:223], v10
    v_add_f32 v88, v88, v90
    v_smfmac_f32_16x16x64_bf16 v[100:103], v[56:59], v[224:231], v10
    s_waitcnt lgkmcnt(2)
    v_add_f32 v89, v89, v91
    v_smfmac_f32_16x16x64_bf16 v[100:103], v[60:63], v[40:47], v10
    v_cvt_pk_bf16_f32 v87, v88, v89
    v_smfmac_f32_16x16x64_bf16 v[100:103], v[64:67], v[232:239], v10
    v_add_f32 v92, v92, v94
    v_smfmac_f32_16x16x64_bf16 v[104:107], v[56:59], v[240:247], v10
    v_permlane16_swap_b32 v86, v87
    v_smfmac_f32_16x16x64_bf16 v[104:107], v[60:63], v[248:255], v10
    s_waitcnt lgkmcnt(0)
    v_add_f32 v93, v93, v95
    v_smfmac_f32_16x16x64_bf16 v[104:107], v[64:67], v[48:55], v10
    buffer_store_dwordx2 v[86:87], v15, s[8:11], s49 offen sc1
    v_cvt_pk_bf16_f32 v94, v92, v93
    v_add_f32 v96, v96, v98
    v_add_f32 v97, v97, v99
    v_cvt_pk_bf16_f32 v95, v96, v97
    v_pk_add_f32 v[100:101], v[100:101], v[102:103]
    s_nop 0
    v_permlane16_swap_b32 v94, v95
    v_cvt_pk_bf16_f32 v102, v100, v101
    v_pk_add_f32 v[104:105], v[104:105], v[106:107]
    v_cvt_pk_bf16_f32 v103, v104, v105
    buffer_store_dwordx2 v[94:95], v15, s[8:11], s50 offen sc1
    s_nop 0
    v_permlane16_swap_b32 v102, v103
    buffer_store_dwordx2 v[102:103], v15, s[8:11], s51 offen sc1
    s_add_u32 s22, s22, 1
    s_cmp_lt_u32 s22, 64
    s_cbranch_scc1 M_z_w2_loop
    s_branch M_g3
M_z_w3_loop:
    v_mov_b32 v56, 0
    v_mov_b32 v57, 0
    v_mov_b32 v58, 0
    v_mov_b32 v59, 0
    v_mov_b32 v60, 0
    v_mov_b32 v61, 0
    v_mov_b32 v62, 0
    v_mov_b32 v63, 0
    v_mov_b32 v64, 0
    v_mov_b32 v65, 0
    v_mov_b32 v66, 0
    v_mov_b32 v67, 0
    v_mov_b32 v68, 0
    v_mov_b32 v69, 0
    v_mov_b32 v70, 0
    v_mov_b32 v71, 0
    v_mov_b32 v72, 0
    v_mov_b32 v73, 0
    v_mov_b32 v74, 0
    v_mov_b32 v75, 0
    v_mov_b32 v76, 0
    v_mov_b32 v77, 0
    v_mov_b32 v78, 0
    v_mov_b32 v79, 0
    v_mov_b32 v80, 0
    v_mov_b32 v81, 0
    v_mov_b32 v82, 0
    v_mov_b32 v83, 0
    v_mov_b32 v84, 0
    v_mov_b32 v85, 0
    v_mov_b32 v86, 0
    v_mov_b32 v87, 0
    v_mov_b32 v88, 0
    v_mov_b32 v89, 0
    v_mov_b32 v90, 0
    v_mov_b32 v91, 0
    v_mov_b32 v92, 0
    v_mov_b32 v93, 0
    v_mov_b32 v94, 0
    v_mov_b32 v95, 0
    v_mov_b32 v96, 0
    v_mov_b32 v97, 0
    v_mov_b32 v98, 0
    v_mov_b32 v99, 0
    v_mov_b32 v100, 0
    v_mov_b32 v101, 0
    v_mov_b32 v102, 0
    v_mov_b32 v103, 0
    v_mov_b32 v104, 0
    v_mov_b32 v105, 0
    v_mov_b32 v106, 0
    v_mov_b32 v107, 0
    ds_read_b128 v[108:111], v3 offset:0
    ds_read_b128 v[112:115], v3 offset:1024
    ds_read_b128 v[116:119], v3 offset:6144
    ds_read_b128 v[120:123], v3 offset:7168
    s_sub_u32 s46, s22, 1
    s_lshr_b32 s28, s46, 1
    s_xor_b32 s28, s28, s53
    s_and_b32 s28, s28, 1
    s_xor_b32 s28, s28, 1
    s_lshl_b32 s28, s28, 13
    s_lshl_b32 s40, s46, 20
    s_add_u32 s40, s40, s28
    s_add_u32 s40, s40, 0xc0c0000
    s_lshr_b32 s28, s22, 1
    s_xor_b32 s28, s28, s53
    s_and_b32 s28, s28, 1
    s_xor_b32 s28, s28, 1
    s_lshl_b32 s28, s28, 13
    s_lshl_b32 s43, s22, 20
    s_add_u32 s43, s43, s28
    s_add_u32 s43, s43, s42
    s_cmp_lt_u32 s22, s54
    s_cselect_b32 s45, 0x0, s44
    s_add_u32 s48, s43, 131072
    s_add_u32 s49, s43, 262144
    s_add_u32 s50, s43, 393216
    s_add_u32 s51, s43, 524288
    s_waitcnt lgkmcnt(0)
    s_barrier
    buffer_load_dwordx4 v[28:31], v4, s[8:11], s40 offen sc1
    s_barrier
    buffer_load_dwordx4 v[44:47], v5, s[8:11], s40 offen sc1
    s_barrier
    s_mov_b32 s39, 1
    s_waitcnt vmcnt(1)
    ds_write_b128 v7, v[28:31] offset:0
    v_max3_u32 v11, v28, v29, v30
    v_max_u32 v11, v11, v31
    v_cmp_eq_u32 vcc, -1, v11
    v_smfmac_f32_16x16x64_bf16 v[56:59], v[28:31], a[72:79], v10
    v_smfmac_f32_16x16x64_bf16 v[60:63], v[28:31], a[80:87], v10
    v_smfmac_f32_16x16x64_bf16 v[64:67], v[28:31], a[88:95], v10
    s_cbranch_vccnz M_z_w3_slow1
M_z_w3_back1:
    s_waitcnt lgkmcnt(0)
    s_barrier
    ds_read_b128 v[16:19], v9 offset:0
    ds_read_b128 v[20:23], v9 offset:1024
    ds_read_b128 v[24:27], v9 offset:2048
    s_waitcnt vmcnt(0)
    ds_write_b128 v7, v[44:47] offset:4096
    v_smfmac_f32_16x16x64_bf16 v[56:59], v[44:47], a[168:175], v10
    v_max3_u32 v11, v44, v45, v46
    v_max_u32 v11, v11, v47
    v_smfmac_f32_16x16x64_bf16 v[60:63], v[44:47], a[176:183], v10
    v_cmp_eq_u32 vcc, -1, v11
    v_smfmac_f32_16x16x64_bf16 v[64:67], v[44:47], a[184:191], v10
    s_waitcnt lgkmcnt(3)
    v_smfmac_f32_16x16x64_bf16 v[56:59], v[16:19], a[0:7], v10
    v_smfmac_f32_16x16x64_bf16 v[60:63], v[16:19], a[8:15], v10
    s_cbranch_vccnz M_z_w3_slow2
M_z_w3_back2:
    s_waitcnt lgkmcnt(0)
    s_barrier
    v_smfmac_f32_16x16x64_bf16 v[64:67], v[16:19], a[16:23], v10
    ds_read_b128 v[48:51], v9 offset:8192
    v_smfmac_f32_16x16x64_bf16 v[56:59], v[20:23], a[24:31], v10
    ds_read_b128 v[32:35], v9 offset:4096
    ds_read_b128 v[52:55], v9 offset:9216
    v_smfmac_f32_16x16x64_bf16 v[60:63], v[20:23], a[32:39], v10
    ds_read_b128 v[36:39], v9 offset:5120
    ds_read_b128 v[40:43], v9 offset:6144
    v_smfmac_f32_16x16x64_bf16 v[64:67], v[20:23], a[40:47], v10
    v_smfmac_f32_16x16x64_bf16 v[56:59], v[24:27], a[48:55], v10
    buffer_load_dword v127, v13, s[8:11], s45 offen sc1
    s_add_u32 s44, s44, 1310720
    v_smfmac_f32_16x16x64_bf16 v[60:63], v[24:27], a[56:63], v10
    s_nop 0
    v_smfmac_f32_16x16x64_bf16 v[64:67], v[24:27], a[64:71], v10
    s_waitcnt lgkmcnt(2)
    ds_read_b128 v[16:19], v3 offset:2048
    v_smfmac_f32_16x16x64_bf16 v[56:59], v[48:51], v[108:115], v10
    ds_read_b128 v[20:23], v3 offset:3072
    ds_read_b128 v[108:111], v3 offset:8192
    v_smfmac_f32_16x16x64_bf16 v[56:59], v[32:35], a[96:103], v10
    ds_read_b128 v[112:115], v3 offset:9216
    ds_read_b128 v[24:27], v3 offset:4096
    v_smfmac_f32_16x16x64_bf16 v[56:59], v[52:55], v[116:123], v10
    s_waitcnt lgkmcnt(5)
    ds_read_b128 v[28:31], v3 offset:5120
    v_smfmac_f32_16x16x64_bf16 v[56:59], v[36:39], a[120:127], v10
    ds_read_b128 v[116:119], v3 offset:10240
    ds_read_b128 v[120:123], v3 offset:11264
    v_smfmac_f32_16x16x64_bf16 v[56:59], v[40:43], a[144:151], v10
    s_nop 1
    v_smfmac_f32_16x16x64_bf16 v[60:63], v[32:35], a[104:111], v10
    s_nop 1
    v_smfmac_f32_16x16x64_bf16 v[64:67], v[32:35], a[112:119], v10
    s_nop 1
    v_smfmac_f32_16x16x64_bf16 v[60:63], v[36:39], a[128:135], v10
    v_add_f32 v56, v56, v58
    v_smfmac_f32_16x16x64_bf16 v[64:67], v[36:39], a[136:143], v10
    s_waitcnt lgkmcnt(4)
    v_add_f32 v57, v57, v59
    v_smfmac_f32_16x16x64_bf16 v[60:63], v[48:51], v[16:23], v10
    ds_read_b128 v[32:35], v3 offset:12288
    v_cvt_pk_bf16_f32 v124, v56, v57
    v_smfmac_f32_16x16x64_bf16 v[60:63], v[40:43], a[152:159], v10
    ds_read_b128 v[36:39], v3 offset:13312
    ds_read_b128 v[16:19], v3 offset:14336
    v_smfmac_f32_16x16x64_bf16 v[60:63], v[52:55], v[108:115], v10
    s_waitcnt lgkmcnt(5)
    ds_read_b128 v[20:23], v3 offset:15360
    v_smfmac_f32_16x16x64_bf16 v[64:67], v[48:51], v[24:31], v10
    ds_write_b32 v12, v124
    s_nop 0
    v_smfmac_f32_16x16x64_bf16 v[64:67], v[40:43], a[160:167], v10
    s_nop 1
    v_smfmac_f32_16x16x64_bf16 v[64:67], v[52:55], a[192:199], v10
    s_nop 1
    v_pk_add_f32 v[60:61], v[60:61], v[62:63]
    v_cvt_pk_bf16_f32 v125, v60, v61
    s_nop 0
    s_nop 0
    s_nop 0
    s_nop 0
    v_pk_add_f32 v[64:65], v[64:65], v[66:67]
    v_cvt_pk_bf16_f32 v126, v64, v65
    ds_write2_b32 v12, v125, v126 offset0:16 offset1:32
    s_waitcnt lgkmcnt(0)
    s_barrier
    ds_read_b64_tr_b16 v[56:57], v14 offset:0
    ds_read_b64_tr_b16 v[58:59], v14 offset:32
    ds_read_b64_tr_b16 v[60:61], v14 offset:256
    ds_read_b64_tr_b16 v[62:63], v14 offset:288
    ds_read_b64_tr_b16 v[64:65], v14 offset:512
    ds_read_b64_tr_b16 v[66:67], v14 offset:544
    s_waitcnt lgkmcnt(4)
    v_smfmac_f32_16x16x64_bf16 v[68:71], v[56:59], a[200:207], v10
    s_waitcnt lgkmcnt(2)
    v_smfmac_f32_16x16x64_bf16 v[68:71], v[60:63], a[208:215], v10
    s_waitcnt lgkmcnt(0)
    v_smfmac_f32_16x16x64_bf16 v[68:71], v[64:67], a[216:223], v10
    ds_read_b128 v[108:111], v3 offset:16384
    ds_read_b128 v[112:115], v3 offset:17408
    v_smfmac_f32_16x16x64_bf16 v[72:75], v[56:59], a[224:231], v10
    ds_read_b128 v[24:27], v3 offset:18432
    ds_read_b128 v[28:31], v3 offset:19456
    v_smfmac_f32_16x16x64_bf16 v[72:75], v[60:63], a[232:239], v10
    ds_read_b128 v[40:43], v3 offset:20480
    ds_read_b128 v[44:47], v3 offset:21504
    v_smfmac_f32_16x16x64_bf16 v[72:75], v[64:67], v[116:123], v10
    ds_read_b128 v[48:51], v3 offset:22528
    v_add_f32 v68, v68, v70
    v_smfmac_f32_16x16x64_bf16 v[76:79], v[56:59], a[240:247], v10
    ds_read_b128 v[52:55], v3 offset:23552
    v_add_f32 v69, v69, v71
    v_smfmac_f32_16x16x64_bf16 v[76:79], v[60:63], a[248:255], v10
    v_cvt_pk_bf16_f32 v70, v68, v69
    v_smfmac_f32_16x16x64_bf16 v[76:79], v[64:67], v[128:135], v10
    v_add_f32 v72, v72, v74
    v_smfmac_f32_16x16x64_bf16 v[80:83], v[56:59], v[32:39], v10
    v_add_f32 v73, v73, v75
    v_smfmac_f32_16x16x64_bf16 v[80:83], v[60:63], v[136:143], v10
    v_cvt_pk_bf16_f32 v71, v72, v73
    v_smfmac_f32_16x16x64_bf16 v[80:83], v[64:67], v[144:151], v10
    s_nop 1
    v_smfmac_f32_16x16x64_bf16 v[84:87], v[56:59], v[152:159], v10
    v_add_f32 v76, v76, v78
    v_smfmac_f32_16x16x64_bf16 v[84:87], v[60:63], v[16:23], v10
    v_permlane16_swap_b32 v70, v71
    v_smfmac_f32_16x16x64_bf16 v[84:87], v[64:67], v[160:167], v10
    buffer_store_dwordx2 v[70:71], v15, s[8:11], s43 offen sc1
    v_add_f32 v77, v77, v79
    v_smfmac_f32_16x16x64_bf16 v[88:91], v[56:59], v[168:175], v10
    v_cvt_pk_bf16_f32 v78, v76, v77
    v_smfmac_f32_16x16x64_bf16 v[88:91], v[60:63], v[176:183], v10
    s_waitcnt lgkmcnt(6)
    v_add_f32 v80, v80, v82
    v_smfmac_f32_16x16x64_bf16 v[88:91], v[64:67], v[108:115], v10
    v_add_f32 v81, v81, v83
    v_smfmac_f32_16x16x64_bf16 v[92:95], v[56:59], v[184:191], v10
    v_cvt_pk_bf16_f32 v79, v80, v81
    v_smfmac_f32_16x16x64_bf16 v[92:95], v[60:63], v[192:199], v10
    v_add_f32 v84, v84, v86
    v_smfmac_f32_16x16x64_bf16 v[92:95], v[64:67], v[200:207], v10
    s_waitcnt lgkmcnt(4)
    v_permlane16_swap_b32 v78, v79
    v_smfmac_f32_16x16x64_bf16 v[96:99], v[56:59], v[24:31], v10
    buffer_store_dwordx2 v[78:79], v15, s[8:11], s48 offen sc1
    v_add_f32 v85, v85, v87
    v_smfmac_f32_16x16x64_bf16 v[96:99], v[60:63], v[208:215], v10
    v_cvt_pk_bf16_f32 v86, v84, v85
    v_smfmac_f32_16x16x64_bf16 v[96:99], v[64:67], v[216:223], v10
    v_add_f32 v88, v88, v90
    v_smfmac_f32_16x16x64_bf16 v[100:103], v[56:59], v[224:231], v10
    s_waitcnt lgkmcnt(2)
    v_add_f32 v89, v89, v91
    v_smfmac_f32_16x16x64_bf16 v[100:103], v[60:63], v[40:47], v10
    v_cvt_pk_bf16_f32 v87, v88, v89
    v_smfmac_f32_16x16x64_bf16 v[100:103], v[64:67], v[232:239], v10
    v_add_f32 v92, v92, v94
    v_smfmac_f32_16x16x64_bf16 v[104:107], v[56:59], v[240:247], v10
    v_permlane16_swap_b32 v86, v87
    v_smfmac_f32_16x16x64_bf16 v[104:107], v[60:63], v[248:255], v10
    s_waitcnt lgkmcnt(0)
    v_add_f32 v93, v93, v95
    v_smfmac_f32_16x16x64_bf16 v[104:107], v[64:67], v[48:55], v10
    buffer_store_dwordx2 v[86:87], v15, s[8:11], s49 offen sc1
    v_cvt_pk_bf16_f32 v94, v92, v93
    v_add_f32 v96, v96, v98
    v_add_f32 v97, v97, v99
    v_cvt_pk_bf16_f32 v95, v96, v97
    v_pk_add_f32 v[100:101], v[100:101], v[102:103]
    s_nop 0
    v_permlane16_swap_b32 v94, v95
    v_cvt_pk_bf16_f32 v102, v100, v101
    v_pk_add_f32 v[104:105], v[104:105], v[106:107]
    v_cvt_pk_bf16_f32 v103, v104, v105
    buffer_store_dwordx2 v[94:95], v15, s[8:11], s50 offen sc1
    s_nop 0
    v_permlane16_swap_b32 v102, v103
    buffer_store_dwordx2 v[102:103], v15, s[8:11], s51 offen sc1
    s_add_u32 s22, s22, 1
    s_cmp_lt_u32 s22, 64
    s_cbranch_scc1 M_z_w3_loop
    s_branch M_g3
M_z_w0_slow1:
    s_mov_b64 exec, vcc
    buffer_load_dwordx4 v[16:19], v4, s[8:11], s40 offen sc1
    buffer_load_dwordx4 v[32:35], v5, s[8:11], s40 offen sc1
    s_mov_b64 exec, -1
    s_nop 2
    v_mov_b32 v56, 0
    v_mov_b32 v57, 0
    v_mov_b32 v58, 0
    v_mov_b32 v59, 0
    v_mov_b32 v60, 0
    v_mov_b32 v61, 0
    v_mov_b32 v62, 0
    v_mov_b32 v63, 0
    v_mov_b32 v64, 0
    v_mov_b32 v65, 0
    v_mov_b32 v66, 0
    v_mov_b32 v67, 0
    s_add_u32 s39, s39, 1
    s_cmp_gt_u32 s39, 400000
    s_cbranch_scc1 M_fail
    s_waitcnt vmcnt(0)
    ds_write_b128 v7, v[16:19] offset:0
    ds_write_b128 v7, v[32:35] offset:4096
    v_max3_u32 v11, v16, v17, v18
    v_max3_u32 v11, v11, v19, v32
    v_max3_u32 v11, v11, v33, v34
    v_max_u32 v11, v11, v35
    v_cmp_eq_u32 vcc, -1, v11
    s_cbranch_vccnz M_z_w0_slow1
    v_smfmac_f32_16x16x64_bf16 v[56:59], v[16:19], a[0:7], v10
    v_smfmac_f32_16x16x64_bf16 v[60:63], v[16:19], a[8:15], v10
    v_smfmac_f32_16x16x64_bf16 v[64:67], v[16:19], a[16:23], v10
    s_waitcnt lgkmcnt(0)
    s_branch M_z_w0_back1
M_z_w0_slow2:
    s_mov_b64 exec, vcc
    buffer_load_dwordx4 v[16:19], v4, s[8:11], s40 offen sc1
    buffer_load_dwordx4 v[32:35], v5, s[8:11], s40 offen sc1
    s_mov_b64 exec, -1
    s_nop 2
    v_mov_b32 v56, 0
    v_mov_b32 v57, 0
    v_mov_b32 v58, 0
    v_mov_b32 v59, 0
    v_mov_b32 v60, 0
    v_mov_b32 v61, 0
    v_mov_b32 v62, 0
    v_mov_b32 v63, 0
    v_mov_b32 v64, 0
    v_mov_b32 v65, 0
    v_mov_b32 v66, 0
    v_mov_b32 v67, 0
    s_add_u32 s39, s39, 1
    s_cmp_gt_u32 s39, 400000
    s_cbranch_scc1 M_fail
    s_waitcnt vmcnt(0)
    ds_write_b128 v7, v[16:19] offset:0
    ds_write_b128 v7, v[32:35] offset:4096
    v_max3_u32 v11, v16, v17, v18
    v_max3_u32 v11, v11, v19, v32
    v_max3_u32 v11, v11, v33, v34
    v_max_u32 v11, v11, v35
    v_cmp_eq_u32 vcc, -1, v11
    s_cbranch_vccnz M_z_w0_slow2
    v_smfmac_f32_16x16x64_bf16 v[56:59], v[16:19], a[0:7], v10
    v_smfmac_f32_16x16x64_bf16 v[60:63], v[16:19], a[8:15], v10
    v_smfmac_f32_16x16x64_bf16 v[64:67], v[16:19], a[16:23], v10
    v_smfmac_f32_16x16x64_bf16 v[56:59], v[32:35], a[96:103], v10
    v_smfmac_f32_16x16x64_bf16 v[60:63], v[32:35], a[104:111], v10
    v_smfmac_f32_16x16x64_bf16 v[64:67], v[32:35], a[112:119], v10
    v_smfmac_f32_16x16x64_bf16 v[56:59], v[20:23], a[24:31], v10
    v_smfmac_f32_16x16x64_bf16 v[60:63], v[20:23], a[32:39], v10
    s_waitcnt lgkmcnt(0)
    s_branch M_z_w0_back2
M_z_w1_slow1:
    s_mov_b64 exec, vcc
    buffer_load_dwordx4 v[20:23], v4, s[8:11], s40 offen sc1
    buffer_load_dwordx4 v[36:39], v5, s[8:11], s40 offen sc1
    buffer_load_dwordx4 v[48:51], v6, s[8:11], s40 offen sc1
    s_mov_b64 exec, -1
    s_nop 2
    v_mov_b32 v56, 0
    v_mov_b32 v57, 0
    v_mov_b32 v58, 0
    v_mov_b32 v59, 0
    v_mov_b32 v60, 0
    v_mov_b32 v61, 0
    v_mov_b32 v62, 0
    v_mov_b32 v63, 0
    v_mov_b32 v64, 0
    v_mov_b32 v65, 0
    v_mov_b32 v66, 0
    v_mov_b32 v67, 0
    s_add_u32 s39, s39, 1
    s_cmp_gt_u32 s39, 400000
    s_cbranch_scc1 M_fail
    s_waitcnt vmcnt(0)
    ds_write_b128 v7, v[20:23] offset:0
    ds_write_b128 v7, v[36:39] offset:4096
    ds_write_b128 v7, v[48:51] offset:7168
    v_max3_u32 v11, v20, v21, v22
    v_max3_u32 v11, v11, v23, v36
    v_max3_u32 v11, v11, v37, v38
    v_max3_u32 v11, v11, v39, v48
    v_max3_u32 v11, v11, v49, v50
    v_max_u32 v11, v11, v51
    v_cmp_eq_u32 vcc, -1, v11
    s_cbranch_vccnz M_z_w1_slow1
    v_smfmac_f32_16x16x64_bf16 v[56:59], v[20:23], a[24:31], v10
    v_smfmac_f32_16x16x64_bf16 v[60:63], v[20:23], a[32:39], v10
    v_smfmac_f32_16x16x64_bf16 v[64:67], v[20:23], a[40:47], v10
    s_waitcnt lgkmcnt(0)
    s_branch M_z_w1_back1
M_z_w1_slow2:
    s_mov_b64 exec, vcc
    buffer_load_dwordx4 v[20:23], v4, s[8:11], s40 offen sc1
    buffer_load_dwordx4 v[36:39], v5, s[8:11], s40 offen sc1
    buffer_load_dwordx4 v[48:51], v6, s[8:11], s40 offen sc1
    s_mov_b64 exec, -1
    s_nop 2
    v_mov_b32 v56, 0
    v_mov_b32 v57, 0
    v_mov_b32 v58, 0
    v_mov_b32 v59, 0
    v_mov_b32 v60, 0
    v_mov_b32 v61, 0
    v_mov_b32 v62, 0
    v_mov_b32 v63, 0
    v_mov_b32 v64, 0
    v_mov_b32 v65, 0
    v_mov_b32 v66, 0
    v_mov_b32 v67, 0
    s_add_u32 s39, s39, 1
    s_cmp_gt_u32 s39, 400000
    s_cbranch_scc1 M_fail
    s_waitcnt vmcnt(0)
    ds_write_b128 v7, v[20:23] offset:0
    ds_write_b128 v7, v[36:39] offset:4096
    ds_write_b128 v7, v[48:51] offset:7168
    v_max3_u32 v11, v20, v21, v22
    v_max3_u32 v11, v11, v23, v36
    v_max3_u32 v11, v11, v37, v38
    v_max3_u32 v11, v11, v39, v48
    v_max3_u32 v11, v11, v49, v50
    v_max_u32 v11, v11, v51
    v_cmp_eq_u32 vcc, -1, v11
    s_cbranch_vccnz M_z_w1_slow2
    v_smfmac_f32_16x16x64_bf16 v[56:59], v[20:23], a[24:31], v10
    v_smfmac_f32_16x16x64_bf16 v[60:63], v[20:23], a[32:39], v10
    v_smfmac_f32_16x16x64_bf16 v[64:67], v[20:23], a[40:47], v10
    v_smfmac_f32_16x16x64_bf16 v[56:59], v[36:39], a[120:127], v10
    v_smfmac_f32_16x16x64_bf16 v[60:63], v[36:39], a[128:135], v10
    v_smfmac_f32_16x16x64_bf16 v[64:67], v[36:39], a[136:143], v10
    v_smfmac_f32_16x16x64_bf16 v[56:59], v[16:19], a[0:7], v10
    v_smfmac_f32_16x16x64_bf16 v[60:63], v[16:19], a[8:15], v10
    s_waitcnt lgkmcnt(0)
    s_branch M_z_w1_back2
M_z_w2_slow1:
    s_mov_b64 exec, vcc
    buffer_load_dwordx4 v[24:27], v4, s[8:11], s40 offen sc1
    buffer_load_dwordx4 v[40:43], v5, s[8:11], s40 offen sc1
    buffer_load_dwordx4 v[52:55], v6, s[8:11], s40 offen sc1
    s_mov_b64 exec, -1
    s_nop 2
    v_mov_b32 v56, 0
    v_mov_b32 v57, 0
    v_mov_b32 v58, 0
    v_mov_b32 v59, 0
    v_mov_b32 v60, 0
    v_mov_b32 v61, 0
    v_mov_b32 v62, 0
    v_mov_b32 v63, 0
    v_mov_b32 v64, 0
    v_mov_b32 v65, 0
    v_mov_b32 v66, 0
    v_mov_b32 v67, 0
    s_add_u32 s39, s39, 1
    s_cmp_gt_u32 s39, 400000
    s_cbranch_scc1 M_fail
    s_waitcnt vmcnt(0)
    ds_write_b128 v7, v[24:27] offset:0
    ds_write_b128 v7, v[40:43] offset:4096
    ds_write_b128 v7, v[52:55] offset:7168
    v_max3_u32 v11, v24, v25, v26
    v_max3_u32 v11, v11, v27, v40
    v_max3_u32 v11, v11, v41, v42
    v_max3_u32 v11, v11, v43, v52
    v_max3_u32 v11, v11, v53, v54
    v_max_u32 v11, v11, v55
    v_cmp_eq_u32 vcc, -1, v11
    s_cbranch_vccnz M_z_w2_slow1
    v_smfmac_f32_16x16x64_bf16 v[56:59], v[24:27], a[48:55], v10
    v_smfmac_f32_16x16x64_bf16 v[60:63], v[24:27], a[56:63], v10
    v_smfmac_f32_16x16x64_bf16 v[64:67], v[24:27], a[64:71], v10
    s_waitcnt lgkmcnt(0)
    s_branch M_z_w2_back1
M_z_w2_slow2:
    s_mov_b64 exec, vcc
    buffer_load_dwordx4 v[24:27], v4, s[8:11], s40 offen sc1
    buffer_load_dwordx4 v[40:43], v5, s[8:11], s40 offen sc1
    buffer_load_dwordx4 v[52:55], v6, s[8:11], s40 offen sc1
    s_mov_b64 exec, -1
    s_nop 2
    v_mov_b32 v56, 0
    v_mov_b32 v57, 0
    v_mov_b32 v58, 0
    v_mov_b32 v59, 0
    v_mov_b32 v60, 0
    v_mov_b32 v61, 0
    v_mov_b32 v62, 0
    v_mov_b32 v63, 0
    v_mov_b32 v64, 0
    v_mov_b32 v65, 0
    v_mov_b32 v66, 0
    v_mov_b32 v67, 0
    s_add_u32 s39, s39, 1
    s_cmp_gt_u32 s39, 400000
    s_cbranch_scc1 M_fail
    s_waitcnt vmcnt(0)
    ds_write_b128 v7, v[24:27] offset:0
    ds_write_b128 v7, v[40:43] offset:4096
    ds_write_b128 v7, v[52:55] offset:7168
    v_max3_u32 v11, v24, v25, v26
    v_max3_u32 v11, v11, v27, v40
    v_max3_u32 v11, v11, v41, v42
    v_max3_u32 v11, v11, v43, v52
    v_max3_u32 v11, v11, v53, v54
    v_max_u32 v11, v11, v55
    v_cmp_eq_u32 vcc, -1, v11
    s_cbranch_vccnz M_z_w2_slow2
    v_smfmac_f32_16x16x64_bf16 v[56:59], v[24:27], a[48:55], v10
    v_smfmac_f32_16x16x64_bf16 v[60:63], v[24:27], a[56:63], v10
    v_smfmac_f32_16x16x64_bf16 v[64:67], v[24:27], a[64:71], v10
    v_smfmac_f32_16x16x64_bf16 v[56:59], v[40:43], a[144:151], v10
    v_smfmac_f32_16x16x64_bf16 v[60:63], v[40:43], a[152:159], v10
    v_smfmac_f32_16x16x64_bf16 v[64:67], v[40:43], a[160:167], v10
    v_smfmac_f32_16x16x64_bf16 v[56:59], v[16:19], a[0:7], v10
    v_smfmac_f32_16x16x64_bf16 v[60:63], v[16:19], a[8:15], v10
    s_waitcnt lgkmcnt(0)
    s_branch M_z_w2_back2
M_z_w3_slow1:
    s_mov_b64 exec, vcc
    buffer_load_dwordx4 v[28:31], v4, s[8:11], s40 offen sc1
    buffer_load_dwordx4 v[44:47], v5, s[8:11], s40 offen sc1
    s_mov_b64 exec, -1
    s_nop 2
    v_mov_b32 v56, 0
    v_mov_b32 v57, 0
    v_mov_b32 v58, 0
    v_mov_b32 v59, 0
    v_mov_b32 v60, 0
    v_mov_b32 v61, 0
    v_mov_b32 v62, 0
    v_mov_b32 v63, 0
    v_mov_b32 v64, 0
    v_mov_b32 v65, 0
    v_mov_b32 v66, 0
    v_mov_b32 v67, 0
    s_add_u32 s39, s39, 1
    s_cmp_gt_u32 s39, 400000
    s_cbranch_scc1 M_fail
    s_waitcnt vmcnt(0)
    ds_write_b128 v7, v[28:31] offset:0
    ds_write_b128 v7, v[44:47] offset:4096
    v_max3_u32 v11, v28, v29, v30
    v_max3_u32 v11, v11, v31, v44
    v_max3_u32 v11, v11, v45, v46
    v_max_u32 v11, v11, v47
    v_cmp_eq_u32 vcc, -1, v11
    s_cbranch_vccnz M_z_w3_slow1
    v_smfmac_f32_16x16x64_bf16 v[56:59], v[28:31], a[72:79], v10
    v_smfmac_f32_16x16x64_bf16 v[60:63], v[28:31], a[80:87], v10
    v_smfmac_f32_16x16x64_bf16 v[64:67], v[28:31], a[88:95], v10
    s_waitcnt lgkmcnt(0)
    s_branch M_z_w3_back1
M_z_w3_slow2:
    s_mov_b64 exec, vcc
    buffer_load_dwordx4 v[28:31], v4, s[8:11], s40 offen sc1
    buffer_load_dwordx4 v[44:47], v5, s[8:11], s40 offen sc1
    s_mov_b64 exec, -1
    s_nop 2
    v_mov_b32 v56, 0
    v_mov_b32 v57, 0
    v_mov_b32 v58, 0
    v_mov_b32 v59, 0
    v_mov_b32 v60, 0
    v_mov_b32 v61, 0
    v_mov_b32 v62, 0
    v_mov_b32 v63, 0
    v_mov_b32 v64, 0
    v_mov_b32 v65, 0
    v_mov_b32 v66, 0
    v_mov_b32 v67, 0
    s_add_u32 s39, s39, 1
    s_cmp_gt_u32 s39, 400000
    s_cbranch_scc1 M_fail
    s_waitcnt vmcnt(0)
    ds_write_b128 v7, v[28:31] offset:0
    ds_write_b128 v7, v[44:47] offset:4096
    v_max3_u32 v11, v28, v29, v30
    v_max3_u32 v11, v11, v31, v44
    v_max3_u32 v11, v11, v45, v46
    v_max_u32 v11, v11, v47
    v_cmp_eq_u32 vcc, -1, v11
    s_cbranch_vccnz M_z_w3_slow2
    v_smfmac_f32_16x16x64_bf16 v[56:59], v[28:31], a[72:79], v10
    v_smfmac_f32_16x16x64_bf16 v[60:63], v[28:31], a[80:87], v10
    v_smfmac_f32_16x16x64_bf16 v[64:67], v[28:31], a[88:95], v10
    v_smfmac_f32_16x16x64_bf16 v[56:59], v[44:47], a[168:175], v10
    v_smfmac_f32_16x16x64_bf16 v[60:63], v[44:47], a[176:183], v10
    v_smfmac_f32_16x16x64_bf16 v[64:67], v[44:47], a[184:191], v10
    v_smfmac_f32_16x16x64_bf16 v[56:59], v[16:19], a[0:7], v10
    v_smfmac_f32_16x16x64_bf16 v[60:63], v[16:19], a[8:15], v10
    s_waitcnt lgkmcnt(0)
    s_branch M_z_w3_back2
M_h:
    s_mov_b32 s12, s92
    s_and_b32 s13, s93, 0xffff
    s_mov_b32 s14, 0x780000
    s_mov_b32 s15, 0x20000
    s_mov_b32 s16, s94
    s_and_b32 s17, s95, 0xffff
    s_mov_b32 s18, 0x780000
    s_mov_b32 s19, 0x20000
    v_add_u32 v8, 0, v1
    v_mul_u32_u24 v9, 2731, v8
    v_lshrrev_b32 v9, 16, v9
    v_mul_u32_u24 v10, 24, v9
    v_sub_u32 v10, v8, v10
    v_mul_u32_u24 v9, 12288, v9
    v_lshl_add_u32 v4, v10, 4, v9
    v_add_u32 v8, 64, v1
    v_mul_u32_u24 v9, 2731, v8
    v_lshrrev_b32 v9, 16, v9
    v_mul_u32_u24 v10, 24, v9
    v_sub_u32 v10, v8, v10
    v_mul_u32_u24 v9, 12288, v9
    v_lshl_add_u32 v5, v10, 4, v9
    v_add_u32 v8, 128, v1
    v_mul_u32_u24 v9, 2731, v8
    v_lshrrev_b32 v9, 16, v9
    v_mul_u32_u24 v10, 24, v9
    v_sub_u32 v10, v8, v10
    v_mul_u32_u24 v9, 12288, v9
    v_lshl_add_u32 v6, v10, 4, v9
    v_lshrrev_b32 v8, 3, v1
    v_mul_u32_u24 v8, 1280, v8
    v_and_b32 v9, 7, v1
    v_lshl_add_u32 v7, v9, 4, v8
    v_lshrrev_b32 v8, 4, v1
    v_bfe_u32 v9, v1, 2, 2
    v_and_b32 v10, 3, v1
    v_lshrrev_b32 v11, 1, v8
    v_lshlrev_b32 v11, 4, v11
    v_and_b32 v12, 1, v8
    v_lshl_add_u32 v11, v12, 2, v11
    v_and_b32 v12, 1, v9
    v_add_u32 v11, v11, v12
    v_lshrrev_b32 v12, 1, v9
    v_lshl_add_u32 v11, v12, 3, v11
    v_mul_u32_u24 v11, 384, v11
    v_lshl_add_u32 v11, v10, 3, v11
    s_lshr_b32 s28, s21, 1
    s_mul_i32 s28, s28, 24576
    s_and_b32 s29, s21, 1
    s_mul_i32 s29, s29, 192
    s_add_u32 s28, s28, s29
    v_add_u32 v11, s28, v11
    s_mul_i32 s30, s20, 384
    s_mul_i32 s28, s21, 196608
    s_add_u32 s30, s30, s28
    s_mul_i32 s31, s20, 245760
    s_mul_i32 s28, s21, 61440
    s_add_u32 s31, s31, s28
    s_mul_i32 s32, s21, 6144
    s_add_u32 m0, s32, 98304
    s_add_u32 s33, s30, 0
    buffer_load_dwordx4 v4, s[12:15], s33 offen nt lds
    s_add_u32 m0, s32, 99328
    s_add_u32 s33, s30, 0
    buffer_load_dwordx4 v5, s[12:15], s33 offen nt lds
    s_add_u32 m0, s32, 100352
    s_add_u32 s33, s30, 0
    buffer_load_dwordx4 v6, s[12:15], s33 offen nt lds
    s_add_u32 m0, s32, 101376
    s_add_u32 s33, s30, 98304
    buffer_load_dwordx4 v4, s[12:15], s33 offen nt lds
    s_add_u32 m0, s32, 102400
    s_add_u32 s33, s30, 98304
    buffer_load_dwordx4 v5, s[12:15], s33 offen nt lds
    s_add_u32 m0, s32, 103424
    s_add_u32 s33, s30, 98304
    buffer_load_dwordx4 v6, s[12:15], s33 offen nt lds
    s_add_u32 m0, s32, 122880
    s_add_u32 s33, s30, 0
    buffer_load_dwordx4 v4, s[16:19], s33 offen nt lds
    s_add_u32 m0, s32, 123904
    s_add_u32 s33, s30, 0
    buffer_load_dwordx4 v5, s[16:19], s33 offen nt lds
    s_add_u32 m0, s32, 124928
    s_add_u32 s33, s30, 0
    buffer_load_dwordx4 v6, s[16:19], s33 offen nt lds
    s_add_u32 m0, s32, 125952
    s_add_u32 s33, s30, 98304
    buffer_load_dwordx4 v4, s[16:19], s33 offen nt lds
    s_add_u32 m0, s32, 126976
    s_add_u32 s33, s30, 98304
    buffer_load_dwordx4 v5, s[16:19], s33 offen nt lds
    s_add_u32 m0, s32, 128000
    s_add_u32 s33, s30, 98304
    buffer_load_dwordx4 v6, s[16:19], s33 offen nt lds
    s_add_u32 m0, s32, 0
    s_add_u32 s33, s30, 786432
    buffer_load_dwordx4 v4, s[12:15], s33 offen nt lds
    s_add_u32 m0, s32, 1024
    s_add_u32 s33, s30, 786432
    buffer_load_dwordx4 v5, s[12:15], s33 offen nt lds
    s_add_u32 m0, s32, 2048
    s_add_u32 s33, s30, 786432
    buffer_load_dwordx4 v6, s[12:15], s33 offen nt lds
    s_add_u32 m0, s32, 3072
    s_add_u32 s33, s30, 884736
    buffer_load_dwordx4 v4, s[12:15], s33 offen nt lds
    s_add_u32 m0, s32, 4096
    s_add_u32 s33, s30, 884736
    buffer_load_dwordx4 v5, s[12:15], s33 offen nt lds
    s_add_u32 m0, s32, 5120
    s_add_u32 s33, s30, 884736
    buffer_load_dwordx4 v6, s[12:15], s33 offen nt lds
    s_add_u32 m0, s32, 24576
    s_add_u32 s33, s30, 786432
    buffer_load_dwordx4 v4, s[16:19], s33 offen nt lds
    s_add_u32 m0, s32, 25600
    s_add_u32 s33, s30, 786432
    buffer_load_dwordx4 v5, s[16:19], s33 offen nt lds
    s_add_u32 m0, s32, 26624
    s_add_u32 s33, s30, 786432
    buffer_load_dwordx4 v6, s[16:19], s33 offen nt lds
    s_add_u32 m0, s32, 27648
    s_add_u32 s33, s30, 884736
    buffer_load_dwordx4 v4, s[16:19], s33 offen nt lds
    s_add_u32 m0, s32, 28672
    s_add_u32 s33, s30, 884736
    buffer_load_dwordx4 v5, s[16:19], s33 offen nt lds
    s_add_u32 m0, s32, 29696
    s_add_u32 s33, s30, 884736
    buffer_load_dwordx4 v6, s[16:19], s33 offen nt lds
    s_add_u32 m0, s32, 49152
    s_add_u32 s33, s30, 1572864
    buffer_load_dwordx4 v4, s[12:15], s33 offen nt lds
    s_add_u32 m0, s32, 50176
    s_add_u32 s33, s30, 1572864
    buffer_load_dwordx4 v5, s[12:15], s33 offen nt lds
    s_add_u32 m0, s32, 51200
    s_add_u32 s33, s30, 1572864
    buffer_load_dwordx4 v6, s[12:15], s33 offen nt lds
    s_add_u32 m0, s32, 52224
    s_add_u32 s33, s30, 1671168
    buffer_load_dwordx4 v4, s[12:15], s33 offen nt lds
    s_add_u32 m0, s32, 53248
    s_add_u32 s33, s30, 1671168
    buffer_load_dwordx4 v5, s[12:15], s33 offen nt lds
    s_add_u32 m0, s32, 54272
    s_add_u32 s33, s30, 1671168
    buffer_load_dwordx4 v6, s[12:15], s33 offen nt lds
    s_add_u32 m0, s32, 73728
    s_add_u32 s33, s30, 1572864
    buffer_load_dwordx4 v4, s[16:19], s33 offen nt lds
    s_add_u32 m0, s32, 74752
    s_add_u32 s33, s30, 1572864
    buffer_load_dwordx4 v5, s[16:19], s33 offen nt lds
    s_add_u32 m0, s32, 75776
    s_add_u32 s33, s30, 1572864
    buffer_load_dwordx4 v6, s[16:19], s33 offen nt lds
    s_add_u32 m0, s32, 76800
    s_add_u32 s33, s30, 1671168
    buffer_load_dwordx4 v4, s[16:19], s33 offen nt lds
    s_add_u32 m0, s32, 77824
    s_add_u32 s33, s30, 1671168
    buffer_load_dwordx4 v5, s[16:19], s33 offen nt lds
    s_add_u32 m0, s32, 78848
    s_add_u32 s33, s30, 1671168
    buffer_load_dwordx4 v6, s[16:19], s33 offen nt lds
    s_waitcnt vmcnt(24)
    s_barrier
    v_add_u32 v13, 98304, v11
    ds_read_b64_tr_b16 a[0:1], v13 offset:0
    ds_read_b64_tr_b16 a[2:3], v13 offset:768
    ds_read_b64_tr_b16 a[4:5], v13 offset:12288
    ds_read_b64_tr_b16 a[6:7], v13 offset:13056
    ds_read_b64_tr_b16 a[8:9], v13 offset:32
    ds_read_b64_tr_b16 a[10:11], v13 offset:800
    ds_read_b64_tr_b16 a[12:13], v13 offset:12320
    ds_read_b64_tr_b16 a[14:15], v13 offset:13088
    ds_read_b64_tr_b16 a[128:129], v13 offset:64
    ds_read_b64_tr_b16 a[130:131], v13 offset:832
    ds_read_b64_tr_b16 a[132:133], v13 offset:12352
    ds_read_b64_tr_b16 a[134:135], v13 offset:13120
    ds_read_b64_tr_b16 a[136:137], v13 offset:96
    ds_read_b64_tr_b16 a[138:139], v13 offset:864
    ds_read_b64_tr_b16 a[140:141], v13 offset:12384
    ds_read_b64_tr_b16 a[142:143], v13 offset:13152
    ds_read_b64_tr_b16 v[128:129], v13 offset:128
    ds_read_b64_tr_b16 v[130:131], v13 offset:896
    ds_read_b64_tr_b16 v[132:133], v13 offset:12416
    ds_read_b64_tr_b16 v[134:135], v13 offset:13184
    ds_read_b64_tr_b16 v[136:137], v13 offset:160
    ds_read_b64_tr_b16 v[138:139], v13 offset:928
    ds_read_b64_tr_b16 v[140:141], v13 offset:12448
    ds_read_b64_tr_b16 v[142:143], v13 offset:13216
    s_waitcnt lgkmcnt(0)
    s_barrier
    s_add_u32 m0, s32, 98304
    s_add_u32 s33, s30, 2359296
    buffer_load_dwordx4 v4, s[12:15], s33 offen nt lds
    s_add_u32 m0, s32, 99328
    s_add_u32 s33, s30, 2359296
    buffer_load_dwordx4 v5, s[12:15], s33 offen nt lds
    s_add_u32 m0, s32, 100352
    s_add_u32 s33, s30, 2359296
    buffer_load_dwordx4 v6, s[12:15], s33 offen nt lds
    s_add_u32 m0, s32, 101376
    s_add_u32 s33, s30, 2457600
    buffer_load_dwordx4 v4, s[12:15], s33 offen nt lds
    s_add_u32 m0, s32, 102400
    s_add_u32 s33, s30, 2457600
    buffer_load_dwordx4 v5, s[12:15], s33 offen nt lds
    s_add_u32 m0, s32, 103424
    s_add_u32 s33, s30, 2457600
    buffer_load_dwordx4 v6, s[12:15], s33 offen nt lds
    s_add_u32 m0, s32, 122880
    s_add_u32 s33, s30, 2359296
    buffer_load_dwordx4 v4, s[16:19], s33 offen nt lds
    s_add_u32 m0, s32, 123904
    s_add_u32 s33, s30, 2359296
    buffer_load_dwordx4 v5, s[16:19], s33 offen nt lds
    s_add_u32 m0, s32, 124928
    s_add_u32 s33, s30, 2359296
    buffer_load_dwordx4 v6, s[16:19], s33 offen nt lds
    s_add_u32 m0, s32, 125952
    s_add_u32 s33, s30, 2457600
    buffer_load_dwordx4 v4, s[16:19], s33 offen nt lds
    s_add_u32 m0, s32, 126976
    s_add_u32 s33, s30, 2457600
    buffer_load_dwordx4 v5, s[16:19], s33 offen nt lds
    s_add_u32 m0, s32, 128000
    s_add_u32 s33, s30, 2457600
    buffer_load_dwordx4 v6, s[16:19], s33 offen nt lds
    s_waitcnt vmcnt(24)
    s_barrier
    v_add_u32 v13, 0, v11
    ds_read_b64_tr_b16 a[16:17], v13 offset:0
    ds_read_b64_tr_b16 a[18:19], v13 offset:768
    ds_read_b64_tr_b16 a[20:21], v13 offset:12288
    ds_read_b64_tr_b16 a[22:23], v13 offset:13056
    ds_read_b64_tr_b16 a[24:25], v13 offset:32
    ds_read_b64_tr_b16 a[26:27], v13 offset:800
    ds_read_b64_tr_b16 a[28:29], v13 offset:12320
    ds_read_b64_tr_b16 a[30:31], v13 offset:13088
    ds_read_b64_tr_b16 a[144:145], v13 offset:64
    ds_read_b64_tr_b16 a[146:147], v13 offset:832
    ds_read_b64_tr_b16 a[148:149], v13 offset:12352
    ds_read_b64_tr_b16 a[150:151], v13 offset:13120
    ds_read_b64_tr_b16 a[152:153], v13 offset:96
    ds_read_b64_tr_b16 a[154:155], v13 offset:864
    ds_read_b64_tr_b16 a[156:157], v13 offset:12384
    ds_read_b64_tr_b16 a[158:159], v13 offset:13152
    ds_read_b64_tr_b16 v[144:145], v13 offset:128
    ds_read_b64_tr_b16 v[146:147], v13 offset:896
    ds_read_b64_tr_b16 v[148:149], v13 offset:12416
    ds_read_b64_tr_b16 v[150:151], v13 offset:13184
    ds_read_b64_tr_b16 v[152:153], v13 offset:160
    ds_read_b64_tr_b16 v[154:155], v13 offset:928
    ds_read_b64_tr_b16 v[156:157], v13 offset:12448
    ds_read_b64_tr_b16 v[158:159], v13 offset:13216
    s_waitcnt lgkmcnt(0)
    s_barrier
    s_add_u32 m0, s32, 0
    s_add_u32 s33, s30, 3145728
    buffer_load_dwordx4 v4, s[12:15], s33 offen nt lds
    s_add_u32 m0, s32, 1024
    s_add_u32 s33, s30, 3145728
    buffer_load_dwordx4 v5, s[12:15], s33 offen nt lds
    s_add_u32 m0, s32, 2048
    s_add_u32 s33, s30, 3145728
    buffer_load_dwordx4 v6, s[12:15], s33 offen nt lds
    s_add_u32 m0, s32, 3072
    s_add_u32 s33, s30, 3244032
    buffer_load_dwordx4 v4, s[12:15], s33 offen nt lds
    s_add_u32 m0, s32, 4096
    s_add_u32 s33, s30, 3244032
    buffer_load_dwordx4 v5, s[12:15], s33 offen nt lds
    s_add_u32 m0, s32, 5120
    s_add_u32 s33, s30, 3244032
    buffer_load_dwordx4 v6, s[12:15], s33 offen nt lds
    s_add_u32 m0, s32, 24576
    s_add_u32 s33, s30, 3145728
    buffer_load_dwordx4 v4, s[16:19], s33 offen nt lds
    s_add_u32 m0, s32, 25600
    s_add_u32 s33, s30, 3145728
    buffer_load_dwordx4 v5, s[16:19], s33 offen nt lds
    s_add_u32 m0, s32, 26624
    s_add_u32 s33, s30, 3145728
    buffer_load_dwordx4 v6, s[16:19], s33 offen nt lds
    s_add_u32 m0, s32, 27648
    s_add_u32 s33, s30, 3244032
    buffer_load_dwordx4 v4, s[16:19], s33 offen nt lds
    s_add_u32 m0, s32, 28672
    s_add_u32 s33, s30, 3244032
    buffer_load_dwordx4 v5, s[16:19], s33 offen nt lds
    s_add_u32 m0, s32, 29696
    s_add_u32 s33, s30, 3244032
    buffer_load_dwordx4 v6, s[16:19], s33 offen nt lds
    s_waitcnt vmcnt(24)
    s_barrier
    v_add_u32 v13, 49152, v11
    ds_read_b64_tr_b16 a[32:33], v13 offset:0
    ds_read_b64_tr_b16 a[34:35], v13 offset:768
    ds_read_b64_tr_b16 a[36:37], v13 offset:12288
    ds_read_b64_tr_b16 a[38:39], v13 offset:13056
    ds_read_b64_tr_b16 a[40:41], v13 offset:32
    ds_read_b64_tr_b16 a[42:43], v13 offset:800
    ds_read_b64_tr_b16 a[44:45], v13 offset:12320
    ds_read_b64_tr_b16 a[46:47], v13 offset:13088
    ds_read_b64_tr_b16 a[160:161], v13 offset:64
    ds_read_b64_tr_b16 a[162:163], v13 offset:832
    ds_read_b64_tr_b16 a[164:165], v13 offset:12352
    ds_read_b64_tr_b16 a[166:167], v13 offset:13120
    ds_read_b64_tr_b16 a[168:169], v13 offset:96
    ds_read_b64_tr_b16 a[170:171], v13 offset:864
    ds_read_b64_tr_b16 a[172:173], v13 offset:12384
    ds_read_b64_tr_b16 a[174:175], v13 offset:13152
    ds_read_b64_tr_b16 v[160:161], v13 offset:128
    ds_read_b64_tr_b16 v[162:163], v13 offset:896
    ds_read_b64_tr_b16 v[164:165], v13 offset:12416
    ds_read_b64_tr_b16 v[166:167], v13 offset:13184
    ds_read_b64_tr_b16 v[168:169], v13 offset:160
    ds_read_b64_tr_b16 v[170:171], v13 offset:928
    ds_read_b64_tr_b16 v[172:173], v13 offset:12448
    ds_read_b64_tr_b16 v[174:175], v13 offset:13216
    s_waitcnt lgkmcnt(0)
    s_barrier
    s_add_u32 m0, s32, 49152
    s_add_u32 s33, s30, 3932160
    buffer_load_dwordx4 v4, s[12:15], s33 offen nt lds
    s_add_u32 m0, s32, 50176
    s_add_u32 s33, s30, 3932160
    buffer_load_dwordx4 v5, s[12:15], s33 offen nt lds
    s_add_u32 m0, s32, 51200
    s_add_u32 s33, s30, 3932160
    buffer_load_dwordx4 v6, s[12:15], s33 offen nt lds
    s_add_u32 m0, s32, 52224
    s_add_u32 s33, s30, 4030464
    buffer_load_dwordx4 v4, s[12:15], s33 offen nt lds
    s_add_u32 m0, s32, 53248
    s_add_u32 s33, s30, 4030464
    buffer_load_dwordx4 v5, s[12:15], s33 offen nt lds
    s_add_u32 m0, s32, 54272
    s_add_u32 s33, s30, 4030464
    buffer_load_dwordx4 v6, s[12:15], s33 offen nt lds
    s_add_u32 m0, s32, 73728
    s_add_u32 s33, s30, 3932160
    buffer_load_dwordx4 v4, s[16:19], s33 offen nt lds
    s_add_u32 m0, s32, 74752
    s_add_u32 s33, s30, 3932160
    buffer_load_dwordx4 v5, s[16:19], s33 offen nt lds
    s_add_u32 m0, s32, 75776
    s_add_u32 s33, s30, 3932160
    buffer_load_dwordx4 v6, s[16:19], s33 offen nt lds
    s_add_u32 m0, s32, 76800
    s_add_u32 s33, s30, 4030464
    buffer_load_dwordx4 v4, s[16:19], s33 offen nt lds
    s_add_u32 m0, s32, 77824
    s_add_u32 s33, s30, 4030464
    buffer_load_dwordx4 v5, s[16:19], s33 offen nt lds
    s_add_u32 m0, s32, 78848
    s_add_u32 s33, s30, 4030464
    buffer_load_dwordx4 v6, s[16:19], s33 offen nt lds
    s_waitcnt vmcnt(24)
    s_barrier
    v_add_u32 v13, 98304, v11
    ds_read_b64_tr_b16 a[48:49], v13 offset:0
    ds_read_b64_tr_b16 a[50:51], v13 offset:768
    ds_read_b64_tr_b16 a[52:53], v13 offset:12288
    ds_read_b64_tr_b16 a[54:55], v13 offset:13056
    ds_read_b64_tr_b16 a[56:57], v13 offset:32
    ds_read_b64_tr_b16 a[58:59], v13 offset:800
    ds_read_b64_tr_b16 a[60:61], v13 offset:12320
    ds_read_b64_tr_b16 a[62:63], v13 offset:13088
    ds_read_b64_tr_b16 a[176:177], v13 offset:64
    ds_read_b64_tr_b16 a[178:179], v13 offset:832
    ds_read_b64_tr_b16 a[180:181], v13 offset:12352
    ds_read_b64_tr_b16 a[182:183], v13 offset:13120
    ds_read_b64_tr_b16 a[184:185], v13 offset:96
    ds_read_b64_tr_b16 a[186:187], v13 offset:864
    ds_read_b64_tr_b16 a[188:189], v13 offset:12384
    ds_read_b64_tr_b16 a[190:191], v13 offset:13152
    ds_read_b64_tr_b16 v[176:177], v13 offset:128
    ds_read_b64_tr_b16 v[178:179], v13 offset:896
    ds_read_b64_tr_b16 v[180:181], v13 offset:12416
    ds_read_b64_tr_b16 v[182:183], v13 offset:13184
    ds_read_b64_tr_b16 v[184:185], v13 offset:160
    ds_read_b64_tr_b16 v[186:187], v13 offset:928
    ds_read_b64_tr_b16 v[188:189], v13 offset:12448
    ds_read_b64_tr_b16 v[190:191], v13 offset:13216
    s_waitcnt lgkmcnt(0)
    s_barrier
    s_add_u32 m0, s32, 98304
    s_add_u32 s33, s30, 5505024
    buffer_load_dwordx4 v4, s[12:15], s33 offen nt lds
    s_add_u32 m0, s32, 99328
    s_add_u32 s33, s30, 5505024
    buffer_load_dwordx4 v5, s[12:15], s33 offen nt lds
    s_add_u32 m0, s32, 100352
    s_add_u32 s33, s30, 5505024
    buffer_load_dwordx4 v6, s[12:15], s33 offen nt lds
    s_add_u32 m0, s32, 101376
    s_add_u32 s33, s30, 5603328
    buffer_load_dwordx4 v4, s[12:15], s33 offen nt lds
    s_add_u32 m0, s32, 102400
    s_add_u32 s33, s30, 5603328
    buffer_load_dwordx4 v5, s[12:15], s33 offen nt lds
    s_add_u32 m0, s32, 103424
    s_add_u32 s33, s30, 5603328
    buffer_load_dwordx4 v6, s[12:15], s33 offen nt lds
    s_add_u32 m0, s32, 122880
    s_add_u32 s33, s30, 5505024
    buffer_load_dwordx4 v4, s[16:19], s33 offen nt lds
    s_add_u32 m0, s32, 123904
    s_add_u32 s33, s30, 5505024
    buffer_load_dwordx4 v5, s[16:19], s33 offen nt lds
    s_add_u32 m0, s32, 124928
    s_add_u32 s33, s30, 5505024
    buffer_load_dwordx4 v6, s[16:19], s33 offen nt lds
    s_add_u32 m0, s32, 125952
    s_add_u32 s33, s30, 5603328
    buffer_load_dwordx4 v4, s[16:19], s33 offen nt lds
    s_add_u32 m0, s32, 126976
    s_add_u32 s33, s30, 5603328
    buffer_load_dwordx4 v5, s[16:19], s33 offen nt lds
    s_add_u32 m0, s32, 128000
    s_add_u32 s33, s30, 5603328
    buffer_load_dwordx4 v6, s[16:19], s33 offen nt lds
    s_waitcnt vmcnt(24)
    s_barrier
    v_add_u32 v13, 0, v11
    ds_read_b64_tr_b16 a[64:65], v13 offset:0
    ds_read_b64_tr_b16 a[66:67], v13 offset:768
    ds_read_b64_tr_b16 a[68:69], v13 offset:12288
    ds_read_b64_tr_b16 a[70:71], v13 offset:13056
    ds_read_b64_tr_b16 a[72:73], v13 offset:32
    ds_read_b64_tr_b16 a[74:75], v13 offset:800
    ds_read_b64_tr_b16 a[76:77], v13 offset:12320
    ds_read_b64_tr_b16 a[78:79], v13 offset:13088
    ds_read_b64_tr_b16 a[192:193], v13 offset:64
    ds_read_b64_tr_b16 a[194:195], v13 offset:832
    ds_read_b64_tr_b16 a[196:197], v13 offset:12352
    ds_read_b64_tr_b16 a[198:199], v13 offset:13120
    ds_read_b64_tr_b16 a[200:201], v13 offset:96
    ds_read_b64_tr_b16 a[202:203], v13 offset:864
    ds_read_b64_tr_b16 a[204:205], v13 offset:12384
    ds_read_b64_tr_b16 a[206:207], v13 offset:13152
    ds_read_b64_tr_b16 v[192:193], v13 offset:128
    ds_read_b64_tr_b16 v[194:195], v13 offset:896
    ds_read_b64_tr_b16 v[196:197], v13 offset:12416
    ds_read_b64_tr_b16 v[198:199], v13 offset:13184
    ds_read_b64_tr_b16 v[200:201], v13 offset:160
    ds_read_b64_tr_b16 v[202:203], v13 offset:928
    ds_read_b64_tr_b16 v[204:205], v13 offset:12448
    ds_read_b64_tr_b16 v[206:207], v13 offset:13216
    s_waitcnt lgkmcnt(0)
    s_barrier
    s_add_u32 m0, s32, 0
    s_add_u32 s33, s30, 6291456
    buffer_load_dwordx4 v4, s[12:15], s33 offen nt lds
    s_add_u32 m0, s32, 1024
    s_add_u32 s33, s30, 6291456
    buffer_load_dwordx4 v5, s[12:15], s33 offen nt lds
    s_add_u32 m0, s32, 2048
    s_add_u32 s33, s30, 6291456
    buffer_load_dwordx4 v6, s[12:15], s33 offen nt lds
    s_add_u32 m0, s32, 3072
    s_add_u32 s33, s30, 6389760
    buffer_load_dwordx4 v4, s[12:15], s33 offen nt lds
    s_add_u32 m0, s32, 4096
    s_add_u32 s33, s30, 6389760
    buffer_load_dwordx4 v5, s[12:15], s33 offen nt lds
    s_add_u32 m0, s32, 5120
    s_add_u32 s33, s30, 6389760
    buffer_load_dwordx4 v6, s[12:15], s33 offen nt lds
    s_add_u32 m0, s32, 24576
    s_add_u32 s33, s30, 6291456
    buffer_load_dwordx4 v4, s[16:19], s33 offen nt lds
    s_add_u32 m0, s32, 25600
    s_add_u32 s33, s30, 6291456
    buffer_load_dwordx4 v5, s[16:19], s33 offen nt lds
    s_add_u32 m0, s32, 26624
    s_add_u32 s33, s30, 6291456
    buffer_load_dwordx4 v6, s[16:19], s33 offen nt lds
    s_add_u32 m0, s32, 27648
    s_add_u32 s33, s30, 6389760
    buffer_load_dwordx4 v4, s[16:19], s33 offen nt lds
    s_add_u32 m0, s32, 28672
    s_add_u32 s33, s30, 6389760
    buffer_load_dwordx4 v5, s[16:19], s33 offen nt lds
    s_add_u32 m0, s32, 29696
    s_add_u32 s33, s30, 6389760
    buffer_load_dwordx4 v6, s[16:19], s33 offen nt lds
    s_waitcnt vmcnt(24)
    s_barrier
    v_add_u32 v13, 49152, v11
    ds_read_b64_tr_b16 a[80:81], v13 offset:0
    ds_read_b64_tr_b16 a[82:83], v13 offset:768
    ds_read_b64_tr_b16 a[84:85], v13 offset:12288
    ds_read_b64_tr_b16 a[86:87], v13 offset:13056
    ds_read_b64_tr_b16 a[88:89], v13 offset:32
    ds_read_b64_tr_b16 a[90:91], v13 offset:800
    ds_read_b64_tr_b16 a[92:93], v13 offset:12320
    ds_read_b64_tr_b16 a[94:95], v13 offset:13088
    ds_read_b64_tr_b16 a[208:209], v13 offset:64
    ds_read_b64_tr_b16 a[210:211], v13 offset:832
    ds_read_b64_tr_b16 a[212:213], v13 offset:12352
    ds_read_b64_tr_b16 a[214:215], v13 offset:13120
    ds_read_b64_tr_b16 a[216:217], v13 offset:96
    ds_read_b64_tr_b16 a[218:219], v13 offset:864
    ds_read_b64_tr_b16 a[220:221], v13 offset:12384
    ds_read_b64_tr_b16 a[222:223], v13 offset:13152
    ds_read_b64_tr_b16 v[208:209], v13 offset:128
    ds_read_b64_tr_b16 v[210:211], v13 offset:896
    ds_read_b64_tr_b16 v[212:213], v13 offset:12416
    ds_read_b64_tr_b16 v[214:215], v13 offset:13184
    ds_read_b64_tr_b16 v[216:217], v13 offset:160
    ds_read_b64_tr_b16 v[218:219], v13 offset:928
    ds_read_b64_tr_b16 v[220:221], v13 offset:12448
    ds_read_b64_tr_b16 v[222:223], v13 offset:13216
    s_waitcnt lgkmcnt(0)
    s_barrier
    s_add_u32 m0, s32, 49152
    s_add_u32 s33, s30, 7077888
    buffer_load_dwordx4 v4, s[12:15], s33 offen nt lds
    s_add_u32 m0, s32, 50176
    s_add_u32 s33, s30, 7077888
    buffer_load_dwordx4 v5, s[12:15], s33 offen nt lds
    s_add_u32 m0, s32, 51200
    s_add_u32 s33, s30, 7077888
    buffer_load_dwordx4 v6, s[12:15], s33 offen nt lds
    s_add_u32 m0, s32, 52224
    s_add_u32 s33, s30, 7176192
    buffer_load_dwordx4 v4, s[12:15], s33 offen nt lds
    s_add_u32 m0, s32, 53248
    s_add_u32 s33, s30, 7176192
    buffer_load_dwordx4 v5, s[12:15], s33 offen nt lds
    s_add_u32 m0, s32, 54272
    s_add_u32 s33, s30, 7176192
    buffer_load_dwordx4 v6, s[12:15], s33 offen nt lds
    s_add_u32 m0, s32, 73728
    s_add_u32 s33, s30, 7077888
    buffer_load_dwordx4 v4, s[16:19], s33 offen nt lds
    s_add_u32 m0, s32, 74752
    s_add_u32 s33, s30, 7077888
    buffer_load_dwordx4 v5, s[16:19], s33 offen nt lds
    s_add_u32 m0, s32, 75776
    s_add_u32 s33, s30, 7077888
    buffer_load_dwordx4 v6, s[16:19], s33 offen nt lds
    s_add_u32 m0, s32, 76800
    s_add_u32 s33, s30, 7176192
    buffer_load_dwordx4 v4, s[16:19], s33 offen nt lds
    s_add_u32 m0, s32, 77824
    s_add_u32 s33, s30, 7176192
    buffer_load_dwordx4 v5, s[16:19], s33 offen nt lds
    s_add_u32 m0, s32, 78848
    s_add_u32 s33, s30, 7176192
    buffer_load_dwordx4 v6, s[16:19], s33 offen nt lds
    s_waitcnt vmcnt(24)
    s_barrier
    v_add_u32 v13, 98304, v11
    ds_read_b64_tr_b16 a[112:113], v13 offset:0
    ds_read_b64_tr_b16 a[114:115], v13 offset:768
    ds_read_b64_tr_b16 a[116:117], v13 offset:12288
    ds_read_b64_tr_b16 a[118:119], v13 offset:13056
    ds_read_b64_tr_b16 a[120:121], v13 offset:32
    ds_read_b64_tr_b16 a[122:123], v13 offset:800
    ds_read_b64_tr_b16 a[124:125], v13 offset:12320
    ds_read_b64_tr_b16 a[126:127], v13 offset:13088
    ds_read_b64_tr_b16 a[240:241], v13 offset:64
    ds_read_b64_tr_b16 a[242:243], v13 offset:832
    ds_read_b64_tr_b16 a[244:245], v13 offset:12352
    ds_read_b64_tr_b16 a[246:247], v13 offset:13120
    ds_read_b64_tr_b16 a[248:249], v13 offset:96
    ds_read_b64_tr_b16 a[250:251], v13 offset:864
    ds_read_b64_tr_b16 a[252:253], v13 offset:12384
    ds_read_b64_tr_b16 a[254:255], v13 offset:13152
    ds_read_b64_tr_b16 v[240:241], v13 offset:128
    ds_read_b64_tr_b16 v[242:243], v13 offset:896
    ds_read_b64_tr_b16 v[244:245], v13 offset:12416
    ds_read_b64_tr_b16 v[246:247], v13 offset:13184
    ds_read_b64_tr_b16 v[248:249], v13 offset:160
    ds_read_b64_tr_b16 v[250:251], v13 offset:928
    ds_read_b64_tr_b16 v[252:253], v13 offset:12448
    ds_read_b64_tr_b16 v[254:255], v13 offset:13216
    s_waitcnt lgkmcnt(0)
    s_barrier
    v_mov_b32 v16, 128
    buffer_load_dwordx4 v[20:23], v16, s[88:91], 0 offen sc1
    s_add_u32 m0, s32, 98304
    s_add_u32 s33, s30, 4718592
    buffer_load_dwordx4 v4, s[12:15], s33 offen nt lds
    s_add_u32 m0, s32, 99328
    s_add_u32 s33, s30, 4718592
    buffer_load_dwordx4 v5, s[12:15], s33 offen nt lds
    s_add_u32 m0, s32, 100352
    s_add_u32 s33, s30, 4718592
    buffer_load_dwordx4 v6, s[12:15], s33 offen nt lds
    s_add_u32 m0, s32, 101376
    s_add_u32 s33, s30, 4816896
    buffer_load_dwordx4 v4, s[12:15], s33 offen nt lds
    s_add_u32 m0, s32, 102400
    s_add_u32 s33, s30, 4816896
    buffer_load_dwordx4 v5, s[12:15], s33 offen nt lds
    s_add_u32 m0, s32, 103424
    s_add_u32 s33, s30, 4816896
    buffer_load_dwordx4 v6, s[12:15], s33 offen nt lds
    s_add_u32 m0, s32, 122880
    s_add_u32 s33, s30, 4718592
    buffer_load_dwordx4 v4, s[16:19], s33 offen nt lds
    s_add_u32 m0, s32, 123904
    s_add_u32 s33, s30, 4718592
    buffer_load_dwordx4 v5, s[16:19], s33 offen nt lds
    s_add_u32 m0, s32, 124928
    s_add_u32 s33, s30, 4718592
    buffer_load_dwordx4 v6, s[16:19], s33 offen nt lds
    s_add_u32 m0, s32, 125952
    s_add_u32 s33, s30, 4816896
    buffer_load_dwordx4 v4, s[16:19], s33 offen nt lds
    s_add_u32 m0, s32, 126976
    s_add_u32 s33, s30, 4816896
    buffer_load_dwordx4 v5, s[16:19], s33 offen nt lds
    s_add_u32 m0, s32, 128000
    s_add_u32 s33, s30, 4816896
    buffer_load_dwordx4 v6, s[16:19], s33 offen nt lds
    s_waitcnt vmcnt(25)
    s_barrier
    v_add_u32 v13, 0, v11
    ds_read_b64_tr_b16 v[32:33], v13 offset:0
    ds_read_b64_tr_b16 v[34:35], v13 offset:768
    ds_read_b64_tr_b16 v[36:37], v13 offset:12288
    ds_read_b64_tr_b16 v[38:39], v13 offset:13056
    ds_read_b64_tr_b16 v[40:41], v13 offset:32
    ds_read_b64_tr_b16 v[42:43], v13 offset:800
    ds_read_b64_tr_b16 v[44:45], v13 offset:12320
    ds_read_b64_tr_b16 v[46:47], v13 offset:13088
    ds_read_b64_tr_b16 v[64:65], v13 offset:64
    ds_read_b64_tr_b16 v[66:67], v13 offset:832
    ds_read_b64_tr_b16 v[68:69], v13 offset:12352
    ds_read_b64_tr_b16 v[70:71], v13 offset:13120
    ds_read_b64_tr_b16 v[72:73], v13 offset:96
    ds_read_b64_tr_b16 v[74:75], v13 offset:864
    ds_read_b64_tr_b16 v[76:77], v13 offset:12384
    ds_read_b64_tr_b16 v[78:79], v13 offset:13152
    ds_read_b64_tr_b16 v[96:97], v13 offset:128
    ds_read_b64_tr_b16 v[98:99], v13 offset:896
    ds_read_b64_tr_b16 v[100:101], v13 offset:12416
    ds_read_b64_tr_b16 v[102:103], v13 offset:13184
    ds_read_b64_tr_b16 v[104:105], v13 offset:160
    ds_read_b64_tr_b16 v[106:107], v13 offset:928
    ds_read_b64_tr_b16 v[108:109], v13 offset:12448
    ds_read_b64_tr_b16 v[110:111], v13 offset:13216
    s_waitcnt lgkmcnt(0)
    s_barrier
    s_waitcnt vmcnt(12)
    s_barrier
    v_add_u32 v13, 49152, v11
    ds_read_b64_tr_b16 v[48:49], v13 offset:0
    ds_read_b64_tr_b16 v[50:51], v13 offset:768
    ds_read_b64_tr_b16 v[52:53], v13 offset:12288
    ds_read_b64_tr_b16 v[54:55], v13 offset:13056
    ds_read_b64_tr_b16 v[56:57], v13 offset:32
    ds_read_b64_tr_b16 v[58:59], v13 offset:800
    ds_read_b64_tr_b16 v[60:61], v13 offset:12320
    ds_read_b64_tr_b16 v[62:63], v13 offset:13088
    ds_read_b64_tr_b16 v[80:81], v13 offset:64
    ds_read_b64_tr_b16 v[82:83], v13 offset:832
    ds_read_b64_tr_b16 v[84:85], v13 offset:12352
    ds_read_b64_tr_b16 v[86:87], v13 offset:13120
    ds_read_b64_tr_b16 v[88:89], v13 offset:96
    ds_read_b64_tr_b16 v[90:91], v13 offset:864
    ds_read_b64_tr_b16 v[92:93], v13 offset:12384
    ds_read_b64_tr_b16 v[94:95], v13 offset:13152
    ds_read_b64_tr_b16 v[112:113], v13 offset:128
    ds_read_b64_tr_b16 v[114:115], v13 offset:896
    ds_read_b64_tr_b16 v[116:117], v13 offset:12416
    ds_read_b64_tr_b16 v[118:119], v13 offset:13184
    ds_read_b64_tr_b16 v[120:121], v13 offset:160
    ds_read_b64_tr_b16 v[122:123], v13 offset:928
    ds_read_b64_tr_b16 v[124:125], v13 offset:12448
    ds_read_b64_tr_b16 v[126:127], v13 offset:13216
    s_waitcnt lgkmcnt(0)
    s_barrier
    v_lshlrev_b32 v2, 4, v1
    s_mul_i32 s28, s21, 24576
    v_add_u32 v3, s28, v2
    ds_write_b128 v3, v[32:35] offset:0
    ds_write_b128 v3, v[36:39] offset:1024
    ds_write_b128 v3, v[40:43] offset:2048
    ds_write_b128 v3, v[44:47] offset:3072
    ds_write_b128 v3, v[48:51] offset:4096
    ds_write_b128 v3, v[52:55] offset:5120
    ds_write_b128 v3, v[56:59] offset:6144
    ds_write_b128 v3, v[60:63] offset:7168
    ds_write_b128 v3, v[64:67] offset:8192
    ds_write_b128 v3, v[68:71] offset:9216
    ds_write_b128 v3, v[72:75] offset:10240
    ds_write_b128 v3, v[76:79] offset:11264
    ds_write_b128 v3, v[80:83] offset:12288
    ds_write_b128 v3, v[84:87] offset:13312
    ds_write_b128 v3, v[88:91] offset:14336
    ds_write_b128 v3, v[92:95] offset:15360
    ds_write_b128 v3, v[96:99] offset:16384
    ds_write_b128 v3, v[100:103] offset:17408
    ds_write_b128 v3, v[104:107] offset:18432
    ds_write_b128 v3, v[108:111] offset:19456
    ds_write_b128 v3, v[112:115] offset:20480
    ds_write_b128 v3, v[116:119] offset:21504
    ds_write_b128 v3, v[120:123] offset:22528
    ds_write_b128 v3, v[124:127] offset:23552
    s_waitcnt lgkmcnt(0)
    s_lshl_b32 s28, s20, 7
    v_mov_b32 v122, s28
    s_mov_b32 s43, 0x840000
    buffer_load_dword v24, v122, s[8:11], s43 offen sc1
    s_waitcnt vmcnt(1)
    s_barrier
    v_add_u32 v13, 98304, v11
    ds_read_b64_tr_b16 a[96:97], v13 offset:0
    ds_read_b64_tr_b16 a[98:99], v13 offset:768
    ds_read_b64_tr_b16 a[100:101], v13 offset:12288
    ds_read_b64_tr_b16 a[102:103], v13 offset:13056
    ds_read_b64_tr_b16 a[104:105], v13 offset:32
    ds_read_b64_tr_b16 a[106:107], v13 offset:800
    ds_read_b64_tr_b16 a[108:109], v13 offset:12320
    ds_read_b64_tr_b16 a[110:111], v13 offset:13088
    ds_read_b64_tr_b16 a[224:225], v13 offset:64
    ds_read_b64_tr_b16 a[226:227], v13 offset:832
    ds_read_b64_tr_b16 a[228:229], v13 offset:12352
    ds_read_b64_tr_b16 a[230:231], v13 offset:13120
    ds_read_b64_tr_b16 a[232:233], v13 offset:96
    ds_read_b64_tr_b16 a[234:235], v13 offset:864
    ds_read_b64_tr_b16 a[236:237], v13 offset:12384
    ds_read_b64_tr_b16 a[238:239], v13 offset:13152
    ds_read_b64_tr_b16 v[224:225], v13 offset:128
    ds_read_b64_tr_b16 v[226:227], v13 offset:896
    ds_read_b64_tr_b16 v[228:229], v13 offset:12416
    ds_read_b64_tr_b16 v[230:231], v13 offset:13184
    ds_read_b64_tr_b16 v[232:233], v13 offset:160
    ds_read_b64_tr_b16 v[234:235], v13 offset:928
    ds_read_b64_tr_b16 v[236:237], v13 offset:12448
    ds_read_b64_tr_b16 v[238:239], v13 offset:13216
    s_waitcnt lgkmcnt(0)
    s_barrier
    s_waitcnt vmcnt(0)
    v_min_u32 v24, v24, v20
    v_cmp_ne_u32 vcc, 0, v20
    s_cbranch_vccz M_h_sl
    v_readfirstlane_b32 s28, v23
    s_cmp_lg_u32 s28, s23
    s_cbranch_scc1 M_redo
    v_readfirstlane_b32 s53, v20
    s_sub_u32 s53, s53, 1
    s_and_b32 s53, s53, 1
    s_lshl_b32 s52, s53, 13
    s_add_u32 s52, s52, 0xa00000
    s_xor_b32 s56, s53, 1
    s_lshl_b32 s56, s56, 13
    s_lshr_b32 s55, s25, 2
    s_and_b32 s55, s55, 15
    s_mul_i32 s55, s55, 256
    s_mov_b32 s58, 0
    s_branch M_h_sk
M_h_sl:
    v_mov_b32 v16, 128
    s_mov_b32 s39, 0
L_go_6:
    buffer_load_dword v17, v16, s[88:91], 0 offen sc1
    buffer_load_dword v18, v16, s[88:91], 0 offen offset:12 sc1
    s_add_u32 s39, s39, 1
    s_cmp_gt_u32 s39, 400000
    s_cbranch_scc1 M_fail
    s_waitcnt vmcnt(0)
    v_cmp_eq_u32 vcc, 0, v18
    s_cbranch_vccnz L_go_6
    v_readfirstlane_b32 s28, v18
    s_cmp_lg_u32 s28, s23
    s_cbranch_scc1 M_redo
    v_cmp_ne_u32 vcc, 0, v17
    s_cbranch_vccnz L_go_6k
    s_sleep 3
    s_branch L_go_6
L_go_6k:
    v_readfirstlane_b32 s53, v17
    s_sub_u32 s53, s53, 1
    s_and_b32 s53, s53, 1
    s_lshl_b32 s52, s53, 13
    s_add_u32 s52, s52, 0xa00000
    s_xor_b32 s56, s53, 1
    s_lshl_b32 s56, s56, 13
    s_lshr_b32 s55, s25, 2
    s_and_b32 s55, s55, 15
    s_mul_i32 s55, s55, 256
    s_mov_b32 s58, 0
M_h_sk:
    s_lshl_b32 s28, s21, 10
    v_add_u32 v7, s28, v2
    v_add_u32 v4, 20480, v7
    v_add_u32 v5, 24576, v7
    v_add_u32 v7, 98304, v7
    v_add_u32 v6, 3072, v5
    v_add_u32 v9, 98304, v2
    v_lshrrev_b32 v11, 13, v4
    v_lshlrev_b32 v11, 13, v11
    v_add_u32 v4, v4, v11
    v_lshrrev_b32 v11, 13, v5
    v_lshlrev_b32 v11, 13, v11
    v_add_u32 v5, v5, v11
    v_lshrrev_b32 v11, 13, v6
    v_lshlrev_b32 v11, 13, v11
    v_add_u32 v6, v6, v11
    v_and_b32 v11, 2, v1
    v_mov_b32 v10, 0x4444
    v_mov_b32 v12, 0xeeee
    v_cmp_ne_u32 vcc, 0, v11
    s_nop 1
    v_cndmask_b32 v10, v10, v12, vcc
    v_and_b32 v11, 15, v1
    v_lshrrev_b32 v12, 2, v11
    v_mul_u32_u24 v12, 272, v12
    v_lshrrev_b32 v13, 4, v1
    v_lshl_add_u32 v121, v13, 4, v2
    v_add_u32 v121, 108544, v121
    v_lshl_add_u32 v12, v13, 5, v12
    v_and_b32 v13, 3, v1
    v_lshl_add_u32 v12, v13, 2, v12
    s_lshr_b32 s28, s21, 1
    s_lshl_b32 s28, s28, 7
    s_and_b32 s29, s21, 1
    s_mul_i32 s29, s29, 3264
    s_add_u32 s28, s28, s29
    s_add_u32 s28, s28, 108544
    v_add_u32 v120, s28, v12
    v_add_u32 v126, 1088, v120
    v_add_u32 v127, 2176, v120
    v_add_u32 v0, 131072, v2
    s_max_u32 s48, s21, 1
    s_sub_u32 s48, s48, 1
    s_lshl_b32 s48, s48, 12
    s_add_u32 s47, s48, 131072
    s_mul_i32 s28, s20, 24576
    s_add_u32 s48, s48, s28
    s_add_u32 s48, s48, 0x1003000
    s_lshl_b32 s28, s20, 7
    v_mov_b32 v122, s28
    s_mov_b32 s43, 0x840000
    v_cmp_ne_u32 vcc, 0, v24
    s_cbranch_vccnz M_h_pk
    s_mov_b32 s39, 0
M_h_pz:
    buffer_load_dword v17, v122, s[8:11], s43 offen sc1
    s_add_u32 s39, s39, 1
    s_cmp_gt_u32 s39, 400000
    s_cbranch_scc1 M_fail
    s_waitcnt vmcnt(0)
    v_cmp_eq_u32 vcc, 0, v17
    s_cbranch_vccz M_h_pz_ok
    s_sleep 1
    s_branch M_h_pz
M_h_pz_ok:
M_h_pk:
    s_mov_b32 s49, s47
    s_mov_b32 m0, s49
    s_xor_b32 s47, s47, 16384
    buffer_load_dwordx4 v2, s[8:11], s48 offen offset:0 sc1 lds
    buffer_load_dwordx4 v2, s[8:11], s48 offen offset:1024 sc1 lds
    buffer_load_dwordx4 v2, s[8:11], s48 offen offset:2048 sc1 lds
    buffer_load_dwordx4 v2, s[8:11], s48 offen offset:3072 sc1 lds
    s_mov_b32 s49, s47
    s_add_u32 s48, s48, 786432
    s_nop 0
    s_sub_u32 s49, s47, 30720
    v_lshrrev_b32 v13, 4, v1
    s_waitcnt lgkmcnt(0)
    s_mov_b32 s22, 0
    s_cmp_eq_u32 s21, 0
    s_cbranch_scc1 M_h_w0
    s_cmp_eq_u32 s21, 1
    s_cbranch_scc1 M_h_w1
    s_cmp_eq_u32 s21, 2
    s_cbranch_scc1 M_h_w2
    s_branch M_h_w3
M_h_w0:
    s_mul_i32 s28, s20, 640
    v_and_b32 v12, 7, v1
    v_lshlrev_b32 v12, 4, v12
    v_lshl_add_u32 v122, v13, 7, v12
    v_lshrrev_b32 v14, 3, v11
    v_lshl_add_u32 v122, v14, 3, v122
    v_add_u32 v122, s28, v122
    v_lshl_add_u32 v123, v14, 2, v12
    v_and_b32 v14, 1, v13
    v_lshl_add_u32 v123, v14, 3, v123
    s_add_u32 s28, s28, 512
    v_add_u32 v123, s28, v123
    v_lshrrev_b32 v12, 13, v122
    v_lshlrev_b32 v12, 13, v12
    v_add_u32 v122, v122, v12
    v_lshrrev_b32 v12, 13, v123
    v_lshlrev_b32 v12, 13, v12
    v_add_u32 v123, v123, v12
    v_cmp_lt_u32 s[44:45], 1, v13
    v_mov_b32 v12, 0x7ff00000
    v_cmp_lt_u32 vcc, 1, v13
    v_mov_b32 v1, 0.10411754627697264
    s_nop 0
    v_cndmask_b32 v123, v12, v123, vcc
    v_mov_b32 v12, 0xff800000
    v_cndmask_b32_e64 v12, v12, 0, vcc
    v_mov_b32 v13, v12
    v_mov_b32 v14, v12
    v_mov_b32 v15, v12
    s_mov_b32 s42, 0.10411754627697264
    s_mov_b32 s43, 0.10411754627697264
M_h_w0_loop:
    v_mov_b32 v56, 0
    v_mov_b32 v57, 0
    v_mov_b32 v58, 0
    v_mov_b32 v59, 0
    v_mov_b32 v60, 0
    v_mov_b32 v61, 0
    v_mov_b32 v62, 0
    v_mov_b32 v63, 0
    v_mov_b32 v64, 0
    v_mov_b32 v65, 0
    v_mov_b32 v66, 0
    v_mov_b32 v67, 0
    v_mov_b32 v68, 0
    v_mov_b32 v69, 0
    v_mov_b32 v70, 0
    v_mov_b32 v71, 0
    v_mov_b32 v72, 0
    v_mov_b32 v73, 0
    v_mov_b32 v74, 0
    v_mov_b32 v75, 0
    v_mov_b32 v76, 0
    v_mov_b32 v77, 0
    v_mov_b32 v78, 0
    v_mov_b32 v79, 0
    ds_read_b128 v[80:83], v3 offset:0
    ds_read_b128 v[84:87], v3 offset:1024
    ds_read_b128 v[88:91], v3 offset:2048
    ds_read_b128 v[92:95], v3 offset:3072
    ds_read_b128 v[96:99], v3 offset:4096
    ds_read_b128 v[100:103], v3 offset:5120
    ds_read_b128 v[104:107], v3 offset:6144
    ds_read_b128 v[108:111], v3 offset:7168
    ds_read_b128 v[112:115], v3 offset:8192
    ds_read_b128 v[116:119], v3 offset:9216
    s_sub_u32 s46, s22, 1
    s_lshr_b32 s28, s46, 1
    s_xor_b32 s28, s28, s53
    s_and_b32 s28, s28, 1
    s_xor_b32 s28, s28, 1
    s_lshl_b32 s28, s28, 13
    s_lshl_b32 s40, s46, 20
    s_add_u32 s40, s40, s28
    s_add_u32 s40, s40, 0xc0c0000
    s_lshr_b32 s28, s22, 1
    s_xor_b32 s28, s28, s53
    s_and_b32 s28, s28, 1
    s_xor_b32 s28, s28, 1
    s_lshl_b32 s28, s28, 13
    s_lshl_b32 s41, s22, 20
    s_add_u32 s41, s41, s28
    s_add_u32 s41, s41, 0xc0c0000
    s_waitcnt lgkmcnt(0)
    s_waitcnt vmcnt(0)
    s_add_u32 s28, s55, 0xa4000
    v_mov_b32 v20, s28
    s_mov_b32 s39, 0
    s_waitcnt vmcnt(0)
    buffer_load_dword v21, v20, s[8:11], s52 offen sc1
    s_nop 15
    buffer_load_dword v22, v20, s[8:11], s52 offen sc1
    s_nop 15
    buffer_load_dword v23, v20, s[8:11], s52 offen sc1
M_h_w0_hu:
    s_waitcnt vmcnt(2)
    v_cmp_gt_i32 vcc, s46, v21
    s_cbranch_vccz M_h_w0_hud
    buffer_load_dword v21, v20, s[8:11], s52 offen sc1
    s_waitcnt vmcnt(2)
    v_cmp_gt_i32 vcc, s46, v22
    s_cbranch_vccz M_h_w0_hud
    buffer_load_dword v22, v20, s[8:11], s52 offen sc1
    s_waitcnt vmcnt(2)
    v_cmp_gt_i32 vcc, s46, v23
    s_cbranch_vccz M_h_w0_hud
    buffer_load_dword v23, v20, s[8:11], s52 offen sc1
    s_add_u32 s39, s39, 1
    s_cmp_gt_u32 s39, 400000
    s_cbranch_scc1 M_fail
    s_branch M_h_w0_hu
M_h_w0_hud:
    s_barrier
    buffer_load_dwordx4 v[16:19], v4, s[8:11], s40 offen sc1
    s_barrier
    buffer_load_dwordx4 v[32:35], v5, s[8:11], s40 offen sc1
    s_barrier
    s_barrier
    s_mov_b32 s39, 1
    s_waitcnt vmcnt(1)
    ds_write_b128 v7, v[16:19] offset:0
    v_max3_u32 v11, v16, v17, v18
    v_max_u32 v11, v11, v19
    v_cmp_eq_u32 vcc, -1, v11
    v_smfmac_f32_16x16x64_bf16 v[56:59], v[16:19], a[0:7], v10
    v_smfmac_f32_16x16x64_bf16 v[60:63], v[16:19], a[8:15], v10
    v_smfmac_f32_16x16x64_bf16 v[64:67], v[16:19], a[128:135], v10
    v_smfmac_f32_16x16x64_bf16 v[68:71], v[16:19], a[136:143], v10
    s_cbranch_vccnz M_h_w0_slow1
M_h_w0_back1:
    s_waitcnt lgkmcnt(0)
    s_barrier
    ds_read_b128 v[20:23], v9 offset:1024
    v_smfmac_f32_16x16x64_bf16 v[72:75], v[16:19], v[128:135], v10
    ds_read_b128 v[24:27], v9 offset:2048
    ds_read_b128 v[28:31], v9 offset:3072
    v_smfmac_f32_16x16x64_bf16 v[76:79], v[16:19], v[136:143], v10
    s_waitcnt vmcnt(0)
    ds_write_b128 v7, v[32:35] offset:4096
    v_smfmac_f32_16x16x64_bf16 v[56:59], v[32:35], a[64:71], v10
    v_max3_u32 v11, v32, v33, v34
    v_smfmac_f32_16x16x64_bf16 v[60:63], v[32:35], a[72:79], v10
    v_smfmac_f32_16x16x64_bf16 v[64:67], v[32:35], a[192:199], v10
    v_max_u32 v11, v11, v35
    v_smfmac_f32_16x16x64_bf16 v[68:71], v[32:35], a[200:207], v10
    v_cmp_eq_u32 vcc, -1, v11
    s_waitcnt lgkmcnt(3)
    v_smfmac_f32_16x16x64_bf16 v[56:59], v[20:23], a[16:23], v10
    v_smfmac_f32_16x16x64_bf16 v[60:63], v[20:23], a[24:31], v10
    s_cbranch_vccnz M_h_w0_slow2
M_h_w0_back2:
    s_waitcnt lgkmcnt(0)
    s_barrier
    ds_read_b128 v[36:39], v9 offset:5120
    v_smfmac_f32_16x16x64_bf16 v[56:59], v[24:27], a[32:39], v10
    ds_read_b128 v[48:51], v9 offset:8192
    ds_read_b128 v[40:43], v9 offset:6144
    v_smfmac_f32_16x16x64_bf16 v[60:63], v[24:27], a[40:47], v10
    ds_read_b128 v[44:47], v9 offset:7168
    ds_read_b128 v[52:55], v9 offset:9216
    v_smfmac_f32_16x16x64_bf16 v[56:59], v[28:31], a[48:55], v10
    v_smfmac_f32_16x16x64_bf16 v[60:63], v[28:31], a[56:63], v10
    v_smfmac_f32_16x16x64_bf16 v[64:67], v[20:23], a[144:151], v10
    ds_read_b128 v[16:19], v0 offset:0
    v_smfmac_f32_16x16x64_bf16 v[68:71], v[20:23], a[152:159], v10
    s_waitcnt lgkmcnt(4)
    v_smfmac_f32_16x16x64_bf16 v[56:59], v[36:39], a[80:87], v10
    v_smfmac_f32_16x16x64_bf16 v[60:63], v[36:39], a[88:95], v10
    v_smfmac_f32_16x16x64_bf16 v[56:59], v[48:51], v[80:87], v10
    ds_read_b128 v[80:83], v3 offset:10240
    ds_read_b128 v[84:87], v3 offset:11264
    v_smfmac_f32_16x16x64_bf16 v[60:63], v[48:51], v[88:95], v10
    s_waitcnt lgkmcnt(4)
    v_smfmac_f32_16x16x64_bf16 v[56:59], v[40:43], a[96:103], v10
    ds_read_b128 v[88:91], v3 offset:12288
    ds_read_b128 v[92:95], v3 offset:13312
    v_smfmac_f32_16x16x64_bf16 v[60:63], v[40:43], a[104:111], v10
    v_smfmac_f32_16x16x64_bf16 v[56:59], v[44:47], a[112:119], v10
    v_smfmac_f32_16x16x64_bf16 v[60:63], v[44:47], a[120:127], v10
    s_waitcnt lgkmcnt(5)
    v_smfmac_f32_16x16x64_bf16 v[56:59], v[52:55], v[96:103], v10
    ds_read_b128 v[96:99], v3 offset:14336
    ds_read_b128 v[100:103], v3 offset:15360
    v_smfmac_f32_16x16x64_bf16 v[60:63], v[52:55], v[104:111], v10
    ds_read_b128 v[104:107], v3 offset:16384
    ds_read_b128 v[108:111], v3 offset:17408
    v_smfmac_f32_16x16x64_bf16 v[64:67], v[24:27], a[160:167], v10
    s_nop 1
    v_smfmac_f32_16x16x64_bf16 v[68:71], v[24:27], a[168:175], v10
    v_add_f32 v56, v56, v58
    v_smfmac_f32_16x16x64_bf16 v[64:67], v[28:31], a[176:183], v10
    v_add_f32 v57, v57, v59
    v_smfmac_f32_16x16x64_bf16 v[68:71], v[28:31], a[184:191], v10
    v_add_f32 v60, v60, v62
    v_smfmac_f32_16x16x64_bf16 v[64:67], v[48:51], v[112:119], v10
    s_waitcnt lgkmcnt(6)
    v_add_f32 v61, v61, v63
    v_smfmac_f32_16x16x64_bf16 v[68:71], v[48:51], v[80:87], v10
    ds_read_b128 v[112:115], v3 offset:18432
    v_cvt_pk_bf16_f32 v124, v56, v60
    v_smfmac_f32_16x16x64_bf16 v[64:67], v[36:39], a[208:215], v10
    ds_read_b128 v[116:119], v3 offset:19456
    v_cvt_pk_bf16_f32 v125, v57, v61
    v_smfmac_f32_16x16x64_bf16 v[68:71], v[36:39], a[216:223], v10
    ds_read_b128 v[80:83], v3 offset:20480
    ds_read_b128 v[84:87], v3 offset:21504
    v_smfmac_f32_16x16x64_bf16 v[64:67], v[40:43], a[224:231], v10
    ds_write2_b32 v120, v124, v125 offset0:0 offset1:4
    v_smfmac_f32_16x16x64_bf16 v[68:71], v[40:43], a[232:239], v10
    s_waitcnt lgkmcnt(7)
    ds_read_b128 v[56:59], v0 offset:6144
    v_smfmac_f32_16x16x64_bf16 v[64:67], v[52:55], v[88:95], v10
    ds_read_b128 v[88:91], v3 offset:22528
    ds_read_b128 v[92:95], v3 offset:23552
    v_smfmac_f32_16x16x64_bf16 v[68:71], v[52:55], v[96:103], v10
    ds_read_b128 v[60:63], v0 offset:3072
    v_smfmac_f32_16x16x64_bf16 v[64:67], v[44:47], a[240:247], v10
    s_nop 1
    v_smfmac_f32_16x16x64_bf16 v[68:71], v[44:47], a[248:255], v10
    s_waitcnt lgkmcnt(7)
    s_nop 0
    v_smfmac_f32_16x16x64_bf16 v[72:75], v[48:51], v[104:111], v10
    s_nop 1
    v_smfmac_f32_16x16x64_bf16 v[76:79], v[48:51], v[112:119], v10
    ds_read_b128 v[48:51], v0 offset:9216
    v_add_f32 v64, v64, v66
    v_smfmac_f32_16x16x64_bf16 v[72:75], v[20:23], v[144:151], v10
    v_add_f32 v65, v65, v67
    v_smfmac_f32_16x16x64_bf16 v[76:79], v[20:23], v[152:159], v10
    s_waitcnt lgkmcnt(2)
    v_add_f32 v68, v68, v70
    v_smfmac_f32_16x16x64_bf16 v[72:75], v[52:55], v[80:87], v10
    ds_read_b128 v[20:23], v0 offset:1024
    v_add_f32 v69, v69, v71
    v_smfmac_f32_16x16x64_bf16 v[76:79], v[52:55], v[88:95], v10
    ds_read_b128 v[52:55], v0 offset:7168
    v_cvt_pk_bf16_f32 v124, v64, v68
    v_smfmac_f32_16x16x64_bf16 v[72:75], v[32:35], v[192:199], v10
    v_cvt_pk_bf16_f32 v125, v65, v69
    v_smfmac_f32_16x16x64_bf16 v[76:79], v[32:35], v[200:207], v10
    ds_write2_b32 v126, v124, v125 offset0:0 offset1:4
    ds_read_b128 v[32:35], v0 offset:4096
    v_smfmac_f32_16x16x64_bf16 v[72:75], v[24:27], v[160:167], v10
    v_smfmac_f32_16x16x64_bf16 v[76:79], v[24:27], v[168:175], v10
    ds_read_b128 v[24:27], v0 offset:10240
    v_smfmac_f32_16x16x64_bf16 v[72:75], v[28:31], v[176:183], v10
    v_smfmac_f32_16x16x64_bf16 v[76:79], v[28:31], v[184:191], v10
    ds_read_b128 v[28:31], v0 offset:2048
    v_smfmac_f32_16x16x64_bf16 v[72:75], v[36:39], v[208:215], v10
    s_waitcnt lgkmcnt(3)
    s_barrier
    v_smfmac_f32_16x16x64_bf16 v[72:75], v[40:43], v[224:231], v10
    ds_read_b128 v[96:99], v121 offset:0
    ds_read_b128 v[100:103], v121 offset:3264
    v_smfmac_f32_16x16x64_bf16 v[72:75], v[44:47], v[240:247], v10
    ds_read_b128 v[80:83], v121 offset:1088
    ds_read_b128 v[84:87], v121 offset:4352
    v_smfmac_f32_16x16x64_bf16 v[76:79], v[36:39], v[216:223], v10
    ds_read_b128 v[36:39], v0 offset:8192
    s_nop 0
    v_smfmac_f32_16x16x64_bf16 v[76:79], v[40:43], v[232:239], v10
    ds_read_b128 v[40:43], v0 offset:5120
    s_nop 0
    v_smfmac_f32_16x16x64_bf16 v[76:79], v[44:47], v[248:255], v10
    s_waitcnt lgkmcnt(4)
    v_add_f32 v72, v72, v74
    v_mfma_f32_16x16x32_bf16 v[64:67], v[16:19], v[96:99], 0
    ds_read_b128 v[44:47], v0 offset:11264
    v_add_f32 v73, v73, v75
    v_mfma_f32_16x16x32_bf16 v[68:71], v[56:59], v[96:99], 0
    s_nop 1
    v_mfma_f32_16x16x32_bf16 v[116:119], v[96:99], v[96:99], v[12:15]
    v_add_f32 v76, v76, v78
    v_add_f32 v77, v77, v79
    v_mfma_f32_16x16x32_bf16 v[64:67], v[60:63], v[100:103], v[64:67]
    v_cvt_pk_bf16_f32 v124, v72, v76
    v_cvt_pk_bf16_f32 v125, v73, v77
    ds_write2_b32 v127, v124, v125 offset0:0 offset1:4
    v_mfma_f32_16x16x32_bf16 v[68:71], v[48:51], v[100:103], v[68:71]
    v_mfma_f32_16x16x32_bf16 v[116:119], v[100:103], v[100:103], v[116:119]
    s_waitcnt lgkmcnt(4)
    v_mfma_f32_16x16x32_bf16 v[64:67], v[20:23], v[80:83], v[64:67]
    v_mfma_f32_16x16x32_bf16 v[68:71], v[52:55], v[80:83], v[68:71]
    v_mfma_f32_16x16x32_bf16 v[116:119], v[80:83], v[80:83], v[116:119]
    s_waitcnt lgkmcnt(0)
    s_barrier
    ds_read_b128 v[88:91], v121 offset:2176
    ds_read_b128 v[92:95], v121 offset:5440
    v_mfma_f32_16x16x32_bf16 v[64:67], v[32:35], v[84:87], v[64:67]
    v_mfma_f32_16x16x32_bf16 v[68:71], v[24:27], v[84:87], v[68:71]
    v_mfma_f32_16x16x32_bf16 v[116:119], v[84:87], v[84:87], v[116:119]
    s_waitcnt lgkmcnt(1)
    v_mfma_f32_16x16x32_bf16 v[116:119], v[88:91], v[88:91], v[116:119]
    s_waitcnt lgkmcnt(0)
    v_mfma_f32_16x16x32_bf16 v[116:119], v[92:95], v[92:95], v[116:119]
    s_nop 1
    v_mfma_f32_16x16x32_bf16 v[68:71], v[36:39], v[88:91], v[68:71]
    s_nop 1
    v_mfma_f32_16x16x32_bf16 v[68:71], v[44:47], v[92:95], v[68:71]
    s_nop 1
    v_mfma_f32_16x16x32_bf16 v[64:67], v[28:31], v[88:91], v[64:67]
    v_max3_f32 v72, v116, v117, v118
    v_max_f32 v72, v72, v119
    v_mfma_f32_16x16x32_bf16 v[64:67], v[40:43], v[92:95], v[64:67]
    v_mov_b32_dpp v116, v118 row_ror:8 row_mask:0xf bank_mask:0xc
    v_mov_b32_dpp v117, v119 row_ror:8 row_mask:0xf bank_mask:0xc
    v_max3_f32 v72, v72, v68, v69
    v_max3_f32 v72, v72, v70, v71
    s_nop 0
    s_nop 0
    s_nop 0
    s_nop 0
    v_max3_f32 v72, v72, v64, v65
    v_max3_f32 v72, v72, v66, v67
    v_mov_b32 v73, v72
    v_mov_b32_dpp v64, v68 row_ror:8 row_mask:0xf bank_mask:0xc
    v_mov_b32_dpp v65, v69 row_ror:8 row_mask:0xf bank_mask:0xc
    v_permlane32_swap_b32 v72, v73
    v_max_f32 v72, v72, v73
    v_mov_b32 v73, v72
    v_mov_b32_dpp v66, v70 row_ror:8 row_mask:0xf bank_mask:0xc
    v_mov_b32_dpp v67, v71 row_ror:8 row_mask:0xf bank_mask:0xc
    v_permlane16_swap_b32 v72, v73
    v_max_f32 v72, v72, v73
    v_mul_f32 v74, v72, v1
    v_xor_b32 v0, 16384, v0
    v_mul_f32_dpp v74, v72, v1 row_ror:8 row_mask:0xf bank_mask:0xc
    v_pk_fma_f32 v[64:65], v[64:65], s[42:43], v[74:75] op_sel_hi:[1,1,0] neg_lo:[0,0,1] neg_hi:[0,0,1]
    v_pk_fma_f32 v[66:67], v[66:67], s[42:43], v[74:75] op_sel_hi:[1,1,0] neg_lo:[0,0,1] neg_hi:[0,0,1]
    v_pk_fma_f32 v[116:117], v[116:117], s[42:43], v[74:75] op_sel_hi:[1,1,0] neg_lo:[0,0,1] neg_hi:[0,0,1]
    v_exp_f32 v64, v64
    v_exp_f32 v65, v65
    v_exp_f32 v66, v66
    v_exp_f32 v67, v67
    v_exp_f32 v116, v116
    v_exp_f32 v117, v117
    v_pk_add_f32 v[72:73], v[64:65], v[66:67]
    v_pk_add_f32 v[72:73], v[72:73], v[116:117]
    v_add_f32 v72, v72, v73
    s_nop 0
    s_nop 0
    v_add_f32_dpp v72, v72, v72 row_ror:8 row_mask:0xf bank_mask:0xf
    v_mov_b32 v73, v72
    s_nop 1
    v_permlane32_swap_b32 v72, v73
    v_add_f32 v72, v72, v73
    v_mov_b32 v73, v72
    s_nop 1
    v_permlane16_swap_b32 v72, v73
    v_add_f32 v72, v72, v73
    v_rcp_f32 v72, v72
    s_nop 0
    v_pk_mul_f32 v[64:65], v[64:65], v[72:73] op_sel_hi:[1,0]
    v_pk_mul_f32 v[66:67], v[66:67], v[72:73] op_sel_hi:[1,0]
    v_cvt_pk_bf16_f32 v74, v64, v65
    v_cvt_pk_bf16_f32 v75, v66, v67
    buffer_store_dwordx2 v[74:75], v122, s[8:11], s41 offen sc1
    v_pk_mul_f32 v[116:117], v[116:117], v[72:73] op_sel_hi:[1,0]
    v_cvt_pk_bf16_f32 v76, v116, v117
    buffer_store_dword v76, v123, s[8:11], s41 offen sc1
    s_add_u32 s22, s22, 1
    s_cmp_lt_u32 s22, 64
    s_cbranch_scc1 M_h_w0_loop
    s_branch M_g3
M_h_w1:
    v_mov_b32 v123, v122
    v_lshlrev_b32 v12, 4, v11
    v_lshl_add_u32 v122, v13, 7, v12
    v_subrev_u32 v122, 128, v122
    v_mov_b32 v12, 0x7ff00000
    v_cmp_lt_u32 vcc, 7, v11
    s_nop 1
    v_cndmask_b32 v122, v12, v122, vcc
    v_cmp_gt_u32 vcc, 32, v1
    v_lshl_add_u32 v123, v1, 2, v123
    s_nop 0
    v_cndmask_b32 v123, v12, v123, vcc
    v_mov_b32 v14, 1
    v_mov_b32 v13, 0
    s_mul_i32 s42, s20, 3072
    s_add_u32 s42, s42, 0xa400000
    s_add_u32 s43, s56, 0x8c0000
M_h_w1_loop:
    v_mov_b32 v56, 0
    v_mov_b32 v57, 0
    v_mov_b32 v58, 0
    v_mov_b32 v59, 0
    v_mov_b32 v60, 0
    v_mov_b32 v61, 0
    v_mov_b32 v62, 0
    v_mov_b32 v63, 0
    v_mov_b32 v64, 0
    v_mov_b32 v65, 0
    v_mov_b32 v66, 0
    v_mov_b32 v67, 0
    v_mov_b32 v68, 0
    v_mov_b32 v69, 0
    v_mov_b32 v70, 0
    v_mov_b32 v71, 0
    v_mov_b32 v72, 0
    v_mov_b32 v73, 0
    v_mov_b32 v74, 0
    v_mov_b32 v75, 0
    v_mov_b32 v76, 0
    v_mov_b32 v77, 0
    v_mov_b32 v78, 0
    v_mov_b32 v79, 0
    ds_read_b128 v[80:83], v3 offset:0
    ds_read_b128 v[84:87], v3 offset:1024
    ds_read_b128 v[88:91], v3 offset:2048
    ds_read_b128 v[92:95], v3 offset:3072
    ds_read_b128 v[96:99], v3 offset:4096
    ds_read_b128 v[100:103], v3 offset:5120
    ds_read_b128 v[104:107], v3 offset:6144
    ds_read_b128 v[108:111], v3 offset:7168
    ds_read_b128 v[112:115], v3 offset:8192
    ds_read_b128 v[116:119], v3 offset:9216
    s_sub_u32 s46, s22, 1
    s_lshr_b32 s28, s46, 1
    s_xor_b32 s28, s28, s53
    s_and_b32 s28, s28, 1
    s_xor_b32 s28, s28, 1
    s_lshl_b32 s28, s28, 13
    s_lshl_b32 s40, s46, 20
    s_add_u32 s40, s40, s28
    s_add_u32 s40, s40, 0xc0c0000
    s_waitcnt lgkmcnt(0)
    s_waitcnt vmcnt(0)
    s_barrier
    buffer_load_dwordx4 v[20:23], v4, s[8:11], s40 offen sc1
    s_barrier
    buffer_load_dwordx4 v[36:39], v5, s[8:11], s40 offen sc1
    s_barrier
    buffer_load_dwordx4 v[48:51], v6, s[8:11], s40 offen sc1
    s_barrier
    s_mov_b32 m0, s49
    s_xor_b32 s47, s47, 16384
    buffer_load_dwordx4 v2, s[8:11], s48 offen offset:0 sc1 lds
    buffer_load_dwordx4 v2, s[8:11], s48 offen offset:1024 sc1 lds
    buffer_load_dwordx4 v2, s[8:11], s48 offen offset:2048 sc1 lds
    buffer_load_dwordx4 v2, s[8:11], s48 offen offset:3072 sc1 lds
    s_mov_b32 s49, s47
    s_add_u32 s48, s48, 786432
    s_nop 0
    s_mov_b32 s39, 1
    s_waitcnt vmcnt(6)
    ds_write_b128 v7, v[20:23] offset:0
    v_max3_u32 v11, v20, v21, v22
    v_max_u32 v11, v11, v23
    v_cmp_eq_u32 vcc, -1, v11
    v_smfmac_f32_16x16x64_bf16 v[56:59], v[20:23], a[16:23], v10
    v_smfmac_f32_16x16x64_bf16 v[60:63], v[20:23], a[24:31], v10
    v_smfmac_f32_16x16x64_bf16 v[64:67], v[20:23], a[144:151], v10
    v_smfmac_f32_16x16x64_bf16 v[68:71], v[20:23], a[152:159], v10
    s_cbranch_vccnz M_h_w1_slow1
M_h_w1_back1:
    s_waitcnt lgkmcnt(0)
    s_barrier
    ds_read_b128 v[16:19], v9 offset:0
    v_smfmac_f32_16x16x64_bf16 v[72:75], v[20:23], v[144:151], v10
    ds_read_b128 v[24:27], v9 offset:2048
    ds_read_b128 v[28:31], v9 offset:3072
    v_smfmac_f32_16x16x64_bf16 v[76:79], v[20:23], v[152:159], v10
    s_waitcnt vmcnt(5)
    ds_write_b128 v7, v[36:39] offset:4096
    v_smfmac_f32_16x16x64_bf16 v[56:59], v[36:39], a[80:87], v10
    v_max3_u32 v11, v36, v37, v38
    v_smfmac_f32_16x16x64_bf16 v[60:63], v[36:39], a[88:95], v10
    s_waitcnt vmcnt(4)
    ds_write_b128 v7, v[48:51] offset:7168
    v_smfmac_f32_16x16x64_bf16 v[64:67], v[36:39], a[208:215], v10
    v_max_u32 v11, v11, v39
    v_max3_u32 v11, v11, v48, v49
    v_smfmac_f32_16x16x64_bf16 v[68:71], v[36:39], a[216:223], v10
    v_max3_u32 v11, v11, v50, v51
    v_cmp_eq_u32 vcc, -1, v11
    s_waitcnt lgkmcnt(4)
    v_smfmac_f32_16x16x64_bf16 v[56:59], v[16:19], a[0:7], v10
    v_smfmac_f32_16x16x64_bf16 v[60:63], v[16:19], a[8:15], v10
    s_cbranch_vccnz M_h_w1_slow2
M_h_w1_back2:
    s_waitcnt lgkmcnt(0)
    s_barrier
    ds_read_b128 v[32:35], v9 offset:4096
    v_smfmac_f32_16x16x64_bf16 v[56:59], v[24:27], a[32:39], v10
    ds_read_b128 v[40:43], v9 offset:6144
    ds_read_b128 v[44:47], v9 offset:7168
    v_smfmac_f32_16x16x64_bf16 v[60:63], v[24:27], a[40:47], v10
    ds_read_b128 v[52:55], v9 offset:9216
    v_smfmac_f32_16x16x64_bf16 v[56:59], v[28:31], a[48:55], v10
    v_smfmac_f32_16x16x64_bf16 v[60:63], v[28:31], a[56:63], v10
    v_smfmac_f32_16x16x64_bf16 v[64:67], v[16:19], a[128:135], v10
    v_smfmac_f32_16x16x64_bf16 v[68:71], v[16:19], a[136:143], v10
    s_waitcnt lgkmcnt(3)
    v_smfmac_f32_16x16x64_bf16 v[56:59], v[32:35], a[64:71], v10
    v_smfmac_f32_16x16x64_bf16 v[60:63], v[32:35], a[72:79], v10
    v_smfmac_f32_16x16x64_bf16 v[56:59], v[48:51], v[80:87], v10
    ds_read_b128 v[80:83], v3 offset:10240
    ds_read_b128 v[84:87], v3 offset:11264
    v_smfmac_f32_16x16x64_bf16 v[60:63], v[48:51], v[88:95], v10
    s_waitcnt lgkmcnt(3)
    v_smfmac_f32_16x16x64_bf16 v[56:59], v[40:43], a[96:103], v10
    ds_read_b128 v[88:91], v3 offset:12288
    ds_read_b128 v[92:95], v3 offset:13312
    v_smfmac_f32_16x16x64_bf16 v[60:63], v[40:43], a[104:111], v10
    v_smfmac_f32_16x16x64_bf16 v[56:59], v[44:47], a[112:119], v10
    v_smfmac_f32_16x16x64_bf16 v[60:63], v[44:47], a[120:127], v10
    s_waitcnt lgkmcnt(4)
    v_smfmac_f32_16x16x64_bf16 v[56:59], v[52:55], v[96:103], v10
    ds_read_b128 v[96:99], v3 offset:14336
    ds_read_b128 v[100:103], v3 offset:15360
    v_smfmac_f32_16x16x64_bf16 v[60:63], v[52:55], v[104:111], v10
    ds_read_b128 v[104:107], v3 offset:16384
    ds_read_b128 v[108:111], v3 offset:17408
    v_smfmac_f32_16x16x64_bf16 v[64:67], v[24:27], a[160:167], v10
    s_nop 1
    v_smfmac_f32_16x16x64_bf16 v[68:71], v[24:27], a[168:175], v10
    v_add_f32 v56, v56, v58
    v_smfmac_f32_16x16x64_bf16 v[64:67], v[28:31], a[176:183], v10
    v_add_f32 v57, v57, v59
    v_smfmac_f32_16x16x64_bf16 v[68:71], v[28:31], a[184:191], v10
    v_add_f32 v60, v60, v62
    v_smfmac_f32_16x16x64_bf16 v[64:67], v[48:51], v[112:119], v10
    s_waitcnt lgkmcnt(6)
    v_add_f32 v61, v61, v63
    v_smfmac_f32_16x16x64_bf16 v[68:71], v[48:51], v[80:87], v10
    ds_read_b128 v[112:115], v3 offset:18432
    v_cvt_pk_bf16_f32 v124, v56, v60
    v_smfmac_f32_16x16x64_bf16 v[64:67], v[32:35], a[192:199], v10
    ds_read_b128 v[116:119], v3 offset:19456
    v_cvt_pk_bf16_f32 v125, v57, v61
    v_smfmac_f32_16x16x64_bf16 v[68:71], v[32:35], a[200:207], v10
    ds_read_b128 v[80:83], v3 offset:20480
    ds_read_b128 v[84:87], v3 offset:21504
    v_smfmac_f32_16x16x64_bf16 v[64:67], v[40:43], a[224:231], v10
    ds_write2_b32 v120, v124, v125 offset0:0 offset1:4
    v_smfmac_f32_16x16x64_bf16 v[68:71], v[40:43], a[232:239], v10
    s_waitcnt lgkmcnt(7)
    v_smfmac_f32_16x16x64_bf16 v[64:67], v[52:55], v[88:95], v10
    ds_read_b128 v[88:91], v3 offset:22528
    ds_read_b128 v[92:95], v3 offset:23552
    v_smfmac_f32_16x16x64_bf16 v[68:71], v[52:55], v[96:103], v10
    v_smfmac_f32_16x16x64_bf16 v[64:67], v[44:47], a[240:247], v10
    s_nop 1
    v_smfmac_f32_16x16x64_bf16 v[68:71], v[44:47], a[248:255], v10
    s_waitcnt lgkmcnt(5)
    s_nop 0
    v_smfmac_f32_16x16x64_bf16 v[72:75], v[48:51], v[104:111], v10
    s_nop 1
    v_smfmac_f32_16x16x64_bf16 v[76:79], v[48:51], v[112:119], v10
    v_add_f32 v64, v64, v66
    v_smfmac_f32_16x16x64_bf16 v[72:75], v[16:19], v[128:135], v10
    v_add_f32 v65, v65, v67
    v_smfmac_f32_16x16x64_bf16 v[76:79], v[16:19], v[136:143], v10
    s_waitcnt lgkmcnt(3)
    v_add_f32 v68, v68, v70
    v_smfmac_f32_16x16x64_bf16 v[72:75], v[52:55], v[80:87], v10
    s_waitcnt lgkmcnt(0)
    v_add_f32 v69, v69, v71
    v_smfmac_f32_16x16x64_bf16 v[76:79], v[52:55], v[88:95], v10
    v_cvt_pk_bf16_f32 v124, v64, v68
    v_smfmac_f32_16x16x64_bf16 v[72:75], v[36:39], v[208:215], v10
    v_cvt_pk_bf16_f32 v125, v65, v69
    v_smfmac_f32_16x16x64_bf16 v[76:79], v[36:39], v[216:223], v10
    ds_write2_b32 v126, v124, v125 offset0:0 offset1:4
    v_smfmac_f32_16x16x64_bf16 v[72:75], v[24:27], v[160:167], v10
    v_smfmac_f32_16x16x64_bf16 v[76:79], v[24:27], v[168:175], v10
    v_smfmac_f32_16x16x64_bf16 v[72:75], v[28:31], v[176:183], v10
    v_smfmac_f32_16x16x64_bf16 v[76:79], v[28:31], v[184:191], v10
    v_smfmac_f32_16x16x64_bf16 v[72:75], v[32:35], v[192:199], v10
    s_waitcnt lgkmcnt(0)
    s_barrier
    v_smfmac_f32_16x16x64_bf16 v[72:75], v[40:43], v[224:231], v10
    v_smfmac_f32_16x16x64_bf16 v[72:75], v[44:47], v[240:247], v10
    s_nop 1
    v_smfmac_f32_16x16x64_bf16 v[76:79], v[32:35], v[200:207], v10
    s_nop 1
    v_smfmac_f32_16x16x64_bf16 v[76:79], v[40:43], v[232:239], v10
    s_nop 1
    v_smfmac_f32_16x16x64_bf16 v[76:79], v[44:47], v[248:255], v10
    v_pk_add_f32 v[72:73], v[72:73], v[74:75]
    s_nop 0
    s_nop 0
    s_nop 0
    s_nop 0
    s_nop 0
    s_nop 0
    s_nop 0
    v_pk_add_f32 v[76:77], v[76:77], v[78:79]
    v_cvt_pk_bf16_f32 v124, v72, v76
    v_cvt_pk_bf16_f32 v125, v73, v77
    ds_write2_b32 v127, v124, v125 offset0:0 offset1:4
    s_waitcnt lgkmcnt(0)
    s_barrier
    ds_read_b128 v[88:91], v121 offset:0
    ds_read_b128 v[92:95], v121 offset:1088
    ds_read_b128 v[96:99], v121 offset:2176
    ds_read_b128 v[100:103], v121 offset:3264
    ds_read_b128 v[104:107], v121 offset:4352
    ds_read_b128 v[108:111], v121 offset:5440
    s_waitcnt lgkmcnt(5)
    buffer_store_dwordx4 v[88:91], v122, s[8:11], s42 offen offset:0 sc1
    s_waitcnt lgkmcnt(4)
    buffer_store_dwordx4 v[92:95], v122, s[8:11], s42 offen offset:512 sc1
    s_waitcnt lgkmcnt(3)
    buffer_store_dwordx4 v[96:99], v122, s[8:11], s42 offen offset:1024 sc1
    s_waitcnt lgkmcnt(2)
    buffer_store_dwordx4 v[100:103], v122, s[8:11], s42 offen offset:1536 sc1
    s_waitcnt lgkmcnt(1)
    buffer_store_dwordx4 v[104:107], v122, s[8:11], s42 offen offset:2048 sc1
    s_waitcnt lgkmcnt(0)
    buffer_store_dwordx4 v[108:111], v122, s[8:11], s42 offen offset:2560 sc1
    s_waitcnt vmcnt(0)
    buffer_store_dword v14, v123, s[8:11], s43 offen sc1
    s_add_u32 s42, s42, 98304
    s_add_u32 s43, s43, 4096
    s_add_u32 s22, s22, 1
    s_cmp_lt_u32 s22, 64
    s_cbranch_scc1 M_h_w1_loop
    s_branch M_g3
M_h_w2:
    s_lshr_b32 s28, s20, 2
    s_and_b32 s54, s28, 3
    s_add_u32 s54, s54, 4
    s_mul_i32 s28, s28, 2
    s_add_u32 s28, s28, 0
    s_lshr_b32 s29, s28, 2
    s_lshl_b32 s29, s29, 17
    s_and_b32 s28, s28, 3
    s_lshl_b32 s28, s28, 13
    s_add_u32 s50, s28, s29
    s_and_b32 s28, s20, 3
    s_lshl_b32 s28, s28, 15
    s_add_u32 s50, s50, s28
    s_add_u32 s50, s50, 0x4140000
    v_lshlrev_b32 v13, 7, v1
M_h_w2_loop:
    s_add_u32 s43, s43, 4096
    s_min_u32 s43, s43, 0x87f000
    s_cmp_eq_u32 s22, 0
    s_cbranch_scc1 M_h_w2_go
    s_cmp_lg_u32 s22, 1
    s_cbranch_scc1 M_h_w2_n1
    s_sub_u32 s44, s43, 4096
    s_mov_b32 s39, 0
M_h_w2_f1:
    buffer_load_dword v16, v122, s[8:11], s44 offen sc1
    s_add_u32 s39, s39, 1
    s_cmp_gt_u32 s39, 400000
    s_cbranch_scc1 M_fail
    s_waitcnt vmcnt(0)
    v_cmp_eq_u32 vcc, 0, v16
    s_cbranch_vccz M_h_w2_f1_ok
    s_sleep 2
    s_branch M_h_w2_f1
M_h_w2_f1_ok:
    s_mul_i32 s28, s20, 24576
    s_add_u32 s28, s28, 0x10c3000
    s_mov_b32 m0, 147456
    s_add_u32 s29, s28, 0
    buffer_load_dwordx4 v2, s[8:11], s29 offen offset:0 sc1 lds
    buffer_load_dwordx4 v2, s[8:11], s29 offen offset:1024 sc1 lds
    buffer_load_dwordx4 v2, s[8:11], s29 offen offset:2048 sc1 lds
    buffer_load_dwordx4 v2, s[8:11], s29 offen offset:3072 sc1 lds
    s_mov_b32 m0, 151552
    s_add_u32 s29, s28, 4096
    buffer_load_dwordx4 v2, s[8:11], s29 offen offset:0 sc1 lds
    buffer_load_dwordx4 v2, s[8:11], s29 offen offset:1024 sc1 lds
    buffer_load_dwordx4 v2, s[8:11], s29 offen offset:2048 sc1 lds
    buffer_load_dwordx4 v2, s[8:11], s29 offen offset:3072 sc1 lds
    s_mov_b32 m0, 155648
    s_add_u32 s29, s28, 8192
    buffer_load_dwordx4 v2, s[8:11], s29 offen offset:0 sc1 lds
    buffer_load_dwordx4 v2, s[8:11], s29 offen offset:1024 sc1 lds
    buffer_load_dwordx4 v2, s[8:11], s29 offen offset:2048 sc1 lds
    buffer_load_dwordx4 v2, s[8:11], s29 offen offset:3072 sc1 lds
M_h_w2_n1:
    s_mov_b32 s39, 0
M_h_w2_fl:
    buffer_load_dword v16, v122, s[8:11], s43 offen sc1
    s_add_u32 s39, s39, 1
    s_cmp_gt_u32 s39, 400000
    s_cbranch_scc1 M_fail
    s_waitcnt vmcnt(0)
    v_cmp_eq_u32 vcc, 0, v16
    s_cbranch_vccz M_h_w2_fl_ok
    s_sleep 2
    s_branch M_h_w2_fl
M_h_w2_fl_ok:
M_h_w2_go:
    v_mov_b32 v56, 0
    v_mov_b32 v57, 0
    v_mov_b32 v58, 0
    v_mov_b32 v59, 0
    v_mov_b32 v60, 0
    v_mov_b32 v61, 0
    v_mov_b32 v62, 0
    v_mov_b32 v63, 0
    v_mov_b32 v64, 0
    v_mov_b32 v65, 0
    v_mov_b32 v66, 0
    v_mov_b32 v67, 0
    v_mov_b32 v68, 0
    v_mov_b32 v69, 0
    v_mov_b32 v70, 0
    v_mov_b32 v71, 0
    v_mov_b32 v72, 0
    v_mov_b32 v73, 0
    v_mov_b32 v74, 0
    v_mov_b32 v75, 0
    v_mov_b32 v76, 0
    v_mov_b32 v77, 0
    v_mov_b32 v78, 0
    v_mov_b32 v79, 0
    ds_read_b128 v[80:83], v3 offset:0
    ds_read_b128 v[84:87], v3 offset:1024
    ds_read_b128 v[88:91], v3 offset:2048
    ds_read_b128 v[92:95], v3 offset:3072
    ds_read_b128 v[96:99], v3 offset:4096
    ds_read_b128 v[100:103], v3 offset:5120
    ds_read_b128 v[104:107], v3 offset:6144
    ds_read_b128 v[108:111], v3 offset:7168
    ds_read_b128 v[112:115], v3 offset:8192
    ds_read_b128 v[116:119], v3 offset:9216
    s_sub_u32 s46, s22, 1
    s_lshr_b32 s28, s46, 1
    s_xor_b32 s28, s28, s53
    s_and_b32 s28, s28, 1
    s_xor_b32 s28, s28, 1
    s_lshl_b32 s28, s28, 13
    s_lshl_b32 s40, s46, 20
    s_add_u32 s40, s40, s28
    s_add_u32 s40, s40, 0xc0c0000
    s_cmp_lt_u32 s22, s54
    s_cselect_b32 s51, 0x0, s50
    s_waitcnt lgkmcnt(0)
    s_waitcnt vmcnt(0)
    s_barrier
    buffer_load_dwordx4 v[24:27], v4, s[8:11], s40 offen sc1
    s_barrier
    buffer_load_dwordx4 v[40:43], v5, s[8:11], s40 offen sc1
    s_barrier
    buffer_load_dwordx4 v[52:55], v6, s[8:11], s40 offen sc1
    s_barrier
    s_mov_b32 m0, s49
    s_xor_b32 s47, s47, 16384
    buffer_load_dwordx4 v2, s[8:11], s48 offen offset:0 sc1 lds
    buffer_load_dwordx4 v2, s[8:11], s48 offen offset:1024 sc1 lds
    buffer_load_dwordx4 v2, s[8:11], s48 offen offset:2048 sc1 lds
    buffer_load_dwordx4 v2, s[8:11], s48 offen offset:3072 sc1 lds
    s_mov_b32 s49, s47
    s_add_u32 s48, s48, 786432
    s_nop 0
    s_mov_b32 s39, 1
    s_waitcnt vmcnt(6)
    ds_write_b128 v7, v[24:27] offset:0
    v_max3_u32 v11, v24, v25, v26
    v_max_u32 v11, v11, v27
    v_cmp_eq_u32 vcc, -1, v11
    v_smfmac_f32_16x16x64_bf16 v[56:59], v[24:27], a[32:39], v10
    v_smfmac_f32_16x16x64_bf16 v[60:63], v[24:27], a[40:47], v10
    v_smfmac_f32_16x16x64_bf16 v[64:67], v[24:27], a[160:167], v10
    v_smfmac_f32_16x16x64_bf16 v[68:71], v[24:27], a[168:175], v10
    s_cbranch_vccnz M_h_w2_slow1
M_h_w2_back1:
    s_waitcnt lgkmcnt(0)
    s_barrier
    ds_read_b128 v[16:19], v9 offset:0
    v_smfmac_f32_16x16x64_bf16 v[72:75], v[24:27], v[160:167], v10
    ds_read_b128 v[20:23], v9 offset:1024
    ds_read_b128 v[28:31], v9 offset:3072
    v_smfmac_f32_16x16x64_bf16 v[76:79], v[24:27], v[168:175], v10
    s_waitcnt vmcnt(5)
    ds_write_b128 v7, v[40:43] offset:4096
    v_smfmac_f32_16x16x64_bf16 v[56:59], v[40:43], a[96:103], v10
    v_max3_u32 v11, v40, v41, v42
    v_smfmac_f32_16x16x64_bf16 v[60:63], v[40:43], a[104:111], v10
    s_waitcnt vmcnt(4)
    ds_write_b128 v7, v[52:55] offset:7168
    v_smfmac_f32_16x16x64_bf16 v[64:67], v[40:43], a[224:231], v10
    v_max_u32 v11, v11, v43
    v_max3_u32 v11, v11, v52, v53
    v_smfmac_f32_16x16x64_bf16 v[68:71], v[40:43], a[232:239], v10
    v_max3_u32 v11, v11, v54, v55
    v_cmp_eq_u32 vcc, -1, v11
    s_waitcnt lgkmcnt(4)
    v_smfmac_f32_16x16x64_bf16 v[56:59], v[16:19], a[0:7], v10
    v_smfmac_f32_16x16x64_bf16 v[60:63], v[16:19], a[8:15], v10
    s_cbranch_vccnz M_h_w2_slow2
M_h_w2_back2:
    s_waitcnt lgkmcnt(0)
    s_barrier
    ds_read_b128 v[32:35], v9 offset:4096
    v_smfmac_f32_16x16x64_bf16 v[56:59], v[20:23], a[16:23], v10
    ds_read_b128 v[48:51], v9 offset:8192
    ds_read_b128 v[36:39], v9 offset:5120
    v_smfmac_f32_16x16x64_bf16 v[60:63], v[20:23], a[24:31], v10
    ds_read_b128 v[44:47], v9 offset:7168
    v_smfmac_f32_16x16x64_bf16 v[56:59], v[28:31], a[48:55], v10
    buffer_load_dword v12, v13, s[8:11], s51 offen sc1
    s_add_u32 s50, s50, 1310720
    v_smfmac_f32_16x16x64_bf16 v[60:63], v[28:31], a[56:63], v10
    v_smfmac_f32_16x16x64_bf16 v[64:67], v[16:19], a[128:135], v10
    v_smfmac_f32_16x16x64_bf16 v[68:71], v[16:19], a[136:143], v10
    s_waitcnt lgkmcnt(2)
    v_smfmac_f32_16x16x64_bf16 v[56:59], v[32:35], a[64:71], v10
    v_smfmac_f32_16x16x64_bf16 v[60:63], v[32:35], a[72:79], v10
    v_smfmac_f32_16x16x64_bf16 v[56:59], v[48:51], v[80:87], v10
    ds_read_b128 v[80:83], v3 offset:10240
    ds_read_b128 v[84:87], v3 offset:11264
    v_smfmac_f32_16x16x64_bf16 v[60:63], v[48:51], v[88:95], v10
    s_waitcnt lgkmcnt(2)
    v_smfmac_f32_16x16x64_bf16 v[56:59], v[36:39], a[80:87], v10
    ds_read_b128 v[88:91], v3 offset:12288
    ds_read_b128 v[92:95], v3 offset:13312
    v_smfmac_f32_16x16x64_bf16 v[60:63], v[36:39], a[88:95], v10
    s_nop 0
    v_smfmac_f32_16x16x64_bf16 v[56:59], v[44:47], a[112:119], v10
    v_smfmac_f32_16x16x64_bf16 v[60:63], v[44:47], a[120:127], v10
    v_smfmac_f32_16x16x64_bf16 v[56:59], v[52:55], v[96:103], v10
    ds_read_b128 v[96:99], v3 offset:14336
    ds_read_b128 v[100:103], v3 offset:15360
    v_smfmac_f32_16x16x64_bf16 v[60:63], v[52:55], v[104:111], v10
    ds_read_b128 v[104:107], v3 offset:16384
    ds_read_b128 v[108:111], v3 offset:17408
    v_smfmac_f32_16x16x64_bf16 v[64:67], v[20:23], a[144:151], v10
    s_nop 1
    v_smfmac_f32_16x16x64_bf16 v[68:71], v[20:23], a[152:159], v10
    v_add_f32 v56, v56, v58
    v_smfmac_f32_16x16x64_bf16 v[64:67], v[28:31], a[176:183], v10
    v_add_f32 v57, v57, v59
    v_smfmac_f32_16x16x64_bf16 v[68:71], v[28:31], a[184:191], v10
    v_add_f32 v60, v60, v62
    v_smfmac_f32_16x16x64_bf16 v[64:67], v[48:51], v[112:119], v10
    s_waitcnt lgkmcnt(6)
    v_add_f32 v61, v61, v63
    v_smfmac_f32_16x16x64_bf16 v[68:71], v[48:51], v[80:87], v10
    ds_read_b128 v[112:115], v3 offset:18432
    v_cvt_pk_bf16_f32 v124, v56, v60
    v_smfmac_f32_16x16x64_bf16 v[64:67], v[32:35], a[192:199], v10
    ds_read_b128 v[116:119], v3 offset:19456
    v_cvt_pk_bf16_f32 v125, v57, v61
    v_smfmac_f32_16x16x64_bf16 v[68:71], v[32:35], a[200:207], v10
    ds_read_b128 v[80:83], v3 offset:20480
    ds_read_b128 v[84:87], v3 offset:21504
    v_smfmac_f32_16x16x64_bf16 v[64:67], v[36:39], a[208:215], v10
    ds_write2_b32 v120, v124, v125 offset0:0 offset1:4
    v_smfmac_f32_16x16x64_bf16 v[68:71], v[36:39], a[216:223], v10
    s_waitcnt lgkmcnt(7)
    v_smfmac_f32_16x16x64_bf16 v[64:67], v[52:55], v[88:95], v10
    ds_read_b128 v[88:91], v3 offset:22528
    ds_read_b128 v[92:95], v3 offset:23552
    v_smfmac_f32_16x16x64_bf16 v[68:71], v[52:55], v[96:103], v10
    v_smfmac_f32_16x16x64_bf16 v[64:67], v[44:47], a[240:247], v10
    s_nop 1
    v_smfmac_f32_16x16x64_bf16 v[68:71], v[44:47], a[248:255], v10
    s_waitcnt lgkmcnt(5)
    s_nop 0
    v_smfmac_f32_16x16x64_bf16 v[72:75], v[48:51], v[104:111], v10
    s_nop 1
    v_smfmac_f32_16x16x64_bf16 v[76:79], v[48:51], v[112:119], v10
    v_add_f32 v64, v64, v66
    v_smfmac_f32_16x16x64_bf16 v[72:75], v[16:19], v[128:135], v10
    v_add_f32 v65, v65, v67
    v_smfmac_f32_16x16x64_bf16 v[76:79], v[16:19], v[136:143], v10
    s_waitcnt lgkmcnt(3)
    v_add_f32 v68, v68, v70
    v_smfmac_f32_16x16x64_bf16 v[72:75], v[52:55], v[80:87], v10
    s_waitcnt lgkmcnt(0)
    v_add_f32 v69, v69, v71
    v_smfmac_f32_16x16x64_bf16 v[76:79], v[52:55], v[88:95], v10
    v_cvt_pk_bf16_f32 v124, v64, v68
    v_smfmac_f32_16x16x64_bf16 v[72:75], v[40:43], v[224:231], v10
    v_cvt_pk_bf16_f32 v125, v65, v69
    v_smfmac_f32_16x16x64_bf16 v[76:79], v[40:43], v[232:239], v10
    ds_write2_b32 v126, v124, v125 offset0:0 offset1:4
    v_smfmac_f32_16x16x64_bf16 v[72:75], v[20:23], v[144:151], v10
    v_smfmac_f32_16x16x64_bf16 v[76:79], v[20:23], v[152:159], v10
    v_smfmac_f32_16x16x64_bf16 v[72:75], v[28:31], v[176:183], v10
    v_smfmac_f32_16x16x64_bf16 v[76:79], v[28:31], v[184:191], v10
    v_smfmac_f32_16x16x64_bf16 v[72:75], v[32:35], v[192:199], v10
    s_waitcnt lgkmcnt(0)
    s_barrier
    v_smfmac_f32_16x16x64_bf16 v[72:75], v[36:39], v[208:215], v10
    v_smfmac_f32_16x16x64_bf16 v[72:75], v[44:47], v[240:247], v10
    s_nop 1
    v_smfmac_f32_16x16x64_bf16 v[76:79], v[32:35], v[200:207], v10
    s_nop 1
    v_smfmac_f32_16x16x64_bf16 v[76:79], v[36:39], v[216:223], v10
    s_nop 1
    v_smfmac_f32_16x16x64_bf16 v[76:79], v[44:47], v[248:255], v10
    v_pk_add_f32 v[72:73], v[72:73], v[74:75]
    s_nop 0
    s_nop 0
    s_nop 0
    s_nop 0
    s_nop 0
    s_nop 0
    s_nop 0
    v_pk_add_f32 v[76:77], v[76:77], v[78:79]
    v_cvt_pk_bf16_f32 v124, v72, v76
    v_cvt_pk_bf16_f32 v125, v73, v77
    ds_write2_b32 v127, v124, v125 offset0:0 offset1:4
    s_waitcnt lgkmcnt(0)
    s_barrier
    s_add_u32 s22, s22, 1
    s_cmp_lt_u32 s22, 64
    s_cbranch_scc1 M_h_w2_loop
    s_branch M_g3
M_h_w3:
    s_cmp_eq_u32 s20, 0
    s_cselect_b32 s28, 16, 0
    v_cmp_gt_u32 vcc, s28, v1
    v_mul_u32_u24 v14, 256, v1
    v_add_u32 v14, 0xa0000, v14
    v_mov_b32 v12, 0x7ff00000
    v_cndmask_b32 v123, v12, v14, vcc
    v_mov_b32 v15, -1
    v_lshlrev_b32 v13, 7, v1
    s_lshr_b32 s28, s20, 2
    s_and_b32 s54, s28, 3
    s_add_u32 s54, s54, 4
    s_mul_i32 s28, s28, 2
    s_add_u32 s28, s28, 1
    s_lshr_b32 s29, s28, 2
    s_lshl_b32 s29, s29, 17
    s_and_b32 s28, s28, 3
    s_lshl_b32 s28, s28, 13
    s_add_u32 s50, s28, s29
    s_and_b32 s28, s20, 3
    s_lshl_b32 s28, s28, 15
    s_add_u32 s50, s50, s28
    s_add_u32 s50, s50, 0x4140000
M_h_w3_loop:
    v_mov_b32 v56, 0
    v_mov_b32 v57, 0
    v_mov_b32 v58, 0
    buffer_store_dword v15, v123, s[8:11], s52 offen sc1
    v_mov_b32 v15, s22
    v_mov_b32 v59, 0
    v_mov_b32 v60, 0
    v_mov_b32 v61, 0
    v_mov_b32 v62, 0
    v_mov_b32 v63, 0
    v_mov_b32 v64, 0
    v_mov_b32 v65, 0
    v_mov_b32 v66, 0
    v_mov_b32 v67, 0
    v_mov_b32 v68, 0
    v_mov_b32 v69, 0
    v_mov_b32 v70, 0
    v_mov_b32 v71, 0
    v_mov_b32 v72, 0
    v_mov_b32 v73, 0
    v_mov_b32 v74, 0
    v_mov_b32 v75, 0
    v_mov_b32 v76, 0
    v_mov_b32 v77, 0
    v_mov_b32 v78, 0
    v_mov_b32 v79, 0
    ds_read_b128 v[80:83], v3 offset:0
    ds_read_b128 v[84:87], v3 offset:1024
    ds_read_b128 v[88:91], v3 offset:2048
    ds_read_b128 v[92:95], v3 offset:3072
    ds_read_b128 v[96:99], v3 offset:4096
    ds_read_b128 v[100:103], v3 offset:5120
    ds_read_b128 v[104:107], v3 offset:6144
    ds_read_b128 v[108:111], v3 offset:7168
    ds_read_b128 v[112:115], v3 offset:8192
    ds_read_b128 v[116:119], v3 offset:9216
    s_sub_u32 s46, s22, 1
    s_lshr_b32 s28, s46, 1
    s_xor_b32 s28, s28, s53
    s_and_b32 s28, s28, 1
    s_xor_b32 s28, s28, 1
    s_lshl_b32 s28, s28, 13
    s_lshl_b32 s40, s46, 20
    s_add_u32 s40, s40, s28
    s_add_u32 s40, s40, 0xc0c0000
    s_cmp_lt_u32 s22, s54
    s_cselect_b32 s51, 0x0, s50
    s_waitcnt lgkmcnt(0)
    s_waitcnt vmcnt(0)
    s_barrier
    buffer_load_dwordx4 v[28:31], v4, s[8:11], s40 offen sc1
    s_barrier
    buffer_load_dwordx4 v[44:47], v5, s[8:11], s40 offen sc1
    s_barrier
    s_barrier
    s_mov_b32 m0, s49
    s_xor_b32 s47, s47, 16384
    buffer_load_dwordx4 v2, s[8:11], s48 offen offset:0 sc1 lds
    buffer_load_dwordx4 v2, s[8:11], s48 offen offset:1024 sc1 lds
    buffer_load_dwordx4 v2, s[8:11], s48 offen offset:2048 sc1 lds
    buffer_load_dwordx4 v2, s[8:11], s48 offen offset:3072 sc1 lds
    s_mov_b32 s49, s47
    s_add_u32 s48, s48, 786432
    s_nop 0
    s_mov_b32 s39, 1
    s_waitcnt vmcnt(5)
    ds_write_b128 v7, v[28:31] offset:0
    v_max3_u32 v11, v28, v29, v30
    v_max_u32 v11, v11, v31
    v_cmp_eq_u32 vcc, -1, v11
    v_smfmac_f32_16x16x64_bf16 v[56:59], v[28:31], a[48:55], v10
    v_smfmac_f32_16x16x64_bf16 v[60:63], v[28:31], a[56:63], v10
    v_smfmac_f32_16x16x64_bf16 v[64:67], v[28:31], a[176:183], v10
    v_smfmac_f32_16x16x64_bf16 v[68:71], v[28:31], a[184:191], v10
    s_cbranch_vccnz M_h_w3_slow1
M_h_w3_back1:
    s_waitcnt lgkmcnt(0)
    s_barrier
    ds_read_b128 v[16:19], v9 offset:0
    v_smfmac_f32_16x16x64_bf16 v[72:75], v[28:31], v[176:183], v10
    ds_read_b128 v[20:23], v9 offset:1024
    ds_read_b128 v[24:27], v9 offset:2048
    v_smfmac_f32_16x16x64_bf16 v[76:79], v[28:31], v[184:191], v10
    s_waitcnt vmcnt(4)
    ds_write_b128 v7, v[44:47] offset:4096
    v_smfmac_f32_16x16x64_bf16 v[56:59], v[44:47], a[112:119], v10
    v_max3_u32 v11, v44, v45, v46
    v_smfmac_f32_16x16x64_bf16 v[60:63], v[44:47], a[120:127], v10
    v_smfmac_f32_16x16x64_bf16 v[64:67], v[44:47], a[240:247], v10
    v_max_u32 v11, v11, v47
    v_smfmac_f32_16x16x64_bf16 v[68:71], v[44:47], a[248:255], v10
    v_cmp_eq_u32 vcc, -1, v11
    s_waitcnt lgkmcnt(3)
    v_smfmac_f32_16x16x64_bf16 v[56:59], v[16:19], a[0:7], v10
    v_smfmac_f32_16x16x64_bf16 v[60:63], v[16:19], a[8:15], v10
    s_cbranch_vccnz M_h_w3_slow2
M_h_w3_back2:
    s_waitcnt lgkmcnt(0)
    s_barrier
    ds_read_b128 v[32:35], v9 offset:4096
    v_smfmac_f32_16x16x64_bf16 v[56:59], v[20:23], a[16:23], v10
    ds_read_b128 v[48:51], v9 offset:8192
    ds_read_b128 v[36:39], v9 offset:5120
    v_smfmac_f32_16x16x64_bf16 v[60:63], v[20:23], a[24:31], v10
    ds_read_b128 v[40:43], v9 offset:6144
    ds_read_b128 v[52:55], v9 offset:9216
    v_smfmac_f32_16x16x64_bf16 v[56:59], v[24:27], a[32:39], v10
    buffer_load_dword v12, v13, s[8:11], s51 offen sc1
    s_add_u32 s50, s50, 1310720
    v_smfmac_f32_16x16x64_bf16 v[60:63], v[24:27], a[40:47], v10
    v_smfmac_f32_16x16x64_bf16 v[64:67], v[16:19], a[128:135], v10
    v_smfmac_f32_16x16x64_bf16 v[68:71], v[16:19], a[136:143], v10
    s_waitcnt lgkmcnt(3)
    v_smfmac_f32_16x16x64_bf16 v[56:59], v[32:35], a[64:71], v10
    v_smfmac_f32_16x16x64_bf16 v[60:63], v[32:35], a[72:79], v10
    v_smfmac_f32_16x16x64_bf16 v[56:59], v[48:51], v[80:87], v10
    ds_read_b128 v[80:83], v3 offset:10240
    ds_read_b128 v[84:87], v3 offset:11264
    v_smfmac_f32_16x16x64_bf16 v[60:63], v[48:51], v[88:95], v10
    s_waitcnt lgkmcnt(3)
    v_smfmac_f32_16x16x64_bf16 v[56:59], v[36:39], a[80:87], v10
    ds_read_b128 v[88:91], v3 offset:12288
    ds_read_b128 v[92:95], v3 offset:13312
    v_smfmac_f32_16x16x64_bf16 v[60:63], v[36:39], a[88:95], v10
    s_nop 0
    v_smfmac_f32_16x16x64_bf16 v[56:59], v[40:43], a[96:103], v10
    v_smfmac_f32_16x16x64_bf16 v[60:63], v[40:43], a[104:111], v10
    s_waitcnt lgkmcnt(4)
    v_smfmac_f32_16x16x64_bf16 v[56:59], v[52:55], v[96:103], v10
    ds_read_b128 v[96:99], v3 offset:14336
    ds_read_b128 v[100:103], v3 offset:15360
    v_smfmac_f32_16x16x64_bf16 v[60:63], v[52:55], v[104:111], v10
    ds_read_b128 v[104:107], v3 offset:16384
    ds_read_b128 v[108:111], v3 offset:17408
    v_smfmac_f32_16x16x64_bf16 v[64:67], v[20:23], a[144:151], v10
    s_nop 1
    v_smfmac_f32_16x16x64_bf16 v[68:71], v[20:23], a[152:159], v10
    v_add_f32 v56, v56, v58
    v_smfmac_f32_16x16x64_bf16 v[64:67], v[24:27], a[160:167], v10
    v_add_f32 v57, v57, v59
    v_smfmac_f32_16x16x64_bf16 v[68:71], v[24:27], a[168:175], v10
    v_add_f32 v60, v60, v62
    v_smfmac_f32_16x16x64_bf16 v[64:67], v[48:51], v[112:119], v10
    s_waitcnt lgkmcnt(6)
    v_add_f32 v61, v61, v63
    v_smfmac_f32_16x16x64_bf16 v[68:71], v[48:51], v[80:87], v10
    ds_read_b128 v[112:115], v3 offset:18432
    v_cvt_pk_bf16_f32 v124, v56, v60
    v_smfmac_f32_16x16x64_bf16 v[64:67], v[32:35], a[192:199], v10
    ds_read_b128 v[116:119], v3 offset:19456
    v_cvt_pk_bf16_f32 v125, v57, v61
    v_smfmac_f32_16x16x64_bf16 v[68:71], v[32:35], a[200:207], v10
    ds_read_b128 v[80:83], v3 offset:20480
    ds_read_b128 v[84:87], v3 offset:21504
    v_smfmac_f32_16x16x64_bf16 v[64:67], v[36:39], a[208:215], v10
    ds_write2_b32 v120, v124, v125 offset0:0 offset1:4
    v_smfmac_f32_16x16x64_bf16 v[68:71], v[36:39], a[216:223], v10
    s_waitcnt lgkmcnt(7)
    v_smfmac_f32_16x16x64_bf16 v[64:67], v[52:55], v[88:95], v10
    ds_read_b128 v[88:91], v3 offset:22528
    ds_read_b128 v[92:95], v3 offset:23552
    v_smfmac_f32_16x16x64_bf16 v[68:71], v[52:55], v[96:103], v10
    v_smfmac_f32_16x16x64_bf16 v[64:67], v[40:43], a[224:231], v10
    s_nop 1
    v_smfmac_f32_16x16x64_bf16 v[68:71], v[40:43], a[232:239], v10
    s_waitcnt lgkmcnt(5)
    s_nop 0
    v_smfmac_f32_16x16x64_bf16 v[72:75], v[48:51], v[104:111], v10
    s_nop 1
    v_smfmac_f32_16x16x64_bf16 v[76:79], v[48:51], v[112:119], v10
    v_add_f32 v64, v64, v66
    v_smfmac_f32_16x16x64_bf16 v[72:75], v[16:19], v[128:135], v10
    v_add_f32 v65, v65, v67
    v_smfmac_f32_16x16x64_bf16 v[76:79], v[16:19], v[136:143], v10
    s_waitcnt lgkmcnt(3)
    v_add_f32 v68, v68, v70
    v_smfmac_f32_16x16x64_bf16 v[72:75], v[52:55], v[80:87], v10
    s_waitcnt lgkmcnt(0)
    v_add_f32 v69, v69, v71
    v_smfmac_f32_16x16x64_bf16 v[76:79], v[52:55], v[88:95], v10
    v_cvt_pk_bf16_f32 v124, v64, v68
    v_smfmac_f32_16x16x64_bf16 v[72:75], v[44:47], v[240:247], v10
    v_cvt_pk_bf16_f32 v125, v65, v69
    v_smfmac_f32_16x16x64_bf16 v[76:79], v[44:47], v[248:255], v10
    ds_write2_b32 v126, v124, v125 offset0:0 offset1:4
    v_smfmac_f32_16x16x64_bf16 v[72:75], v[20:23], v[144:151], v10
    v_smfmac_f32_16x16x64_bf16 v[76:79], v[20:23], v[152:159], v10
    v_smfmac_f32_16x16x64_bf16 v[72:75], v[24:27], v[160:167], v10
    v_smfmac_f32_16x16x64_bf16 v[76:79], v[24:27], v[168:175], v10
    v_smfmac_f32_16x16x64_bf16 v[72:75], v[32:35], v[192:199], v10
    s_waitcnt lgkmcnt(0)
    s_barrier
    v_smfmac_f32_16x16x64_bf16 v[72:75], v[36:39], v[208:215], v10
    v_smfmac_f32_16x16x64_bf16 v[72:75], v[40:43], v[224:231], v10
    s_nop 1
    v_smfmac_f32_16x16x64_bf16 v[76:79], v[32:35], v[200:207], v10
    s_nop 1
    v_smfmac_f32_16x16x64_bf16 v[76:79], v[36:39], v[216:223], v10
    s_nop 1
    v_smfmac_f32_16x16x64_bf16 v[76:79], v[40:43], v[232:239], v10
    v_pk_add_f32 v[72:73], v[72:73], v[74:75]
    s_nop 0
    s_nop 0
    s_nop 0
    s_nop 0
    s_nop 0
    s_nop 0
    s_nop 0
    v_pk_add_f32 v[76:77], v[76:77], v[78:79]
    v_cvt_pk_bf16_f32 v124, v72, v76
    v_cvt_pk_bf16_f32 v125, v73, v77
    ds_write2_b32 v127, v124, v125 offset0:0 offset1:4
    s_waitcnt lgkmcnt(0)
    s_barrier
    s_add_u32 s22, s22, 1
    s_cmp_lt_u32 s22, 64
    s_cbranch_scc1 M_h_w3_loop
    s_branch M_g3
M_h_w0_slow1:
    s_mov_b64 exec, vcc
    buffer_load_dwordx4 v[16:19], v4, s[8:11], s40 offen sc1
    buffer_load_dwordx4 v[32:35], v5, s[8:11], s40 offen sc1
    s_mov_b64 exec, -1
    s_nop 2
    v_mov_b32 v56, 0
    v_mov_b32 v57, 0
    v_mov_b32 v58, 0
    v_mov_b32 v59, 0
    v_mov_b32 v60, 0
    v_mov_b32 v61, 0
    v_mov_b32 v62, 0
    v_mov_b32 v63, 0
    v_mov_b32 v64, 0
    v_mov_b32 v65, 0
    v_mov_b32 v66, 0
    v_mov_b32 v67, 0
    v_mov_b32 v68, 0
    v_mov_b32 v69, 0
    v_mov_b32 v70, 0
    v_mov_b32 v71, 0
    v_mov_b32 v72, 0
    v_mov_b32 v73, 0
    v_mov_b32 v74, 0
    v_mov_b32 v75, 0
    v_mov_b32 v76, 0
    v_mov_b32 v77, 0
    v_mov_b32 v78, 0
    v_mov_b32 v79, 0
    s_add_u32 s39, s39, 1
    s_cmp_gt_u32 s39, 400000
    s_cbranch_scc1 M_fail
    s_waitcnt vmcnt(0)
    ds_write_b128 v7, v[16:19] offset:0
    ds_write_b128 v7, v[32:35] offset:4096
    v_max3_u32 v11, v16, v17, v18
    v_max3_u32 v11, v11, v19, v32
    v_max3_u32 v11, v11, v33, v34
    v_max_u32 v11, v11, v35
    v_cmp_eq_u32 vcc, -1, v11
    s_cbranch_vccnz M_h_w0_slow1
    v_smfmac_f32_16x16x64_bf16 v[56:59], v[16:19], a[0:7], v10
    v_smfmac_f32_16x16x64_bf16 v[60:63], v[16:19], a[8:15], v10
    v_smfmac_f32_16x16x64_bf16 v[64:67], v[16:19], a[128:135], v10
    v_smfmac_f32_16x16x64_bf16 v[68:71], v[16:19], a[136:143], v10
    s_waitcnt lgkmcnt(0)
    s_branch M_h_w0_back1
M_h_w0_slow2:
    s_mov_b64 exec, vcc
    buffer_load_dwordx4 v[16:19], v4, s[8:11], s40 offen sc1
    buffer_load_dwordx4 v[32:35], v5, s[8:11], s40 offen sc1
    s_mov_b64 exec, -1
    s_nop 2
    v_mov_b32 v56, 0
    v_mov_b32 v57, 0
    v_mov_b32 v58, 0
    v_mov_b32 v59, 0
    v_mov_b32 v60, 0
    v_mov_b32 v61, 0
    v_mov_b32 v62, 0
    v_mov_b32 v63, 0
    v_mov_b32 v64, 0
    v_mov_b32 v65, 0
    v_mov_b32 v66, 0
    v_mov_b32 v67, 0
    v_mov_b32 v68, 0
    v_mov_b32 v69, 0
    v_mov_b32 v70, 0
    v_mov_b32 v71, 0
    v_mov_b32 v72, 0
    v_mov_b32 v73, 0
    v_mov_b32 v74, 0
    v_mov_b32 v75, 0
    v_mov_b32 v76, 0
    v_mov_b32 v77, 0
    v_mov_b32 v78, 0
    v_mov_b32 v79, 0
    s_add_u32 s39, s39, 1
    s_cmp_gt_u32 s39, 400000
    s_cbranch_scc1 M_fail
    s_waitcnt vmcnt(0)
    ds_write_b128 v7, v[16:19] offset:0
    ds_write_b128 v7, v[32:35] offset:4096
    v_max3_u32 v11, v16, v17, v18
    v_max3_u32 v11, v11, v19, v32
    v_max3_u32 v11, v11, v33, v34
    v_max_u32 v11, v11, v35
    v_cmp_eq_u32 vcc, -1, v11
    s_cbranch_vccnz M_h_w0_slow2
    v_smfmac_f32_16x16x64_bf16 v[56:59], v[16:19], a[0:7], v10
    v_smfmac_f32_16x16x64_bf16 v[60:63], v[16:19], a[8:15], v10
    v_smfmac_f32_16x16x64_bf16 v[64:67], v[16:19], a[128:135], v10
    v_smfmac_f32_16x16x64_bf16 v[68:71], v[16:19], a[136:143], v10
    v_smfmac_f32_16x16x64_bf16 v[72:75], v[16:19], v[128:135], v10
    v_smfmac_f32_16x16x64_bf16 v[76:79], v[16:19], v[136:143], v10
    v_smfmac_f32_16x16x64_bf16 v[56:59], v[32:35], a[64:71], v10
    v_smfmac_f32_16x16x64_bf16 v[60:63], v[32:35], a[72:79], v10
    v_smfmac_f32_16x16x64_bf16 v[64:67], v[32:35], a[192:199], v10
    v_smfmac_f32_16x16x64_bf16 v[68:71], v[32:35], a[200:207], v10
    v_smfmac_f32_16x16x64_bf16 v[56:59], v[20:23], a[16:23], v10
    v_smfmac_f32_16x16x64_bf16 v[60:63], v[20:23], a[24:31], v10
    s_waitcnt lgkmcnt(0)
    s_branch M_h_w0_back2
M_h_w1_slow1:
    s_mov_b64 exec, vcc
    buffer_load_dwordx4 v[20:23], v4, s[8:11], s40 offen sc1
    buffer_load_dwordx4 v[36:39], v5, s[8:11], s40 offen sc1
    buffer_load_dwordx4 v[48:51], v6, s[8:11], s40 offen sc1
    s_mov_b64 exec, -1
    s_nop 2
    v_mov_b32 v56, 0
    v_mov_b32 v57, 0
    v_mov_b32 v58, 0
    v_mov_b32 v59, 0
    v_mov_b32 v60, 0
    v_mov_b32 v61, 0
    v_mov_b32 v62, 0
    v_mov_b32 v63, 0
    v_mov_b32 v64, 0
    v_mov_b32 v65, 0
    v_mov_b32 v66, 0
    v_mov_b32 v67, 0
    v_mov_b32 v68, 0
    v_mov_b32 v69, 0
    v_mov_b32 v70, 0
    v_mov_b32 v71, 0
    v_mov_b32 v72, 0
    v_mov_b32 v73, 0
    v_mov_b32 v74, 0
    v_mov_b32 v75, 0
    v_mov_b32 v76, 0
    v_mov_b32 v77, 0
    v_mov_b32 v78, 0
    v_mov_b32 v79, 0
    s_add_u32 s39, s39, 1
    s_cmp_gt_u32 s39, 400000
    s_cbranch_scc1 M_fail
    s_waitcnt vmcnt(0)
    ds_write_b128 v7, v[20:23] offset:0
    ds_write_b128 v7, v[36:39] offset:4096
    ds_write_b128 v7, v[48:51] offset:7168
    v_max3_u32 v11, v20, v21, v22
    v_max3_u32 v11, v11, v23, v36
    v_max3_u32 v11, v11, v37, v38
    v_max3_u32 v11, v11, v39, v48
    v_max3_u32 v11, v11, v49, v50
    v_max_u32 v11, v11, v51
    v_cmp_eq_u32 vcc, -1, v11
    s_cbranch_vccnz M_h_w1_slow1
    v_smfmac_f32_16x16x64_bf16 v[56:59], v[20:23], a[16:23], v10
    v_smfmac_f32_16x16x64_bf16 v[60:63], v[20:23], a[24:31], v10
    v_smfmac_f32_16x16x64_bf16 v[64:67], v[20:23], a[144:151], v10
    v_smfmac_f32_16x16x64_bf16 v[68:71], v[20:23], a[152:159], v10
    s_waitcnt lgkmcnt(0)
    s_branch M_h_w1_back1
M_h_w1_slow2:
    s_mov_b64 exec, vcc
    buffer_load_dwordx4 v[20:23], v4, s[8:11], s40 offen sc1
    buffer_load_dwordx4 v[36:39], v5, s[8:11], s40 offen sc1
    buffer_load_dwordx4 v[48:51], v6, s[8:11], s40 offen sc1
    s_mov_b64 exec, -1
    s_nop 2
    v_mov_b32 v56, 0
    v_mov_b32 v57, 0
    v_mov_b32 v58, 0
    v_mov_b32 v59, 0
    v_mov_b32 v60, 0
    v_mov_b32 v61, 0
    v_mov_b32 v62, 0
    v_mov_b32 v63, 0
    v_mov_b32 v64, 0
    v_mov_b32 v65, 0
    v_mov_b32 v66, 0
    v_mov_b32 v67, 0
    v_mov_b32 v68, 0
    v_mov_b32 v69, 0
    v_mov_b32 v70, 0
    v_mov_b32 v71, 0
    v_mov_b32 v72, 0
    v_mov_b32 v73, 0
    v_mov_b32 v74, 0
    v_mov_b32 v75, 0
    v_mov_b32 v76, 0
    v_mov_b32 v77, 0
    v_mov_b32 v78, 0
    v_mov_b32 v79, 0
    s_add_u32 s39, s39, 1
    s_cmp_gt_u32 s39, 400000
    s_cbranch_scc1 M_fail
    s_waitcnt vmcnt(0)
    ds_write_b128 v7, v[20:23] offset:0
    ds_write_b128 v7, v[36:39] offset:4096
    ds_write_b128 v7, v[48:51] offset:7168
    v_max3_u32 v11, v20, v21, v22
    v_max3_u32 v11, v11, v23, v36
    v_max3_u32 v11, v11, v37, v38
    v_max3_u32 v11, v11, v39, v48
    v_max3_u32 v11, v11, v49, v50
    v_max_u32 v11, v11, v51
    v_cmp_eq_u32 vcc, -1, v11
    s_cbranch_vccnz M_h_w1_slow2
    v_smfmac_f32_16x16x64_bf16 v[56:59], v[20:23], a[16:23], v10
    v_smfmac_f32_16x16x64_bf16 v[60:63], v[20:23], a[24:31], v10
    v_smfmac_f32_16x16x64_bf16 v[64:67], v[20:23], a[144:151], v10
    v_smfmac_f32_16x16x64_bf16 v[68:71], v[20:23], a[152:159], v10
    v_smfmac_f32_16x16x64_bf16 v[72:75], v[20:23], v[144:151], v10
    v_smfmac_f32_16x16x64_bf16 v[76:79], v[20:23], v[152:159], v10
    v_smfmac_f32_16x16x64_bf16 v[56:59], v[36:39], a[80:87], v10
    v_smfmac_f32_16x16x64_bf16 v[60:63], v[36:39], a[88:95], v10
    v_smfmac_f32_16x16x64_bf16 v[64:67], v[36:39], a[208:215], v10
    v_smfmac_f32_16x16x64_bf16 v[68:71], v[36:39], a[216:223], v10
    v_smfmac_f32_16x16x64_bf16 v[56:59], v[16:19], a[0:7], v10
    v_smfmac_f32_16x16x64_bf16 v[60:63], v[16:19], a[8:15], v10
    s_waitcnt lgkmcnt(0)
    s_branch M_h_w1_back2
M_h_w2_slow1:
    s_mov_b64 exec, vcc
    buffer_load_dwordx4 v[24:27], v4, s[8:11], s40 offen sc1
    buffer_load_dwordx4 v[40:43], v5, s[8:11], s40 offen sc1
    buffer_load_dwordx4 v[52:55], v6, s[8:11], s40 offen sc1
    s_mov_b64 exec, -1
    s_nop 2
    v_mov_b32 v56, 0
    v_mov_b32 v57, 0
    v_mov_b32 v58, 0
    v_mov_b32 v59, 0
    v_mov_b32 v60, 0
    v_mov_b32 v61, 0
    v_mov_b32 v62, 0
    v_mov_b32 v63, 0
    v_mov_b32 v64, 0
    v_mov_b32 v65, 0
    v_mov_b32 v66, 0
    v_mov_b32 v67, 0
    v_mov_b32 v68, 0
    v_mov_b32 v69, 0
    v_mov_b32 v70, 0
    v_mov_b32 v71, 0
    v_mov_b32 v72, 0
    v_mov_b32 v73, 0
    v_mov_b32 v74, 0
    v_mov_b32 v75, 0
    v_mov_b32 v76, 0
    v_mov_b32 v77, 0
    v_mov_b32 v78, 0
    v_mov_b32 v79, 0
    s_add_u32 s39, s39, 1
    s_cmp_gt_u32 s39, 400000
    s_cbranch_scc1 M_fail
    s_waitcnt vmcnt(0)
    ds_write_b128 v7, v[24:27] offset:0
    ds_write_b128 v7, v[40:43] offset:4096
    ds_write_b128 v7, v[52:55] offset:7168
    v_max3_u32 v11, v24, v25, v26
    v_max3_u32 v11, v11, v27, v40
    v_max3_u32 v11, v11, v41, v42
    v_max3_u32 v11, v11, v43, v52
    v_max3_u32 v11, v11, v53, v54
    v_max_u32 v11, v11, v55
    v_cmp_eq_u32 vcc, -1, v11
    s_cbranch_vccnz M_h_w2_slow1
    v_smfmac_f32_16x16x64_bf16 v[56:59], v[24:27], a[32:39], v10
    v_smfmac_f32_16x16x64_bf16 v[60:63], v[24:27], a[40:47], v10
    v_smfmac_f32_16x16x64_bf16 v[64:67], v[24:27], a[160:167], v10
    v_smfmac_f32_16x16x64_bf16 v[68:71], v[24:27], a[168:175], v10
    s_waitcnt lgkmcnt(0)
    s_branch M_h_w2_back1
M_h_w2_slow2:
    s_mov_b64 exec, vcc
    buffer_load_dwordx4 v[24:27], v4, s[8:11], s40 offen sc1
    buffer_load_dwordx4 v[40:43], v5, s[8:11], s40 offen sc1
    buffer_load_dwordx4 v[52:55], v6, s[8:11], s40 offen sc1
    s_mov_b64 exec, -1
    s_nop 2
    v_mov_b32 v56, 0
    v_mov_b32 v57, 0
    v_mov_b32 v58, 0
    v_mov_b32 v59, 0
    v_mov_b32 v60, 0
    v_mov_b32 v61, 0
    v_mov_b32 v62, 0
    v_mov_b32 v63, 0
    v_mov_b32 v64, 0
    v_mov_b32 v65, 0
    v_mov_b32 v66, 0
    v_mov_b32 v67, 0
    v_mov_b32 v68, 0
    v_mov_b32 v69, 0
    v_mov_b32 v70, 0
    v_mov_b32 v71, 0
    v_mov_b32 v72, 0
    v_mov_b32 v73, 0
    v_mov_b32 v74, 0
    v_mov_b32 v75, 0
    v_mov_b32 v76, 0
    v_mov_b32 v77, 0
    v_mov_b32 v78, 0
    v_mov_b32 v79, 0
    s_add_u32 s39, s39, 1
    s_cmp_gt_u32 s39, 400000
    s_cbranch_scc1 M_fail
    s_waitcnt vmcnt(0)
    ds_write_b128 v7, v[24:27] offset:0
    ds_write_b128 v7, v[40:43] offset:4096
    ds_write_b128 v7, v[52:55] offset:7168
    v_max3_u32 v11, v24, v25, v26
    v_max3_u32 v11, v11, v27, v40
    v_max3_u32 v11, v11, v41, v42
    v_max3_u32 v11, v11, v43, v52
    v_max3_u32 v11, v11, v53, v54
    v_max_u32 v11, v11, v55
    v_cmp_eq_u32 vcc, -1, v11
    s_cbranch_vccnz M_h_w2_slow2
    v_smfmac_f32_16x16x64_bf16 v[56:59], v[24:27], a[32:39], v10
    v_smfmac_f32_16x16x64_bf16 v[60:63], v[24:27], a[40:47], v10
    v_smfmac_f32_16x16x64_bf16 v[64:67], v[24:27], a[160:167], v10
    v_smfmac_f32_16x16x64_bf16 v[68:71], v[24:27], a[168:175], v10
    v_smfmac_f32_16x16x64_bf16 v[72:75], v[24:27], v[160:167], v10
    v_smfmac_f32_16x16x64_bf16 v[76:79], v[24:27], v[168:175], v10
    v_smfmac_f32_16x16x64_bf16 v[56:59], v[40:43], a[96:103], v10
    v_smfmac_f32_16x16x64_bf16 v[60:63], v[40:43], a[104:111], v10
    v_smfmac_f32_16x16x64_bf16 v[64:67], v[40:43], a[224:231], v10
    v_smfmac_f32_16x16x64_bf16 v[68:71], v[40:43], a[232:239], v10
    v_smfmac_f32_16x16x64_bf16 v[56:59], v[16:19], a[0:7], v10
    v_smfmac_f32_16x16x64_bf16 v[60:63], v[16:19], a[8:15], v10
    s_waitcnt lgkmcnt(0)
    s_branch M_h_w2_back2
M_h_w3_slow1:
    s_mov_b64 exec, vcc
    buffer_load_dwordx4 v[28:31], v4, s[8:11], s40 offen sc1
    buffer_load_dwordx4 v[44:47], v5, s[8:11], s40 offen sc1
    s_mov_b64 exec, -1
    s_nop 2
    v_mov_b32 v56, 0
    v_mov_b32 v57, 0
    v_mov_b32 v58, 0
    v_mov_b32 v59, 0
    v_mov_b32 v60, 0
    v_mov_b32 v61, 0
    v_mov_b32 v62, 0
    v_mov_b32 v63, 0
    v_mov_b32 v64, 0
    v_mov_b32 v65, 0
    v_mov_b32 v66, 0
    v_mov_b32 v67, 0
    v_mov_b32 v68, 0
    v_mov_b32 v69, 0
    v_mov_b32 v70, 0
    v_mov_b32 v71, 0
    v_mov_b32 v72, 0
    v_mov_b32 v73, 0
    v_mov_b32 v74, 0
    v_mov_b32 v75, 0
    v_mov_b32 v76, 0
    v_mov_b32 v77, 0
    v_mov_b32 v78, 0
    v_mov_b32 v79, 0
    s_add_u32 s39, s39, 1
    s_cmp_gt_u32 s39, 400000
    s_cbranch_scc1 M_fail
    s_waitcnt vmcnt(0)
    ds_write_b128 v7, v[28:31] offset:0
    ds_write_b128 v7, v[44:47] offset:4096
    v_max3_u32 v11, v28, v29, v30
    v_max3_u32 v11, v11, v31, v44
    v_max3_u32 v11, v11, v45, v46
    v_max_u32 v11, v11, v47
    v_cmp_eq_u32 vcc, -1, v11
    s_cbranch_vccnz M_h_w3_slow1
    v_smfmac_f32_16x16x64_bf16 v[56:59], v[28:31], a[48:55], v10
    v_smfmac_f32_16x16x64_bf16 v[60:63], v[28:31], a[56:63], v10
    v_smfmac_f32_16x16x64_bf16 v[64:67], v[28:31], a[176:183], v10
    v_smfmac_f32_16x16x64_bf16 v[68:71], v[28:31], a[184:191], v10
    s_waitcnt lgkmcnt(0)
    s_branch M_h_w3_back1
M_h_w3_slow2:
    s_mov_b64 exec, vcc
    buffer_load_dwordx4 v[28:31], v4, s[8:11], s40 offen sc1
    buffer_load_dwordx4 v[44:47], v5, s[8:11], s40 offen sc1
    s_mov_b64 exec, -1
    s_nop 2
    v_mov_b32 v56, 0
    v_mov_b32 v57, 0
    v_mov_b32 v58, 0
    v_mov_b32 v59, 0
    v_mov_b32 v60, 0
    v_mov_b32 v61, 0
    v_mov_b32 v62, 0
    v_mov_b32 v63, 0
    v_mov_b32 v64, 0
    v_mov_b32 v65, 0
    v_mov_b32 v66, 0
    v_mov_b32 v67, 0
    v_mov_b32 v68, 0
    v_mov_b32 v69, 0
    v_mov_b32 v70, 0
    v_mov_b32 v71, 0
    v_mov_b32 v72, 0
    v_mov_b32 v73, 0
    v_mov_b32 v74, 0
    v_mov_b32 v75, 0
    v_mov_b32 v76, 0
    v_mov_b32 v77, 0
    v_mov_b32 v78, 0
    v_mov_b32 v79, 0
    s_add_u32 s39, s39, 1
    s_cmp_gt_u32 s39, 400000
    s_cbranch_scc1 M_fail
    s_waitcnt vmcnt(0)
    ds_write_b128 v7, v[28:31] offset:0
    ds_write_b128 v7, v[44:47] offset:4096
    v_max3_u32 v11, v28, v29, v30
    v_max3_u32 v11, v11, v31, v44
    v_max3_u32 v11, v11, v45, v46
    v_max_u32 v11, v11, v47
    v_cmp_eq_u32 vcc, -1, v11
    s_cbranch_vccnz M_h_w3_slow2
    v_smfmac_f32_16x16x64_bf16 v[56:59], v[28:31], a[48:55], v10
    v_smfmac_f32_16x16x64_bf16 v[60:63], v[28:31], a[56:63], v10
    v_smfmac_f32_16x16x64_bf16 v[64:67], v[28:31], a[176:183], v10
    v_smfmac_f32_16x16x64_bf16 v[68:71], v[28:31], a[184:191], v10
    v_smfmac_f32_16x16x64_bf16 v[72:75], v[28:31], v[176:183], v10
    v_smfmac_f32_16x16x64_bf16 v[76:79], v[28:31], v[184:191], v10
    v_smfmac_f32_16x16x64_bf16 v[56:59], v[44:47], a[112:119], v10
    v_smfmac_f32_16x16x64_bf16 v[60:63], v[44:47], a[120:127], v10
    v_smfmac_f32_16x16x64_bf16 v[64:67], v[44:47], a[240:247], v10
    v_smfmac_f32_16x16x64_bf16 v[68:71], v[44:47], a[248:255], v10
    v_smfmac_f32_16x16x64_bf16 v[56:59], v[16:19], a[0:7], v10
    v_smfmac_f32_16x16x64_bf16 v[60:63], v[16:19], a[8:15], v10
    s_waitcnt lgkmcnt(0)
    s_branch M_h_w3_back2
M_vu0:
    s_bfe_u32 s24, s25, 0x10005
    s_cmp_eq_u32 s24, 0
    s_cselect_b64 s[28:29], s[94:95], s[92:93]
    s_lshl_b32 s33, s24, 7
    s_mov_b32 s12, s28
    s_and_b32 s13, s29, 0xffff
    s_mov_b32 s14, 0x780000
    s_mov_b32 s15, 0x20000
    s_mov_b32 s16, s96
    s_and_b32 s17, s97, 0xffff
    s_mov_b32 s18, 0x780000
    s_mov_b32 s19, 0x20000
    v_add_u32 v100, 0, v1
    v_mul_u32_u24 v101, 2731, v100
    v_lshrrev_b32 v101, 16, v101
    v_mul_u32_u24 v102, 24, v101
    v_sub_u32 v102, v100, v102
    v_mul_u32_u24 v101, 12288, v101
    v_lshl_add_u32 v96, v102, 4, v101
    v_add_u32 v100, 64, v1
    v_mul_u32_u24 v101, 2731, v100
    v_lshrrev_b32 v101, 16, v101
    v_mul_u32_u24 v102, 24, v101
    v_sub_u32 v102, v100, v102
    v_mul_u32_u24 v101, 12288, v101
    v_lshl_add_u32 v97, v102, 4, v101
    v_add_u32 v100, 128, v1
    v_mul_u32_u24 v101, 2731, v100
    v_lshrrev_b32 v101, 16, v101
    v_mul_u32_u24 v102, 24, v101
    v_sub_u32 v102, v100, v102
    v_mul_u32_u24 v101, 12288, v101
    v_lshl_add_u32 v98, v102, 4, v101
    v_lshrrev_b32 v100, 3, v1
    v_and_b32 v101, 7, v1
    v_lshlrev_b32 v101, 4, v101
    v_mul_u32_u24 v99, 12288, v100
    v_add_u32 v99, v99, v101
    v_lshrrev_b32 v100, 4, v1
    v_bfe_u32 v101, v1, 2, 2
    v_and_b32 v102, 3, v1
    v_lshl_add_u32 v103, v100, 3, v101
    v_lshlrev_b32 v104, 7, v103
    v_lshl_add_u32 v104, v102, 3, v104
    v_add_u32 v104, 24576, v104
    v_mul_u32_u24 v103, 384, v103
    v_lshl_add_u32 v103, v102, 3, v103
    s_lshl_b32 s28, s21, 7
    v_add_u32 v103, s28, v103
    s_mul_i32 s80, s20, 384
    s_mul_i32 s28, s21, 196608
    s_add_u32 s80, s80, s28
    s_add_u32 s81, s80, s33
    s_mul_i32 s82, s21, 6144
    s_lshl_b32 s84, s21, 11
    v_mov_b32 v100, 128
    v_mov_b32 v92, 0
    v_mov_b32 v93, 0
    v_mov_b32 v94, 0
    v_mov_b32 v95, 0
    s_mov_b32 s86, 0
    v_lshlrev_b32 v2, 4, v1
    s_add_u32 m0, s82, 61440
    s_add_u32 s85, s80, 0
    buffer_load_dwordx4 v96, s[12:15], s85 offen nt lds
    s_add_u32 m0, s82, 62464
    s_add_u32 s85, s80, 0
    buffer_load_dwordx4 v97, s[12:15], s85 offen nt lds
    s_add_u32 m0, s82, 63488
    s_add_u32 s85, s80, 0
    buffer_load_dwordx4 v98, s[12:15], s85 offen nt lds
    s_add_u32 m0, s82, 64512
    s_add_u32 s85, s80, 98304
    buffer_load_dwordx4 v96, s[12:15], s85 offen nt lds
    s_add_u32 m0, s82, 65536
    s_add_u32 s85, s80, 98304
    buffer_load_dwordx4 v97, s[12:15], s85 offen nt lds
    s_add_u32 m0, s82, 66560
    s_add_u32 s85, s80, 98304
    buffer_load_dwordx4 v98, s[12:15], s85 offen nt lds
    s_add_u32 m0, s84, 86016
    s_add_u32 s85, s81, 0
    buffer_load_dwordx4 v99, s[16:19], s85 offen nt lds
    s_add_u32 m0, s84, 87040
    s_add_u32 s85, s81, 98304
    buffer_load_dwordx4 v99, s[16:19], s85 offen nt lds
    s_add_u32 m0, s82, 94208
    s_add_u32 s85, s80, 786432
    buffer_load_dwordx4 v96, s[12:15], s85 offen nt lds
    s_add_u32 m0, s82, 95232
    s_add_u32 s85, s80, 786432
    buffer_load_dwordx4 v97, s[12:15], s85 offen nt lds
    s_add_u32 m0, s82, 96256
    s_add_u32 s85, s80, 786432
    buffer_load_dwordx4 v98, s[12:15], s85 offen nt lds
    s_add_u32 m0, s82, 97280
    s_add_u32 s85, s80, 884736
    buffer_load_dwordx4 v96, s[12:15], s85 offen nt lds
    s_add_u32 m0, s82, 98304
    s_add_u32 s85, s80, 884736
    buffer_load_dwordx4 v97, s[12:15], s85 offen nt lds
    s_add_u32 m0, s82, 99328
    s_add_u32 s85, s80, 884736
    buffer_load_dwordx4 v98, s[12:15], s85 offen nt lds
    s_add_u32 m0, s84, 118784
    s_add_u32 s85, s81, 786432
    buffer_load_dwordx4 v99, s[16:19], s85 offen nt lds
    s_add_u32 m0, s84, 119808
    s_add_u32 s85, s81, 884736
    buffer_load_dwordx4 v99, s[16:19], s85 offen nt lds
    s_add_u32 m0, s82, 126976
    s_add_u32 s85, s80, 1572864
    buffer_load_dwordx4 v96, s[12:15], s85 offen nt lds
    s_add_u32 m0, s82, 128000
    s_add_u32 s85, s80, 1572864
    buffer_load_dwordx4 v97, s[12:15], s85 offen nt lds
    s_add_u32 m0, s82, 129024
    s_add_u32 s85, s80, 1572864
    buffer_load_dwordx4 v98, s[12:15], s85 offen nt lds
    s_add_u32 m0, s82, 130048
    s_add_u32 s85, s80, 1671168
    buffer_load_dwordx4 v96, s[12:15], s85 offen nt lds
    s_add_u32 m0, s82, 131072
    s_add_u32 s85, s80, 1671168
    buffer_load_dwordx4 v97, s[12:15], s85 offen nt lds
    s_add_u32 m0, s82, 132096
    s_add_u32 s85, s80, 1671168
    buffer_load_dwordx4 v98, s[12:15], s85 offen nt lds
    s_add_u32 m0, s84, 151552
    s_add_u32 s85, s81, 1572864
    buffer_load_dwordx4 v99, s[16:19], s85 offen nt lds
    s_add_u32 m0, s84, 152576
    s_add_u32 s85, s81, 1671168
    buffer_load_dwordx4 v99, s[16:19], s85 offen nt lds
    s_lshl_b32 s28, s20, 7
    v_mov_b32 v6, 0x7ff00000
    v_lshl_add_u32 v7, v0, 2, s28
    v_cmp_gt_u32 vcc, 32, v0
    s_nop 1
    v_cndmask_b32 v6, v6, v7, vcc
    v_mov_b32 v7, 1
    s_mul_i32 s35, s21, 5120
    s_add_u32 s34, s35, 0
    s_lshl_b32 s38, s21, 11
    s_mul_i32 s28, s24, 12288
    s_sub_u32 s38, s38, s28
    s_add_u32 s38, s38, 0x1003000
    s_lshl_b32 s28, s24, 11
    s_add_u32 s28, s28, 0x9000000
    s_mov_b32 s44, 6144
    s_cmp_eq_u32 s21, 3
    s_cselect_b32 s38, s28, s38
    s_cselect_b32 s44, 4096, s44
    s_cselect_b32 s45, 1, 3
    s_lshl_b32 s28, s45, 13
    s_mul_i32 s28, s20, s28
    s_add_u32 s38, s38, s28
    s_lshl_b32 s45, s45, 18
    s_mov_b32 s36, 0x9c1000
    s_mov_b32 s37, 0x9c0000
    s_mul_i32 s43, s24, 0x40000
    s_add_u32 s43, s43, 0x840000
    s_mov_b32 s40, 40960
    s_mov_b32 s41, 0
    s_mov_b32 s42, 20480
    v_add_u32 v4, 40960, v2
    v_add_u32 v5, 0, v2
    s_mul_i32 s28, s21, 12
    s_add_u32 s28, s28, 0
    v_lshrrev_b32 v8, 4, v1
    v_add_u32 v8, s28, v8
    v_and_b32 v9, 15, v1
    v_lshlrev_b32 v9, 4, v9
    s_lshl_b32 s28, s20, 8
    v_lshl_add_u32 v24, v8, 14, v9
    v_add_u32 v24, s28, v24
    v_subrev_u32 v10, 40, v8
    v_lshl_add_u32 v10, v10, 8, v9
    s_mul_i32 s28, s20, 640
    v_add_u32 v11, s28, v10
    s_mul_i32 s28, s20, 384
    s_add_u32 s28, s28, 19840
    v_add_u32 v12, s28, v10
    v_cmp_gt_u32 vcc, 640, v10
    s_nop 1
    v_cndmask_b32 v11, v12, v11, vcc
    v_lshrrev_b32 v12, 13, v11
    v_lshlrev_b32 v12, 13, v12
    v_add_u32 v11, v11, v12
    v_add_u32 v11, 0xc0000, v11
    v_mov_b32 v12, 0x7ff00000
    v_cmp_gt_u32 vcc, 1024, v10
    s_nop 1
    v_cndmask_b32 v11, v12, v11, vcc
    v_cmp_gt_u32 vcc, 40, v8
    s_nop 1
    v_cndmask_b32 v24, v11, v24, vcc
    s_mul_i32 s28, s21, 12
    s_add_u32 s28, s28, 4
    v_lshrrev_b32 v8, 4, v1
    v_add_u32 v8, s28, v8
    v_and_b32 v9, 15, v1
    v_lshlrev_b32 v9, 4, v9
    s_lshl_b32 s28, s20, 8
    v_lshl_add_u32 v25, v8, 14, v9
    v_add_u32 v25, s28, v25
    v_subrev_u32 v10, 40, v8
    v_lshl_add_u32 v10, v10, 8, v9
    s_mul_i32 s28, s20, 640
    v_add_u32 v11, s28, v10
    s_mul_i32 s28, s20, 384
    s_add_u32 s28, s28, 19840
    v_add_u32 v12, s28, v10
    v_cmp_gt_u32 vcc, 640, v10
    s_nop 1
    v_cndmask_b32 v11, v12, v11, vcc
    v_lshrrev_b32 v12, 13, v11
    v_lshlrev_b32 v12, 13, v12
    v_add_u32 v11, v11, v12
    v_add_u32 v11, 0xc0000, v11
    v_mov_b32 v12, 0x7ff00000
    v_cmp_gt_u32 vcc, 1024, v10
    s_nop 1
    v_cndmask_b32 v11, v12, v11, vcc
    v_cmp_gt_u32 vcc, 40, v8
    s_nop 1
    v_cndmask_b32 v25, v11, v25, vcc
    s_mul_i32 s28, s21, 12
    s_add_u32 s28, s28, 8
    v_lshrrev_b32 v8, 4, v1
    v_add_u32 v8, s28, v8
    v_and_b32 v9, 15, v1
    v_lshlrev_b32 v9, 4, v9
    s_lshl_b32 s28, s20, 8
    v_lshl_add_u32 v26, v8, 14, v9
    v_add_u32 v26, s28, v26
    v_subrev_u32 v10, 40, v8
    v_lshl_add_u32 v10, v10, 8, v9
    s_mul_i32 s28, s20, 640
    v_add_u32 v11, s28, v10
    s_mul_i32 s28, s20, 384
    s_add_u32 s28, s28, 19840
    v_add_u32 v12, s28, v10
    v_cmp_gt_u32 vcc, 640, v10
    s_nop 1
    v_cndmask_b32 v11, v12, v11, vcc
    v_lshrrev_b32 v12, 13, v11
    v_lshlrev_b32 v12, 13, v12
    v_add_u32 v11, v11, v12
    v_add_u32 v11, 0xc0000, v11
    v_mov_b32 v12, 0x7ff00000
    v_cmp_gt_u32 vcc, 1024, v10
    s_nop 1
    v_cndmask_b32 v11, v12, v11, vcc
    v_cmp_gt_u32 vcc, 40, v8
    s_nop 1
    v_cndmask_b32 v26, v11, v26, vcc
    s_cmp_eq_u32 s24, 0
    s_cselect_b64 vcc, -1, 0
    v_cndmask_b32 v24, v12, v24, vcc
    v_cndmask_b32 v25, v12, v25, vcc
    v_cndmask_b32 v26, v12, v26, vcc
    v_mov_b32 v28, -1
    v_mov_b32 v29, -1
    v_mov_b32 v30, -1
    v_mov_b32 v31, -1
    s_mov_b32 s46, 0xc200000
    s_waitcnt vmcnt(16)
    s_barrier
    v_add_u32 v105, 61440, v103
    v_add_u32 v106, 61440, v104
    s_cmp_eq_u32 s21, 3
    s_cbranch_scc1 M_pj_l0v
    ds_read_b64_tr_b16 a[0:1], v105 offset:0
    ds_read_b64_tr_b16 a[2:3], v105 offset:1536
    ds_read_b64_tr_b16 a[16:17], v105 offset:12288
    ds_read_b64_tr_b16 a[18:19], v105 offset:13824
    ds_read_b64_tr_b16 a[4:5], v105 offset:32
    ds_read_b64_tr_b16 a[6:7], v105 offset:1568
    ds_read_b64_tr_b16 a[20:21], v105 offset:12320
    ds_read_b64_tr_b16 a[22:23], v105 offset:13856
    ds_read_b64_tr_b16 a[8:9], v105 offset:64
    ds_read_b64_tr_b16 a[10:11], v105 offset:1600
    ds_read_b64_tr_b16 a[24:25], v105 offset:12352
    ds_read_b64_tr_b16 a[26:27], v105 offset:13888
    ds_read_b64_tr_b16 a[12:13], v105 offset:96
    ds_read_b64_tr_b16 a[14:15], v105 offset:1632
    ds_read_b64_tr_b16 a[28:29], v105 offset:12384
    ds_read_b64_tr_b16 a[30:31], v105 offset:13920
    s_branch M_pj_l0e
M_pj_l0v:
    ds_read_b64_tr_b16 a[0:1], v106 offset:0
    ds_read_b64_tr_b16 a[2:3], v106 offset:512
    ds_read_b64_tr_b16 a[16:17], v106 offset:4096
    ds_read_b64_tr_b16 a[18:19], v106 offset:4608
    ds_read_b64_tr_b16 a[4:5], v106 offset:32
    ds_read_b64_tr_b16 a[6:7], v106 offset:544
    ds_read_b64_tr_b16 a[20:21], v106 offset:4128
    ds_read_b64_tr_b16 a[22:23], v106 offset:4640
    ds_read_b64_tr_b16 a[8:9], v106 offset:64
    ds_read_b64_tr_b16 a[10:11], v106 offset:576
    ds_read_b64_tr_b16 a[24:25], v106 offset:4160
    ds_read_b64_tr_b16 a[26:27], v106 offset:4672
    ds_read_b64_tr_b16 a[12:13], v106 offset:96
    ds_read_b64_tr_b16 a[14:15], v106 offset:608
    ds_read_b64_tr_b16 a[28:29], v106 offset:4192
    ds_read_b64_tr_b16 a[30:31], v106 offset:4704
M_pj_l0e:
    s_waitcnt lgkmcnt(0)
    s_barrier
    buffer_load_dwordx4 v[92:95], v100, s[88:91], 0 offen sc1
    s_add_u32 m0, s82, 61440
    s_add_u32 s85, s80, 2359296
    buffer_load_dwordx4 v96, s[12:15], s85 offen nt lds
    s_add_u32 m0, s82, 62464
    s_add_u32 s85, s80, 2359296
    buffer_load_dwordx4 v97, s[12:15], s85 offen nt lds
    s_add_u32 m0, s82, 63488
    s_add_u32 s85, s80, 2359296
    buffer_load_dwordx4 v98, s[12:15], s85 offen nt lds
    s_add_u32 m0, s82, 64512
    s_add_u32 s85, s80, 2457600
    buffer_load_dwordx4 v96, s[12:15], s85 offen nt lds
    s_add_u32 m0, s82, 65536
    s_add_u32 s85, s80, 2457600
    buffer_load_dwordx4 v97, s[12:15], s85 offen nt lds
    s_add_u32 m0, s82, 66560
    s_add_u32 s85, s80, 2457600
    buffer_load_dwordx4 v98, s[12:15], s85 offen nt lds
    s_add_u32 m0, s84, 86016
    s_add_u32 s85, s81, 2359296
    buffer_load_dwordx4 v99, s[16:19], s85 offen nt lds
    s_add_u32 m0, s84, 87040
    s_add_u32 s85, s81, 2457600
    buffer_load_dwordx4 v99, s[16:19], s85 offen nt lds
    s_waitcnt vmcnt(17)
    s_barrier
    v_add_u32 v105, 94208, v103
    v_add_u32 v106, 94208, v104
    s_cmp_eq_u32 s21, 3
    s_cbranch_scc1 M_pj_l1v
    ds_read_b64_tr_b16 a[32:33], v105 offset:0
    ds_read_b64_tr_b16 a[34:35], v105 offset:1536
    ds_read_b64_tr_b16 a[48:49], v105 offset:12288
    ds_read_b64_tr_b16 a[50:51], v105 offset:13824
    ds_read_b64_tr_b16 a[36:37], v105 offset:32
    ds_read_b64_tr_b16 a[38:39], v105 offset:1568
    ds_read_b64_tr_b16 a[52:53], v105 offset:12320
    ds_read_b64_tr_b16 a[54:55], v105 offset:13856
    ds_read_b64_tr_b16 a[40:41], v105 offset:64
    ds_read_b64_tr_b16 a[42:43], v105 offset:1600
    ds_read_b64_tr_b16 a[56:57], v105 offset:12352
    ds_read_b64_tr_b16 a[58:59], v105 offset:13888
    ds_read_b64_tr_b16 a[44:45], v105 offset:96
    ds_read_b64_tr_b16 a[46:47], v105 offset:1632
    ds_read_b64_tr_b16 a[60:61], v105 offset:12384
    ds_read_b64_tr_b16 a[62:63], v105 offset:13920
    s_branch M_pj_l1e
M_pj_l1v:
    ds_read_b64_tr_b16 a[32:33], v106 offset:0
    ds_read_b64_tr_b16 a[34:35], v106 offset:512
    ds_read_b64_tr_b16 a[48:49], v106 offset:4096
    ds_read_b64_tr_b16 a[50:51], v106 offset:4608
    ds_read_b64_tr_b16 a[36:37], v106 offset:32
    ds_read_b64_tr_b16 a[38:39], v106 offset:544
    ds_read_b64_tr_b16 a[52:53], v106 offset:4128
    ds_read_b64_tr_b16 a[54:55], v106 offset:4640
    ds_read_b64_tr_b16 a[40:41], v106 offset:64
    ds_read_b64_tr_b16 a[42:43], v106 offset:576
    ds_read_b64_tr_b16 a[56:57], v106 offset:4160
    ds_read_b64_tr_b16 a[58:59], v106 offset:4672
    ds_read_b64_tr_b16 a[44:45], v106 offset:96
    ds_read_b64_tr_b16 a[46:47], v106 offset:608
    ds_read_b64_tr_b16 a[60:61], v106 offset:4192
    ds_read_b64_tr_b16 a[62:63], v106 offset:4704
M_pj_l1e:
    s_waitcnt lgkmcnt(0)
    s_barrier
    buffer_load_dwordx4 v[92:95], v100, s[88:91], 0 offen sc1
    s_add_u32 m0, s82, 94208
    s_add_u32 s85, s80, 3145728
    buffer_load_dwordx4 v96, s[12:15], s85 offen nt lds
    s_add_u32 m0, s82, 95232
    s_add_u32 s85, s80, 3145728
    buffer_load_dwordx4 v97, s[12:15], s85 offen nt lds
    s_add_u32 m0, s82, 96256
    s_add_u32 s85, s80, 3145728
    buffer_load_dwordx4 v98, s[12:15], s85 offen nt lds
    s_add_u32 m0, s82, 97280
    s_add_u32 s85, s80, 3244032
    buffer_load_dwordx4 v96, s[12:15], s85 offen nt lds
    s_add_u32 m0, s82, 98304
    s_add_u32 s85, s80, 3244032
    buffer_load_dwordx4 v97, s[12:15], s85 offen nt lds
    s_add_u32 m0, s82, 99328
    s_add_u32 s85, s80, 3244032
    buffer_load_dwordx4 v98, s[12:15], s85 offen nt lds
    s_add_u32 m0, s84, 118784
    s_add_u32 s85, s81, 3145728
    buffer_load_dwordx4 v99, s[16:19], s85 offen nt lds
    s_add_u32 m0, s84, 119808
    s_add_u32 s85, s81, 3244032
    buffer_load_dwordx4 v99, s[16:19], s85 offen nt lds
    s_waitcnt vmcnt(17)
    s_barrier
    v_add_u32 v105, 126976, v103
    v_add_u32 v106, 126976, v104
    s_cmp_eq_u32 s21, 3
    s_cbranch_scc1 M_pj_l2v
    ds_read_b64_tr_b16 a[64:65], v105 offset:0
    ds_read_b64_tr_b16 a[66:67], v105 offset:1536
    ds_read_b64_tr_b16 a[80:81], v105 offset:12288
    ds_read_b64_tr_b16 a[82:83], v105 offset:13824
    ds_read_b64_tr_b16 a[68:69], v105 offset:32
    ds_read_b64_tr_b16 a[70:71], v105 offset:1568
    ds_read_b64_tr_b16 a[84:85], v105 offset:12320
    ds_read_b64_tr_b16 a[86:87], v105 offset:13856
    ds_read_b64_tr_b16 a[72:73], v105 offset:64
    ds_read_b64_tr_b16 a[74:75], v105 offset:1600
    ds_read_b64_tr_b16 a[88:89], v105 offset:12352
    ds_read_b64_tr_b16 a[90:91], v105 offset:13888
    ds_read_b64_tr_b16 a[76:77], v105 offset:96
    ds_read_b64_tr_b16 a[78:79], v105 offset:1632
    ds_read_b64_tr_b16 a[92:93], v105 offset:12384
    ds_read_b64_tr_b16 a[94:95], v105 offset:13920
    s_branch M_pj_l2e
M_pj_l2v:
    ds_read_b64_tr_b16 a[64:65], v106 offset:0
    ds_read_b64_tr_b16 a[66:67], v106 offset:512
    ds_read_b64_tr_b16 a[80:81], v106 offset:4096
    ds_read_b64_tr_b16 a[82:83], v106 offset:4608
    ds_read_b64_tr_b16 a[68:69], v106 offset:32
    ds_read_b64_tr_b16 a[70:71], v106 offset:544
    ds_read_b64_tr_b16 a[84:85], v106 offset:4128
    ds_read_b64_tr_b16 a[86:87], v106 offset:4640
    ds_read_b64_tr_b16 a[72:73], v106 offset:64
    ds_read_b64_tr_b16 a[74:75], v106 offset:576
    ds_read_b64_tr_b16 a[88:89], v106 offset:4160
    ds_read_b64_tr_b16 a[90:91], v106 offset:4672
    ds_read_b64_tr_b16 a[76:77], v106 offset:96
    ds_read_b64_tr_b16 a[78:79], v106 offset:608
    ds_read_b64_tr_b16 a[92:93], v106 offset:4192
    ds_read_b64_tr_b16 a[94:95], v106 offset:4704
M_pj_l2e:
    s_waitcnt lgkmcnt(0)
    s_barrier
    v_cmp_eq_u32 vcc, 0, v95
    s_cbranch_vccnz M_pj_r0
    v_readfirstlane_b32 s28, v95
    s_cmp_lg_u32 s28, s23
    s_cbranch_scc1 M_redo
    s_branch M_pj_r1
M_pj_r0:
    v_mov_b32 v101, 140
    s_mov_b32 s39, 0
L_rw_7:
    buffer_load_dword v102, v101, s[88:91], 0 offen sc1
    s_add_u32 s39, s39, 1
    s_cmp_gt_u32 s39, 400000
    s_cbranch_scc1 M_fail
    s_waitcnt vmcnt(0)
    v_cmp_eq_u32 vcc, 0, v102
    s_cbranch_vccnz L_rw_7
    v_readfirstlane_b32 s28, v102
    s_cmp_lg_u32 s28, s23
    s_cbranch_scc1 M_redo
M_pj_r1:
    s_cmp_lg_u32 s86, 0
    s_cbranch_scc1 M_pj_g2
    v_min_u32 v101, v93, v94
    v_cmp_ne_u32 vcc, 0, v101
    s_cbranch_vccz M_pj_g2
    s_add_u32 m0, s34, 0
    s_add_u32 s29, s35, 4096
    buffer_load_dwordx4 v2, s[8:11], s35 offen sc1 lds
    buffer_load_dwordx4 v2, s[8:11], s35 offen offset:1024 sc1 lds
    buffer_load_dwordx4 v2, s[8:11], s35 offen offset:2048 sc1 lds
    buffer_load_dwordx4 v2, s[8:11], s35 offen offset:3072 sc1 lds
    s_add_u32 m0, m0, 4096
    s_add_u32 s35, s35, 20480
    buffer_load_dwordx4 v2, s[8:11], s29 offen sc1 lds
    s_add_u32 m0, s34, 20480
    s_add_u32 s29, s35, 4096
    buffer_load_dwordx4 v2, s[8:11], s35 offen sc1 lds
    buffer_load_dwordx4 v2, s[8:11], s35 offen offset:1024 sc1 lds
    buffer_load_dwordx4 v2, s[8:11], s35 offen offset:2048 sc1 lds
    buffer_load_dwordx4 v2, s[8:11], s35 offen offset:3072 sc1 lds
    s_add_u32 m0, m0, 4096
    s_add_u32 s35, s35, 20480
    buffer_load_dwordx4 v2, s[8:11], s29 offen sc1 lds
    s_add_u32 m0, s34, 40960
    s_add_u32 s29, s35, 4096
    buffer_load_dwordx4 v2, s[8:11], s35 offen sc1 lds
    buffer_load_dwordx4 v2, s[8:11], s35 offen offset:1024 sc1 lds
    buffer_load_dwordx4 v2, s[8:11], s35 offen offset:2048 sc1 lds
    buffer_load_dwordx4 v2, s[8:11], s35 offen offset:3072 sc1 lds
    s_add_u32 m0, m0, 4096
    s_add_u32 s35, s35, 20480
    buffer_load_dwordx4 v2, s[8:11], s29 offen sc1 lds
    s_mov_b32 s86, 1
M_pj_g2:
    buffer_load_dwordx4 v[92:95], v100, s[88:91], 0 offen sc1
    s_add_u32 m0, s82, 126976
    s_add_u32 s85, s80, 3932160
    buffer_load_dwordx4 v96, s[12:15], s85 offen nt lds
    s_add_u32 m0, s82, 128000
    s_add_u32 s85, s80, 3932160
    buffer_load_dwordx4 v97, s[12:15], s85 offen nt lds
    s_add_u32 m0, s82, 129024
    s_add_u32 s85, s80, 3932160
    buffer_load_dwordx4 v98, s[12:15], s85 offen nt lds
    s_add_u32 m0, s82, 130048
    s_add_u32 s85, s80, 4030464
    buffer_load_dwordx4 v96, s[12:15], s85 offen nt lds
    s_add_u32 m0, s82, 131072
    s_add_u32 s85, s80, 4030464
    buffer_load_dwordx4 v97, s[12:15], s85 offen nt lds
    s_add_u32 m0, s82, 132096
    s_add_u32 s85, s80, 4030464
    buffer_load_dwordx4 v98, s[12:15], s85 offen nt lds
    s_add_u32 m0, s84, 151552
    s_add_u32 s85, s81, 3932160
    buffer_load_dwordx4 v99, s[16:19], s85 offen nt lds
    s_add_u32 m0, s84, 152576
    s_add_u32 s85, s81, 4030464
    buffer_load_dwordx4 v99, s[16:19], s85 offen nt lds
    s_waitcnt vmcnt(17)
    s_barrier
    v_add_u32 v105, 61440, v103
    v_add_u32 v106, 61440, v104
    s_cmp_eq_u32 s21, 3
    s_cbranch_scc1 M_pj_l3v
    ds_read_b64_tr_b16 a[96:97], v105 offset:0
    ds_read_b64_tr_b16 a[98:99], v105 offset:1536
    ds_read_b64_tr_b16 a[112:113], v105 offset:12288
    ds_read_b64_tr_b16 a[114:115], v105 offset:13824
    ds_read_b64_tr_b16 a[100:101], v105 offset:32
    ds_read_b64_tr_b16 a[102:103], v105 offset:1568
    ds_read_b64_tr_b16 a[116:117], v105 offset:12320
    ds_read_b64_tr_b16 a[118:119], v105 offset:13856
    ds_read_b64_tr_b16 a[104:105], v105 offset:64
    ds_read_b64_tr_b16 a[106:107], v105 offset:1600
    ds_read_b64_tr_b16 a[120:121], v105 offset:12352
    ds_read_b64_tr_b16 a[122:123], v105 offset:13888
    ds_read_b64_tr_b16 a[108:109], v105 offset:96
    ds_read_b64_tr_b16 a[110:111], v105 offset:1632
    ds_read_b64_tr_b16 a[124:125], v105 offset:12384
    ds_read_b64_tr_b16 a[126:127], v105 offset:13920
    s_branch M_pj_l3e
M_pj_l3v:
    ds_read_b64_tr_b16 a[96:97], v106 offset:0
    ds_read_b64_tr_b16 a[98:99], v106 offset:512
    ds_read_b64_tr_b16 a[112:113], v106 offset:4096
    ds_read_b64_tr_b16 a[114:115], v106 offset:4608
    ds_read_b64_tr_b16 a[100:101], v106 offset:32
    ds_read_b64_tr_b16 a[102:103], v106 offset:544
    ds_read_b64_tr_b16 a[116:117], v106 offset:4128
    ds_read_b64_tr_b16 a[118:119], v106 offset:4640
    ds_read_b64_tr_b16 a[104:105], v106 offset:64
    ds_read_b64_tr_b16 a[106:107], v106 offset:576
    ds_read_b64_tr_b16 a[120:121], v106 offset:4160
    ds_read_b64_tr_b16 a[122:123], v106 offset:4672
    ds_read_b64_tr_b16 a[108:109], v106 offset:96
    ds_read_b64_tr_b16 a[110:111], v106 offset:608
    ds_read_b64_tr_b16 a[124:125], v106 offset:4192
    ds_read_b64_tr_b16 a[126:127], v106 offset:4704
M_pj_l3e:
    s_waitcnt lgkmcnt(0)
    s_barrier
    s_cmp_lg_u32 s86, 0
    s_cbranch_scc1 M_pj_g3
    v_min_u32 v101, v93, v94
    v_cmp_ne_u32 vcc, 0, v101
    s_cbranch_vccz M_pj_g3
    s_add_u32 m0, s34, 0
    s_add_u32 s29, s35, 4096
    buffer_load_dwordx4 v2, s[8:11], s35 offen sc1 lds
    buffer_load_dwordx4 v2, s[8:11], s35 offen offset:1024 sc1 lds
    buffer_load_dwordx4 v2, s[8:11], s35 offen offset:2048 sc1 lds
    buffer_load_dwordx4 v2, s[8:11], s35 offen offset:3072 sc1 lds
    s_add_u32 m0, m0, 4096
    s_add_u32 s35, s35, 20480
    buffer_load_dwordx4 v2, s[8:11], s29 offen sc1 lds
    s_add_u32 m0, s34, 20480
    s_add_u32 s29, s35, 4096
    buffer_load_dwordx4 v2, s[8:11], s35 offen sc1 lds
    buffer_load_dwordx4 v2, s[8:11], s35 offen offset:1024 sc1 lds
    buffer_load_dwordx4 v2, s[8:11], s35 offen offset:2048 sc1 lds
    buffer_load_dwordx4 v2, s[8:11], s35 offen offset:3072 sc1 lds
    s_add_u32 m0, m0, 4096
    s_add_u32 s35, s35, 20480
    buffer_load_dwordx4 v2, s[8:11], s29 offen sc1 lds
    s_add_u32 m0, s34, 40960
    s_add_u32 s29, s35, 4096
    buffer_load_dwordx4 v2, s[8:11], s35 offen sc1 lds
    buffer_load_dwordx4 v2, s[8:11], s35 offen offset:1024 sc1 lds
    buffer_load_dwordx4 v2, s[8:11], s35 offen offset:2048 sc1 lds
    buffer_load_dwordx4 v2, s[8:11], s35 offen offset:3072 sc1 lds
    s_add_u32 m0, m0, 4096
    s_add_u32 s35, s35, 20480
    buffer_load_dwordx4 v2, s[8:11], s29 offen sc1 lds
    s_mov_b32 s86, 1
M_pj_g3:
    buffer_load_dwordx4 v[92:95], v100, s[88:91], 0 offen sc1
    s_add_u32 m0, s82, 61440
    s_add_u32 s85, s80, 4718592
    buffer_load_dwordx4 v96, s[12:15], s85 offen nt lds
    s_add_u32 m0, s82, 62464
    s_add_u32 s85, s80, 4718592
    buffer_load_dwordx4 v97, s[12:15], s85 offen nt lds
    s_add_u32 m0, s82, 63488
    s_add_u32 s85, s80, 4718592
    buffer_load_dwordx4 v98, s[12:15], s85 offen nt lds
    s_add_u32 m0, s82, 64512
    s_add_u32 s85, s80, 4816896
    buffer_load_dwordx4 v96, s[12:15], s85 offen nt lds
    s_add_u32 m0, s82, 65536
    s_add_u32 s85, s80, 4816896
    buffer_load_dwordx4 v97, s[12:15], s85 offen nt lds
    s_add_u32 m0, s82, 66560
    s_add_u32 s85, s80, 4816896
    buffer_load_dwordx4 v98, s[12:15], s85 offen nt lds
    s_add_u32 m0, s84, 86016
    s_add_u32 s85, s81, 4718592
    buffer_load_dwordx4 v99, s[16:19], s85 offen nt lds
    s_add_u32 m0, s84, 87040
    s_add_u32 s85, s81, 4816896
    buffer_load_dwordx4 v99, s[16:19], s85 offen nt lds
    s_waitcnt vmcnt(17)
    s_barrier
    v_add_u32 v105, 94208, v103
    v_add_u32 v106, 94208, v104
    s_cmp_eq_u32 s21, 3
    s_cbranch_scc1 M_pj_l4v
    ds_read_b64_tr_b16 a[128:129], v105 offset:0
    ds_read_b64_tr_b16 a[130:131], v105 offset:1536
    ds_read_b64_tr_b16 a[144:145], v105 offset:12288
    ds_read_b64_tr_b16 a[146:147], v105 offset:13824
    ds_read_b64_tr_b16 a[132:133], v105 offset:32
    ds_read_b64_tr_b16 a[134:135], v105 offset:1568
    ds_read_b64_tr_b16 a[148:149], v105 offset:12320
    ds_read_b64_tr_b16 a[150:151], v105 offset:13856
    ds_read_b64_tr_b16 a[136:137], v105 offset:64
    ds_read_b64_tr_b16 a[138:139], v105 offset:1600
    ds_read_b64_tr_b16 a[152:153], v105 offset:12352
    ds_read_b64_tr_b16 a[154:155], v105 offset:13888
    ds_read_b64_tr_b16 a[140:141], v105 offset:96
    ds_read_b64_tr_b16 a[142:143], v105 offset:1632
    ds_read_b64_tr_b16 a[156:157], v105 offset:12384
    ds_read_b64_tr_b16 a[158:159], v105 offset:13920
    s_branch M_pj_l4e
M_pj_l4v:
    ds_read_b64_tr_b16 a[128:129], v106 offset:0
    ds_read_b64_tr_b16 a[130:131], v106 offset:512
    ds_read_b64_tr_b16 a[144:145], v106 offset:4096
    ds_read_b64_tr_b16 a[146:147], v106 offset:4608
    ds_read_b64_tr_b16 a[132:133], v106 offset:32
    ds_read_b64_tr_b16 a[134:135], v106 offset:544
    ds_read_b64_tr_b16 a[148:149], v106 offset:4128
    ds_read_b64_tr_b16 a[150:151], v106 offset:4640
    ds_read_b64_tr_b16 a[136:137], v106 offset:64
    ds_read_b64_tr_b16 a[138:139], v106 offset:576
    ds_read_b64_tr_b16 a[152:153], v106 offset:4160
    ds_read_b64_tr_b16 a[154:155], v106 offset:4672
    ds_read_b64_tr_b16 a[140:141], v106 offset:96
    ds_read_b64_tr_b16 a[142:143], v106 offset:608
    ds_read_b64_tr_b16 a[156:157], v106 offset:4192
    ds_read_b64_tr_b16 a[158:159], v106 offset:4704
M_pj_l4e:
    s_waitcnt lgkmcnt(0)
    s_barrier
    s_cmp_lg_u32 s86, 0
    s_cbranch_scc1 M_pj_g4
    v_min_u32 v101, v93, v94
    v_cmp_ne_u32 vcc, 0, v101
    s_cbranch_vccz M_pj_g4
    s_add_u32 m0, s34, 0
    s_add_u32 s29, s35, 4096
    buffer_load_dwordx4 v2, s[8:11], s35 offen sc1 lds
    buffer_load_dwordx4 v2, s[8:11], s35 offen offset:1024 sc1 lds
    buffer_load_dwordx4 v2, s[8:11], s35 offen offset:2048 sc1 lds
    buffer_load_dwordx4 v2, s[8:11], s35 offen offset:3072 sc1 lds
    s_add_u32 m0, m0, 4096
    s_add_u32 s35, s35, 20480
    buffer_load_dwordx4 v2, s[8:11], s29 offen sc1 lds
    s_add_u32 m0, s34, 20480
    s_add_u32 s29, s35, 4096
    buffer_load_dwordx4 v2, s[8:11], s35 offen sc1 lds
    buffer_load_dwordx4 v2, s[8:11], s35 offen offset:1024 sc1 lds
    buffer_load_dwordx4 v2, s[8:11], s35 offen offset:2048 sc1 lds
    buffer_load_dwordx4 v2, s[8:11], s35 offen offset:3072 sc1 lds
    s_add_u32 m0, m0, 4096
    s_add_u32 s35, s35, 20480
    buffer_load_dwordx4 v2, s[8:11], s29 offen sc1 lds
    s_add_u32 m0, s34, 40960
    s_add_u32 s29, s35, 4096
    buffer_load_dwordx4 v2, s[8:11], s35 offen sc1 lds
    buffer_load_dwordx4 v2, s[8:11], s35 offen offset:1024 sc1 lds
    buffer_load_dwordx4 v2, s[8:11], s35 offen offset:2048 sc1 lds
    buffer_load_dwordx4 v2, s[8:11], s35 offen offset:3072 sc1 lds
    s_add_u32 m0, m0, 4096
    s_add_u32 s35, s35, 20480
    buffer_load_dwordx4 v2, s[8:11], s29 offen sc1 lds
    s_mov_b32 s86, 1
M_pj_g4:
    buffer_load_dwordx4 v[92:95], v100, s[88:91], 0 offen sc1
    s_add_u32 m0, s82, 94208
    s_add_u32 s85, s80, 5505024
    buffer_load_dwordx4 v96, s[12:15], s85 offen nt lds
    s_add_u32 m0, s82, 95232
    s_add_u32 s85, s80, 5505024
    buffer_load_dwordx4 v97, s[12:15], s85 offen nt lds
    s_add_u32 m0, s82, 96256
    s_add_u32 s85, s80, 5505024
    buffer_load_dwordx4 v98, s[12:15], s85 offen nt lds
    s_add_u32 m0, s82, 97280
    s_add_u32 s85, s80, 5603328
    buffer_load_dwordx4 v96, s[12:15], s85 offen nt lds
    s_add_u32 m0, s82, 98304
    s_add_u32 s85, s80, 5603328
    buffer_load_dwordx4 v97, s[12:15], s85 offen nt lds
    s_add_u32 m0, s82, 99328
    s_add_u32 s85, s80, 5603328
    buffer_load_dwordx4 v98, s[12:15], s85 offen nt lds
    s_add_u32 m0, s84, 118784
    s_add_u32 s85, s81, 5505024
    buffer_load_dwordx4 v99, s[16:19], s85 offen nt lds
    s_add_u32 m0, s84, 119808
    s_add_u32 s85, s81, 5603328
    buffer_load_dwordx4 v99, s[16:19], s85 offen nt lds
    s_waitcnt vmcnt(17)
    s_barrier
    v_add_u32 v105, 126976, v103
    v_add_u32 v106, 126976, v104
    s_cmp_eq_u32 s21, 3
    s_cbranch_scc1 M_pj_l5v
    ds_read_b64_tr_b16 a[160:161], v105 offset:0
    ds_read_b64_tr_b16 a[162:163], v105 offset:1536
    ds_read_b64_tr_b16 a[176:177], v105 offset:12288
    ds_read_b64_tr_b16 a[178:179], v105 offset:13824
    ds_read_b64_tr_b16 a[164:165], v105 offset:32
    ds_read_b64_tr_b16 a[166:167], v105 offset:1568
    ds_read_b64_tr_b16 a[180:181], v105 offset:12320
    ds_read_b64_tr_b16 a[182:183], v105 offset:13856
    ds_read_b64_tr_b16 a[168:169], v105 offset:64
    ds_read_b64_tr_b16 a[170:171], v105 offset:1600
    ds_read_b64_tr_b16 a[184:185], v105 offset:12352
    ds_read_b64_tr_b16 a[186:187], v105 offset:13888
    ds_read_b64_tr_b16 a[172:173], v105 offset:96
    ds_read_b64_tr_b16 a[174:175], v105 offset:1632
    ds_read_b64_tr_b16 a[188:189], v105 offset:12384
    ds_read_b64_tr_b16 a[190:191], v105 offset:13920
    s_branch M_pj_l5e
M_pj_l5v:
    ds_read_b64_tr_b16 a[160:161], v106 offset:0
    ds_read_b64_tr_b16 a[162:163], v106 offset:512
    ds_read_b64_tr_b16 a[176:177], v106 offset:4096
    ds_read_b64_tr_b16 a[178:179], v106 offset:4608
    ds_read_b64_tr_b16 a[164:165], v106 offset:32
    ds_read_b64_tr_b16 a[166:167], v106 offset:544
    ds_read_b64_tr_b16 a[180:181], v106 offset:4128
    ds_read_b64_tr_b16 a[182:183], v106 offset:4640
    ds_read_b64_tr_b16 a[168:169], v106 offset:64
    ds_read_b64_tr_b16 a[170:171], v106 offset:576
    ds_read_b64_tr_b16 a[184:185], v106 offset:4160
    ds_read_b64_tr_b16 a[186:187], v106 offset:4672
    ds_read_b64_tr_b16 a[172:173], v106 offset:96
    ds_read_b64_tr_b16 a[174:175], v106 offset:608
    ds_read_b64_tr_b16 a[188:189], v106 offset:4192
    ds_read_b64_tr_b16 a[190:191], v106 offset:4704
M_pj_l5e:
    s_waitcnt lgkmcnt(0)
    s_barrier
    s_cmp_lg_u32 s86, 0
    s_cbranch_scc1 M_pj_g5
    v_min_u32 v101, v93, v94
    v_cmp_ne_u32 vcc, 0, v101
    s_cbranch_vccnz M_pj_gs
    v_mov_b32 v101, 128
    s_mov_b32 s39, 0
L_go_8:
    buffer_load_dword v102, v101, s[88:91], 0 offen sc1
    buffer_load_dword v107, v101, s[88:91], 0 offen offset:12 sc1
    s_add_u32 s39, s39, 1
    s_cmp_gt_u32 s39, 400000
    s_cbranch_scc1 M_fail
    s_waitcnt vmcnt(0)
    v_cmp_eq_u32 vcc, 0, v107
    s_cbranch_vccnz L_go_8
    v_readfirstlane_b32 s28, v107
    s_cmp_lg_u32 s28, s23
    s_cbranch_scc1 M_redo
    v_cmp_ne_u32 vcc, 0, v102
    s_cbranch_vccnz L_go_8k
    s_sleep 3
    s_branch L_go_8
L_go_8k:
    v_readfirstlane_b32 s53, v102
    s_sub_u32 s53, s53, 1
    s_and_b32 s53, s53, 1
    s_lshl_b32 s52, s53, 13
    s_add_u32 s52, s52, 0xa00000
    s_xor_b32 s56, s53, 1
    s_lshl_b32 s56, s56, 13
    s_lshr_b32 s55, s25, 2
    s_and_b32 s55, s55, 15
    s_mul_i32 s55, s55, 256
    s_mov_b32 s58, 0
M_pj_gs:
    s_add_u32 m0, s34, 0
    s_add_u32 s29, s35, 4096
    buffer_load_dwordx4 v2, s[8:11], s35 offen sc1 lds
    buffer_load_dwordx4 v2, s[8:11], s35 offen offset:1024 sc1 lds
    buffer_load_dwordx4 v2, s[8:11], s35 offen offset:2048 sc1 lds
    buffer_load_dwordx4 v2, s[8:11], s35 offen offset:3072 sc1 lds
    s_add_u32 m0, m0, 4096
    s_add_u32 s35, s35, 20480
    buffer_load_dwordx4 v2, s[8:11], s29 offen sc1 lds
    s_add_u32 m0, s34, 20480
    s_add_u32 s29, s35, 4096
    buffer_load_dwordx4 v2, s[8:11], s35 offen sc1 lds
    buffer_load_dwordx4 v2, s[8:11], s35 offen offset:1024 sc1 lds
    buffer_load_dwordx4 v2, s[8:11], s35 offen offset:2048 sc1 lds
    buffer_load_dwordx4 v2, s[8:11], s35 offen offset:3072 sc1 lds
    s_add_u32 m0, m0, 4096
    s_add_u32 s35, s35, 20480
    buffer_load_dwordx4 v2, s[8:11], s29 offen sc1 lds
    s_add_u32 m0, s34, 40960
    s_add_u32 s29, s35, 4096
    buffer_load_dwordx4 v2, s[8:11], s35 offen sc1 lds
    buffer_load_dwordx4 v2, s[8:11], s35 offen offset:1024 sc1 lds
    buffer_load_dwordx4 v2, s[8:11], s35 offen offset:2048 sc1 lds
    buffer_load_dwordx4 v2, s[8:11], s35 offen offset:3072 sc1 lds
    s_add_u32 m0, m0, 4096
    s_add_u32 s35, s35, 20480
    buffer_load_dwordx4 v2, s[8:11], s29 offen sc1 lds
    s_mov_b32 s86, 1
M_pj_g5:
    buffer_load_dwordx4 v[92:95], v100, s[88:91], 0 offen sc1
    s_add_u32 m0, s82, 126976
    s_add_u32 s85, s80, 6291456
    buffer_load_dwordx4 v96, s[12:15], s85 offen nt lds
    s_add_u32 m0, s82, 128000
    s_add_u32 s85, s80, 6291456
    buffer_load_dwordx4 v97, s[12:15], s85 offen nt lds
    s_add_u32 m0, s82, 129024
    s_add_u32 s85, s80, 6291456
    buffer_load_dwordx4 v98, s[12:15], s85 offen nt lds
    s_add_u32 m0, s82, 130048
    s_add_u32 s85, s80, 6389760
    buffer_load_dwordx4 v96, s[12:15], s85 offen nt lds
    s_add_u32 m0, s82, 131072
    s_add_u32 s85, s80, 6389760
    buffer_load_dwordx4 v97, s[12:15], s85 offen nt lds
    s_add_u32 m0, s82, 132096
    s_add_u32 s85, s80, 6389760
    buffer_load_dwordx4 v98, s[12:15], s85 offen nt lds
    s_add_u32 m0, s84, 151552
    s_add_u32 s85, s81, 6291456
    buffer_load_dwordx4 v99, s[16:19], s85 offen nt lds
    s_add_u32 m0, s84, 152576
    s_add_u32 s85, s81, 6389760
    buffer_load_dwordx4 v99, s[16:19], s85 offen nt lds
    s_waitcnt vmcnt(17)
    s_barrier
    v_add_u32 v105, 61440, v103
    v_add_u32 v106, 61440, v104
    s_cmp_eq_u32 s21, 3
    s_cbranch_scc1 M_pj_l6v
    ds_read_b64_tr_b16 a[192:193], v105 offset:0
    ds_read_b64_tr_b16 a[194:195], v105 offset:1536
    ds_read_b64_tr_b16 a[208:209], v105 offset:12288
    ds_read_b64_tr_b16 a[210:211], v105 offset:13824
    ds_read_b64_tr_b16 a[196:197], v105 offset:32
    ds_read_b64_tr_b16 a[198:199], v105 offset:1568
    ds_read_b64_tr_b16 a[212:213], v105 offset:12320
    ds_read_b64_tr_b16 a[214:215], v105 offset:13856
    ds_read_b64_tr_b16 a[200:201], v105 offset:64
    ds_read_b64_tr_b16 a[202:203], v105 offset:1600
    ds_read_b64_tr_b16 a[216:217], v105 offset:12352
    ds_read_b64_tr_b16 a[218:219], v105 offset:13888
    ds_read_b64_tr_b16 a[204:205], v105 offset:96
    ds_read_b64_tr_b16 a[206:207], v105 offset:1632
    ds_read_b64_tr_b16 a[220:221], v105 offset:12384
    ds_read_b64_tr_b16 a[222:223], v105 offset:13920
    s_branch M_pj_l6e
M_pj_l6v:
    ds_read_b64_tr_b16 a[192:193], v106 offset:0
    ds_read_b64_tr_b16 a[194:195], v106 offset:512
    ds_read_b64_tr_b16 a[208:209], v106 offset:4096
    ds_read_b64_tr_b16 a[210:211], v106 offset:4608
    ds_read_b64_tr_b16 a[196:197], v106 offset:32
    ds_read_b64_tr_b16 a[198:199], v106 offset:544
    ds_read_b64_tr_b16 a[212:213], v106 offset:4128
    ds_read_b64_tr_b16 a[214:215], v106 offset:4640
    ds_read_b64_tr_b16 a[200:201], v106 offset:64
    ds_read_b64_tr_b16 a[202:203], v106 offset:576
    ds_read_b64_tr_b16 a[216:217], v106 offset:4160
    ds_read_b64_tr_b16 a[218:219], v106 offset:4672
    ds_read_b64_tr_b16 a[204:205], v106 offset:96
    ds_read_b64_tr_b16 a[206:207], v106 offset:608
    ds_read_b64_tr_b16 a[220:221], v106 offset:4192
    ds_read_b64_tr_b16 a[222:223], v106 offset:4704
M_pj_l6e:
    s_waitcnt lgkmcnt(0)
    s_barrier
    buffer_load_dwordx4 v[92:95], v100, s[88:91], 0 offen sc1
    s_add_u32 m0, s82, 61440
    s_add_u32 s85, s80, 7077888
    buffer_load_dwordx4 v96, s[12:15], s85 offen nt lds
    s_add_u32 m0, s82, 62464
    s_add_u32 s85, s80, 7077888
    buffer_load_dwordx4 v97, s[12:15], s85 offen nt lds
    s_add_u32 m0, s82, 63488
    s_add_u32 s85, s80, 7077888
    buffer_load_dwordx4 v98, s[12:15], s85 offen nt lds
    s_add_u32 m0, s82, 64512
    s_add_u32 s85, s80, 7176192
    buffer_load_dwordx4 v96, s[12:15], s85 offen nt lds
    s_add_u32 m0, s82, 65536
    s_add_u32 s85, s80, 7176192
    buffer_load_dwordx4 v97, s[12:15], s85 offen nt lds
    s_add_u32 m0, s82, 66560
    s_add_u32 s85, s80, 7176192
    buffer_load_dwordx4 v98, s[12:15], s85 offen nt lds
    s_add_u32 m0, s84, 86016
    s_add_u32 s85, s81, 7077888
    buffer_load_dwordx4 v99, s[16:19], s85 offen nt lds
    s_add_u32 m0, s84, 87040
    s_add_u32 s85, s81, 7176192
    buffer_load_dwordx4 v99, s[16:19], s85 offen nt lds
    s_waitcnt vmcnt(17)
    s_barrier
    v_add_u32 v105, 94208, v103
    v_add_u32 v106, 94208, v104
    s_cmp_eq_u32 s21, 3
    s_cbranch_scc1 M_pj_l7v
    ds_read_b64_tr_b16 a[224:225], v105 offset:0
    ds_read_b64_tr_b16 a[226:227], v105 offset:1536
    ds_read_b64_tr_b16 a[240:241], v105 offset:12288
    ds_read_b64_tr_b16 a[242:243], v105 offset:13824
    ds_read_b64_tr_b16 a[228:229], v105 offset:32
    ds_read_b64_tr_b16 a[230:231], v105 offset:1568
    ds_read_b64_tr_b16 a[244:245], v105 offset:12320
    ds_read_b64_tr_b16 a[246:247], v105 offset:13856
    ds_read_b64_tr_b16 a[232:233], v105 offset:64
    ds_read_b64_tr_b16 a[234:235], v105 offset:1600
    ds_read_b64_tr_b16 a[248:249], v105 offset:12352
    ds_read_b64_tr_b16 a[250:251], v105 offset:13888
    ds_read_b64_tr_b16 a[236:237], v105 offset:96
    ds_read_b64_tr_b16 a[238:239], v105 offset:1632
    ds_read_b64_tr_b16 a[252:253], v105 offset:12384
    ds_read_b64_tr_b16 a[254:255], v105 offset:13920
    s_branch M_pj_l7e
M_pj_l7v:
    ds_read_b64_tr_b16 a[224:225], v106 offset:0
    ds_read_b64_tr_b16 a[226:227], v106 offset:512
    ds_read_b64_tr_b16 a[240:241], v106 offset:4096
    ds_read_b64_tr_b16 a[242:243], v106 offset:4608
    ds_read_b64_tr_b16 a[228:229], v106 offset:32
    ds_read_b64_tr_b16 a[230:231], v106 offset:544
    ds_read_b64_tr_b16 a[244:245], v106 offset:4128
    ds_read_b64_tr_b16 a[246:247], v106 offset:4640
    ds_read_b64_tr_b16 a[232:233], v106 offset:64
    ds_read_b64_tr_b16 a[234:235], v106 offset:576
    ds_read_b64_tr_b16 a[248:249], v106 offset:4160
    ds_read_b64_tr_b16 a[250:251], v106 offset:4672
    ds_read_b64_tr_b16 a[236:237], v106 offset:96
    ds_read_b64_tr_b16 a[238:239], v106 offset:608
    ds_read_b64_tr_b16 a[252:253], v106 offset:4192
    ds_read_b64_tr_b16 a[254:255], v106 offset:4704
M_pj_l7e:
    s_waitcnt lgkmcnt(0)
    s_waitcnt vmcnt(8)
    s_barrier
    v_add_u32 v105, 126976, v103
    v_add_u32 v106, 126976, v104
    s_cmp_eq_u32 s21, 3
    s_cbranch_scc1 M_pj_l8v
    ds_read_b64_tr_b16 v[192:193], v105 offset:0
    ds_read_b64_tr_b16 v[194:195], v105 offset:1536
    ds_read_b64_tr_b16 v[208:209], v105 offset:12288
    ds_read_b64_tr_b16 v[210:211], v105 offset:13824
    ds_read_b64_tr_b16 v[196:197], v105 offset:32
    ds_read_b64_tr_b16 v[198:199], v105 offset:1568
    ds_read_b64_tr_b16 v[212:213], v105 offset:12320
    ds_read_b64_tr_b16 v[214:215], v105 offset:13856
    ds_read_b64_tr_b16 v[200:201], v105 offset:64
    ds_read_b64_tr_b16 v[202:203], v105 offset:1600
    ds_read_b64_tr_b16 v[216:217], v105 offset:12352
    ds_read_b64_tr_b16 v[218:219], v105 offset:13888
    ds_read_b64_tr_b16 v[204:205], v105 offset:96
    ds_read_b64_tr_b16 v[206:207], v105 offset:1632
    ds_read_b64_tr_b16 v[220:221], v105 offset:12384
    ds_read_b64_tr_b16 v[222:223], v105 offset:13920
    s_branch M_pj_l8e
M_pj_l8v:
    ds_read_b64_tr_b16 v[192:193], v106 offset:0
    ds_read_b64_tr_b16 v[194:195], v106 offset:512
    ds_read_b64_tr_b16 v[208:209], v106 offset:4096
    ds_read_b64_tr_b16 v[210:211], v106 offset:4608
    ds_read_b64_tr_b16 v[196:197], v106 offset:32
    ds_read_b64_tr_b16 v[198:199], v106 offset:544
    ds_read_b64_tr_b16 v[212:213], v106 offset:4128
    ds_read_b64_tr_b16 v[214:215], v106 offset:4640
    ds_read_b64_tr_b16 v[200:201], v106 offset:64
    ds_read_b64_tr_b16 v[202:203], v106 offset:576
    ds_read_b64_tr_b16 v[216:217], v106 offset:4160
    ds_read_b64_tr_b16 v[218:219], v106 offset:4672
    ds_read_b64_tr_b16 v[204:205], v106 offset:96
    ds_read_b64_tr_b16 v[206:207], v106 offset:608
    ds_read_b64_tr_b16 v[220:221], v106 offset:4192
    ds_read_b64_tr_b16 v[222:223], v106 offset:4704
M_pj_l8e:
    s_waitcnt lgkmcnt(0)
    v_cmp_ne_u32 vcc, 0, v92
    s_cbranch_vccz M_pj_gw
    v_readfirstlane_b32 s53, v92
    s_sub_u32 s53, s53, 1
    s_and_b32 s53, s53, 1
    s_lshl_b32 s52, s53, 13
    s_add_u32 s52, s52, 0xa00000
    s_xor_b32 s56, s53, 1
    s_lshl_b32 s56, s56, 13
    s_lshr_b32 s55, s25, 2
    s_and_b32 s55, s55, 15
    s_mul_i32 s55, s55, 256
    s_mov_b32 s58, 0
    s_branch M_pj_gx
M_pj_gw:
    v_mov_b32 v101, 128
    s_mov_b32 s39, 0
L_go_9:
    buffer_load_dword v102, v101, s[88:91], 0 offen sc1
    buffer_load_dword v107, v101, s[88:91], 0 offen offset:12 sc1
    s_add_u32 s39, s39, 1
    s_cmp_gt_u32 s39, 400000
    s_cbranch_scc1 M_fail
    s_waitcnt vmcnt(0)
    v_cmp_eq_u32 vcc, 0, v107
    s_cbranch_vccnz L_go_9
    v_readfirstlane_b32 s28, v107
    s_cmp_lg_u32 s28, s23
    s_cbranch_scc1 M_redo
    v_cmp_ne_u32 vcc, 0, v102
    s_cbranch_vccnz L_go_9k
    s_sleep 3
    s_branch L_go_9
L_go_9k:
    v_readfirstlane_b32 s53, v102
    s_sub_u32 s53, s53, 1
    s_and_b32 s53, s53, 1
    s_lshl_b32 s52, s53, 13
    s_add_u32 s52, s52, 0xa00000
    s_xor_b32 s56, s53, 1
    s_lshl_b32 s56, s56, 13
    s_lshr_b32 s55, s25, 2
    s_and_b32 s55, s55, 15
    s_mul_i32 s55, s55, 256
    s_mov_b32 s58, 0
M_pj_gx:
    ds_read_b128 v[32:35], v2 offset:0
    ds_read_b128 v[36:39], v2 offset:20480
    ds_read_b128 v[40:43], v2 offset:1024
    ds_read_b128 v[44:47], v2 offset:21504
    s_waitcnt lgkmcnt(3)
    v_mfma_f32_16x16x32_bf16 v[8:11], a[0:3], v[32:35], 0
    v_mfma_f32_16x16x32_bf16 v[12:15], a[4:7], v[32:35], 0
    v_mfma_f32_16x16x32_bf16 v[16:19], a[8:11], v[32:35], 0
    v_mfma_f32_16x16x32_bf16 v[20:23], a[12:15], v[32:35], 0
    ds_read_b128 v[48:51], v2 offset:2048
    s_waitcnt lgkmcnt(3)
    v_mfma_f32_16x16x32_bf16 v[76:79], a[0:3], v[36:39], 0
    v_mfma_f32_16x16x32_bf16 v[80:83], a[4:7], v[36:39], 0
    v_mfma_f32_16x16x32_bf16 v[84:87], a[8:11], v[36:39], 0
    v_mfma_f32_16x16x32_bf16 v[88:91], a[12:15], v[36:39], 0
    ds_read_b128 v[32:35], v2 offset:22528
    s_waitcnt lgkmcnt(3)
    v_mfma_f32_16x16x32_bf16 v[8:11], a[16:19], v[40:43], v[8:11]
    v_mfma_f32_16x16x32_bf16 v[12:15], a[20:23], v[40:43], v[12:15]
    v_mfma_f32_16x16x32_bf16 v[16:19], a[24:27], v[40:43], v[16:19]
    v_mfma_f32_16x16x32_bf16 v[20:23], a[28:31], v[40:43], v[20:23]
    ds_read_b128 v[36:39], v2 offset:3072
    s_waitcnt lgkmcnt(3)
    v_mfma_f32_16x16x32_bf16 v[76:79], a[16:19], v[44:47], v[76:79]
    v_mfma_f32_16x16x32_bf16 v[80:83], a[20:23], v[44:47], v[80:83]
    v_mfma_f32_16x16x32_bf16 v[84:87], a[24:27], v[44:47], v[84:87]
    v_mfma_f32_16x16x32_bf16 v[88:91], a[28:31], v[44:47], v[88:91]
    ds_read_b128 v[40:43], v2 offset:23552
    s_waitcnt lgkmcnt(3)
    v_mfma_f32_16x16x32_bf16 v[8:11], a[32:35], v[48:51], v[8:11]
    v_mfma_f32_16x16x32_bf16 v[12:15], a[36:39], v[48:51], v[12:15]
    v_mfma_f32_16x16x32_bf16 v[16:19], a[40:43], v[48:51], v[16:19]
    v_mfma_f32_16x16x32_bf16 v[20:23], a[44:47], v[48:51], v[20:23]
    ds_read_b128 v[44:47], v2 offset:4096
    s_waitcnt lgkmcnt(3)
    v_mfma_f32_16x16x32_bf16 v[76:79], a[32:35], v[32:35], v[76:79]
    v_mfma_f32_16x16x32_bf16 v[80:83], a[36:39], v[32:35], v[80:83]
    v_mfma_f32_16x16x32_bf16 v[84:87], a[40:43], v[32:35], v[84:87]
    v_mfma_f32_16x16x32_bf16 v[88:91], a[44:47], v[32:35], v[88:91]
    ds_read_b128 v[48:51], v2 offset:24576
    s_waitcnt lgkmcnt(3)
    v_mfma_f32_16x16x32_bf16 v[8:11], a[48:51], v[36:39], v[8:11]
    v_mfma_f32_16x16x32_bf16 v[12:15], a[52:55], v[36:39], v[12:15]
    v_mfma_f32_16x16x32_bf16 v[16:19], a[56:59], v[36:39], v[16:19]
    v_mfma_f32_16x16x32_bf16 v[20:23], a[60:63], v[36:39], v[20:23]
    ds_read_b128 v[32:35], v2 offset:5120
    s_waitcnt lgkmcnt(3)
    v_mfma_f32_16x16x32_bf16 v[76:79], a[48:51], v[40:43], v[76:79]
    v_mfma_f32_16x16x32_bf16 v[80:83], a[52:55], v[40:43], v[80:83]
    v_mfma_f32_16x16x32_bf16 v[84:87], a[56:59], v[40:43], v[84:87]
    v_mfma_f32_16x16x32_bf16 v[88:91], a[60:63], v[40:43], v[88:91]
    ds_read_b128 v[36:39], v2 offset:25600
    s_waitcnt lgkmcnt(3)
    v_mfma_f32_16x16x32_bf16 v[8:11], a[64:67], v[44:47], v[8:11]
    v_mfma_f32_16x16x32_bf16 v[12:15], a[68:71], v[44:47], v[12:15]
    v_mfma_f32_16x16x32_bf16 v[16:19], a[72:75], v[44:47], v[16:19]
    v_mfma_f32_16x16x32_bf16 v[20:23], a[76:79], v[44:47], v[20:23]
    ds_read_b128 v[40:43], v2 offset:6144
    s_waitcnt lgkmcnt(3)
    v_mfma_f32_16x16x32_bf16 v[76:79], a[64:67], v[48:51], v[76:79]
    v_mfma_f32_16x16x32_bf16 v[80:83], a[68:71], v[48:51], v[80:83]
    v_mfma_f32_16x16x32_bf16 v[84:87], a[72:75], v[48:51], v[84:87]
    v_mfma_f32_16x16x32_bf16 v[88:91], a[76:79], v[48:51], v[88:91]
    ds_read_b128 v[44:47], v2 offset:26624
    s_waitcnt lgkmcnt(3)
    v_mfma_f32_16x16x32_bf16 v[8:11], a[80:83], v[32:35], v[8:11]
    v_mfma_f32_16x16x32_bf16 v[12:15], a[84:87], v[32:35], v[12:15]
    v_mfma_f32_16x16x32_bf16 v[16:19], a[88:91], v[32:35], v[16:19]
    v_mfma_f32_16x16x32_bf16 v[20:23], a[92:95], v[32:35], v[20:23]
    ds_read_b128 v[48:51], v2 offset:7168
    s_waitcnt lgkmcnt(3)
    v_mfma_f32_16x16x32_bf16 v[76:79], a[80:83], v[36:39], v[76:79]
    v_mfma_f32_16x16x32_bf16 v[80:83], a[84:87], v[36:39], v[80:83]
    v_mfma_f32_16x16x32_bf16 v[84:87], a[88:91], v[36:39], v[84:87]
    v_mfma_f32_16x16x32_bf16 v[88:91], a[92:95], v[36:39], v[88:91]
    ds_read_b128 v[32:35], v2 offset:27648
    s_waitcnt lgkmcnt(3)
    v_mfma_f32_16x16x32_bf16 v[8:11], a[96:99], v[40:43], v[8:11]
    v_mfma_f32_16x16x32_bf16 v[12:15], a[100:103], v[40:43], v[12:15]
    v_mfma_f32_16x16x32_bf16 v[16:19], a[104:107], v[40:43], v[16:19]
    v_mfma_f32_16x16x32_bf16 v[20:23], a[108:111], v[40:43], v[20:23]
    ds_read_b128 v[36:39], v2 offset:8192
    s_waitcnt lgkmcnt(3)
    v_mfma_f32_16x16x32_bf16 v[76:79], a[96:99], v[44:47], v[76:79]
    v_mfma_f32_16x16x32_bf16 v[80:83], a[100:103], v[44:47], v[80:83]
    v_mfma_f32_16x16x32_bf16 v[84:87], a[104:107], v[44:47], v[84:87]
    v_mfma_f32_16x16x32_bf16 v[88:91], a[108:111], v[44:47], v[88:91]
    ds_read_b128 v[40:43], v2 offset:28672
    s_waitcnt lgkmcnt(3)
    v_mfma_f32_16x16x32_bf16 v[8:11], a[112:115], v[48:51], v[8:11]
    v_mfma_f32_16x16x32_bf16 v[12:15], a[116:119], v[48:51], v[12:15]
    v_mfma_f32_16x16x32_bf16 v[16:19], a[120:123], v[48:51], v[16:19]
    v_mfma_f32_16x16x32_bf16 v[20:23], a[124:127], v[48:51], v[20:23]
    ds_read_b128 v[44:47], v2 offset:9216
    s_waitcnt lgkmcnt(3)
    v_mfma_f32_16x16x32_bf16 v[76:79], a[112:115], v[32:35], v[76:79]
    v_mfma_f32_16x16x32_bf16 v[80:83], a[116:119], v[32:35], v[80:83]
    v_mfma_f32_16x16x32_bf16 v[84:87], a[120:123], v[32:35], v[84:87]
    v_mfma_f32_16x16x32_bf16 v[88:91], a[124:127], v[32:35], v[88:91]
    ds_read_b128 v[48:51], v2 offset:29696
    s_waitcnt lgkmcnt(3)
    v_mfma_f32_16x16x32_bf16 v[8:11], a[128:131], v[36:39], v[8:11]
    v_mfma_f32_16x16x32_bf16 v[12:15], a[132:135], v[36:39], v[12:15]
    v_mfma_f32_16x16x32_bf16 v[16:19], a[136:139], v[36:39], v[16:19]
    v_mfma_f32_16x16x32_bf16 v[20:23], a[140:143], v[36:39], v[20:23]
    ds_read_b128 v[32:35], v2 offset:10240
    s_waitcnt lgkmcnt(3)
    v_mfma_f32_16x16x32_bf16 v[76:79], a[128:131], v[40:43], v[76:79]
    v_mfma_f32_16x16x32_bf16 v[80:83], a[132:135], v[40:43], v[80:83]
    v_mfma_f32_16x16x32_bf16 v[84:87], a[136:139], v[40:43], v[84:87]
    v_mfma_f32_16x16x32_bf16 v[88:91], a[140:143], v[40:43], v[88:91]
    ds_read_b128 v[36:39], v2 offset:30720
    s_waitcnt lgkmcnt(3)
    v_mfma_f32_16x16x32_bf16 v[8:11], a[144:147], v[44:47], v[8:11]
    v_mfma_f32_16x16x32_bf16 v[12:15], a[148:151], v[44:47], v[12:15]
    v_mfma_f32_16x16x32_bf16 v[16:19], a[152:155], v[44:47], v[16:19]
    v_mfma_f32_16x16x32_bf16 v[20:23], a[156:159], v[44:47], v[20:23]
    ds_read_b128 v[40:43], v2 offset:11264
    s_waitcnt lgkmcnt(3)
    v_mfma_f32_16x16x32_bf16 v[76:79], a[144:147], v[48:51], v[76:79]
    v_mfma_f32_16x16x32_bf16 v[80:83], a[148:151], v[48:51], v[80:83]
    v_mfma_f32_16x16x32_bf16 v[84:87], a[152:155], v[48:51], v[84:87]
    v_mfma_f32_16x16x32_bf16 v[88:91], a[156:159], v[48:51], v[88:91]
    ds_read_b128 v[44:47], v2 offset:31744
    s_waitcnt lgkmcnt(3)
    v_mfma_f32_16x16x32_bf16 v[8:11], a[160:163], v[32:35], v[8:11]
    v_mfma_f32_16x16x32_bf16 v[12:15], a[164:167], v[32:35], v[12:15]
    v_mfma_f32_16x16x32_bf16 v[16:19], a[168:171], v[32:35], v[16:19]
    v_mfma_f32_16x16x32_bf16 v[20:23], a[172:175], v[32:35], v[20:23]
    ds_read_b128 v[48:51], v2 offset:12288
    s_waitcnt lgkmcnt(3)
    v_mfma_f32_16x16x32_bf16 v[76:79], a[160:163], v[36:39], v[76:79]
    v_mfma_f32_16x16x32_bf16 v[80:83], a[164:167], v[36:39], v[80:83]
    v_mfma_f32_16x16x32_bf16 v[84:87], a[168:171], v[36:39], v[84:87]
    v_mfma_f32_16x16x32_bf16 v[88:91], a[172:175], v[36:39], v[88:91]
    ds_read_b128 v[32:35], v2 offset:32768
    s_waitcnt lgkmcnt(3)
    v_mfma_f32_16x16x32_bf16 v[8:11], a[176:179], v[40:43], v[8:11]
    v_mfma_f32_16x16x32_bf16 v[12:15], a[180:183], v[40:43], v[12:15]
    v_mfma_f32_16x16x32_bf16 v[16:19], a[184:187], v[40:43], v[16:19]
    v_mfma_f32_16x16x32_bf16 v[20:23], a[188:191], v[40:43], v[20:23]
    ds_read_b128 v[36:39], v2 offset:13312
    s_waitcnt lgkmcnt(3)
    v_mfma_f32_16x16x32_bf16 v[76:79], a[176:179], v[44:47], v[76:79]
    v_mfma_f32_16x16x32_bf16 v[80:83], a[180:183], v[44:47], v[80:83]
    v_mfma_f32_16x16x32_bf16 v[84:87], a[184:187], v[44:47], v[84:87]
    v_mfma_f32_16x16x32_bf16 v[88:91], a[188:191], v[44:47], v[88:91]
    ds_read_b128 v[40:43], v2 offset:33792
    s_waitcnt lgkmcnt(3)
    v_mfma_f32_16x16x32_bf16 v[8:11], a[192:195], v[48:51], v[8:11]
    v_mfma_f32_16x16x32_bf16 v[12:15], a[196:199], v[48:51], v[12:15]
    v_mfma_f32_16x16x32_bf16 v[16:19], a[200:203], v[48:51], v[16:19]
    v_mfma_f32_16x16x32_bf16 v[20:23], a[204:207], v[48:51], v[20:23]
    ds_read_b128 v[44:47], v2 offset:14336
    s_waitcnt lgkmcnt(3)
    v_mfma_f32_16x16x32_bf16 v[76:79], a[192:195], v[32:35], v[76:79]
    v_mfma_f32_16x16x32_bf16 v[80:83], a[196:199], v[32:35], v[80:83]
    v_mfma_f32_16x16x32_bf16 v[84:87], a[200:203], v[32:35], v[84:87]
    v_mfma_f32_16x16x32_bf16 v[88:91], a[204:207], v[32:35], v[88:91]
    ds_read_b128 v[48:51], v2 offset:34816
    s_waitcnt lgkmcnt(3)
    v_mfma_f32_16x16x32_bf16 v[8:11], a[208:211], v[36:39], v[8:11]
    v_mfma_f32_16x16x32_bf16 v[12:15], a[212:215], v[36:39], v[12:15]
    v_mfma_f32_16x16x32_bf16 v[16:19], a[216:219], v[36:39], v[16:19]
    v_mfma_f32_16x16x32_bf16 v[20:23], a[220:223], v[36:39], v[20:23]
    ds_read_b128 v[32:35], v2 offset:15360
    s_waitcnt lgkmcnt(3)
    v_mfma_f32_16x16x32_bf16 v[76:79], a[208:211], v[40:43], v[76:79]
    v_mfma_f32_16x16x32_bf16 v[80:83], a[212:215], v[40:43], v[80:83]
    v_mfma_f32_16x16x32_bf16 v[84:87], a[216:219], v[40:43], v[84:87]
    v_mfma_f32_16x16x32_bf16 v[88:91], a[220:223], v[40:43], v[88:91]
    ds_read_b128 v[36:39], v2 offset:35840
    s_waitcnt lgkmcnt(3)
    v_mfma_f32_16x16x32_bf16 v[8:11], a[224:227], v[44:47], v[8:11]
    v_mfma_f32_16x16x32_bf16 v[12:15], a[228:231], v[44:47], v[12:15]
    v_mfma_f32_16x16x32_bf16 v[16:19], a[232:235], v[44:47], v[16:19]
    v_mfma_f32_16x16x32_bf16 v[20:23], a[236:239], v[44:47], v[20:23]
    ds_read_b128 v[40:43], v2 offset:16384
    s_waitcnt lgkmcnt(3)
    v_mfma_f32_16x16x32_bf16 v[76:79], a[224:227], v[48:51], v[76:79]
    v_mfma_f32_16x16x32_bf16 v[80:83], a[228:231], v[48:51], v[80:83]
    v_mfma_f32_16x16x32_bf16 v[84:87], a[232:235], v[48:51], v[84:87]
    v_mfma_f32_16x16x32_bf16 v[88:91], a[236:239], v[48:51], v[88:91]
    ds_read_b128 v[44:47], v2 offset:36864
    s_waitcnt lgkmcnt(3)
    v_mfma_f32_16x16x32_bf16 v[8:11], a[240:243], v[32:35], v[8:11]
    v_mfma_f32_16x16x32_bf16 v[12:15], a[244:247], v[32:35], v[12:15]
    v_mfma_f32_16x16x32_bf16 v[16:19], a[248:251], v[32:35], v[16:19]
    v_mfma_f32_16x16x32_bf16 v[20:23], a[252:255], v[32:35], v[20:23]
    ds_read_b128 v[48:51], v2 offset:17408
    s_waitcnt lgkmcnt(3)
    v_mfma_f32_16x16x32_bf16 v[76:79], a[240:243], v[36:39], v[76:79]
    v_mfma_f32_16x16x32_bf16 v[80:83], a[244:247], v[36:39], v[80:83]
    v_mfma_f32_16x16x32_bf16 v[84:87], a[248:251], v[36:39], v[84:87]
    v_mfma_f32_16x16x32_bf16 v[88:91], a[252:255], v[36:39], v[88:91]
    ds_read_b128 v[32:35], v2 offset:37888
    s_waitcnt lgkmcnt(3)
    v_mfma_f32_16x16x32_bf16 v[8:11], v[192:195], v[40:43], v[8:11]
    v_mfma_f32_16x16x32_bf16 v[12:15], v[196:199], v[40:43], v[12:15]
    v_mfma_f32_16x16x32_bf16 v[16:19], v[200:203], v[40:43], v[16:19]
    v_mfma_f32_16x16x32_bf16 v[20:23], v[204:207], v[40:43], v[20:23]
    s_waitcnt lgkmcnt(2)
    v_mfma_f32_16x16x32_bf16 v[76:79], v[192:195], v[44:47], v[76:79]
    v_mfma_f32_16x16x32_bf16 v[80:83], v[196:199], v[44:47], v[80:83]
    v_mfma_f32_16x16x32_bf16 v[84:87], v[200:203], v[44:47], v[84:87]
    v_mfma_f32_16x16x32_bf16 v[88:91], v[204:207], v[44:47], v[88:91]
    s_waitcnt lgkmcnt(1)
    v_mfma_f32_16x16x32_bf16 v[8:11], v[208:211], v[48:51], v[8:11]
    v_mfma_f32_16x16x32_bf16 v[12:15], v[212:215], v[48:51], v[12:15]
    v_mfma_f32_16x16x32_bf16 v[16:19], v[216:219], v[48:51], v[16:19]
    v_mfma_f32_16x16x32_bf16 v[20:23], v[220:223], v[48:51], v[20:23]
    s_waitcnt lgkmcnt(0)
    v_mfma_f32_16x16x32_bf16 v[76:79], v[208:211], v[32:35], v[76:79]
    v_mfma_f32_16x16x32_bf16 v[80:83], v[212:215], v[32:35], v[80:83]
    v_mfma_f32_16x16x32_bf16 v[84:87], v[216:219], v[32:35], v[84:87]
    v_mfma_f32_16x16x32_bf16 v[88:91], v[220:223], v[32:35], v[88:91]
    s_waitcnt vmcnt(0)
    s_barrier
    v_add_u32 v105, 61440, v103
    v_add_u32 v106, 61440, v104
    s_cmp_eq_u32 s21, 3
    s_cbranch_scc1 M_pj_l9v
    ds_read_b64_tr_b16 v[224:225], v105 offset:0
    ds_read_b64_tr_b16 v[226:227], v105 offset:1536
    ds_read_b64_tr_b16 v[240:241], v105 offset:12288
    ds_read_b64_tr_b16 v[242:243], v105 offset:13824
    ds_read_b64_tr_b16 v[228:229], v105 offset:32
    ds_read_b64_tr_b16 v[230:231], v105 offset:1568
    ds_read_b64_tr_b16 v[244:245], v105 offset:12320
    ds_read_b64_tr_b16 v[246:247], v105 offset:13856
    ds_read_b64_tr_b16 v[232:233], v105 offset:64
    ds_read_b64_tr_b16 v[234:235], v105 offset:1600
    ds_read_b64_tr_b16 v[248:249], v105 offset:12352
    ds_read_b64_tr_b16 v[250:251], v105 offset:13888
    ds_read_b64_tr_b16 v[236:237], v105 offset:96
    ds_read_b64_tr_b16 v[238:239], v105 offset:1632
    ds_read_b64_tr_b16 v[252:253], v105 offset:12384
    ds_read_b64_tr_b16 v[254:255], v105 offset:13920
    s_branch M_pj_l9e
M_pj_l9v:
    ds_read_b64_tr_b16 v[224:225], v106 offset:0
    ds_read_b64_tr_b16 v[226:227], v106 offset:512
    ds_read_b64_tr_b16 v[240:241], v106 offset:4096
    ds_read_b64_tr_b16 v[242:243], v106 offset:4608
    ds_read_b64_tr_b16 v[228:229], v106 offset:32
    ds_read_b64_tr_b16 v[230:231], v106 offset:544
    ds_read_b64_tr_b16 v[244:245], v106 offset:4128
    ds_read_b64_tr_b16 v[246:247], v106 offset:4640
    ds_read_b64_tr_b16 v[232:233], v106 offset:64
    ds_read_b64_tr_b16 v[234:235], v106 offset:576
    ds_read_b64_tr_b16 v[248:249], v106 offset:4160
    ds_read_b64_tr_b16 v[250:251], v106 offset:4672
    ds_read_b64_tr_b16 v[236:237], v106 offset:96
    ds_read_b64_tr_b16 v[238:239], v106 offset:608
    ds_read_b64_tr_b16 v[252:253], v106 offset:4192
    ds_read_b64_tr_b16 v[254:255], v106 offset:4704
M_pj_l9e:
    s_waitcnt lgkmcnt(0)
    s_barrier
    ds_read_b128 v[32:35], v2 offset:18432
    ds_read_b128 v[36:39], v2 offset:38912
    ds_read_b128 v[40:43], v2 offset:19456
    ds_read_b128 v[44:47], v2 offset:39936
    s_waitcnt lgkmcnt(3)
    v_mfma_f32_16x16x32_bf16 v[8:11], v[224:227], v[32:35], v[8:11]
    v_mfma_f32_16x16x32_bf16 v[12:15], v[228:231], v[32:35], v[12:15]
    v_mfma_f32_16x16x32_bf16 v[16:19], v[232:235], v[32:35], v[16:19]
    v_mfma_f32_16x16x32_bf16 v[20:23], v[236:239], v[32:35], v[20:23]
    s_waitcnt lgkmcnt(2)
    v_mfma_f32_16x16x32_bf16 v[76:79], v[224:227], v[36:39], v[76:79]
    v_mfma_f32_16x16x32_bf16 v[80:83], v[228:231], v[36:39], v[80:83]
    v_mfma_f32_16x16x32_bf16 v[84:87], v[232:235], v[36:39], v[84:87]
    v_mfma_f32_16x16x32_bf16 v[88:91], v[236:239], v[36:39], v[88:91]
    s_waitcnt lgkmcnt(1)
    v_mfma_f32_16x16x32_bf16 v[8:11], v[240:243], v[40:43], v[8:11]
    v_mfma_f32_16x16x32_bf16 v[12:15], v[244:247], v[40:43], v[12:15]
    v_mfma_f32_16x16x32_bf16 v[16:19], v[248:251], v[40:43], v[16:19]
    v_mfma_f32_16x16x32_bf16 v[20:23], v[252:255], v[40:43], v[20:23]
    s_waitcnt lgkmcnt(0)
    v_mfma_f32_16x16x32_bf16 v[76:79], v[240:243], v[44:47], v[76:79]
    v_mfma_f32_16x16x32_bf16 v[80:83], v[244:247], v[44:47], v[80:83]
    v_mfma_f32_16x16x32_bf16 v[84:87], v[248:251], v[44:47], v[84:87]
    v_mfma_f32_16x16x32_bf16 v[88:91], v[252:255], v[44:47], v[88:91]
    s_add_u32 s28, s38, s44
    s_nop 3
    v_cvt_pk_bf16_f32 v52, v8, v12
    v_cvt_pk_bf16_f32 v53, v9, v13
    v_cvt_pk_bf16_f32 v54, v10, v14
    v_cvt_pk_bf16_f32 v55, v11, v15
    buffer_store_dwordx4 v[52:55], v2, s[8:11], s38 offen offset:0 sc1
    v_cvt_pk_bf16_f32 v56, v16, v20
    v_cvt_pk_bf16_f32 v57, v17, v21
    v_cvt_pk_bf16_f32 v58, v18, v22
    v_cvt_pk_bf16_f32 v59, v19, v23
    buffer_store_dwordx4 v[56:59], v2, s[8:11], s38 offen offset:1024 sc1
    v_cvt_pk_bf16_f32 v60, v76, v80
    v_cvt_pk_bf16_f32 v61, v77, v81
    v_cvt_pk_bf16_f32 v62, v78, v82
    v_cvt_pk_bf16_f32 v63, v79, v83
    buffer_store_dwordx4 v[60:63], v2, s[8:11], s28 offen offset:0 sc1
    v_cvt_pk_bf16_f32 v64, v84, v88
    v_cvt_pk_bf16_f32 v65, v85, v89
    v_cvt_pk_bf16_f32 v66, v86, v90
    v_cvt_pk_bf16_f32 v67, v87, v91
    buffer_store_dwordx4 v[64:67], v2, s[8:11], s28 offen offset:1024 sc1
    s_add_u32 s38, s38, s45
    s_mov_b32 s22, 1
    s_waitcnt vmcnt(0)
    s_barrier
    buffer_store_dword v7, v6, s[8:11], s43 offen sc1
    s_add_u32 s43, s43, 4096
    s_add_u32 m0, s34, s41
    s_add_u32 s29, s35, 4096
    buffer_load_dwordx4 v2, s[8:11], s35 offen sc1 lds
    buffer_load_dwordx4 v2, s[8:11], s35 offen offset:1024 sc1 lds
    buffer_load_dwordx4 v2, s[8:11], s35 offen offset:2048 sc1 lds
    buffer_load_dwordx4 v2, s[8:11], s35 offen offset:3072 sc1 lds
    s_add_u32 m0, m0, 4096
    s_add_u32 s35, s35, 20480
    buffer_load_dwordx4 v2, s[8:11], s29 offen sc1 lds
    ds_read_b128 v[96:99], v4 offset:0
    ds_read_b128 v[100:103], v4 offset:1024
    ds_read_b128 v[104:107], v4 offset:2048
    ds_read_b128 v[108:111], v4 offset:3072
M_pj_loop:
    s_waitcnt lgkmcnt(2)
    v_mfma_f32_16x16x32_bf16 v[8:11], a[0:3], v[96:99], 0
    s_add_u32 s28, s41, 0
    v_add_u32 v5, s28, v2
    v_mfma_f32_16x16x32_bf16 v[12:15], a[4:7], v[96:99], 0
    ds_read_b128 v[112:115], v4 offset:4096
    ds_read_b128 v[116:119], v4 offset:5120
    v_mfma_f32_16x16x32_bf16 v[16:19], a[8:11], v[96:99], 0
    s_nop 1
    v_mfma_f32_16x16x32_bf16 v[20:23], a[12:15], v[96:99], 0
    v_cvt_pk_bf16_f32 v64, v76, v80
    v_cvt_pk_bf16_f32 v65, v77, v81
    v_mfma_f32_16x16x32_bf16 v[8:11], a[16:19], v[100:103], v[8:11]
    v_cvt_pk_bf16_f32 v66, v78, v82
    v_cvt_pk_bf16_f32 v67, v79, v83
    v_mfma_f32_16x16x32_bf16 v[12:15], a[20:23], v[100:103], v[12:15]
    v_cvt_pk_bf16_f32 v68, v84, v88
    v_cvt_pk_bf16_f32 v69, v85, v89
    v_mfma_f32_16x16x32_bf16 v[16:19], a[24:27], v[100:103], v[16:19]
    buffer_store_dwordx4 v[64:67], v2, s[8:11], s36 offen offset:0 sc1
    v_cvt_pk_bf16_f32 v70, v86, v90
    v_mfma_f32_16x16x32_bf16 v[20:23], a[28:31], v[100:103], v[20:23]
    s_waitcnt lgkmcnt(2)
    v_cvt_pk_bf16_f32 v71, v87, v91
    v_mfma_f32_16x16x32_bf16 v[8:11], a[32:35], v[104:107], v[8:11]
    v_mfma_f32_16x16x32_bf16 v[12:15], a[36:39], v[104:107], v[12:15]
    ds_read_b128 v[120:123], v4 offset:6144
    ds_read_b128 v[124:127], v4 offset:7168
    v_mfma_f32_16x16x32_bf16 v[16:19], a[40:43], v[104:107], v[16:19]
    buffer_store_dwordx4 v[68:71], v2, s[8:11], s36 offen offset:1024 sc1
    v_mfma_f32_16x16x32_bf16 v[20:23], a[44:47], v[104:107], v[20:23]
    v_mfma_f32_16x16x32_bf16 v[8:11], a[48:51], v[108:111], v[8:11]
    s_mov_b32 s36, s38
    s_add_u32 s38, s38, s45
    v_mfma_f32_16x16x32_bf16 v[12:15], a[52:55], v[108:111], v[12:15]
    v_mfma_f32_16x16x32_bf16 v[16:19], a[56:59], v[108:111], v[16:19]
    v_mfma_f32_16x16x32_bf16 v[20:23], a[60:63], v[108:111], v[20:23]
    s_waitcnt lgkmcnt(2)
    v_mfma_f32_16x16x32_bf16 v[8:11], a[64:67], v[112:115], v[8:11]
    v_mfma_f32_16x16x32_bf16 v[12:15], a[68:71], v[112:115], v[12:15]
    ds_read_b128 v[96:99], v4 offset:8192
    ds_read_b128 v[100:103], v4 offset:9216
    v_mfma_f32_16x16x32_bf16 v[16:19], a[72:75], v[112:115], v[16:19]
    s_lshr_b32 s47, s46, 21
    s_xor_b32 s47, s47, s53
    v_mfma_f32_16x16x32_bf16 v[20:23], a[76:79], v[112:115], v[20:23]
    s_and_b32 s47, s47, 1
    s_xor_b32 s47, s47, 1
    v_mfma_f32_16x16x32_bf16 v[8:11], a[80:83], v[116:119], v[8:11]
    s_lshl_b32 s47, s47, 13
    s_add_u32 s47, s47, s46
    v_mfma_f32_16x16x32_bf16 v[12:15], a[84:87], v[116:119], v[12:15]
    s_add_u32 s46, s46, 0x100000
    s_cmp_eq_u32 s22, 63
    v_mfma_f32_16x16x32_bf16 v[16:19], a[88:91], v[116:119], v[16:19]
    s_cselect_b32 s47, 0xe00000, s47
    v_mfma_f32_16x16x32_bf16 v[20:23], a[92:95], v[116:119], v[20:23]
    s_waitcnt lgkmcnt(2)
    v_mfma_f32_16x16x32_bf16 v[8:11], a[96:99], v[120:123], v[8:11]
    v_mfma_f32_16x16x32_bf16 v[12:15], a[100:103], v[120:123], v[12:15]
    ds_read_b128 v[104:107], v4 offset:10240
    ds_read_b128 v[108:111], v4 offset:11264
    v_mfma_f32_16x16x32_bf16 v[16:19], a[104:107], v[120:123], v[16:19]
    v_mfma_f32_16x16x32_bf16 v[20:23], a[108:111], v[120:123], v[20:23]
    v_mfma_f32_16x16x32_bf16 v[8:11], a[112:115], v[124:127], v[8:11]
    v_mfma_f32_16x16x32_bf16 v[12:15], a[116:119], v[124:127], v[12:15]
    v_mfma_f32_16x16x32_bf16 v[16:19], a[120:123], v[124:127], v[16:19]
    v_mfma_f32_16x16x32_bf16 v[20:23], a[124:127], v[124:127], v[20:23]
    s_waitcnt lgkmcnt(2)
    v_mfma_f32_16x16x32_bf16 v[8:11], a[128:131], v[96:99], v[8:11]
    v_mfma_f32_16x16x32_bf16 v[12:15], a[132:135], v[96:99], v[12:15]
    ds_read_b128 v[112:115], v4 offset:12288
    ds_read_b128 v[116:119], v4 offset:13312
    v_mfma_f32_16x16x32_bf16 v[16:19], a[136:139], v[96:99], v[16:19]
    v_mfma_f32_16x16x32_bf16 v[20:23], a[140:143], v[96:99], v[20:23]
    v_mfma_f32_16x16x32_bf16 v[8:11], a[144:147], v[100:103], v[8:11]
    v_mfma_f32_16x16x32_bf16 v[12:15], a[148:151], v[100:103], v[12:15]
    v_mfma_f32_16x16x32_bf16 v[16:19], a[152:155], v[100:103], v[16:19]
    v_mfma_f32_16x16x32_bf16 v[20:23], a[156:159], v[100:103], v[20:23]
    s_waitcnt lgkmcnt(2)
    v_mfma_f32_16x16x32_bf16 v[8:11], a[160:163], v[104:107], v[8:11]
    s_cmp_lt_u32 s22, 6
    s_cselect_b32 s49, s37, 0x9c0000
    v_mfma_f32_16x16x32_bf16 v[12:15], a[164:167], v[104:107], v[12:15]
    ds_read_b128 v[120:123], v4 offset:14336
    ds_read_b128 v[124:127], v4 offset:15360
    v_mfma_f32_16x16x32_bf16 v[16:19], a[168:171], v[104:107], v[16:19]
    v_mfma_f32_16x16x32_bf16 v[20:23], a[172:175], v[104:107], v[20:23]
    v_mfma_f32_16x16x32_bf16 v[8:11], a[176:179], v[108:111], v[8:11]
    v_mfma_f32_16x16x32_bf16 v[12:15], a[180:183], v[108:111], v[12:15]
    v_mfma_f32_16x16x32_bf16 v[16:19], a[184:187], v[108:111], v[16:19]
    v_mfma_f32_16x16x32_bf16 v[20:23], a[188:191], v[108:111], v[20:23]
    s_waitcnt lgkmcnt(2)
    v_mfma_f32_16x16x32_bf16 v[8:11], a[192:195], v[112:115], v[8:11]
    v_mfma_f32_16x16x32_bf16 v[12:15], a[196:199], v[112:115], v[12:15]
    ds_read_b128 v[96:99], v4 offset:16384
    ds_read_b128 v[100:103], v4 offset:17408
    v_mfma_f32_16x16x32_bf16 v[16:19], a[200:203], v[112:115], v[16:19]
    v_mfma_f32_16x16x32_bf16 v[20:23], a[204:207], v[112:115], v[20:23]
    v_mfma_f32_16x16x32_bf16 v[8:11], a[208:211], v[116:119], v[8:11]
    v_mfma_f32_16x16x32_bf16 v[12:15], a[212:215], v[116:119], v[12:15]
    v_mfma_f32_16x16x32_bf16 v[16:19], a[216:219], v[116:119], v[16:19]
    v_mfma_f32_16x16x32_bf16 v[20:23], a[220:223], v[116:119], v[20:23]
    s_waitcnt lgkmcnt(2)
    v_mfma_f32_16x16x32_bf16 v[8:11], a[224:227], v[120:123], v[8:11]
    v_mfma_f32_16x16x32_bf16 v[12:15], a[228:231], v[120:123], v[12:15]
    ds_read_b128 v[104:107], v4 offset:18432
    ds_read_b128 v[108:111], v4 offset:19456
    v_mfma_f32_16x16x32_bf16 v[16:19], a[232:235], v[120:123], v[16:19]
    s_cbranch_scc0 M_pj_ne
    s_waitcnt vmcnt(0)
M_pj_ne:
    v_mfma_f32_16x16x32_bf16 v[20:23], a[236:239], v[120:123], v[20:23]
    s_waitcnt vmcnt(2)
    s_barrier
    v_mfma_f32_16x16x32_bf16 v[8:11], a[240:243], v[124:127], v[8:11]
    s_add_u32 m0, s34, s42
    s_add_u32 s29, s35, 4096
    v_mfma_f32_16x16x32_bf16 v[12:15], a[244:247], v[124:127], v[12:15]
    buffer_load_dwordx4 v2, s[8:11], s35 offen offset:0 sc1 lds
    v_mfma_f32_16x16x32_bf16 v[16:19], a[248:251], v[124:127], v[16:19]
    buffer_load_dwordx4 v2, s[8:11], s35 offen offset:1024 sc1 lds
    v_mfma_f32_16x16x32_bf16 v[20:23], a[252:255], v[124:127], v[20:23]
    s_waitcnt lgkmcnt(2)
    v_mfma_f32_16x16x32_bf16 v[8:11], v[192:195], v[96:99], v[8:11]
    buffer_load_dwordx4 v2, s[8:11], s35 offen offset:2048 sc1 lds
    v_mfma_f32_16x16x32_bf16 v[12:15], v[196:199], v[96:99], v[12:15]
    ds_read_b128 v[112:115], v5 offset:0
    ds_read_b128 v[116:119], v5 offset:1024
    v_mfma_f32_16x16x32_bf16 v[16:19], v[200:203], v[96:99], v[16:19]
    buffer_load_dwordx4 v2, s[8:11], s35 offen offset:3072 sc1 lds
    v_mfma_f32_16x16x32_bf16 v[20:23], v[204:207], v[96:99], v[20:23]
    s_add_u32 m0, m0, 4096
    s_add_u32 s35, s35, 20480
    v_mfma_f32_16x16x32_bf16 v[8:11], v[208:211], v[100:103], v[8:11]
    buffer_load_dwordx4 v2, s[8:11], s29 offen sc1 lds
    v_mfma_f32_16x16x32_bf16 v[12:15], v[212:215], v[100:103], v[12:15]
    buffer_store_dword v7, v6, s[8:11], s49 offen sc1
    v_mfma_f32_16x16x32_bf16 v[16:19], v[216:219], v[100:103], v[16:19]
    buffer_store_dwordx4 v[28:31], v24, s[8:11], s47 offen sc1
    v_mfma_f32_16x16x32_bf16 v[20:23], v[220:223], v[100:103], v[20:23]
    s_waitcnt lgkmcnt(2)
    v_mfma_f32_16x16x32_bf16 v[8:11], v[224:227], v[104:107], v[8:11]
    buffer_store_dwordx4 v[28:31], v25, s[8:11], s47 offen sc1
    v_mfma_f32_16x16x32_bf16 v[12:15], v[228:231], v[104:107], v[12:15]
    ds_read_b128 v[120:123], v5 offset:2048
    ds_read_b128 v[124:127], v5 offset:3072
    v_mfma_f32_16x16x32_bf16 v[16:19], v[232:235], v[104:107], v[16:19]
    buffer_store_dwordx4 v[28:31], v26, s[8:11], s47 offen sc1
    v_mfma_f32_16x16x32_bf16 v[20:23], v[236:239], v[104:107], v[20:23]
    s_mov_b32 s28, s40
    s_mov_b32 s40, s41
    v_mfma_f32_16x16x32_bf16 v[8:11], v[240:243], v[108:111], v[8:11]
    s_mov_b32 s41, s42
    s_mov_b32 s42, s28
    v_mfma_f32_16x16x32_bf16 v[12:15], v[244:247], v[108:111], v[12:15]
    v_mfma_f32_16x16x32_bf16 v[16:19], v[248:251], v[108:111], v[16:19]
    v_mfma_f32_16x16x32_bf16 v[20:23], v[252:255], v[108:111], v[20:23]
    s_waitcnt lgkmcnt(2)
    v_mfma_f32_16x16x32_bf16 v[76:79], a[0:3], v[112:115], 0
    s_add_u32 s28, s41, 0
    v_add_u32 v4, s28, v2
    v_mfma_f32_16x16x32_bf16 v[80:83], a[4:7], v[112:115], 0
    ds_read_b128 v[96:99], v5 offset:4096
    ds_read_b128 v[100:103], v5 offset:5120
    v_mfma_f32_16x16x32_bf16 v[84:87], a[8:11], v[112:115], 0
    s_nop 1
    v_mfma_f32_16x16x32_bf16 v[88:91], a[12:15], v[112:115], 0
    v_cvt_pk_bf16_f32 v64, v8, v12
    v_cvt_pk_bf16_f32 v65, v9, v13
    v_mfma_f32_16x16x32_bf16 v[76:79], a[16:19], v[116:119], v[76:79]
    v_cvt_pk_bf16_f32 v66, v10, v14
    v_cvt_pk_bf16_f32 v67, v11, v15
    v_mfma_f32_16x16x32_bf16 v[80:83], a[20:23], v[116:119], v[80:83]
    v_cvt_pk_bf16_f32 v68, v16, v20
    v_cvt_pk_bf16_f32 v69, v17, v21
    v_mfma_f32_16x16x32_bf16 v[84:87], a[24:27], v[116:119], v[84:87]
    buffer_store_dwordx4 v[64:67], v2, s[8:11], s36 offen offset:0 sc1
    v_cvt_pk_bf16_f32 v70, v18, v22
    v_mfma_f32_16x16x32_bf16 v[88:91], a[28:31], v[116:119], v[88:91]
    s_waitcnt lgkmcnt(2)
    v_cvt_pk_bf16_f32 v71, v19, v23
    v_mfma_f32_16x16x32_bf16 v[76:79], a[32:35], v[120:123], v[76:79]
    v_mfma_f32_16x16x32_bf16 v[80:83], a[36:39], v[120:123], v[80:83]
    ds_read_b128 v[104:107], v5 offset:6144
    ds_read_b128 v[108:111], v5 offset:7168
    v_mfma_f32_16x16x32_bf16 v[84:87], a[40:43], v[120:123], v[84:87]
    buffer_store_dwordx4 v[68:71], v2, s[8:11], s36 offen offset:1024 sc1
    v_mfma_f32_16x16x32_bf16 v[88:91], a[44:47], v[120:123], v[88:91]
    v_mfma_f32_16x16x32_bf16 v[76:79], a[48:51], v[124:127], v[76:79]
    s_add_u32 s36, s36, s44
    s_add_u32 s22, s22, 1
    v_mfma_f32_16x16x32_bf16 v[80:83], a[52:55], v[124:127], v[80:83]
    v_mfma_f32_16x16x32_bf16 v[84:87], a[56:59], v[124:127], v[84:87]
    v_mfma_f32_16x16x32_bf16 v[88:91], a[60:63], v[124:127], v[88:91]
    s_waitcnt lgkmcnt(2)
    v_mfma_f32_16x16x32_bf16 v[76:79], a[64:67], v[96:99], v[76:79]
    v_mfma_f32_16x16x32_bf16 v[80:83], a[68:71], v[96:99], v[80:83]
    ds_read_b128 v[112:115], v5 offset:8192
    ds_read_b128 v[116:119], v5 offset:9216
    v_mfma_f32_16x16x32_bf16 v[84:87], a[72:75], v[96:99], v[84:87]
    v_mfma_f32_16x16x32_bf16 v[88:91], a[76:79], v[96:99], v[88:91]
    v_mfma_f32_16x16x32_bf16 v[76:79], a[80:83], v[100:103], v[76:79]
    v_mfma_f32_16x16x32_bf16 v[80:83], a[84:87], v[100:103], v[80:83]
    v_mfma_f32_16x16x32_bf16 v[84:87], a[88:91], v[100:103], v[84:87]
    v_mfma_f32_16x16x32_bf16 v[88:91], a[92:95], v[100:103], v[88:91]
    s_waitcnt lgkmcnt(2)
    v_mfma_f32_16x16x32_bf16 v[76:79], a[96:99], v[104:107], v[76:79]
    v_mfma_f32_16x16x32_bf16 v[80:83], a[100:103], v[104:107], v[80:83]
    ds_read_b128 v[120:123], v5 offset:10240
    ds_read_b128 v[124:127], v5 offset:11264
    v_mfma_f32_16x16x32_bf16 v[84:87], a[104:107], v[104:107], v[84:87]
    v_mfma_f32_16x16x32_bf16 v[88:91], a[108:111], v[104:107], v[88:91]
    v_mfma_f32_16x16x32_bf16 v[76:79], a[112:115], v[108:111], v[76:79]
    v_mfma_f32_16x16x32_bf16 v[80:83], a[116:119], v[108:111], v[80:83]
    v_mfma_f32_16x16x32_bf16 v[84:87], a[120:123], v[108:111], v[84:87]
    v_mfma_f32_16x16x32_bf16 v[88:91], a[124:127], v[108:111], v[88:91]
    s_waitcnt lgkmcnt(2)
    v_mfma_f32_16x16x32_bf16 v[76:79], a[128:131], v[112:115], v[76:79]
    v_mfma_f32_16x16x32_bf16 v[80:83], a[132:135], v[112:115], v[80:83]
    ds_read_b128 v[96:99], v5 offset:12288
    ds_read_b128 v[100:103], v5 offset:13312
    v_mfma_f32_16x16x32_bf16 v[84:87], a[136:139], v[112:115], v[84:87]
    v_mfma_f32_16x16x32_bf16 v[88:91], a[140:143], v[112:115], v[88:91]
    v_mfma_f32_16x16x32_bf16 v[76:79], a[144:147], v[116:119], v[76:79]
    v_mfma_f32_16x16x32_bf16 v[80:83], a[148:151], v[116:119], v[80:83]
    v_mfma_f32_16x16x32_bf16 v[84:87], a[152:155], v[116:119], v[84:87]
    v_mfma_f32_16x16x32_bf16 v[88:91], a[156:159], v[116:119], v[88:91]
    s_waitcnt lgkmcnt(2)
    v_mfma_f32_16x16x32_bf16 v[76:79], a[160:163], v[120:123], v[76:79]
    v_mfma_f32_16x16x32_bf16 v[80:83], a[164:167], v[120:123], v[80:83]
    ds_read_b128 v[104:107], v5 offset:14336
    ds_read_b128 v[108:111], v5 offset:15360
    v_mfma_f32_16x16x32_bf16 v[84:87], a[168:171], v[120:123], v[84:87]
    v_mfma_f32_16x16x32_bf16 v[88:91], a[172:175], v[120:123], v[88:91]
    v_mfma_f32_16x16x32_bf16 v[76:79], a[176:179], v[124:127], v[76:79]
    v_mfma_f32_16x16x32_bf16 v[80:83], a[180:183], v[124:127], v[80:83]
    v_mfma_f32_16x16x32_bf16 v[84:87], a[184:187], v[124:127], v[84:87]
    v_mfma_f32_16x16x32_bf16 v[88:91], a[188:191], v[124:127], v[88:91]
    s_waitcnt lgkmcnt(2)
    v_mfma_f32_16x16x32_bf16 v[76:79], a[192:195], v[96:99], v[76:79]
    v_mfma_f32_16x16x32_bf16 v[80:83], a[196:199], v[96:99], v[80:83]
    ds_read_b128 v[112:115], v5 offset:16384
    ds_read_b128 v[116:119], v5 offset:17408
    v_mfma_f32_16x16x32_bf16 v[84:87], a[200:203], v[96:99], v[84:87]
    v_mfma_f32_16x16x32_bf16 v[88:91], a[204:207], v[96:99], v[88:91]
    v_mfma_f32_16x16x32_bf16 v[76:79], a[208:211], v[100:103], v[76:79]
    v_mfma_f32_16x16x32_bf16 v[80:83], a[212:215], v[100:103], v[80:83]
    v_mfma_f32_16x16x32_bf16 v[84:87], a[216:219], v[100:103], v[84:87]
    v_mfma_f32_16x16x32_bf16 v[88:91], a[220:223], v[100:103], v[88:91]
    s_waitcnt lgkmcnt(2)
    v_mfma_f32_16x16x32_bf16 v[76:79], a[224:227], v[104:107], v[76:79]
    v_mfma_f32_16x16x32_bf16 v[80:83], a[228:231], v[104:107], v[80:83]
    ds_read_b128 v[120:123], v5 offset:18432
    ds_read_b128 v[124:127], v5 offset:19456
    v_mfma_f32_16x16x32_bf16 v[84:87], a[232:235], v[104:107], v[84:87]
    s_waitcnt vmcnt(6)
    s_barrier
    v_mfma_f32_16x16x32_bf16 v[88:91], a[236:239], v[104:107], v[88:91]
    s_add_u32 m0, s34, s42
    s_add_u32 s29, s35, 4096
    v_mfma_f32_16x16x32_bf16 v[76:79], a[240:243], v[108:111], v[76:79]
    buffer_load_dwordx4 v2, s[8:11], s35 offen offset:0 sc1 lds
    v_mfma_f32_16x16x32_bf16 v[80:83], a[244:247], v[108:111], v[80:83]
    v_mfma_f32_16x16x32_bf16 v[84:87], a[248:251], v[108:111], v[84:87]
    buffer_load_dwordx4 v2, s[8:11], s35 offen offset:1024 sc1 lds
    v_mfma_f32_16x16x32_bf16 v[88:91], a[252:255], v[108:111], v[88:91]
    s_waitcnt lgkmcnt(2)
    v_mfma_f32_16x16x32_bf16 v[76:79], v[192:195], v[112:115], v[76:79]
    buffer_load_dwordx4 v2, s[8:11], s35 offen offset:2048 sc1 lds
    v_mfma_f32_16x16x32_bf16 v[80:83], v[196:199], v[112:115], v[80:83]
    ds_read_b128 v[96:99], v4 offset:0
    ds_read_b128 v[100:103], v4 offset:1024
    v_mfma_f32_16x16x32_bf16 v[84:87], v[200:203], v[112:115], v[84:87]
    buffer_load_dwordx4 v2, s[8:11], s35 offen offset:3072 sc1 lds
    v_mfma_f32_16x16x32_bf16 v[88:91], v[204:207], v[112:115], v[88:91]
    s_add_u32 m0, m0, 4096
    s_add_u32 s35, s35, 20480
    v_mfma_f32_16x16x32_bf16 v[76:79], v[208:211], v[116:119], v[76:79]
    buffer_load_dwordx4 v2, s[8:11], s29 offen sc1 lds
    v_mfma_f32_16x16x32_bf16 v[80:83], v[212:215], v[116:119], v[80:83]
    v_mfma_f32_16x16x32_bf16 v[84:87], v[216:219], v[116:119], v[84:87]
    buffer_store_dword v7, v6, s[8:11], s37 offen sc1
    v_mfma_f32_16x16x32_bf16 v[88:91], v[220:223], v[116:119], v[88:91]
    s_waitcnt lgkmcnt(2)
    v_mfma_f32_16x16x32_bf16 v[76:79], v[224:227], v[120:123], v[76:79]
    s_mov_b32 s37, s43
    s_add_u32 s43, s43, 4096
    v_mfma_f32_16x16x32_bf16 v[80:83], v[228:231], v[120:123], v[80:83]
    ds_read_b128 v[104:107], v4 offset:2048
    ds_read_b128 v[108:111], v4 offset:3072
    v_mfma_f32_16x16x32_bf16 v[84:87], v[232:235], v[120:123], v[84:87]
    v_mfma_f32_16x16x32_bf16 v[88:91], v[236:239], v[120:123], v[88:91]
    s_mov_b32 s28, s40
    s_mov_b32 s40, s41
    v_mfma_f32_16x16x32_bf16 v[76:79], v[240:243], v[124:127], v[76:79]
    s_mov_b32 s41, s42
    s_mov_b32 s42, s28
    v_mfma_f32_16x16x32_bf16 v[80:83], v[244:247], v[124:127], v[80:83]
    v_mfma_f32_16x16x32_bf16 v[84:87], v[248:251], v[124:127], v[84:87]
    s_cmp_lt_u32 s22, 64
    v_mfma_f32_16x16x32_bf16 v[88:91], v[252:255], v[124:127], v[88:91]
    s_cbranch_scc1 M_pj_loop
    s_waitcnt lgkmcnt(0)
    s_nop 3
    v_cvt_pk_bf16_f32 v64, v76, v80
    v_cvt_pk_bf16_f32 v65, v77, v81
    v_cvt_pk_bf16_f32 v66, v78, v82
    v_cvt_pk_bf16_f32 v67, v79, v83
    v_cvt_pk_bf16_f32 v68, v84, v88
    v_cvt_pk_bf16_f32 v69, v85, v89
    v_cvt_pk_bf16_f32 v70, v86, v90
    v_cvt_pk_bf16_f32 v71, v87, v91
    buffer_store_dwordx4 v[64:67], v2, s[8:11], s36 offen offset:0 sc1
    buffer_store_dwordx4 v[68:71], v2, s[8:11], s36 offen offset:1024 sc1
    s_waitcnt vmcnt(0)
    s_barrier
    buffer_store_dword v7, v6, s[8:11], s37 offen sc1
    s_branch M_g2
M_g2:
    s_sub_u32 s27, s25, 96
    s_mov_b32 s26, 1
M_g2a:
    s_load_dwordx2 s[28:29], s[0:1], 72
    s_waitcnt lgkmcnt(0)
    s_mov_b32 s12, s28
    s_and_b32 s13, s29, 0xffff
    s_mov_b32 s14, 0x800000
    s_mov_b32 s15, 0x20000
    v_lshlrev_b32 v2, 4, v1
    s_lshl_b32 s31, s21, 14
    s_lshl_b32 s30, s27, 16
    s_add_u32 s30, s30, s31
    s_lshl_b32 s28, s21, 6
    v_xor_b32 v4, s28, v2
    s_add_u32 s28, s28, 16
    v_xor_b32 v5, s28, v2
    s_add_u32 s28, s28, 16
    v_xor_b32 v6, s28, v2
    s_add_u32 s28, s28, 16
    v_xor_b32 v7, s28, v2
    s_add_u32 s28, s28, 16
    v_and_b32 v8, 15, v1
    v_lshrrev_b32 v9, 4, v1
    v_xor_b32 v9, v9, v8
    v_lshlrev_b32 v9, 4, v9
    v_lshl_add_u32 v9, v8, 12, v9
    s_lshl_b32 s28, s21, 10
    v_add_u32 v10, s28, v9
    v_xor_b32 v11, 64, v10
    v_xor_b32 v12, 128, v10
    v_xor_b32 v13, 192, v10
    s_mov_b32 s32, s27
    s_add_u32 s35, s32, s26
    s_add_u32 m0, s31, 0
    s_add_u32 s28, s30, 0
    buffer_load_dwordx4 v4, s[12:15], s28 offen offset:0 nt lds
    buffer_load_dwordx4 v4, s[12:15], s28 offen offset:1024 nt lds
    buffer_load_dwordx4 v4, s[12:15], s28 offen offset:2048 nt lds
    buffer_load_dwordx4 v4, s[12:15], s28 offen offset:3072 nt lds
    s_add_u32 m0, s31, 4096
    s_add_u32 s28, s30, 4096
    buffer_load_dwordx4 v5, s[12:15], s28 offen offset:0 nt lds
    buffer_load_dwordx4 v5, s[12:15], s28 offen offset:1024 nt lds
    buffer_load_dwordx4 v5, s[12:15], s28 offen offset:2048 nt lds
    buffer_load_dwordx4 v5, s[12:15], s28 offen offset:3072 nt lds
    s_add_u32 m0, s31, 8192
    s_add_u32 s28, s30, 8192
    buffer_load_dwordx4 v6, s[12:15], s28 offen offset:0 nt lds
    buffer_load_dwordx4 v6, s[12:15], s28 offen offset:1024 nt lds
    buffer_load_dwordx4 v6, s[12:15], s28 offen offset:2048 nt lds
    buffer_load_dwordx4 v6, s[12:15], s28 offen offset:3072 nt lds
    s_add_u32 m0, s31, 12288
    s_add_u32 s28, s30, 12288
    buffer_load_dwordx4 v7, s[12:15], s28 offen offset:0 nt lds
    buffer_load_dwordx4 v7, s[12:15], s28 offen offset:1024 nt lds
    buffer_load_dwordx4 v7, s[12:15], s28 offen offset:2048 nt lds
    buffer_load_dwordx4 v7, s[12:15], s28 offen offset:3072 nt lds
    s_xor_b32 s31, s31, 65536
    s_add_u32 s30, s30, 65536
    s_and_b32 s30, s30, 0x7fffff
    s_waitcnt vmcnt(0)
M_wt1_loop:
    s_barrier
    ds_read_b128 v[16:19], v10 offset:0
    ds_read_b128 v[20:23], v11 offset:0
    ds_read_b128 v[24:27], v12 offset:0
    ds_read_b128 v[28:31], v13 offset:0
    ds_read_b128 v[32:35], v10 offset:256
    ds_read_b128 v[36:39], v11 offset:256
    ds_read_b128 v[40:43], v12 offset:256
    ds_read_b128 v[44:47], v13 offset:256
    ds_read_b128 v[48:51], v10 offset:512
    ds_read_b128 v[52:55], v11 offset:512
    ds_read_b128 v[56:59], v12 offset:512
    ds_read_b128 v[60:63], v13 offset:512
    ds_read_b128 v[64:67], v10 offset:768
    ds_read_b128 v[68:71], v11 offset:768
    ds_read_b128 v[72:75], v12 offset:768
    ds_read_b128 v[76:79], v13 offset:768
    s_lshr_b32 s28, s32, 1
    s_lshl_b32 s33, s28, 20
    s_and_b32 s28, s28, 15
    s_lshl_b32 s28, s28, 11
    s_add_u32 s33, s33, s28
    s_and_b32 s28, s32, 1
    s_mul_i32 s28, s28, 66560
    s_add_u32 s33, s33, s28
    s_lshl_b32 s28, s21, 14
    s_add_u32 s33, s33, s28
    s_add_u32 s33, s33, 0xc0d0000
    v_xor_b32 v10, 65536, v10
    v_xor_b32 v11, 65536, v11
    v_xor_b32 v12, 65536, v12
    v_xor_b32 v13, 65536, v13
    s_waitcnt lgkmcnt(0)
    buffer_store_dwordx4 v[16:19], v2, s[8:11], s33 offen offset:0 sc1
    buffer_store_dwordx4 v[20:23], v2, s[8:11], s33 offen offset:1024 sc1
    buffer_store_dwordx4 v[24:27], v2, s[8:11], s33 offen offset:2048 sc1
    buffer_store_dwordx4 v[28:31], v2, s[8:11], s33 offen offset:3072 sc1
    s_add_u32 s33, s33, 4096
    buffer_store_dwordx4 v[32:35], v2, s[8:11], s33 offen offset:0 sc1
    buffer_store_dwordx4 v[36:39], v2, s[8:11], s33 offen offset:1024 sc1
    buffer_store_dwordx4 v[40:43], v2, s[8:11], s33 offen offset:2048 sc1
    buffer_store_dwordx4 v[44:47], v2, s[8:11], s33 offen offset:3072 sc1
    s_add_u32 s33, s33, 4096
    buffer_store_dwordx4 v[48:51], v2, s[8:11], s33 offen offset:0 sc1
    buffer_store_dwordx4 v[52:55], v2, s[8:11], s33 offen offset:1024 sc1
    buffer_store_dwordx4 v[56:59], v2, s[8:11], s33 offen offset:2048 sc1
    buffer_store_dwordx4 v[60:63], v2, s[8:11], s33 offen offset:3072 sc1
    s_add_u32 s33, s33, 4096
    buffer_store_dwordx4 v[64:67], v2, s[8:11], s33 offen offset:0 sc1
    buffer_store_dwordx4 v[68:71], v2, s[8:11], s33 offen offset:1024 sc1
    buffer_store_dwordx4 v[72:75], v2, s[8:11], s33 offen offset:2048 sc1
    buffer_store_dwordx4 v[76:79], v2, s[8:11], s33 offen offset:3072 sc1
    s_add_u32 s33, s33, 4096
    s_add_u32 s32, s32, 1
    s_cmp_lt_u32 s32, s35
    s_waitcnt vmcnt(32)
    s_cbranch_scc1 M_wt1_loop
    v_mov_b32 v6, 0x7ff00000
    v_lshlrev_b32 v7, 7, v0
    v_cmp_gt_u32 vcc, s26, v0
    s_lshl_b32 s28, s27, 7
    s_add_u32 s28, s28, 0x9a8000
    v_cndmask_b32 v6, v6, v7, vcc
    v_mov_b32 v7, 1
    s_waitcnt vmcnt(0)
    s_barrier
    buffer_store_dword v7, v6, s[8:11], s28 offen sc1
    s_branch M_g2b
M_g2b:
    s_add_u32 s27, s27, 32
    s_sub_u32 s28, s27, 96
    s_cmp_lt_u32 s28, 32
    s_cbranch_scc1 M_g2a
    s_sub_u32 s20, s25, 128
    s_load_dwordx2 s[28:29], s[0:1], 80
    s_waitcnt lgkmcnt(0)
    s_mov_b32 s12, s28
    s_and_b32 s13, s29, 0xffff
    s_mov_b32 s14, 0x1000
    s_mov_b32 s15, 0x20000
    s_and_b32 s30, s20, 3
    s_lshl_b32 s30, s30, 2
    s_bfe_u32 s31, s20, 0x20002
    s_add_u32 s30, s30, s31
    s_lshr_b32 s31, s20, 4
    s_lshr_b32 s32, s21, 1
    s_and_b32 s33, s21, 1
    v_and_b32 v10, 15, v1
    v_lshlrev_b32 v10, 1, v10
    s_lshl_b32 s28, s30, 8
    s_lshl_b32 s29, s32, 7
    s_add_u32 s28, s28, s29
    buffer_load_ushort v16, v10, s[12:15], s28 offen offset:0
    buffer_load_ushort v17, v10, s[12:15], s28 offen offset:32
    buffer_load_ushort v18, v10, s[12:15], s28 offen offset:64
    buffer_load_ushort v19, v10, s[12:15], s28 offen offset:96
    s_add_u32 s28, s31, 4
    s_lshl_b32 s28, s28, 14
    s_add_u32 s28, s28, s56
    v_lshlrev_b32 v3, 7, v1
    v_add_u32 v3, s28, v3
    s_add_u32 s49, s28, 0x987f00
    v_mov_b32 v9, 0x7ff00000
    v_cmp_gt_u32 vcc, 62, v1
    s_lshl_b32 s28, s32, 13
    v_add_u32 v4, s28, v2
    v_cndmask_b32 v3, v9, v3, vcc
    s_mul_i32 s28, s33, 6144
    s_add_u32 s28, s28, 16384
    v_add_u32 v5, s28, v2
    s_lshl_b32 s36, s21, 12
    s_lshl_b32 s28, s30, 2
    s_add_u32 s28, s28, s21
    s_lshl_b32 s42, s28, 8
    s_add_u32 s42, s42, 0x9a8000
    s_lshl_b32 s34, s28, 20
    s_and_b32 s28, s28, 15
    s_lshl_b32 s28, s28, 11
    s_add_u32 s34, s34, s28
    s_add_u32 s34, s34, 0xc0d0000
    v_add_u32 v12, 64512, v2
    s_mul_i32 s37, s21, 6144
    s_add_u32 s37, s37, 16384
    s_mul_i32 s35, s31, 12288
    s_mul_i32 s28, s32, 49152
    s_add_u32 s35, s35, s28
    s_mul_i32 s28, s33, 6144
    s_add_u32 s35, s35, s28
    s_add_u32 s35, s35, 0xb800000
    s_mov_b32 s38, 0x986000
    v_mov_b32 v8, 0
    v_and_b32 v9, 1, v1
    v_lshlrev_b32 v9, 7, v9
    s_mov_b32 s39, 0
M_g2p_fw:
    buffer_load_dword v11, v9, s[8:11], s42 offen sc1
    s_add_u32 s39, s39, 1
    s_cmp_gt_u32 s39, 400000
    s_cbranch_scc1 M_fail
    s_waitcnt vmcnt(0)
    v_cmp_eq_u32 vcc, 0, v11
    s_cbranch_vccz M_g2p_fw_ok
    s_sleep 4
    s_branch M_g2p_fw
M_g2p_fw_ok:
    v_lshlrev_b32 v16, 16, v16
    v_mov_b32 v64, v16
    v_mov_b32 v65, v16
    v_mov_b32 v66, v16
    v_mov_b32 v67, v16
    v_mov_b32 v68, v16
    v_mov_b32 v69, v16
    v_mov_b32 v70, v16
    v_mov_b32 v71, v16
    v_mov_b32 v72, v16
    v_mov_b32 v73, v16
    v_mov_b32 v74, v16
    v_mov_b32 v75, v16
    v_mov_b32 v76, v16
    v_mov_b32 v77, v16
    v_mov_b32 v78, v16
    v_mov_b32 v79, v16
    v_mov_b32 v80, v16
    v_mov_b32 v81, v16
    v_mov_b32 v82, v16
    v_mov_b32 v83, v16
    v_mov_b32 v84, v16
    v_mov_b32 v85, v16
    v_mov_b32 v86, v16
    v_mov_b32 v87, v16
    v_lshlrev_b32 v17, 16, v17
    v_mov_b32 v88, v17
    v_mov_b32 v89, v17
    v_mov_b32 v90, v17
    v_mov_b32 v91, v17
    v_mov_b32 v92, v17
    v_mov_b32 v93, v17
    v_mov_b32 v94, v17
    v_mov_b32 v95, v17
    v_mov_b32 v96, v17
    v_mov_b32 v97, v17
    v_mov_b32 v98, v17
    v_mov_b32 v99, v17
    v_mov_b32 v100, v17
    v_mov_b32 v101, v17
    v_mov_b32 v102, v17
    v_mov_b32 v103, v17
    v_mov_b32 v104, v17
    v_mov_b32 v105, v17
    v_mov_b32 v106, v17
    v_mov_b32 v107, v17
    v_mov_b32 v108, v17
    v_mov_b32 v109, v17
    v_mov_b32 v110, v17
    v_mov_b32 v111, v17
    v_lshlrev_b32 v18, 16, v18
    v_mov_b32 v112, v18
    v_mov_b32 v113, v18
    v_mov_b32 v114, v18
    v_mov_b32 v115, v18
    v_mov_b32 v116, v18
    v_mov_b32 v117, v18
    v_mov_b32 v118, v18
    v_mov_b32 v119, v18
    v_mov_b32 v120, v18
    v_mov_b32 v121, v18
    v_mov_b32 v122, v18
    v_mov_b32 v123, v18
    v_mov_b32 v124, v18
    v_mov_b32 v125, v18
    v_mov_b32 v126, v18
    v_mov_b32 v127, v18
    v_mov_b32 v128, v18
    v_mov_b32 v129, v18
    v_mov_b32 v130, v18
    v_mov_b32 v131, v18
    v_mov_b32 v132, v18
    v_mov_b32 v133, v18
    v_mov_b32 v134, v18
    v_mov_b32 v135, v18
    v_lshlrev_b32 v19, 16, v19
    v_mov_b32 v136, v19
    v_mov_b32 v137, v19
    v_mov_b32 v138, v19
    v_mov_b32 v139, v19
    v_mov_b32 v140, v19
    v_mov_b32 v141, v19
    v_mov_b32 v142, v19
    v_mov_b32 v143, v19
    v_mov_b32 v144, v19
    v_mov_b32 v145, v19
    v_mov_b32 v146, v19
    v_mov_b32 v147, v19
    v_mov_b32 v148, v19
    v_mov_b32 v149, v19
    v_mov_b32 v150, v19
    v_mov_b32 v151, v19
    v_mov_b32 v152, v19
    v_mov_b32 v153, v19
    v_mov_b32 v154, v19
    v_mov_b32 v155, v19
    v_mov_b32 v156, v19
    v_mov_b32 v157, v19
    v_mov_b32 v158, v19
    v_mov_b32 v159, v19
    s_mov_b32 s40, 0
    s_mov_b32 s22, -1
    s_barrier
    s_lshl_b32 s28, s30, 2
    s_lshl_b32 s29, s32, 1
    s_add_u32 s28, s28, s29
    s_lshl_b32 s42, s31, 7
    s_add_u32 s42, s42, s28
    s_lshl_b32 s42, s42, 7
    s_add_u32 s42, s42, 0x986000
    s_add_u32 s42, s42, s56
    s_mul_i32 s43, s28, 49152
    s_lshl_b32 s29, s28, 20
    s_and_b32 s28, s28, 15
    s_lshl_b32 s28, s28, 11
    s_add_u32 s29, s29, s28
    s_add_u32 s29, s29, 0xc0df800
    s_mul_i32 s28, s31, 6144
    s_add_u32 s43, s43, s28
    s_mul_i32 s28, s33, 3072
    s_add_u32 s43, s43, s28
    s_add_u32 s57, s43, 0xb400000
    s_add_u32 s43, s43, 0xbc00000
    v_lshlrev_b32 v10, 3, v1
    s_mov_b32 s54, 0xffff0000
    s_add_u32 s28, s29, 0
    buffer_load_dwordx4 a[160:163], v2, s[8:11], s28 offen offset:0 sc1
    buffer_load_dwordx4 a[164:167], v2, s[8:11], s28 offen offset:1024 sc1
    s_add_u32 s28, s29, 66560
    buffer_load_dwordx4 a[168:171], v2, s[8:11], s28 offen offset:0 sc1
    buffer_load_dwordx4 a[172:175], v2, s[8:11], s28 offen offset:1024 sc1
    s_add_u32 s28, s29, 1050624
    buffer_load_dwordx4 a[176:179], v2, s[8:11], s28 offen offset:0 sc1
    buffer_load_dwordx4 a[180:183], v2, s[8:11], s28 offen offset:1024 sc1
    s_add_u32 s28, s29, 1117184
    buffer_load_dwordx4 a[184:187], v2, s[8:11], s28 offen offset:0 sc1
    buffer_load_dwordx4 a[188:191], v2, s[8:11], s28 offen offset:1024 sc1
    s_mov_b32 s48, 0
    s_branch M_g2p_late0
M_g2p_it0:
    s_waitcnt lgkmcnt(15)
    v_mfma_f32_16x16x32_bf16 v[64:67], a[0:3], a[24:27], v[64:67]
    v_mfma_f32_16x16x32_bf16 v[68:71], a[4:7], a[24:27], v[68:71]
    v_cmp_ne_u32 s[44:45], 0, v8
    v_mfma_f32_16x16x32_bf16 v[72:75], a[8:11], a[24:27], v[72:75]
    s_add_u32 s29, s22, 1
    s_and_b32 s29, s29, 3
    v_mfma_f32_16x16x32_bf16 v[76:79], a[12:15], a[24:27], v[76:79]
    s_waitcnt lgkmcnt(13)
    v_mfma_f32_16x16x32_bf16 v[80:83], a[16:19], a[24:27], v[80:83]
    s_mul_i32 s29, s29, 40960
    v_add_u32 v6, s29, v4
    v_mfma_f32_16x16x32_bf16 v[84:87], a[20:23], a[24:27], v[84:87]
    s_waitcnt lgkmcnt(12)
    v_mfma_f32_16x16x32_bf16 v[88:91], a[0:3], a[28:31], v[88:91]
    s_sub_u32 s41, s40, s22
    v_add_u32 v7, s29, v5
    v_mfma_f32_16x16x32_bf16 v[92:95], a[4:7], a[28:31], v[92:95]
    s_lshl_b32 s46, s40, 1
    s_add_u32 s46, s46, s32
    v_mfma_f32_16x16x32_bf16 v[96:99], a[8:11], a[28:31], v[96:99]
    s_nop 0
    s_lshr_b64 s[44:45], s[44:45], s46
    v_mfma_f32_16x16x32_bf16 v[100:103], a[12:15], a[28:31], v[100:103]
    s_nop 0
    s_nop 0
    v_mfma_f32_16x16x32_bf16 v[104:107], a[16:19], a[28:31], v[104:107]
    s_cmp_lt_u32 s41, 4
    s_cselect_b32 s46, 5, 1
    v_mfma_f32_16x16x32_bf16 v[108:111], a[20:23], a[28:31], v[108:111]
    s_waitcnt lgkmcnt(0)
    v_mfma_f32_16x16x32_bf16 v[112:115], a[0:3], a[32:35], v[112:115]
    s_and_b32 s44, s44, s46
    s_cmp_eq_u32 s41, 4
    v_mfma_f32_16x16x32_bf16 v[116:119], a[4:7], a[32:35], v[116:119]
    s_cbranch_scc0 M_g2p_n00
    s_waitcnt vmcnt(22)
M_g2p_n10:
    v_mfma_f32_16x16x32_bf16 v[120:123], a[8:11], a[32:35], v[120:123]
    s_barrier
    s_cmp_eq_u32 s44, 1
    v_mfma_f32_16x16x32_bf16 v[124:127], a[12:15], a[32:35], v[124:127]
    s_cbranch_scc0 M_g2p_bd0
    v_mfma_f32_16x16x32_bf16 v[128:131], a[16:19], a[32:35], v[128:131]
    ds_read_b128 a[80:83], v7 offset:0
    ds_read_b128 a[104:107], v6 offset:0
    v_mfma_f32_16x16x32_bf16 v[132:135], a[20:23], a[32:35], v[132:135]
    ds_read_b128 a[84:87], v7 offset:1024
    ds_read_b128 a[88:91], v7 offset:2048
    v_mfma_f32_16x16x32_bf16 v[136:139], a[0:3], a[36:39], v[136:139]
    ds_read_b128 a[92:95], v7 offset:3072
    ds_read_b128 a[96:99], v7 offset:4096
    v_mfma_f32_16x16x32_bf16 v[140:143], a[4:7], a[36:39], v[140:143]
    ds_read_b128 a[100:103], v7 offset:5120
    ds_read_b128 a[108:111], v6 offset:2048
    v_mfma_f32_16x16x32_bf16 v[144:147], a[8:11], a[36:39], v[144:147]
    ds_read_b128 a[112:115], v6 offset:4096
    ds_read_b128 a[116:119], v6 offset:6144
    v_mfma_f32_16x16x32_bf16 v[148:151], a[12:15], a[36:39], v[148:151]
    ds_read_b128 a[120:123], v7 offset:12288
    ds_read_b128 a[144:147], v6 offset:1024
    v_mfma_f32_16x16x32_bf16 v[152:155], a[16:19], a[36:39], v[152:155]
    ds_read_b128 a[124:127], v7 offset:13312
    ds_read_b128 a[128:131], v7 offset:14336
    v_mfma_f32_16x16x32_bf16 v[156:159], a[20:23], a[36:39], v[156:159]
    ds_read_b128 a[132:135], v7 offset:15360
    ds_read_b128 a[136:139], v7 offset:16384
    v_mfma_f32_16x16x32_bf16 v[64:67], a[40:43], a[64:67], v[64:67]
    ds_read_b128 a[140:143], v7 offset:17408
    ds_read_b128 a[148:151], v6 offset:3072
    v_mfma_f32_16x16x32_bf16 v[68:71], a[44:47], a[64:67], v[68:71]
    ds_read_b128 a[152:155], v6 offset:5120
    ds_read_b128 a[156:159], v6 offset:7168
    v_mfma_f32_16x16x32_bf16 v[72:75], a[48:51], a[64:67], v[72:75]
    s_and_b32 s28, s40, 3
    s_mul_i32 s28, s28, 40960
    v_mfma_f32_16x16x32_bf16 v[76:79], a[52:55], a[64:67], v[76:79]
    s_add_u32 m0, s28, s36
    s_add_u32 s40, s40, 1
    v_mfma_f32_16x16x32_bf16 v[80:83], a[56:59], a[64:67], v[80:83]
    buffer_load_dwordx4 v2, s[8:11], s34 offen offset:0 sc1 lds
    v_mfma_f32_16x16x32_bf16 v[84:87], a[60:63], a[64:67], v[84:87]
    buffer_load_dwordx4 v2, s[8:11], s34 offen offset:1024 sc1 lds
    v_mfma_f32_16x16x32_bf16 v[88:91], a[40:43], a[68:71], v[88:91]
    buffer_load_dwordx4 v12, s[8:11], s34 offen offset:2048 sc1 lds
    v_mfma_f32_16x16x32_bf16 v[92:95], a[44:47], a[68:71], v[92:95]
    buffer_load_dwordx4 v12, s[8:11], s34 offen offset:3072 sc1 lds
    v_mfma_f32_16x16x32_bf16 v[96:99], a[48:51], a[68:71], v[96:99]
    s_add_u32 m0, s28, s37
    s_add_u32 s34, s34, 2048
    v_mfma_f32_16x16x32_bf16 v[100:103], a[52:55], a[68:71], v[100:103]
    buffer_load_dwordx4 v2, s[8:11], s35 offen offset:0 sc1 lds
    v_mfma_f32_16x16x32_bf16 v[104:107], a[56:59], a[68:71], v[104:107]
    buffer_load_dwordx4 v2, s[8:11], s35 offen offset:1024 sc1 lds
    v_mfma_f32_16x16x32_bf16 v[108:111], a[60:63], a[68:71], v[108:111]
    buffer_load_dwordx4 v2, s[8:11], s35 offen offset:2048 sc1 lds
    v_mfma_f32_16x16x32_bf16 v[112:115], a[40:43], a[72:75], v[112:115]
    s_add_u32 m0, m0, 3072
    s_add_u32 s35, s35, 3072
    v_mfma_f32_16x16x32_bf16 v[116:119], a[44:47], a[72:75], v[116:119]
    buffer_load_dwordx4 v2, s[8:11], s35 offen offset:0 sc1 lds
    v_mfma_f32_16x16x32_bf16 v[120:123], a[48:51], a[72:75], v[120:123]
    buffer_load_dwordx4 v2, s[8:11], s35 offen offset:1024 sc1 lds
    v_mfma_f32_16x16x32_bf16 v[124:127], a[52:55], a[72:75], v[124:127]
    buffer_load_dwordx4 v2, s[8:11], s35 offen offset:2048 sc1 lds
    v_mfma_f32_16x16x32_bf16 v[128:131], a[56:59], a[72:75], v[128:131]
    buffer_load_dword v8, v3, s[8:11], s38 offen sc1
    s_add_u32 s35, s35, 95232
    v_mfma_f32_16x16x32_bf16 v[132:135], a[60:63], a[72:75], v[132:135]
    v_mfma_f32_16x16x32_bf16 v[136:139], a[40:43], a[76:79], v[136:139]
    v_mfma_f32_16x16x32_bf16 v[140:143], a[44:47], a[76:79], v[140:143]
    v_mfma_f32_16x16x32_bf16 v[144:147], a[48:51], a[76:79], v[144:147]
    v_mfma_f32_16x16x32_bf16 v[148:151], a[52:55], a[76:79], v[148:151]
    v_mfma_f32_16x16x32_bf16 v[152:155], a[56:59], a[76:79], v[152:155]
    s_add_u32 s22, s22, 1
    v_mfma_f32_16x16x32_bf16 v[156:159], a[60:63], a[76:79], v[156:159]
    s_branch M_g2p_it1
M_g2p_bd0:
    s_cmp_eq_u32 s44, 5
    s_cbranch_scc1 M_g2p_d0
    v_mfma_f32_16x16x32_bf16 v[128:131], a[16:19], a[32:35], v[128:131]
    ds_read_b128 a[80:83], v7 offset:0
    ds_read_b128 a[104:107], v6 offset:0
    v_mfma_f32_16x16x32_bf16 v[132:135], a[20:23], a[32:35], v[132:135]
    ds_read_b128 a[84:87], v7 offset:1024
    ds_read_b128 a[88:91], v7 offset:2048
    v_mfma_f32_16x16x32_bf16 v[136:139], a[0:3], a[36:39], v[136:139]
    ds_read_b128 a[92:95], v7 offset:3072
    ds_read_b128 a[96:99], v7 offset:4096
    v_mfma_f32_16x16x32_bf16 v[140:143], a[4:7], a[36:39], v[140:143]
    ds_read_b128 a[100:103], v7 offset:5120
    ds_read_b128 a[108:111], v6 offset:2048
    v_mfma_f32_16x16x32_bf16 v[144:147], a[8:11], a[36:39], v[144:147]
    ds_read_b128 a[112:115], v6 offset:4096
    ds_read_b128 a[116:119], v6 offset:6144
    v_mfma_f32_16x16x32_bf16 v[148:151], a[12:15], a[36:39], v[148:151]
    ds_read_b128 a[120:123], v7 offset:12288
    ds_read_b128 a[144:147], v6 offset:1024
    v_mfma_f32_16x16x32_bf16 v[152:155], a[16:19], a[36:39], v[152:155]
    ds_read_b128 a[124:127], v7 offset:13312
    ds_read_b128 a[128:131], v7 offset:14336
    v_mfma_f32_16x16x32_bf16 v[156:159], a[20:23], a[36:39], v[156:159]
    ds_read_b128 a[132:135], v7 offset:15360
    ds_read_b128 a[136:139], v7 offset:16384
    v_mfma_f32_16x16x32_bf16 v[64:67], a[40:43], a[64:67], v[64:67]
    ds_read_b128 a[140:143], v7 offset:17408
    ds_read_b128 a[148:151], v6 offset:3072
    v_mfma_f32_16x16x32_bf16 v[68:71], a[44:47], a[64:67], v[68:71]
    ds_read_b128 a[152:155], v6 offset:5120
    ds_read_b128 a[156:159], v6 offset:7168
    v_mfma_f32_16x16x32_bf16 v[72:75], a[48:51], a[64:67], v[72:75]
    buffer_load_dword v8, v3, s[8:11], s38 offen sc1
    v_mfma_f32_16x16x32_bf16 v[76:79], a[52:55], a[64:67], v[76:79]
    v_mfma_f32_16x16x32_bf16 v[80:83], a[56:59], a[64:67], v[80:83]
    v_mfma_f32_16x16x32_bf16 v[84:87], a[60:63], a[64:67], v[84:87]
    v_mfma_f32_16x16x32_bf16 v[88:91], a[40:43], a[68:71], v[88:91]
    v_mfma_f32_16x16x32_bf16 v[92:95], a[44:47], a[68:71], v[92:95]
    v_mfma_f32_16x16x32_bf16 v[96:99], a[48:51], a[68:71], v[96:99]
    v_mfma_f32_16x16x32_bf16 v[100:103], a[52:55], a[68:71], v[100:103]
    v_mfma_f32_16x16x32_bf16 v[104:107], a[56:59], a[68:71], v[104:107]
    v_mfma_f32_16x16x32_bf16 v[108:111], a[60:63], a[68:71], v[108:111]
    v_mfma_f32_16x16x32_bf16 v[112:115], a[40:43], a[72:75], v[112:115]
    v_mfma_f32_16x16x32_bf16 v[116:119], a[44:47], a[72:75], v[116:119]
    v_mfma_f32_16x16x32_bf16 v[120:123], a[48:51], a[72:75], v[120:123]
    v_mfma_f32_16x16x32_bf16 v[124:127], a[52:55], a[72:75], v[124:127]
    v_mfma_f32_16x16x32_bf16 v[128:131], a[56:59], a[72:75], v[128:131]
    v_mfma_f32_16x16x32_bf16 v[132:135], a[60:63], a[72:75], v[132:135]
    v_mfma_f32_16x16x32_bf16 v[136:139], a[40:43], a[76:79], v[136:139]
    v_mfma_f32_16x16x32_bf16 v[140:143], a[44:47], a[76:79], v[140:143]
    v_mfma_f32_16x16x32_bf16 v[144:147], a[48:51], a[76:79], v[144:147]
    v_mfma_f32_16x16x32_bf16 v[148:151], a[52:55], a[76:79], v[148:151]
    v_mfma_f32_16x16x32_bf16 v[152:155], a[56:59], a[76:79], v[152:155]
    s_add_u32 s22, s22, 1
    v_mfma_f32_16x16x32_bf16 v[156:159], a[60:63], a[76:79], v[156:159]
    s_branch M_g2p_it1
M_g2p_d0:
    v_mfma_f32_16x16x32_bf16 v[128:131], a[16:19], a[32:35], v[128:131]
    ds_read_b128 a[80:83], v7 offset:0
    ds_read_b128 a[104:107], v6 offset:0
    v_mfma_f32_16x16x32_bf16 v[132:135], a[20:23], a[32:35], v[132:135]
    ds_read_b128 a[84:87], v7 offset:1024
    ds_read_b128 a[88:91], v7 offset:2048
    v_mfma_f32_16x16x32_bf16 v[136:139], a[0:3], a[36:39], v[136:139]
    ds_read_b128 a[92:95], v7 offset:3072
    ds_read_b128 a[96:99], v7 offset:4096
    v_mfma_f32_16x16x32_bf16 v[140:143], a[4:7], a[36:39], v[140:143]
    ds_read_b128 a[100:103], v7 offset:5120
    ds_read_b128 a[108:111], v6 offset:2048
    v_mfma_f32_16x16x32_bf16 v[144:147], a[8:11], a[36:39], v[144:147]
    ds_read_b128 a[112:115], v6 offset:4096
    ds_read_b128 a[116:119], v6 offset:6144
    v_mfma_f32_16x16x32_bf16 v[148:151], a[12:15], a[36:39], v[148:151]
    ds_read_b128 a[120:123], v7 offset:12288
    ds_read_b128 a[144:147], v6 offset:1024
    v_mfma_f32_16x16x32_bf16 v[152:155], a[16:19], a[36:39], v[152:155]
    ds_read_b128 a[124:127], v7 offset:13312
    ds_read_b128 a[128:131], v7 offset:14336
    v_mfma_f32_16x16x32_bf16 v[156:159], a[20:23], a[36:39], v[156:159]
    ds_read_b128 a[132:135], v7 offset:15360
    ds_read_b128 a[136:139], v7 offset:16384
    v_mfma_f32_16x16x32_bf16 v[64:67], a[40:43], a[64:67], v[64:67]
    ds_read_b128 a[140:143], v7 offset:17408
    ds_read_b128 a[148:151], v6 offset:3072
    v_mfma_f32_16x16x32_bf16 v[68:71], a[44:47], a[64:67], v[68:71]
    ds_read_b128 a[152:155], v6 offset:5120
    ds_read_b128 a[156:159], v6 offset:7168
    v_mfma_f32_16x16x32_bf16 v[72:75], a[48:51], a[64:67], v[72:75]
    s_and_b32 s28, s40, 3
    s_mul_i32 s28, s28, 40960
    s_add_u32 m0, s28, s36
    s_add_u32 s40, s40, 1
    v_mfma_f32_16x16x32_bf16 v[76:79], a[52:55], a[64:67], v[76:79]
    buffer_load_dwordx4 v2, s[8:11], s34 offen offset:0 sc1 lds
    buffer_load_dwordx4 v2, s[8:11], s34 offen offset:1024 sc1 lds
    v_mfma_f32_16x16x32_bf16 v[80:83], a[56:59], a[64:67], v[80:83]
    buffer_load_dwordx4 v12, s[8:11], s34 offen offset:2048 sc1 lds
    buffer_load_dwordx4 v12, s[8:11], s34 offen offset:3072 sc1 lds
    v_mfma_f32_16x16x32_bf16 v[84:87], a[60:63], a[64:67], v[84:87]
    s_add_u32 m0, s28, s37
    s_add_u32 s34, s34, 2048
    buffer_load_dwordx4 v2, s[8:11], s35 offen offset:0 sc1 lds
    v_mfma_f32_16x16x32_bf16 v[88:91], a[40:43], a[68:71], v[88:91]
    buffer_load_dwordx4 v2, s[8:11], s35 offen offset:1024 sc1 lds
    buffer_load_dwordx4 v2, s[8:11], s35 offen offset:2048 sc1 lds
    v_mfma_f32_16x16x32_bf16 v[92:95], a[44:47], a[68:71], v[92:95]
    s_add_u32 m0, m0, 3072
    s_add_u32 s35, s35, 3072
    buffer_load_dwordx4 v2, s[8:11], s35 offen offset:0 sc1 lds
    v_mfma_f32_16x16x32_bf16 v[96:99], a[48:51], a[68:71], v[96:99]
    buffer_load_dwordx4 v2, s[8:11], s35 offen offset:1024 sc1 lds
    buffer_load_dwordx4 v2, s[8:11], s35 offen offset:2048 sc1 lds
    v_mfma_f32_16x16x32_bf16 v[100:103], a[52:55], a[68:71], v[100:103]
    buffer_load_dword v8, v3, s[8:11], s38 offen sc1
    s_add_u32 s35, s35, 95232
    s_and_b32 s28, s40, 3
    s_mul_i32 s28, s28, 40960
    v_mfma_f32_16x16x32_bf16 v[104:107], a[56:59], a[68:71], v[104:107]
    s_add_u32 m0, s28, s36
    s_add_u32 s40, s40, 1
    buffer_load_dwordx4 v2, s[8:11], s34 offen offset:0 sc1 lds
    v_mfma_f32_16x16x32_bf16 v[108:111], a[60:63], a[68:71], v[108:111]
    buffer_load_dwordx4 v2, s[8:11], s34 offen offset:1024 sc1 lds
    v_mfma_f32_16x16x32_bf16 v[112:115], a[40:43], a[72:75], v[112:115]
    buffer_load_dwordx4 v12, s[8:11], s34 offen offset:2048 sc1 lds
    v_mfma_f32_16x16x32_bf16 v[116:119], a[44:47], a[72:75], v[116:119]
    buffer_load_dwordx4 v12, s[8:11], s34 offen offset:3072 sc1 lds
    v_mfma_f32_16x16x32_bf16 v[120:123], a[48:51], a[72:75], v[120:123]
    s_add_u32 m0, s28, s37
    s_add_u32 s34, s34, 2048
    v_mfma_f32_16x16x32_bf16 v[124:127], a[52:55], a[72:75], v[124:127]
    buffer_load_dwordx4 v2, s[8:11], s35 offen offset:0 sc1 lds
    v_mfma_f32_16x16x32_bf16 v[128:131], a[56:59], a[72:75], v[128:131]
    buffer_load_dwordx4 v2, s[8:11], s35 offen offset:1024 sc1 lds
    v_mfma_f32_16x16x32_bf16 v[132:135], a[60:63], a[72:75], v[132:135]
    buffer_load_dwordx4 v2, s[8:11], s35 offen offset:2048 sc1 lds
    v_mfma_f32_16x16x32_bf16 v[136:139], a[40:43], a[76:79], v[136:139]
    s_add_u32 m0, m0, 3072
    s_add_u32 s35, s35, 3072
    v_mfma_f32_16x16x32_bf16 v[140:143], a[44:47], a[76:79], v[140:143]
    buffer_load_dwordx4 v2, s[8:11], s35 offen offset:0 sc1 lds
    v_mfma_f32_16x16x32_bf16 v[144:147], a[48:51], a[76:79], v[144:147]
    buffer_load_dwordx4 v2, s[8:11], s35 offen offset:1024 sc1 lds
    v_mfma_f32_16x16x32_bf16 v[148:151], a[52:55], a[76:79], v[148:151]
    buffer_load_dwordx4 v2, s[8:11], s35 offen offset:2048 sc1 lds
    v_mfma_f32_16x16x32_bf16 v[152:155], a[56:59], a[76:79], v[152:155]
    buffer_load_dword v8, v3, s[8:11], s38 offen sc1
    s_add_u32 s35, s35, 95232
    s_add_u32 s22, s22, 1
    v_mfma_f32_16x16x32_bf16 v[156:159], a[60:63], a[76:79], v[156:159]
    s_branch M_g2p_it1
M_g2p_n00:
    s_cmp_eq_u32 s41, 1
    s_cbranch_scc1 M_g2p_c0
    s_cmp_eq_u32 s41, 2
    s_cbranch_scc1 M_g2p_n000
    s_waitcnt vmcnt(11)
    s_branch M_g2p_n10
M_g2p_n000:
    s_waitcnt vmcnt(0)
    s_branch M_g2p_n10
M_g2p_c0:
    v_mfma_f32_16x16x32_bf16 v[120:123], a[8:11], a[32:35], v[120:123]
    v_mfma_f32_16x16x32_bf16 v[124:127], a[12:15], a[32:35], v[124:127]
    v_mfma_f32_16x16x32_bf16 v[128:131], a[16:19], a[32:35], v[128:131]
    v_mfma_f32_16x16x32_bf16 v[132:135], a[20:23], a[32:35], v[132:135]
    v_mfma_f32_16x16x32_bf16 v[136:139], a[0:3], a[36:39], v[136:139]
    v_mfma_f32_16x16x32_bf16 v[140:143], a[4:7], a[36:39], v[140:143]
    v_mfma_f32_16x16x32_bf16 v[144:147], a[8:11], a[36:39], v[144:147]
    v_mfma_f32_16x16x32_bf16 v[148:151], a[12:15], a[36:39], v[148:151]
    v_mfma_f32_16x16x32_bf16 v[152:155], a[16:19], a[36:39], v[152:155]
    v_mfma_f32_16x16x32_bf16 v[156:159], a[20:23], a[36:39], v[156:159]
    v_mfma_f32_16x16x32_bf16 v[64:67], a[40:43], a[64:67], v[64:67]
    v_mfma_f32_16x16x32_bf16 v[68:71], a[44:47], a[64:67], v[68:71]
    v_mfma_f32_16x16x32_bf16 v[72:75], a[48:51], a[64:67], v[72:75]
    v_mfma_f32_16x16x32_bf16 v[76:79], a[52:55], a[64:67], v[76:79]
    v_mfma_f32_16x16x32_bf16 v[80:83], a[56:59], a[64:67], v[80:83]
    v_mfma_f32_16x16x32_bf16 v[84:87], a[60:63], a[64:67], v[84:87]
    v_mfma_f32_16x16x32_bf16 v[88:91], a[40:43], a[68:71], v[88:91]
    v_mfma_f32_16x16x32_bf16 v[92:95], a[44:47], a[68:71], v[92:95]
    v_mfma_f32_16x16x32_bf16 v[96:99], a[48:51], a[68:71], v[96:99]
    v_mfma_f32_16x16x32_bf16 v[100:103], a[52:55], a[68:71], v[100:103]
    v_mfma_f32_16x16x32_bf16 v[104:107], a[56:59], a[68:71], v[104:107]
    v_mfma_f32_16x16x32_bf16 v[108:111], a[60:63], a[68:71], v[108:111]
    v_mfma_f32_16x16x32_bf16 v[112:115], a[40:43], a[72:75], v[112:115]
    v_mfma_f32_16x16x32_bf16 v[116:119], a[44:47], a[72:75], v[116:119]
    v_mfma_f32_16x16x32_bf16 v[120:123], a[48:51], a[72:75], v[120:123]
    v_mfma_f32_16x16x32_bf16 v[124:127], a[52:55], a[72:75], v[124:127]
    v_mfma_f32_16x16x32_bf16 v[128:131], a[56:59], a[72:75], v[128:131]
    v_mfma_f32_16x16x32_bf16 v[132:135], a[60:63], a[72:75], v[132:135]
    v_mfma_f32_16x16x32_bf16 v[136:139], a[40:43], a[76:79], v[136:139]
    v_mfma_f32_16x16x32_bf16 v[140:143], a[44:47], a[76:79], v[140:143]
    v_mfma_f32_16x16x32_bf16 v[144:147], a[48:51], a[76:79], v[144:147]
    v_mfma_f32_16x16x32_bf16 v[148:151], a[52:55], a[76:79], v[148:151]
    v_mfma_f32_16x16x32_bf16 v[152:155], a[56:59], a[76:79], v[152:155]
    v_mfma_f32_16x16x32_bf16 v[156:159], a[60:63], a[76:79], v[156:159]
M_g2p_late1:
    s_cmp_eq_u32 s22, 30
    s_cbranch_scc1 M_g2p_fin
    s_mov_b32 s39, 0
    s_lshl_b32 s46, s40, 1
    s_lshl_b64 s[50:51], 15, s46
M_g2p_lp1:
    s_mov_b64 exec, s[50:51]
    buffer_load_dword v8, v3, s[8:11], s38 offen sc1
    s_mov_b64 exec, -1
    s_add_u32 s39, s39, 1
    s_cmp_gt_u32 s39, 400000
    s_cbranch_scc1 M_fail
    s_waitcnt vmcnt(0)
    v_cmp_ne_u32 s[44:45], 0, v8
    s_nop 3
    s_lshl_b32 s46, s40, 1
    s_add_u32 s46, s46, s32
    s_nop 0
    s_lshr_b64 s[44:45], s[44:45], s46
    s_nop 0
    s_nop 0
    s_bitcmp1_b32 s44, 0
    s_cbranch_scc1 M_g2p_lr1
    s_mov_b32 s47, 1
    s_cmp_eq_u32 s48, 0
    s_cbranch_scc1 M_g2p_tz
M_g2p_tzr1:
    s_sleep 1
    s_cmp_ge_i32 s22, 29
    s_cbranch_scc1 M_g2p_lp1
    s_sleep 24
    s_branch M_g2p_lp1
M_g2p_lr1:
    s_and_b32 s28, s40, 3
    s_mul_i32 s28, s28, 40960
    s_add_u32 m0, s28, s36
    s_add_u32 s40, s40, 1
    buffer_load_dwordx4 v2, s[8:11], s34 offen offset:0 sc1 lds
    buffer_load_dwordx4 v2, s[8:11], s34 offen offset:1024 sc1 lds
    buffer_load_dwordx4 v12, s[8:11], s34 offen offset:2048 sc1 lds
    buffer_load_dwordx4 v12, s[8:11], s34 offen offset:3072 sc1 lds
    s_add_u32 m0, s28, s37
    s_add_u32 s34, s34, 2048
    buffer_load_dwordx4 v2, s[8:11], s35 offen offset:0 sc1 lds
    buffer_load_dwordx4 v2, s[8:11], s35 offen offset:1024 sc1 lds
    buffer_load_dwordx4 v2, s[8:11], s35 offen offset:2048 sc1 lds
    s_add_u32 m0, m0, 3072
    s_add_u32 s35, s35, 3072
    buffer_load_dwordx4 v2, s[8:11], s35 offen offset:0 sc1 lds
    buffer_load_dwordx4 v2, s[8:11], s35 offen offset:1024 sc1 lds
    buffer_load_dwordx4 v2, s[8:11], s35 offen offset:2048 sc1 lds
    buffer_load_dword v8, v3, s[8:11], s38 offen sc1
    s_add_u32 s35, s35, 95232
    s_add_u32 s29, s22, 1
    s_and_b32 s29, s29, 3
    s_mul_i32 s29, s29, 40960
    v_add_u32 v6, s29, v4
    v_add_u32 v7, s29, v5
    s_bitcmp1_b32 s44, 2
    s_cbranch_scc0 M_g2p_l01
    s_and_b32 s28, s40, 3
    s_mul_i32 s28, s28, 40960
    s_add_u32 m0, s28, s36
    s_add_u32 s40, s40, 1
    buffer_load_dwordx4 v2, s[8:11], s34 offen offset:0 sc1 lds
    buffer_load_dwordx4 v2, s[8:11], s34 offen offset:1024 sc1 lds
    buffer_load_dwordx4 v12, s[8:11], s34 offen offset:2048 sc1 lds
    buffer_load_dwordx4 v12, s[8:11], s34 offen offset:3072 sc1 lds
    s_add_u32 m0, s28, s37
    s_add_u32 s34, s34, 2048
    buffer_load_dwordx4 v2, s[8:11], s35 offen offset:0 sc1 lds
    buffer_load_dwordx4 v2, s[8:11], s35 offen offset:1024 sc1 lds
    buffer_load_dwordx4 v2, s[8:11], s35 offen offset:2048 sc1 lds
    s_add_u32 m0, m0, 3072
    s_add_u32 s35, s35, 3072
    buffer_load_dwordx4 v2, s[8:11], s35 offen offset:0 sc1 lds
    buffer_load_dwordx4 v2, s[8:11], s35 offen offset:1024 sc1 lds
    buffer_load_dwordx4 v2, s[8:11], s35 offen offset:2048 sc1 lds
    buffer_load_dword v8, v3, s[8:11], s38 offen sc1
    s_add_u32 s35, s35, 95232
    s_waitcnt vmcnt(11)
    s_branch M_g2p_l11
M_g2p_l01:
    s_waitcnt vmcnt(0)
M_g2p_l11:
    s_barrier
    ds_read_b128 a[80:83], v7 offset:0
    ds_read_b128 a[104:107], v6 offset:0
    ds_read_b128 a[84:87], v7 offset:1024
    ds_read_b128 a[88:91], v7 offset:2048
    ds_read_b128 a[92:95], v7 offset:3072
    ds_read_b128 a[96:99], v7 offset:4096
    ds_read_b128 a[100:103], v7 offset:5120
    ds_read_b128 a[108:111], v6 offset:2048
    ds_read_b128 a[112:115], v6 offset:4096
    ds_read_b128 a[116:119], v6 offset:6144
    ds_read_b128 a[120:123], v7 offset:12288
    ds_read_b128 a[144:147], v6 offset:1024
    ds_read_b128 a[124:127], v7 offset:13312
    ds_read_b128 a[128:131], v7 offset:14336
    ds_read_b128 a[132:135], v7 offset:15360
    ds_read_b128 a[136:139], v7 offset:16384
    ds_read_b128 a[140:143], v7 offset:17408
    ds_read_b128 a[148:151], v6 offset:3072
    ds_read_b128 a[152:155], v6 offset:5120
    ds_read_b128 a[156:159], v6 offset:7168
    s_add_u32 s22, s22, 1
    s_branch M_g2p_it1
M_g2p_it1:
    s_waitcnt lgkmcnt(15)
    v_mfma_f32_16x16x32_bf16 v[64:67], a[80:83], a[104:107], v[64:67]
    v_mfma_f32_16x16x32_bf16 v[68:71], a[84:87], a[104:107], v[68:71]
    v_cmp_ne_u32 s[44:45], 0, v8
    v_mfma_f32_16x16x32_bf16 v[72:75], a[88:91], a[104:107], v[72:75]
    s_add_u32 s29, s22, 1
    s_and_b32 s29, s29, 3
    v_mfma_f32_16x16x32_bf16 v[76:79], a[92:95], a[104:107], v[76:79]
    s_waitcnt lgkmcnt(13)
    v_mfma_f32_16x16x32_bf16 v[80:83], a[96:99], a[104:107], v[80:83]
    s_mul_i32 s29, s29, 40960
    v_add_u32 v6, s29, v4
    v_mfma_f32_16x16x32_bf16 v[84:87], a[100:103], a[104:107], v[84:87]
    s_waitcnt lgkmcnt(12)
    v_mfma_f32_16x16x32_bf16 v[88:91], a[80:83], a[108:111], v[88:91]
    s_sub_u32 s41, s40, s22
    v_add_u32 v7, s29, v5
    v_mfma_f32_16x16x32_bf16 v[92:95], a[84:87], a[108:111], v[92:95]
    s_lshl_b32 s46, s40, 1
    s_add_u32 s46, s46, s32
    v_mfma_f32_16x16x32_bf16 v[96:99], a[88:91], a[108:111], v[96:99]
    s_nop 0
    s_lshr_b64 s[44:45], s[44:45], s46
    v_mfma_f32_16x16x32_bf16 v[100:103], a[92:95], a[108:111], v[100:103]
    s_nop 0
    s_nop 0
    v_mfma_f32_16x16x32_bf16 v[104:107], a[96:99], a[108:111], v[104:107]
    s_cmp_lt_u32 s41, 4
    s_cselect_b32 s46, 5, 1
    v_mfma_f32_16x16x32_bf16 v[108:111], a[100:103], a[108:111], v[108:111]
    s_waitcnt lgkmcnt(0)
    v_mfma_f32_16x16x32_bf16 v[112:115], a[80:83], a[112:115], v[112:115]
    s_and_b32 s44, s44, s46
    s_cmp_eq_u32 s41, 4
    v_mfma_f32_16x16x32_bf16 v[116:119], a[84:87], a[112:115], v[116:119]
    s_cbranch_scc0 M_g2p_n01
    s_waitcnt vmcnt(22)
M_g2p_n11:
    v_mfma_f32_16x16x32_bf16 v[120:123], a[88:91], a[112:115], v[120:123]
    s_barrier
    s_cmp_eq_u32 s44, 1
    v_mfma_f32_16x16x32_bf16 v[124:127], a[92:95], a[112:115], v[124:127]
    s_cbranch_scc0 M_g2p_bd1
    v_mfma_f32_16x16x32_bf16 v[128:131], a[96:99], a[112:115], v[128:131]
    ds_read_b128 a[0:3], v7 offset:0
    ds_read_b128 a[24:27], v6 offset:0
    v_mfma_f32_16x16x32_bf16 v[132:135], a[100:103], a[112:115], v[132:135]
    ds_read_b128 a[4:7], v7 offset:1024
    ds_read_b128 a[8:11], v7 offset:2048
    v_mfma_f32_16x16x32_bf16 v[136:139], a[80:83], a[116:119], v[136:139]
    ds_read_b128 a[12:15], v7 offset:3072
    ds_read_b128 a[16:19], v7 offset:4096
    v_mfma_f32_16x16x32_bf16 v[140:143], a[84:87], a[116:119], v[140:143]
    ds_read_b128 a[20:23], v7 offset:5120
    ds_read_b128 a[28:31], v6 offset:2048
    v_mfma_f32_16x16x32_bf16 v[144:147], a[88:91], a[116:119], v[144:147]
    ds_read_b128 a[32:35], v6 offset:4096
    ds_read_b128 a[36:39], v6 offset:6144
    v_mfma_f32_16x16x32_bf16 v[148:151], a[92:95], a[116:119], v[148:151]
    ds_read_b128 a[40:43], v7 offset:12288
    ds_read_b128 a[64:67], v6 offset:1024
    v_mfma_f32_16x16x32_bf16 v[152:155], a[96:99], a[116:119], v[152:155]
    ds_read_b128 a[44:47], v7 offset:13312
    ds_read_b128 a[48:51], v7 offset:14336
    v_mfma_f32_16x16x32_bf16 v[156:159], a[100:103], a[116:119], v[156:159]
    ds_read_b128 a[52:55], v7 offset:15360
    ds_read_b128 a[56:59], v7 offset:16384
    v_mfma_f32_16x16x32_bf16 v[64:67], a[120:123], a[144:147], v[64:67]
    ds_read_b128 a[60:63], v7 offset:17408
    ds_read_b128 a[68:71], v6 offset:3072
    v_mfma_f32_16x16x32_bf16 v[68:71], a[124:127], a[144:147], v[68:71]
    ds_read_b128 a[72:75], v6 offset:5120
    ds_read_b128 a[76:79], v6 offset:7168
    v_mfma_f32_16x16x32_bf16 v[72:75], a[128:131], a[144:147], v[72:75]
    s_and_b32 s28, s40, 3
    s_mul_i32 s28, s28, 40960
    v_mfma_f32_16x16x32_bf16 v[76:79], a[132:135], a[144:147], v[76:79]
    s_add_u32 m0, s28, s36
    s_add_u32 s40, s40, 1
    v_mfma_f32_16x16x32_bf16 v[80:83], a[136:139], a[144:147], v[80:83]
    buffer_load_dwordx4 v2, s[8:11], s34 offen offset:0 sc1 lds
    v_mfma_f32_16x16x32_bf16 v[84:87], a[140:143], a[144:147], v[84:87]
    buffer_load_dwordx4 v2, s[8:11], s34 offen offset:1024 sc1 lds
    v_mfma_f32_16x16x32_bf16 v[88:91], a[120:123], a[148:151], v[88:91]
    buffer_load_dwordx4 v12, s[8:11], s34 offen offset:2048 sc1 lds
    v_mfma_f32_16x16x32_bf16 v[92:95], a[124:127], a[148:151], v[92:95]
    buffer_load_dwordx4 v12, s[8:11], s34 offen offset:3072 sc1 lds
    v_mfma_f32_16x16x32_bf16 v[96:99], a[128:131], a[148:151], v[96:99]
    s_add_u32 m0, s28, s37
    s_add_u32 s34, s34, 2048
    v_mfma_f32_16x16x32_bf16 v[100:103], a[132:135], a[148:151], v[100:103]
    buffer_load_dwordx4 v2, s[8:11], s35 offen offset:0 sc1 lds
    v_mfma_f32_16x16x32_bf16 v[104:107], a[136:139], a[148:151], v[104:107]
    buffer_load_dwordx4 v2, s[8:11], s35 offen offset:1024 sc1 lds
    v_mfma_f32_16x16x32_bf16 v[108:111], a[140:143], a[148:151], v[108:111]
    buffer_load_dwordx4 v2, s[8:11], s35 offen offset:2048 sc1 lds
    v_mfma_f32_16x16x32_bf16 v[112:115], a[120:123], a[152:155], v[112:115]
    s_add_u32 m0, m0, 3072
    s_add_u32 s35, s35, 3072
    v_mfma_f32_16x16x32_bf16 v[116:119], a[124:127], a[152:155], v[116:119]
    buffer_load_dwordx4 v2, s[8:11], s35 offen offset:0 sc1 lds
    v_mfma_f32_16x16x32_bf16 v[120:123], a[128:131], a[152:155], v[120:123]
    buffer_load_dwordx4 v2, s[8:11], s35 offen offset:1024 sc1 lds
    v_mfma_f32_16x16x32_bf16 v[124:127], a[132:135], a[152:155], v[124:127]
    buffer_load_dwordx4 v2, s[8:11], s35 offen offset:2048 sc1 lds
    v_mfma_f32_16x16x32_bf16 v[128:131], a[136:139], a[152:155], v[128:131]
    buffer_load_dword v8, v3, s[8:11], s38 offen sc1
    s_add_u32 s35, s35, 95232
    v_mfma_f32_16x16x32_bf16 v[132:135], a[140:143], a[152:155], v[132:135]
    v_mfma_f32_16x16x32_bf16 v[136:139], a[120:123], a[156:159], v[136:139]
    v_mfma_f32_16x16x32_bf16 v[140:143], a[124:127], a[156:159], v[140:143]
    v_mfma_f32_16x16x32_bf16 v[144:147], a[128:131], a[156:159], v[144:147]
    v_mfma_f32_16x16x32_bf16 v[148:151], a[132:135], a[156:159], v[148:151]
    v_mfma_f32_16x16x32_bf16 v[152:155], a[136:139], a[156:159], v[152:155]
    s_add_u32 s22, s22, 1
    v_mfma_f32_16x16x32_bf16 v[156:159], a[140:143], a[156:159], v[156:159]
    s_branch M_g2p_it0
M_g2p_bd1:
    s_cmp_eq_u32 s44, 5
    s_cbranch_scc1 M_g2p_d1
    v_mfma_f32_16x16x32_bf16 v[128:131], a[96:99], a[112:115], v[128:131]
    ds_read_b128 a[0:3], v7 offset:0
    ds_read_b128 a[24:27], v6 offset:0
    v_mfma_f32_16x16x32_bf16 v[132:135], a[100:103], a[112:115], v[132:135]
    ds_read_b128 a[4:7], v7 offset:1024
    ds_read_b128 a[8:11], v7 offset:2048
    v_mfma_f32_16x16x32_bf16 v[136:139], a[80:83], a[116:119], v[136:139]
    ds_read_b128 a[12:15], v7 offset:3072
    ds_read_b128 a[16:19], v7 offset:4096
    v_mfma_f32_16x16x32_bf16 v[140:143], a[84:87], a[116:119], v[140:143]
    ds_read_b128 a[20:23], v7 offset:5120
    ds_read_b128 a[28:31], v6 offset:2048
    v_mfma_f32_16x16x32_bf16 v[144:147], a[88:91], a[116:119], v[144:147]
    ds_read_b128 a[32:35], v6 offset:4096
    ds_read_b128 a[36:39], v6 offset:6144
    v_mfma_f32_16x16x32_bf16 v[148:151], a[92:95], a[116:119], v[148:151]
    ds_read_b128 a[40:43], v7 offset:12288
    ds_read_b128 a[64:67], v6 offset:1024
    v_mfma_f32_16x16x32_bf16 v[152:155], a[96:99], a[116:119], v[152:155]
    ds_read_b128 a[44:47], v7 offset:13312
    ds_read_b128 a[48:51], v7 offset:14336
    v_mfma_f32_16x16x32_bf16 v[156:159], a[100:103], a[116:119], v[156:159]
    ds_read_b128 a[52:55], v7 offset:15360
    ds_read_b128 a[56:59], v7 offset:16384
    v_mfma_f32_16x16x32_bf16 v[64:67], a[120:123], a[144:147], v[64:67]
    ds_read_b128 a[60:63], v7 offset:17408
    ds_read_b128 a[68:71], v6 offset:3072
    v_mfma_f32_16x16x32_bf16 v[68:71], a[124:127], a[144:147], v[68:71]
    ds_read_b128 a[72:75], v6 offset:5120
    ds_read_b128 a[76:79], v6 offset:7168
    v_mfma_f32_16x16x32_bf16 v[72:75], a[128:131], a[144:147], v[72:75]
    buffer_load_dword v8, v3, s[8:11], s38 offen sc1
    v_mfma_f32_16x16x32_bf16 v[76:79], a[132:135], a[144:147], v[76:79]
    v_mfma_f32_16x16x32_bf16 v[80:83], a[136:139], a[144:147], v[80:83]
    v_mfma_f32_16x16x32_bf16 v[84:87], a[140:143], a[144:147], v[84:87]
    v_mfma_f32_16x16x32_bf16 v[88:91], a[120:123], a[148:151], v[88:91]
    v_mfma_f32_16x16x32_bf16 v[92:95], a[124:127], a[148:151], v[92:95]
    v_mfma_f32_16x16x32_bf16 v[96:99], a[128:131], a[148:151], v[96:99]
    v_mfma_f32_16x16x32_bf16 v[100:103], a[132:135], a[148:151], v[100:103]
    v_mfma_f32_16x16x32_bf16 v[104:107], a[136:139], a[148:151], v[104:107]
    v_mfma_f32_16x16x32_bf16 v[108:111], a[140:143], a[148:151], v[108:111]
    v_mfma_f32_16x16x32_bf16 v[112:115], a[120:123], a[152:155], v[112:115]
    v_mfma_f32_16x16x32_bf16 v[116:119], a[124:127], a[152:155], v[116:119]
    v_mfma_f32_16x16x32_bf16 v[120:123], a[128:131], a[152:155], v[120:123]
    v_mfma_f32_16x16x32_bf16 v[124:127], a[132:135], a[152:155], v[124:127]
    v_mfma_f32_16x16x32_bf16 v[128:131], a[136:139], a[152:155], v[128:131]
    v_mfma_f32_16x16x32_bf16 v[132:135], a[140:143], a[152:155], v[132:135]
    v_mfma_f32_16x16x32_bf16 v[136:139], a[120:123], a[156:159], v[136:139]
    v_mfma_f32_16x16x32_bf16 v[140:143], a[124:127], a[156:159], v[140:143]
    v_mfma_f32_16x16x32_bf16 v[144:147], a[128:131], a[156:159], v[144:147]
    v_mfma_f32_16x16x32_bf16 v[148:151], a[132:135], a[156:159], v[148:151]
    v_mfma_f32_16x16x32_bf16 v[152:155], a[136:139], a[156:159], v[152:155]
    s_add_u32 s22, s22, 1
    v_mfma_f32_16x16x32_bf16 v[156:159], a[140:143], a[156:159], v[156:159]
    s_branch M_g2p_it0
M_g2p_d1:
    v_mfma_f32_16x16x32_bf16 v[128:131], a[96:99], a[112:115], v[128:131]
    ds_read_b128 a[0:3], v7 offset:0
    ds_read_b128 a[24:27], v6 offset:0
    v_mfma_f32_16x16x32_bf16 v[132:135], a[100:103], a[112:115], v[132:135]
    ds_read_b128 a[4:7], v7 offset:1024
    ds_read_b128 a[8:11], v7 offset:2048
    v_mfma_f32_16x16x32_bf16 v[136:139], a[80:83], a[116:119], v[136:139]
    ds_read_b128 a[12:15], v7 offset:3072
    ds_read_b128 a[16:19], v7 offset:4096
    v_mfma_f32_16x16x32_bf16 v[140:143], a[84:87], a[116:119], v[140:143]
    ds_read_b128 a[20:23], v7 offset:5120
    ds_read_b128 a[28:31], v6 offset:2048
    v_mfma_f32_16x16x32_bf16 v[144:147], a[88:91], a[116:119], v[144:147]
    ds_read_b128 a[32:35], v6 offset:4096
    ds_read_b128 a[36:39], v6 offset:6144
    v_mfma_f32_16x16x32_bf16 v[148:151], a[92:95], a[116:119], v[148:151]
    ds_read_b128 a[40:43], v7 offset:12288
    ds_read_b128 a[64:67], v6 offset:1024
    v_mfma_f32_16x16x32_bf16 v[152:155], a[96:99], a[116:119], v[152:155]
    ds_read_b128 a[44:47], v7 offset:13312
    ds_read_b128 a[48:51], v7 offset:14336
    v_mfma_f32_16x16x32_bf16 v[156:159], a[100:103], a[116:119], v[156:159]
    ds_read_b128 a[52:55], v7 offset:15360
    ds_read_b128 a[56:59], v7 offset:16384
    v_mfma_f32_16x16x32_bf16 v[64:67], a[120:123], a[144:147], v[64:67]
    ds_read_b128 a[60:63], v7 offset:17408
    ds_read_b128 a[68:71], v6 offset:3072
    v_mfma_f32_16x16x32_bf16 v[68:71], a[124:127], a[144:147], v[68:71]
    ds_read_b128 a[72:75], v6 offset:5120
    ds_read_b128 a[76:79], v6 offset:7168
    v_mfma_f32_16x16x32_bf16 v[72:75], a[128:131], a[144:147], v[72:75]
    s_and_b32 s28, s40, 3
    s_mul_i32 s28, s28, 40960
    s_add_u32 m0, s28, s36
    s_add_u32 s40, s40, 1
    v_mfma_f32_16x16x32_bf16 v[76:79], a[132:135], a[144:147], v[76:79]
    buffer_load_dwordx4 v2, s[8:11], s34 offen offset:0 sc1 lds
    buffer_load_dwordx4 v2, s[8:11], s34 offen offset:1024 sc1 lds
    v_mfma_f32_16x16x32_bf16 v[80:83], a[136:139], a[144:147], v[80:83]
    buffer_load_dwordx4 v12, s[8:11], s34 offen offset:2048 sc1 lds
    buffer_load_dwordx4 v12, s[8:11], s34 offen offset:3072 sc1 lds
    v_mfma_f32_16x16x32_bf16 v[84:87], a[140:143], a[144:147], v[84:87]
    s_add_u32 m0, s28, s37
    s_add_u32 s34, s34, 2048
    buffer_load_dwordx4 v2, s[8:11], s35 offen offset:0 sc1 lds
    v_mfma_f32_16x16x32_bf16 v[88:91], a[120:123], a[148:151], v[88:91]
    buffer_load_dwordx4 v2, s[8:11], s35 offen offset:1024 sc1 lds
    buffer_load_dwordx4 v2, s[8:11], s35 offen offset:2048 sc1 lds
    v_mfma_f32_16x16x32_bf16 v[92:95], a[124:127], a[148:151], v[92:95]
    s_add_u32 m0, m0, 3072
    s_add_u32 s35, s35, 3072
    buffer_load_dwordx4 v2, s[8:11], s35 offen offset:0 sc1 lds
    v_mfma_f32_16x16x32_bf16 v[96:99], a[128:131], a[148:151], v[96:99]
    buffer_load_dwordx4 v2, s[8:11], s35 offen offset:1024 sc1 lds
    buffer_load_dwordx4 v2, s[8:11], s35 offen offset:2048 sc1 lds
    v_mfma_f32_16x16x32_bf16 v[100:103], a[132:135], a[148:151], v[100:103]
    buffer_load_dword v8, v3, s[8:11], s38 offen sc1
    s_add_u32 s35, s35, 95232
    s_and_b32 s28, s40, 3
    s_mul_i32 s28, s28, 40960
    v_mfma_f32_16x16x32_bf16 v[104:107], a[136:139], a[148:151], v[104:107]
    s_add_u32 m0, s28, s36
    s_add_u32 s40, s40, 1
    buffer_load_dwordx4 v2, s[8:11], s34 offen offset:0 sc1 lds
    v_mfma_f32_16x16x32_bf16 v[108:111], a[140:143], a[148:151], v[108:111]
    buffer_load_dwordx4 v2, s[8:11], s34 offen offset:1024 sc1 lds
    v_mfma_f32_16x16x32_bf16 v[112:115], a[120:123], a[152:155], v[112:115]
    buffer_load_dwordx4 v12, s[8:11], s34 offen offset:2048 sc1 lds
    v_mfma_f32_16x16x32_bf16 v[116:119], a[124:127], a[152:155], v[116:119]
    buffer_load_dwordx4 v12, s[8:11], s34 offen offset:3072 sc1 lds
    v_mfma_f32_16x16x32_bf16 v[120:123], a[128:131], a[152:155], v[120:123]
    s_add_u32 m0, s28, s37
    s_add_u32 s34, s34, 2048
    v_mfma_f32_16x16x32_bf16 v[124:127], a[132:135], a[152:155], v[124:127]
    buffer_load_dwordx4 v2, s[8:11], s35 offen offset:0 sc1 lds
    v_mfma_f32_16x16x32_bf16 v[128:131], a[136:139], a[152:155], v[128:131]
    buffer_load_dwordx4 v2, s[8:11], s35 offen offset:1024 sc1 lds
    v_mfma_f32_16x16x32_bf16 v[132:135], a[140:143], a[152:155], v[132:135]
    buffer_load_dwordx4 v2, s[8:11], s35 offen offset:2048 sc1 lds
    v_mfma_f32_16x16x32_bf16 v[136:139], a[120:123], a[156:159], v[136:139]
    s_add_u32 m0, m0, 3072
    s_add_u32 s35, s35, 3072
    v_mfma_f32_16x16x32_bf16 v[140:143], a[124:127], a[156:159], v[140:143]
    buffer_load_dwordx4 v2, s[8:11], s35 offen offset:0 sc1 lds
    v_mfma_f32_16x16x32_bf16 v[144:147], a[128:131], a[156:159], v[144:147]
    buffer_load_dwordx4 v2, s[8:11], s35 offen offset:1024 sc1 lds
    v_mfma_f32_16x16x32_bf16 v[148:151], a[132:135], a[156:159], v[148:151]
    buffer_load_dwordx4 v2, s[8:11], s35 offen offset:2048 sc1 lds
    v_mfma_f32_16x16x32_bf16 v[152:155], a[136:139], a[156:159], v[152:155]
    buffer_load_dword v8, v3, s[8:11], s38 offen sc1
    s_add_u32 s35, s35, 95232
    s_add_u32 s22, s22, 1
    v_mfma_f32_16x16x32_bf16 v[156:159], a[140:143], a[156:159], v[156:159]
    s_branch M_g2p_it0
M_g2p_n01:
    s_cmp_eq_u32 s41, 1
    s_cbranch_scc1 M_g2p_c1
    s_cmp_eq_u32 s41, 2
    s_cbranch_scc1 M_g2p_n001
    s_waitcnt vmcnt(11)
    s_branch M_g2p_n11
M_g2p_n001:
    s_waitcnt vmcnt(0)
    s_branch M_g2p_n11
M_g2p_c1:
    v_mfma_f32_16x16x32_bf16 v[120:123], a[88:91], a[112:115], v[120:123]
    v_mfma_f32_16x16x32_bf16 v[124:127], a[92:95], a[112:115], v[124:127]
    v_mfma_f32_16x16x32_bf16 v[128:131], a[96:99], a[112:115], v[128:131]
    v_mfma_f32_16x16x32_bf16 v[132:135], a[100:103], a[112:115], v[132:135]
    v_mfma_f32_16x16x32_bf16 v[136:139], a[80:83], a[116:119], v[136:139]
    v_mfma_f32_16x16x32_bf16 v[140:143], a[84:87], a[116:119], v[140:143]
    v_mfma_f32_16x16x32_bf16 v[144:147], a[88:91], a[116:119], v[144:147]
    v_mfma_f32_16x16x32_bf16 v[148:151], a[92:95], a[116:119], v[148:151]
    v_mfma_f32_16x16x32_bf16 v[152:155], a[96:99], a[116:119], v[152:155]
    v_mfma_f32_16x16x32_bf16 v[156:159], a[100:103], a[116:119], v[156:159]
    v_mfma_f32_16x16x32_bf16 v[64:67], a[120:123], a[144:147], v[64:67]
    v_mfma_f32_16x16x32_bf16 v[68:71], a[124:127], a[144:147], v[68:71]
    v_mfma_f32_16x16x32_bf16 v[72:75], a[128:131], a[144:147], v[72:75]
    v_mfma_f32_16x16x32_bf16 v[76:79], a[132:135], a[144:147], v[76:79]
    v_mfma_f32_16x16x32_bf16 v[80:83], a[136:139], a[144:147], v[80:83]
    v_mfma_f32_16x16x32_bf16 v[84:87], a[140:143], a[144:147], v[84:87]
    v_mfma_f32_16x16x32_bf16 v[88:91], a[120:123], a[148:151], v[88:91]
    v_mfma_f32_16x16x32_bf16 v[92:95], a[124:127], a[148:151], v[92:95]
    v_mfma_f32_16x16x32_bf16 v[96:99], a[128:131], a[148:151], v[96:99]
    v_mfma_f32_16x16x32_bf16 v[100:103], a[132:135], a[148:151], v[100:103]
    v_mfma_f32_16x16x32_bf16 v[104:107], a[136:139], a[148:151], v[104:107]
    v_mfma_f32_16x16x32_bf16 v[108:111], a[140:143], a[148:151], v[108:111]
    v_mfma_f32_16x16x32_bf16 v[112:115], a[120:123], a[152:155], v[112:115]
    v_mfma_f32_16x16x32_bf16 v[116:119], a[124:127], a[152:155], v[116:119]
    v_mfma_f32_16x16x32_bf16 v[120:123], a[128:131], a[152:155], v[120:123]
    v_mfma_f32_16x16x32_bf16 v[124:127], a[132:135], a[152:155], v[124:127]
    v_mfma_f32_16x16x32_bf16 v[128:131], a[136:139], a[152:155], v[128:131]
    v_mfma_f32_16x16x32_bf16 v[132:135], a[140:143], a[152:155], v[132:135]
    v_mfma_f32_16x16x32_bf16 v[136:139], a[120:123], a[156:159], v[136:139]
    v_mfma_f32_16x16x32_bf16 v[140:143], a[124:127], a[156:159], v[140:143]
    v_mfma_f32_16x16x32_bf16 v[144:147], a[128:131], a[156:159], v[144:147]
    v_mfma_f32_16x16x32_bf16 v[148:151], a[132:135], a[156:159], v[148:151]
    v_mfma_f32_16x16x32_bf16 v[152:155], a[136:139], a[156:159], v[152:155]
    v_mfma_f32_16x16x32_bf16 v[156:159], a[140:143], a[156:159], v[156:159]
M_g2p_late0:
    s_cmp_eq_u32 s22, 30
    s_cbranch_scc1 M_g2p_fin
    s_mov_b32 s39, 0
    s_lshl_b32 s46, s40, 1
    s_lshl_b64 s[50:51], 15, s46
M_g2p_lp0:
    s_mov_b64 exec, s[50:51]
    buffer_load_dword v8, v3, s[8:11], s38 offen sc1
    s_mov_b64 exec, -1
    s_add_u32 s39, s39, 1
    s_cmp_gt_u32 s39, 400000
    s_cbranch_scc1 M_fail
    s_waitcnt vmcnt(0)
    v_cmp_ne_u32 s[44:45], 0, v8
    s_nop 3
    s_lshl_b32 s46, s40, 1
    s_add_u32 s46, s46, s32
    s_nop 0
    s_lshr_b64 s[44:45], s[44:45], s46
    s_nop 0
    s_nop 0
    s_bitcmp1_b32 s44, 0
    s_cbranch_scc1 M_g2p_lr0
    s_mov_b32 s47, 0
    s_cmp_eq_u32 s48, 0
    s_cbranch_scc1 M_g2p_tz
M_g2p_tzr0:
    s_sleep 1
    s_cmp_ge_i32 s22, 29
    s_cbranch_scc1 M_g2p_lp0
    s_sleep 24
    s_branch M_g2p_lp0
M_g2p_lr0:
    s_and_b32 s28, s40, 3
    s_mul_i32 s28, s28, 40960
    s_add_u32 m0, s28, s36
    s_add_u32 s40, s40, 1
    buffer_load_dwordx4 v2, s[8:11], s34 offen offset:0 sc1 lds
    buffer_load_dwordx4 v2, s[8:11], s34 offen offset:1024 sc1 lds
    buffer_load_dwordx4 v12, s[8:11], s34 offen offset:2048 sc1 lds
    buffer_load_dwordx4 v12, s[8:11], s34 offen offset:3072 sc1 lds
    s_add_u32 m0, s28, s37
    s_add_u32 s34, s34, 2048
    buffer_load_dwordx4 v2, s[8:11], s35 offen offset:0 sc1 lds
    buffer_load_dwordx4 v2, s[8:11], s35 offen offset:1024 sc1 lds
    buffer_load_dwordx4 v2, s[8:11], s35 offen offset:2048 sc1 lds
    s_add_u32 m0, m0, 3072
    s_add_u32 s35, s35, 3072
    buffer_load_dwordx4 v2, s[8:11], s35 offen offset:0 sc1 lds
    buffer_load_dwordx4 v2, s[8:11], s35 offen offset:1024 sc1 lds
    buffer_load_dwordx4 v2, s[8:11], s35 offen offset:2048 sc1 lds
    buffer_load_dword v8, v3, s[8:11], s38 offen sc1
    s_add_u32 s35, s35, 95232
    s_add_u32 s29, s22, 1
    s_and_b32 s29, s29, 3
    s_mul_i32 s29, s29, 40960
    v_add_u32 v6, s29, v4
    v_add_u32 v7, s29, v5
    s_bitcmp1_b32 s44, 2
    s_cbranch_scc0 M_g2p_l00
    s_and_b32 s28, s40, 3
    s_mul_i32 s28, s28, 40960
    s_add_u32 m0, s28, s36
    s_add_u32 s40, s40, 1
    buffer_load_dwordx4 v2, s[8:11], s34 offen offset:0 sc1 lds
    buffer_load_dwordx4 v2, s[8:11], s34 offen offset:1024 sc1 lds
    buffer_load_dwordx4 v12, s[8:11], s34 offen offset:2048 sc1 lds
    buffer_load_dwordx4 v12, s[8:11], s34 offen offset:3072 sc1 lds
    s_add_u32 m0, s28, s37
    s_add_u32 s34, s34, 2048
    buffer_load_dwordx4 v2, s[8:11], s35 offen offset:0 sc1 lds
    buffer_load_dwordx4 v2, s[8:11], s35 offen offset:1024 sc1 lds
    buffer_load_dwordx4 v2, s[8:11], s35 offen offset:2048 sc1 lds
    s_add_u32 m0, m0, 3072
    s_add_u32 s35, s35, 3072
    buffer_load_dwordx4 v2, s[8:11], s35 offen offset:0 sc1 lds
    buffer_load_dwordx4 v2, s[8:11], s35 offen offset:1024 sc1 lds
    buffer_load_dwordx4 v2, s[8:11], s35 offen offset:2048 sc1 lds
    buffer_load_dword v8, v3, s[8:11], s38 offen sc1
    s_add_u32 s35, s35, 95232
    s_waitcnt vmcnt(11)
    s_branch M_g2p_l10
M_g2p_l00:
    s_waitcnt vmcnt(0)
M_g2p_l10:
    s_barrier
    ds_read_b128 a[0:3], v7 offset:0
    ds_read_b128 a[24:27], v6 offset:0
    ds_read_b128 a[4:7], v7 offset:1024
    ds_read_b128 a[8:11], v7 offset:2048
    ds_read_b128 a[12:15], v7 offset:3072
    ds_read_b128 a[16:19], v7 offset:4096
    ds_read_b128 a[20:23], v7 offset:5120
    ds_read_b128 a[28:31], v6 offset:2048
    ds_read_b128 a[32:35], v6 offset:4096
    ds_read_b128 a[36:39], v6 offset:6144
    ds_read_b128 a[40:43], v7 offset:12288
    ds_read_b128 a[64:67], v6 offset:1024
    ds_read_b128 a[44:47], v7 offset:13312
    ds_read_b128 a[48:51], v7 offset:14336
    ds_read_b128 a[52:55], v7 offset:15360
    ds_read_b128 a[56:59], v7 offset:16384
    ds_read_b128 a[60:63], v7 offset:17408
    ds_read_b128 a[68:71], v6 offset:3072
    ds_read_b128 a[72:75], v6 offset:5120
    ds_read_b128 a[76:79], v6 offset:7168
    s_add_u32 s22, s22, 1
    s_branch M_g2p_it0
M_g2p_tz:
    buffer_load_dword v11, v9, s[8:11], s42 offen sc1
    s_waitcnt vmcnt(0)
    v_cmp_eq_u32 vcc, 0, v11
    s_cbranch_vccnz M_g2p_tzn
    s_add_u32 s28, s57, 0
    buffer_load_dwordx2 v[16:17], v10, s[8:11], s28 offen offset:0 sc1
    buffer_load_dwordx2 v[18:19], v10, s[8:11], s28 offen offset:512 sc1
    buffer_load_dwordx2 v[20:21], v10, s[8:11], s28 offen offset:1024 sc1
    buffer_load_dwordx2 v[22:23], v10, s[8:11], s28 offen offset:1536 sc1
    buffer_load_dwordx2 v[24:25], v10, s[8:11], s28 offen offset:2048 sc1
    buffer_load_dwordx2 v[26:27], v10, s[8:11], s28 offen offset:2560 sc1
    s_add_u32 s28, s57, 24576
    buffer_load_dwordx2 v[28:29], v10, s[8:11], s28 offen offset:0 sc1
    buffer_load_dwordx2 v[30:31], v10, s[8:11], s28 offen offset:512 sc1
    buffer_load_dwordx2 v[32:33], v10, s[8:11], s28 offen offset:1024 sc1
    buffer_load_dwordx2 v[34:35], v10, s[8:11], s28 offen offset:1536 sc1
    buffer_load_dwordx2 v[36:37], v10, s[8:11], s28 offen offset:2048 sc1
    buffer_load_dwordx2 v[38:39], v10, s[8:11], s28 offen offset:2560 sc1
    s_add_u32 s28, s57, 49152
    buffer_load_dwordx2 v[40:41], v10, s[8:11], s28 offen offset:0 sc1
    buffer_load_dwordx2 v[42:43], v10, s[8:11], s28 offen offset:512 sc1
    buffer_load_dwordx2 v[44:45], v10, s[8:11], s28 offen offset:1024 sc1
    buffer_load_dwordx2 v[46:47], v10, s[8:11], s28 offen offset:1536 sc1
    buffer_load_dwordx2 v[48:49], v10, s[8:11], s28 offen offset:2048 sc1
    buffer_load_dwordx2 v[50:51], v10, s[8:11], s28 offen offset:2560 sc1
    s_add_u32 s28, s57, 73728
    buffer_load_dwordx2 v[52:53], v10, s[8:11], s28 offen offset:0 sc1
    buffer_load_dwordx2 v[54:55], v10, s[8:11], s28 offen offset:512 sc1
    buffer_load_dwordx2 v[56:57], v10, s[8:11], s28 offen offset:1024 sc1
    buffer_load_dwordx2 v[58:59], v10, s[8:11], s28 offen offset:1536 sc1
    buffer_load_dwordx2 v[60:61], v10, s[8:11], s28 offen offset:2048 sc1
    buffer_load_dwordx2 v[62:63], v10, s[8:11], s28 offen offset:2560 sc1
    s_mov_b32 s48, 1
    s_waitcnt vmcnt(0)
    v_lshlrev_b32 v160, 16, v16
    v_and_b32 v161, s54, v16
    v_lshlrev_b32 v162, 16, v17
    v_and_b32 v163, s54, v17
    v_lshlrev_b32 v164, 16, v18
    v_and_b32 v165, s54, v18
    v_lshlrev_b32 v166, 16, v19
    v_and_b32 v167, s54, v19
    v_lshlrev_b32 v168, 16, v20
    v_and_b32 v169, s54, v20
    v_lshlrev_b32 v170, 16, v21
    v_and_b32 v171, s54, v21
    v_lshlrev_b32 v172, 16, v22
    v_and_b32 v173, s54, v22
    v_lshlrev_b32 v174, 16, v23
    v_and_b32 v175, s54, v23
    v_lshlrev_b32 v176, 16, v24
    v_and_b32 v177, s54, v24
    v_lshlrev_b32 v178, 16, v25
    v_and_b32 v179, s54, v25
    v_lshlrev_b32 v180, 16, v26
    v_and_b32 v181, s54, v26
    v_lshlrev_b32 v182, 16, v27
    v_and_b32 v183, s54, v27
    v_lshlrev_b32 v184, 16, v28
    v_and_b32 v185, s54, v28
    v_lshlrev_b32 v186, 16, v29
    v_and_b32 v187, s54, v29
    v_lshlrev_b32 v188, 16, v30
    v_and_b32 v189, s54, v30
    v_lshlrev_b32 v190, 16, v31
    v_and_b32 v191, s54, v31
    v_lshlrev_b32 v192, 16, v32
    v_and_b32 v193, s54, v32
    v_lshlrev_b32 v194, 16, v33
    v_and_b32 v195, s54, v33
    v_lshlrev_b32 v196, 16, v34
    v_and_b32 v197, s54, v34
    v_lshlrev_b32 v198, 16, v35
    v_and_b32 v199, s54, v35
    v_lshlrev_b32 v200, 16, v36
    v_and_b32 v201, s54, v36
    v_lshlrev_b32 v202, 16, v37
    v_and_b32 v203, s54, v37
    v_lshlrev_b32 v204, 16, v38
    v_and_b32 v205, s54, v38
    v_lshlrev_b32 v206, 16, v39
    v_and_b32 v207, s54, v39
    v_lshlrev_b32 v208, 16, v40
    v_and_b32 v209, s54, v40
    v_lshlrev_b32 v210, 16, v41
    v_and_b32 v211, s54, v41
    v_lshlrev_b32 v212, 16, v42
    v_and_b32 v213, s54, v42
    v_lshlrev_b32 v214, 16, v43
    v_and_b32 v215, s54, v43
    v_lshlrev_b32 v216, 16, v44
    v_and_b32 v217, s54, v44
    v_lshlrev_b32 v218, 16, v45
    v_and_b32 v219, s54, v45
    v_lshlrev_b32 v220, 16, v46
    v_and_b32 v221, s54, v46
    v_lshlrev_b32 v222, 16, v47
    v_and_b32 v223, s54, v47
    v_lshlrev_b32 v224, 16, v48
    v_and_b32 v225, s54, v48
    v_lshlrev_b32 v226, 16, v49
    v_and_b32 v227, s54, v49
    v_lshlrev_b32 v228, 16, v50
    v_and_b32 v229, s54, v50
    v_lshlrev_b32 v230, 16, v51
    v_and_b32 v231, s54, v51
    v_lshlrev_b32 v232, 16, v52
    v_and_b32 v233, s54, v52
    v_lshlrev_b32 v234, 16, v53
    v_and_b32 v235, s54, v53
    v_lshlrev_b32 v236, 16, v54
    v_and_b32 v237, s54, v54
    v_lshlrev_b32 v238, 16, v55
    v_and_b32 v239, s54, v55
    v_lshlrev_b32 v240, 16, v56
    v_and_b32 v241, s54, v56
    v_lshlrev_b32 v242, 16, v57
    v_and_b32 v243, s54, v57
    v_lshlrev_b32 v244, 16, v58
    v_and_b32 v245, s54, v58
    v_lshlrev_b32 v246, 16, v59
    v_and_b32 v247, s54, v59
    v_lshlrev_b32 v248, 16, v60
    v_and_b32 v249, s54, v60
    v_lshlrev_b32 v250, 16, v61
    v_and_b32 v251, s54, v61
    v_lshlrev_b32 v252, 16, v62
    v_and_b32 v253, s54, v62
    v_lshlrev_b32 v254, 16, v63
    v_and_b32 v255, s54, v63
M_g2p_tzn:
    s_cmp_eq_u32 s47, 0
    s_cbranch_scc1 M_g2p_tzr0
    s_branch M_g2p_tzr1
M_g2p_fin:
    s_mul_i32 s35, s31, 12288
    s_mul_i32 s28, s33, 6144
    s_add_u32 s35, s35, s28
    s_add_u32 s35, s35, 0xbae8000
    v_mov_b32 v9, 0
    s_cmp_eq_u32 s48, 0
    s_cbranch_scc1 M_g2p_fin2
    s_mov_b32 s39, 0
M_g2p_00_fl:
    buffer_load_dword v11, v9, s[8:11], s49 offen sc1
    s_add_u32 s39, s39, 1
    s_cmp_gt_u32 s39, 400000
    s_cbranch_scc1 M_fail
    s_waitcnt vmcnt(0)
    v_cmp_eq_u32 vcc, 0, v11
    s_cbranch_vccz M_g2p_00_fl_ok
    s_sleep 1
    s_branch M_g2p_00_fl
M_g2p_00_fl_ok:
    s_add_u32 s28, s35, 3072
    buffer_load_dwordx4 a[32:35], v2, s[8:11], s35 offen offset:0 sc1
    buffer_load_dwordx4 a[36:39], v2, s[8:11], s35 offen offset:1024 sc1
    buffer_load_dwordx4 a[40:43], v2, s[8:11], s35 offen offset:2048 sc1
    buffer_load_dwordx4 a[44:47], v2, s[8:11], s28 offen offset:0 sc1
    buffer_load_dwordx4 a[48:51], v2, s[8:11], s28 offen offset:1024 sc1
    buffer_load_dwordx4 a[52:55], v2, s[8:11], s28 offen offset:2048 sc1
    s_waitcnt vmcnt(5)
    v_mfma_f32_16x16x32_bf16 v[64:67], a[32:35], a[160:163], v[64:67]
    v_mfma_f32_16x16x32_bf16 v[88:91], a[32:35], a[168:171], v[88:91]
    v_mfma_f32_16x16x32_bf16 v[112:115], a[32:35], a[176:179], v[112:115]
    v_mfma_f32_16x16x32_bf16 v[136:139], a[32:35], a[184:187], v[136:139]
    s_waitcnt vmcnt(4)
    v_mfma_f32_16x16x32_bf16 v[68:71], a[36:39], a[160:163], v[68:71]
    v_mfma_f32_16x16x32_bf16 v[92:95], a[36:39], a[168:171], v[92:95]
    v_mfma_f32_16x16x32_bf16 v[116:119], a[36:39], a[176:179], v[116:119]
    v_mfma_f32_16x16x32_bf16 v[140:143], a[36:39], a[184:187], v[140:143]
    s_waitcnt vmcnt(3)
    v_mfma_f32_16x16x32_bf16 v[72:75], a[40:43], a[160:163], v[72:75]
    v_mfma_f32_16x16x32_bf16 v[96:99], a[40:43], a[168:171], v[96:99]
    v_mfma_f32_16x16x32_bf16 v[120:123], a[40:43], a[176:179], v[120:123]
    v_mfma_f32_16x16x32_bf16 v[144:147], a[40:43], a[184:187], v[144:147]
    s_waitcnt vmcnt(2)
    v_mfma_f32_16x16x32_bf16 v[76:79], a[44:47], a[160:163], v[76:79]
    v_mfma_f32_16x16x32_bf16 v[100:103], a[44:47], a[168:171], v[100:103]
    v_mfma_f32_16x16x32_bf16 v[124:127], a[44:47], a[176:179], v[124:127]
    v_mfma_f32_16x16x32_bf16 v[148:151], a[44:47], a[184:187], v[148:151]
    s_waitcnt vmcnt(1)
    v_mfma_f32_16x16x32_bf16 v[80:83], a[48:51], a[160:163], v[80:83]
    v_mfma_f32_16x16x32_bf16 v[104:107], a[48:51], a[168:171], v[104:107]
    v_mfma_f32_16x16x32_bf16 v[128:131], a[48:51], a[176:179], v[128:131]
    v_mfma_f32_16x16x32_bf16 v[152:155], a[48:51], a[184:187], v[152:155]
    s_waitcnt vmcnt(0)
    v_mfma_f32_16x16x32_bf16 v[84:87], a[52:55], a[160:163], v[84:87]
    v_mfma_f32_16x16x32_bf16 v[108:111], a[52:55], a[168:171], v[108:111]
    v_mfma_f32_16x16x32_bf16 v[132:135], a[52:55], a[176:179], v[132:135]
    v_mfma_f32_16x16x32_bf16 v[156:159], a[52:55], a[184:187], v[156:159]
    s_add_u32 s35, s35, 49152
    s_add_u32 s49, s49, 128
    s_add_u32 s42, s42, 128
    s_mov_b32 s39, 0
M_g2p_10_fl:
    buffer_load_dword v11, v9, s[8:11], s49 offen sc1
    s_add_u32 s39, s39, 1
    s_cmp_gt_u32 s39, 400000
    s_cbranch_scc1 M_fail
    s_waitcnt vmcnt(0)
    v_cmp_eq_u32 vcc, 0, v11
    s_cbranch_vccz M_g2p_10_fl_ok
    s_sleep 1
    s_branch M_g2p_10_fl
M_g2p_10_fl_ok:
    s_add_u32 s28, s35, 3072
    buffer_load_dwordx4 a[32:35], v2, s[8:11], s35 offen offset:0 sc1
    buffer_load_dwordx4 a[36:39], v2, s[8:11], s35 offen offset:1024 sc1
    buffer_load_dwordx4 a[40:43], v2, s[8:11], s35 offen offset:2048 sc1
    buffer_load_dwordx4 a[44:47], v2, s[8:11], s28 offen offset:0 sc1
    buffer_load_dwordx4 a[48:51], v2, s[8:11], s28 offen offset:1024 sc1
    buffer_load_dwordx4 a[52:55], v2, s[8:11], s28 offen offset:2048 sc1
    s_waitcnt vmcnt(5)
    v_mfma_f32_16x16x32_bf16 v[64:67], a[32:35], a[164:167], v[64:67]
    v_mfma_f32_16x16x32_bf16 v[88:91], a[32:35], a[172:175], v[88:91]
    v_mfma_f32_16x16x32_bf16 v[112:115], a[32:35], a[180:183], v[112:115]
    v_mfma_f32_16x16x32_bf16 v[136:139], a[32:35], a[188:191], v[136:139]
    s_waitcnt vmcnt(4)
    v_mfma_f32_16x16x32_bf16 v[68:71], a[36:39], a[164:167], v[68:71]
    v_mfma_f32_16x16x32_bf16 v[92:95], a[36:39], a[172:175], v[92:95]
    v_mfma_f32_16x16x32_bf16 v[116:119], a[36:39], a[180:183], v[116:119]
    v_mfma_f32_16x16x32_bf16 v[140:143], a[36:39], a[188:191], v[140:143]
    s_waitcnt vmcnt(3)
    v_mfma_f32_16x16x32_bf16 v[72:75], a[40:43], a[164:167], v[72:75]
    v_mfma_f32_16x16x32_bf16 v[96:99], a[40:43], a[172:175], v[96:99]
    v_mfma_f32_16x16x32_bf16 v[120:123], a[40:43], a[180:183], v[120:123]
    v_mfma_f32_16x16x32_bf16 v[144:147], a[40:43], a[188:191], v[144:147]
    s_waitcnt vmcnt(2)
    v_mfma_f32_16x16x32_bf16 v[76:79], a[44:47], a[164:167], v[76:79]
    v_mfma_f32_16x16x32_bf16 v[100:103], a[44:47], a[172:175], v[100:103]
    v_mfma_f32_16x16x32_bf16 v[124:127], a[44:47], a[180:183], v[124:127]
    v_mfma_f32_16x16x32_bf16 v[148:151], a[44:47], a[188:191], v[148:151]
    s_waitcnt vmcnt(1)
    v_mfma_f32_16x16x32_bf16 v[80:83], a[48:51], a[164:167], v[80:83]
    v_mfma_f32_16x16x32_bf16 v[104:107], a[48:51], a[172:175], v[104:107]
    v_mfma_f32_16x16x32_bf16 v[128:131], a[48:51], a[180:183], v[128:131]
    v_mfma_f32_16x16x32_bf16 v[152:155], a[48:51], a[188:191], v[152:155]
    s_waitcnt vmcnt(0)
    v_mfma_f32_16x16x32_bf16 v[84:87], a[52:55], a[164:167], v[84:87]
    v_mfma_f32_16x16x32_bf16 v[108:111], a[52:55], a[172:175], v[108:111]
    v_mfma_f32_16x16x32_bf16 v[132:135], a[52:55], a[180:183], v[132:135]
    v_mfma_f32_16x16x32_bf16 v[156:159], a[52:55], a[188:191], v[156:159]
    s_branch M_g2p_epi
M_g2p_fin2:
    s_mov_b32 s39, 0
M_g2p_01_fz:
    buffer_load_dword v11, v9, s[8:11], s42 offen sc1
    s_add_u32 s39, s39, 1
    s_cmp_gt_u32 s39, 400000
    s_cbranch_scc1 M_fail
    s_waitcnt vmcnt(0)
    v_cmp_eq_u32 vcc, 0, v11
    s_cbranch_vccz M_g2p_01_fz_ok
    s_sleep 1
    s_branch M_g2p_01_fz
M_g2p_01_fz_ok:
    s_add_u32 s28, s57, 0
    buffer_load_dwordx2 v[16:17], v10, s[8:11], s28 offen offset:0 sc1
    buffer_load_dwordx2 v[18:19], v10, s[8:11], s28 offen offset:512 sc1
    buffer_load_dwordx2 v[20:21], v10, s[8:11], s28 offen offset:1024 sc1
    buffer_load_dwordx2 v[22:23], v10, s[8:11], s28 offen offset:1536 sc1
    buffer_load_dwordx2 v[24:25], v10, s[8:11], s28 offen offset:2048 sc1
    buffer_load_dwordx2 v[26:27], v10, s[8:11], s28 offen offset:2560 sc1
    s_add_u32 s28, s57, 24576
    buffer_load_dwordx2 v[28:29], v10, s[8:11], s28 offen offset:0 sc1
    buffer_load_dwordx2 v[30:31], v10, s[8:11], s28 offen offset:512 sc1
    buffer_load_dwordx2 v[32:33], v10, s[8:11], s28 offen offset:1024 sc1
    buffer_load_dwordx2 v[34:35], v10, s[8:11], s28 offen offset:1536 sc1
    buffer_load_dwordx2 v[36:37], v10, s[8:11], s28 offen offset:2048 sc1
    buffer_load_dwordx2 v[38:39], v10, s[8:11], s28 offen offset:2560 sc1
    s_mov_b32 s39, 0
M_g2p_01_fl:
    buffer_load_dword v11, v9, s[8:11], s49 offen sc1
    s_add_u32 s39, s39, 1
    s_cmp_gt_u32 s39, 400000
    s_cbranch_scc1 M_fail
    s_waitcnt vmcnt(0)
    v_cmp_eq_u32 vcc, 0, v11
    s_cbranch_vccz M_g2p_01_fl_ok
    s_sleep 1
    s_branch M_g2p_01_fl
M_g2p_01_fl_ok:
    s_add_u32 s28, s35, 3072
    buffer_load_dwordx4 a[32:35], v2, s[8:11], s35 offen offset:0 sc1
    buffer_load_dwordx4 a[36:39], v2, s[8:11], s35 offen offset:1024 sc1
    buffer_load_dwordx4 a[40:43], v2, s[8:11], s35 offen offset:2048 sc1
    buffer_load_dwordx4 a[44:47], v2, s[8:11], s28 offen offset:0 sc1
    buffer_load_dwordx4 a[48:51], v2, s[8:11], s28 offen offset:1024 sc1
    buffer_load_dwordx4 a[52:55], v2, s[8:11], s28 offen offset:2048 sc1
    v_lshlrev_b32 v160, 16, v16
    v_and_b32 v161, s54, v16
    v_lshlrev_b32 v162, 16, v17
    v_and_b32 v163, s54, v17
    v_lshlrev_b32 v164, 16, v18
    v_and_b32 v165, s54, v18
    v_lshlrev_b32 v166, 16, v19
    v_and_b32 v167, s54, v19
    v_lshlrev_b32 v168, 16, v20
    v_and_b32 v169, s54, v20
    v_lshlrev_b32 v170, 16, v21
    v_and_b32 v171, s54, v21
    v_lshlrev_b32 v172, 16, v22
    v_and_b32 v173, s54, v22
    v_lshlrev_b32 v174, 16, v23
    v_and_b32 v175, s54, v23
    v_lshlrev_b32 v176, 16, v24
    v_and_b32 v177, s54, v24
    v_lshlrev_b32 v178, 16, v25
    v_and_b32 v179, s54, v25
    v_lshlrev_b32 v180, 16, v26
    v_and_b32 v181, s54, v26
    v_lshlrev_b32 v182, 16, v27
    v_and_b32 v183, s54, v27
    v_lshlrev_b32 v184, 16, v28
    v_and_b32 v185, s54, v28
    v_lshlrev_b32 v186, 16, v29
    v_and_b32 v187, s54, v29
    v_lshlrev_b32 v188, 16, v30
    v_and_b32 v189, s54, v30
    v_lshlrev_b32 v190, 16, v31
    v_and_b32 v191, s54, v31
    v_lshlrev_b32 v192, 16, v32
    v_and_b32 v193, s54, v32
    v_lshlrev_b32 v194, 16, v33
    v_and_b32 v195, s54, v33
    v_lshlrev_b32 v196, 16, v34
    v_and_b32 v197, s54, v34
    v_lshlrev_b32 v198, 16, v35
    v_and_b32 v199, s54, v35
    v_lshlrev_b32 v200, 16, v36
    v_and_b32 v201, s54, v36
    v_lshlrev_b32 v202, 16, v37
    v_and_b32 v203, s54, v37
    v_lshlrev_b32 v204, 16, v38
    v_and_b32 v205, s54, v38
    v_lshlrev_b32 v206, 16, v39
    v_and_b32 v207, s54, v39
    s_waitcnt vmcnt(5)
    v_mfma_f32_16x16x32_bf16 v[64:67], a[32:35], a[160:163], v[64:67]
    v_mfma_f32_16x16x32_bf16 v[88:91], a[32:35], a[168:171], v[88:91]
    v_mfma_f32_16x16x32_bf16 v[112:115], a[32:35], a[176:179], v[112:115]
    v_mfma_f32_16x16x32_bf16 v[136:139], a[32:35], a[184:187], v[136:139]
    s_waitcnt vmcnt(4)
    v_mfma_f32_16x16x32_bf16 v[68:71], a[36:39], a[160:163], v[68:71]
    v_mfma_f32_16x16x32_bf16 v[92:95], a[36:39], a[168:171], v[92:95]
    v_mfma_f32_16x16x32_bf16 v[116:119], a[36:39], a[176:179], v[116:119]
    v_mfma_f32_16x16x32_bf16 v[140:143], a[36:39], a[184:187], v[140:143]
    s_waitcnt vmcnt(3)
    v_mfma_f32_16x16x32_bf16 v[72:75], a[40:43], a[160:163], v[72:75]
    v_mfma_f32_16x16x32_bf16 v[96:99], a[40:43], a[168:171], v[96:99]
    v_mfma_f32_16x16x32_bf16 v[120:123], a[40:43], a[176:179], v[120:123]
    v_mfma_f32_16x16x32_bf16 v[144:147], a[40:43], a[184:187], v[144:147]
    s_waitcnt vmcnt(2)
    v_mfma_f32_16x16x32_bf16 v[76:79], a[44:47], a[160:163], v[76:79]
    v_mfma_f32_16x16x32_bf16 v[100:103], a[44:47], a[168:171], v[100:103]
    v_mfma_f32_16x16x32_bf16 v[124:127], a[44:47], a[176:179], v[124:127]
    v_mfma_f32_16x16x32_bf16 v[148:151], a[44:47], a[184:187], v[148:151]
    s_waitcnt vmcnt(1)
    v_mfma_f32_16x16x32_bf16 v[80:83], a[48:51], a[160:163], v[80:83]
    v_mfma_f32_16x16x32_bf16 v[104:107], a[48:51], a[168:171], v[104:107]
    v_mfma_f32_16x16x32_bf16 v[128:131], a[48:51], a[176:179], v[128:131]
    v_mfma_f32_16x16x32_bf16 v[152:155], a[48:51], a[184:187], v[152:155]
    s_waitcnt vmcnt(0)
    v_mfma_f32_16x16x32_bf16 v[84:87], a[52:55], a[160:163], v[84:87]
    v_mfma_f32_16x16x32_bf16 v[108:111], a[52:55], a[168:171], v[108:111]
    v_mfma_f32_16x16x32_bf16 v[132:135], a[52:55], a[176:179], v[132:135]
    v_mfma_f32_16x16x32_bf16 v[156:159], a[52:55], a[184:187], v[156:159]
    s_add_u32 s35, s35, 49152
    s_add_u32 s49, s49, 128
    s_add_u32 s42, s42, 128
    s_mov_b32 s39, 0
M_g2p_11_fz:
    buffer_load_dword v11, v9, s[8:11], s42 offen sc1
    s_add_u32 s39, s39, 1
    s_cmp_gt_u32 s39, 400000
    s_cbranch_scc1 M_fail
    s_waitcnt vmcnt(0)
    v_cmp_eq_u32 vcc, 0, v11
    s_cbranch_vccz M_g2p_11_fz_ok
    s_sleep 1
    s_branch M_g2p_11_fz
M_g2p_11_fz_ok:
    s_add_u32 s28, s57, 49152
    buffer_load_dwordx2 v[40:41], v10, s[8:11], s28 offen offset:0 sc1
    buffer_load_dwordx2 v[42:43], v10, s[8:11], s28 offen offset:512 sc1
    buffer_load_dwordx2 v[44:45], v10, s[8:11], s28 offen offset:1024 sc1
    buffer_load_dwordx2 v[46:47], v10, s[8:11], s28 offen offset:1536 sc1
    buffer_load_dwordx2 v[48:49], v10, s[8:11], s28 offen offset:2048 sc1
    buffer_load_dwordx2 v[50:51], v10, s[8:11], s28 offen offset:2560 sc1
    s_add_u32 s28, s57, 73728
    buffer_load_dwordx2 v[52:53], v10, s[8:11], s28 offen offset:0 sc1
    buffer_load_dwordx2 v[54:55], v10, s[8:11], s28 offen offset:512 sc1
    buffer_load_dwordx2 v[56:57], v10, s[8:11], s28 offen offset:1024 sc1
    buffer_load_dwordx2 v[58:59], v10, s[8:11], s28 offen offset:1536 sc1
    buffer_load_dwordx2 v[60:61], v10, s[8:11], s28 offen offset:2048 sc1
    buffer_load_dwordx2 v[62:63], v10, s[8:11], s28 offen offset:2560 sc1
    s_mov_b32 s39, 0
M_g2p_11_fl:
    buffer_load_dword v11, v9, s[8:11], s49 offen sc1
    s_add_u32 s39, s39, 1
    s_cmp_gt_u32 s39, 400000
    s_cbranch_scc1 M_fail
    s_waitcnt vmcnt(0)
    v_cmp_eq_u32 vcc, 0, v11
    s_cbranch_vccz M_g2p_11_fl_ok
    s_sleep 1
    s_branch M_g2p_11_fl
M_g2p_11_fl_ok:
    s_add_u32 s28, s35, 3072
    buffer_load_dwordx4 a[32:35], v2, s[8:11], s35 offen offset:0 sc1
    buffer_load_dwordx4 a[36:39], v2, s[8:11], s35 offen offset:1024 sc1
    buffer_load_dwordx4 a[40:43], v2, s[8:11], s35 offen offset:2048 sc1
    buffer_load_dwordx4 a[44:47], v2, s[8:11], s28 offen offset:0 sc1
    buffer_load_dwordx4 a[48:51], v2, s[8:11], s28 offen offset:1024 sc1
    buffer_load_dwordx4 a[52:55], v2, s[8:11], s28 offen offset:2048 sc1
    v_lshlrev_b32 v208, 16, v40
    v_and_b32 v209, s54, v40
    v_lshlrev_b32 v210, 16, v41
    v_and_b32 v211, s54, v41
    v_lshlrev_b32 v212, 16, v42
    v_and_b32 v213, s54, v42
    v_lshlrev_b32 v214, 16, v43
    v_and_b32 v215, s54, v43
    v_lshlrev_b32 v216, 16, v44
    v_and_b32 v217, s54, v44
    v_lshlrev_b32 v218, 16, v45
    v_and_b32 v219, s54, v45
    v_lshlrev_b32 v220, 16, v46
    v_and_b32 v221, s54, v46
    v_lshlrev_b32 v222, 16, v47
    v_and_b32 v223, s54, v47
    v_lshlrev_b32 v224, 16, v48
    v_and_b32 v225, s54, v48
    v_lshlrev_b32 v226, 16, v49
    v_and_b32 v227, s54, v49
    v_lshlrev_b32 v228, 16, v50
    v_and_b32 v229, s54, v50
    v_lshlrev_b32 v230, 16, v51
    v_and_b32 v231, s54, v51
    v_lshlrev_b32 v232, 16, v52
    v_and_b32 v233, s54, v52
    v_lshlrev_b32 v234, 16, v53
    v_and_b32 v235, s54, v53
    v_lshlrev_b32 v236, 16, v54
    v_and_b32 v237, s54, v54
    v_lshlrev_b32 v238, 16, v55
    v_and_b32 v239, s54, v55
    v_lshlrev_b32 v240, 16, v56
    v_and_b32 v241, s54, v56
    v_lshlrev_b32 v242, 16, v57
    v_and_b32 v243, s54, v57
    v_lshlrev_b32 v244, 16, v58
    v_and_b32 v245, s54, v58
    v_lshlrev_b32 v246, 16, v59
    v_and_b32 v247, s54, v59
    v_lshlrev_b32 v248, 16, v60
    v_and_b32 v249, s54, v60
    v_lshlrev_b32 v250, 16, v61
    v_and_b32 v251, s54, v61
    v_lshlrev_b32 v252, 16, v62
    v_and_b32 v253, s54, v62
    v_lshlrev_b32 v254, 16, v63
    v_and_b32 v255, s54, v63
    s_waitcnt vmcnt(5)
    v_mfma_f32_16x16x32_bf16 v[64:67], a[32:35], a[164:167], v[64:67]
    v_mfma_f32_16x16x32_bf16 v[88:91], a[32:35], a[172:175], v[88:91]
    v_mfma_f32_16x16x32_bf16 v[112:115], a[32:35], a[180:183], v[112:115]
    v_mfma_f32_16x16x32_bf16 v[136:139], a[32:35], a[188:191], v[136:139]
    s_waitcnt vmcnt(4)
    v_mfma_f32_16x16x32_bf16 v[68:71], a[36:39], a[164:167], v[68:71]
    v_mfma_f32_16x16x32_bf16 v[92:95], a[36:39], a[172:175], v[92:95]
    v_mfma_f32_16x16x32_bf16 v[116:119], a[36:39], a[180:183], v[116:119]
    v_mfma_f32_16x16x32_bf16 v[140:143], a[36:39], a[188:191], v[140:143]
    s_waitcnt vmcnt(3)
    v_mfma_f32_16x16x32_bf16 v[72:75], a[40:43], a[164:167], v[72:75]
    v_mfma_f32_16x16x32_bf16 v[96:99], a[40:43], a[172:175], v[96:99]
    v_mfma_f32_16x16x32_bf16 v[120:123], a[40:43], a[180:183], v[120:123]
    v_mfma_f32_16x16x32_bf16 v[144:147], a[40:43], a[188:191], v[144:147]
    s_waitcnt vmcnt(2)
    v_mfma_f32_16x16x32_bf16 v[76:79], a[44:47], a[164:167], v[76:79]
    v_mfma_f32_16x16x32_bf16 v[100:103], a[44:47], a[172:175], v[100:103]
    v_mfma_f32_16x16x32_bf16 v[124:127], a[44:47], a[180:183], v[124:127]
    v_mfma_f32_16x16x32_bf16 v[148:151], a[44:47], a[188:191], v[148:151]
    s_waitcnt vmcnt(1)
    v_mfma_f32_16x16x32_bf16 v[80:83], a[48:51], a[164:167], v[80:83]
    v_mfma_f32_16x16x32_bf16 v[104:107], a[48:51], a[172:175], v[104:107]
    v_mfma_f32_16x16x32_bf16 v[128:131], a[48:51], a[180:183], v[128:131]
    v_mfma_f32_16x16x32_bf16 v[152:155], a[48:51], a[188:191], v[152:155]
    s_waitcnt vmcnt(0)
    v_mfma_f32_16x16x32_bf16 v[84:87], a[52:55], a[164:167], v[84:87]
    v_mfma_f32_16x16x32_bf16 v[108:111], a[52:55], a[172:175], v[108:111]
    v_mfma_f32_16x16x32_bf16 v[132:135], a[52:55], a[180:183], v[132:135]
    v_mfma_f32_16x16x32_bf16 v[156:159], a[52:55], a[188:191], v[156:159]
M_g2p_epi:
    v_pk_mul_f32 v[64:65], v[64:65], v[160:161]
    v_pk_mul_f32 v[66:67], v[66:67], v[162:163]
    v_pk_mul_f32 v[68:69], v[68:69], v[164:165]
    v_pk_mul_f32 v[70:71], v[70:71], v[166:167]
    s_add_u32 s28, s43, 0
    v_cvt_pk_bf16_f32 v16, v64, v65
    v_cvt_pk_bf16_f32 v17, v66, v67
    v_cvt_pk_bf16_f32 v18, v68, v69
    v_cvt_pk_bf16_f32 v19, v70, v71
    buffer_store_dwordx4 v[16:19], v2, s[8:11], s28 offen offset:0 sc1
    v_pk_mul_f32 v[88:89], v[88:89], v[184:185]
    v_pk_mul_f32 v[90:91], v[90:91], v[186:187]
    v_pk_mul_f32 v[92:93], v[92:93], v[188:189]
    v_pk_mul_f32 v[94:95], v[94:95], v[190:191]
    s_add_u32 s28, s43, 24576
    v_cvt_pk_bf16_f32 v20, v88, v89
    v_cvt_pk_bf16_f32 v21, v90, v91
    v_cvt_pk_bf16_f32 v22, v92, v93
    v_cvt_pk_bf16_f32 v23, v94, v95
    buffer_store_dwordx4 v[20:23], v2, s[8:11], s28 offen offset:0 sc1
    v_pk_mul_f32 v[112:113], v[112:113], v[208:209]
    v_pk_mul_f32 v[114:115], v[114:115], v[210:211]
    v_pk_mul_f32 v[116:117], v[116:117], v[212:213]
    v_pk_mul_f32 v[118:119], v[118:119], v[214:215]
    s_add_u32 s28, s43, 49152
    v_cvt_pk_bf16_f32 v24, v112, v113
    v_cvt_pk_bf16_f32 v25, v114, v115
    v_cvt_pk_bf16_f32 v26, v116, v117
    v_cvt_pk_bf16_f32 v27, v118, v119
    buffer_store_dwordx4 v[24:27], v2, s[8:11], s28 offen offset:0 sc1
    v_pk_mul_f32 v[136:137], v[136:137], v[232:233]
    v_pk_mul_f32 v[138:139], v[138:139], v[234:235]
    v_pk_mul_f32 v[140:141], v[140:141], v[236:237]
    v_pk_mul_f32 v[142:143], v[142:143], v[238:239]
    s_add_u32 s28, s43, 73728
    v_cvt_pk_bf16_f32 v28, v136, v137
    v_cvt_pk_bf16_f32 v29, v138, v139
    v_cvt_pk_bf16_f32 v30, v140, v141
    v_cvt_pk_bf16_f32 v31, v142, v143
    buffer_store_dwordx4 v[28:31], v2, s[8:11], s28 offen offset:0 sc1
    v_pk_mul_f32 v[72:73], v[72:73], v[168:169]
    v_pk_mul_f32 v[74:75], v[74:75], v[170:171]
    v_pk_mul_f32 v[76:77], v[76:77], v[172:173]
    v_pk_mul_f32 v[78:79], v[78:79], v[174:175]
    s_add_u32 s28, s43, 0
    v_cvt_pk_bf16_f32 v32, v72, v73
    v_cvt_pk_bf16_f32 v33, v74, v75
    v_cvt_pk_bf16_f32 v34, v76, v77
    v_cvt_pk_bf16_f32 v35, v78, v79
    buffer_store_dwordx4 v[32:35], v2, s[8:11], s28 offen offset:1024 sc1
    v_pk_mul_f32 v[96:97], v[96:97], v[192:193]
    v_pk_mul_f32 v[98:99], v[98:99], v[194:195]
    v_pk_mul_f32 v[100:101], v[100:101], v[196:197]
    v_pk_mul_f32 v[102:103], v[102:103], v[198:199]
    s_add_u32 s28, s43, 24576
    v_cvt_pk_bf16_f32 v36, v96, v97
    v_cvt_pk_bf16_f32 v37, v98, v99
    v_cvt_pk_bf16_f32 v38, v100, v101
    v_cvt_pk_bf16_f32 v39, v102, v103
    buffer_store_dwordx4 v[36:39], v2, s[8:11], s28 offen offset:1024 sc1
    v_pk_mul_f32 v[120:121], v[120:121], v[216:217]
    v_pk_mul_f32 v[122:123], v[122:123], v[218:219]
    v_pk_mul_f32 v[124:125], v[124:125], v[220:221]
    v_pk_mul_f32 v[126:127], v[126:127], v[222:223]
    s_add_u32 s28, s43, 49152
    v_cvt_pk_bf16_f32 v40, v120, v121
    v_cvt_pk_bf16_f32 v41, v122, v123
    v_cvt_pk_bf16_f32 v42, v124, v125
    v_cvt_pk_bf16_f32 v43, v126, v127
    buffer_store_dwordx4 v[40:43], v2, s[8:11], s28 offen offset:1024 sc1
    v_pk_mul_f32 v[144:145], v[144:145], v[240:241]
    v_pk_mul_f32 v[146:147], v[146:147], v[242:243]
    v_pk_mul_f32 v[148:149], v[148:149], v[244:245]
    v_pk_mul_f32 v[150:151], v[150:151], v[246:247]
    s_add_u32 s28, s43, 73728
    v_cvt_pk_bf16_f32 v44, v144, v145
    v_cvt_pk_bf16_f32 v45, v146, v147
    v_cvt_pk_bf16_f32 v46, v148, v149
    v_cvt_pk_bf16_f32 v47, v150, v151
    buffer_store_dwordx4 v[44:47], v2, s[8:11], s28 offen offset:1024 sc1
    v_pk_mul_f32 v[80:81], v[80:81], v[176:177]
    v_pk_mul_f32 v[82:83], v[82:83], v[178:179]
    v_pk_mul_f32 v[84:85], v[84:85], v[180:181]
    v_pk_mul_f32 v[86:87], v[86:87], v[182:183]
    s_add_u32 s28, s43, 0
    v_cvt_pk_bf16_f32 v48, v80, v81
    v_cvt_pk_bf16_f32 v49, v82, v83
    v_cvt_pk_bf16_f32 v50, v84, v85
    v_cvt_pk_bf16_f32 v51, v86, v87
    buffer_store_dwordx4 v[48:51], v2, s[8:11], s28 offen offset:2048 sc1
    v_pk_mul_f32 v[104:105], v[104:105], v[200:201]
    v_pk_mul_f32 v[106:107], v[106:107], v[202:203]
    v_pk_mul_f32 v[108:109], v[108:109], v[204:205]
    v_pk_mul_f32 v[110:111], v[110:111], v[206:207]
    s_add_u32 s28, s43, 24576
    v_cvt_pk_bf16_f32 v52, v104, v105
    v_cvt_pk_bf16_f32 v53, v106, v107
    v_cvt_pk_bf16_f32 v54, v108, v109
    v_cvt_pk_bf16_f32 v55, v110, v111
    buffer_store_dwordx4 v[52:55], v2, s[8:11], s28 offen offset:2048 sc1
    v_pk_mul_f32 v[128:129], v[128:129], v[224:225]
    v_pk_mul_f32 v[130:131], v[130:131], v[226:227]
    v_pk_mul_f32 v[132:133], v[132:133], v[228:229]
    v_pk_mul_f32 v[134:135], v[134:135], v[230:231]
    s_add_u32 s28, s43, 49152
    v_cvt_pk_bf16_f32 v56, v128, v129
    v_cvt_pk_bf16_f32 v57, v130, v131
    v_cvt_pk_bf16_f32 v58, v132, v133
    v_cvt_pk_bf16_f32 v59, v134, v135
    buffer_store_dwordx4 v[56:59], v2, s[8:11], s28 offen offset:2048 sc1
    v_pk_mul_f32 v[152:153], v[152:153], v[248:249]
    v_pk_mul_f32 v[154:155], v[154:155], v[250:251]
    v_pk_mul_f32 v[156:157], v[156:157], v[252:253]
    v_pk_mul_f32 v[158:159], v[158:159], v[254:255]
    s_add_u32 s28, s43, 73728
    v_cvt_pk_bf16_f32 v60, v152, v153
    v_cvt_pk_bf16_f32 v61, v154, v155
    v_cvt_pk_bf16_f32 v62, v156, v157
    v_cvt_pk_bf16_f32 v63, v158, v159
    buffer_store_dwordx4 v[60:63], v2, s[8:11], s28 offen offset:2048 sc1
    s_lshl_b32 s28, s30, 1
    s_add_u32 s28, s28, s32
    s_lshl_b32 s28, s28, 3
    s_lshl_b32 s29, s31, 1
    s_add_u32 s28, s28, s29
    s_add_u32 s28, s28, s33
    s_lshl_b32 s28, s28, 7
    s_add_u32 s28, s28, 0x9ac000
    v_mov_b32 v6, 0x7ff00000
    v_cmp_gt_u32 vcc, 32, v1
    v_lshlrev_b32 v7, 2, v1
    s_nop 0
    v_cndmask_b32 v6, v6, v7, vcc
    v_mov_b32 v7, 1
    s_waitcnt vmcnt(0)
    buffer_store_dword v7, v6, s[8:11], s28 offen sc1
    s_branch M_end
M_qk:
    s_mov_b32 s12, s98
    s_and_b32 s13, s99, 0xffff
    s_mov_b32 s14, 0x780000
    s_mov_b32 s15, 0x20000
    s_mov_b32 s16, s96
    s_and_b32 s17, s97, 0xffff
    s_mov_b32 s18, 0x780000
    s_mov_b32 s19, 0x20000
    v_lshrrev_b32 v100, 3, v1
    v_and_b32 v101, 7, v1
    v_lshlrev_b32 v101, 4, v101
    v_mul_u32_u24 v99, 12288, v100
    v_add_u32 v99, v99, v101
    v_mul_u32_u24 v96, 1280, v100
    v_add_u32 v96, v96, v101
    v_lshrrev_b32 v100, 4, v1
    v_bfe_u32 v101, v1, 2, 2
    v_and_b32 v102, 3, v1
    v_lshl_add_u32 v103, v100, 3, v101
    v_lshlrev_b32 v104, 7, v103
    v_lshl_add_u32 v104, v102, 3, v104
    v_add_u32 v104, 24576, v104
    v_and_b32 v103, 1, v101
    v_lshlrev_b32 v103, 4, v103
    v_lshrrev_b32 v105, 1, v101
    v_add_u32 v103, v103, v105
    v_lshl_add_u32 v103, v100, 2, v103
    v_lshlrev_b32 v103, 7, v103
    v_lshl_add_u32 v103, v102, 3, v103
    s_lshl_b32 s28, s21, 5
    v_add_u32 v103, s28, v103
    s_lshr_b32 s28, s21, 1
    s_lshl_b32 s28, s28, 6
    v_add_u32 v104, s28, v104
    s_mul_i32 s80, s20, 245760
    s_mul_i32 s28, s21, 61440
    s_add_u32 s80, s80, s28
    s_mul_i32 s81, s20, 384
    s_mul_i32 s28, s21, 196608
    s_add_u32 s81, s81, s28
    s_add_u32 s81, s81, 256
    s_mul_i32 s82, s21, 6144
    s_lshl_b32 s84, s21, 11
    v_mov_b32 v100, 128
    v_mov_b32 v92, 0
    v_mov_b32 v93, 0
    v_mov_b32 v94, 0
    v_mov_b32 v95, 0
    s_mov_b32 s86, 0
    v_lshlrev_b32 v2, 4, v1
    s_add_u32 m0, s82, 61440
    s_add_u32 s85, s80, 0
    buffer_load_dwordx4 v96, s[12:15], s85 offen nt lds
    s_add_u32 m0, s82, 62464
    s_add_u32 s85, s80, 10240
    buffer_load_dwordx4 v96, s[12:15], s85 offen nt lds
    s_add_u32 m0, s82, 63488
    s_add_u32 s85, s80, 20480
    buffer_load_dwordx4 v96, s[12:15], s85 offen nt lds
    s_add_u32 m0, s82, 64512
    s_add_u32 s85, s80, 30720
    buffer_load_dwordx4 v96, s[12:15], s85 offen nt lds
    s_add_u32 m0, s82, 65536
    s_add_u32 s85, s80, 40960
    buffer_load_dwordx4 v96, s[12:15], s85 offen nt lds
    s_add_u32 m0, s82, 66560
    s_add_u32 s85, s80, 51200
    buffer_load_dwordx4 v96, s[12:15], s85 offen nt lds
    s_add_u32 m0, s84, 86016
    s_add_u32 s85, s81, 0
    buffer_load_dwordx4 v99, s[16:19], s85 offen nt lds
    s_add_u32 m0, s84, 87040
    s_add_u32 s85, s81, 98304
    buffer_load_dwordx4 v99, s[16:19], s85 offen nt lds
    s_add_u32 m0, s82, 94208
    s_add_u32 s85, s80, 128
    buffer_load_dwordx4 v96, s[12:15], s85 offen nt lds
    s_add_u32 m0, s82, 95232
    s_add_u32 s85, s80, 10368
    buffer_load_dwordx4 v96, s[12:15], s85 offen nt lds
    s_add_u32 m0, s82, 96256
    s_add_u32 s85, s80, 20608
    buffer_load_dwordx4 v96, s[12:15], s85 offen nt lds
    s_add_u32 m0, s82, 97280
    s_add_u32 s85, s80, 30848
    buffer_load_dwordx4 v96, s[12:15], s85 offen nt lds
    s_add_u32 m0, s82, 98304
    s_add_u32 s85, s80, 41088
    buffer_load_dwordx4 v96, s[12:15], s85 offen nt lds
    s_add_u32 m0, s82, 99328
    s_add_u32 s85, s80, 51328
    buffer_load_dwordx4 v96, s[12:15], s85 offen nt lds
    s_add_u32 m0, s84, 118784
    s_add_u32 s85, s81, 786432
    buffer_load_dwordx4 v99, s[16:19], s85 offen nt lds
    s_add_u32 m0, s84, 119808
    s_add_u32 s85, s81, 884736
    buffer_load_dwordx4 v99, s[16:19], s85 offen nt lds
    s_add_u32 m0, s82, 126976
    s_add_u32 s85, s80, 256
    buffer_load_dwordx4 v96, s[12:15], s85 offen nt lds
    s_add_u32 m0, s82, 128000
    s_add_u32 s85, s80, 10496
    buffer_load_dwordx4 v96, s[12:15], s85 offen nt lds
    s_add_u32 m0, s82, 129024
    s_add_u32 s85, s80, 20736
    buffer_load_dwordx4 v96, s[12:15], s85 offen nt lds
    s_add_u32 m0, s82, 130048
    s_add_u32 s85, s80, 30976
    buffer_load_dwordx4 v96, s[12:15], s85 offen nt lds
    s_add_u32 m0, s82, 131072
    s_add_u32 s85, s80, 41216
    buffer_load_dwordx4 v96, s[12:15], s85 offen nt lds
    s_add_u32 m0, s82, 132096
    s_add_u32 s85, s80, 51456
    buffer_load_dwordx4 v96, s[12:15], s85 offen nt lds
    s_add_u32 m0, s84, 151552
    s_add_u32 s85, s81, 1572864
    buffer_load_dwordx4 v99, s[16:19], s85 offen nt lds
    s_add_u32 m0, s84, 152576
    s_add_u32 s85, s81, 1671168
    buffer_load_dwordx4 v99, s[16:19], s85 offen nt lds
    s_lshl_b32 s28, s20, 7
    v_mov_b32 v6, 0x7ff00000
    v_lshl_add_u32 v7, v0, 2, s28
    v_cmp_gt_u32 vcc, 32, v0
    s_nop 1
    v_cndmask_b32 v6, v6, v7, vcc
    v_mov_b32 v7, 1
    s_and_b32 s28, s21, 1
    s_mul_i32 s29, s28, 20480
    v_add_u32 v4, s29, v2
    v_add_u32 v5, 98304, v2
    s_mul_i32 s28, s28, 6144
    s_lshr_b32 s29, s21, 1
    s_lshl_b32 s29, s29, 10
    s_add_u32 s28, s28, s29
    s_add_u32 s28, s28, 4096
    v_add_u32 v3, s28, v5
    v_and_b32 v108, 1, v1
    v_mul_u32_u24 v108, 0x40000, v108
    s_lshl_b32 s28, s20, 7
    v_add_u32 v108, s28, v108
    s_mul_i32 s35, s21, 10240
    s_add_u32 s34, s35, 0
    s_lshl_b32 s36, s21, 15
    s_lshl_b32 s28, s20, 10
    s_add_u32 s36, s36, s28
    s_add_u32 s36, s36, 0x4000000
    s_mov_b32 s37, 0x9c0000
    s_mov_b32 s43, 0x800000
    s_mov_b32 s44, 0x840000
    s_mov_b32 s47, 1
    s_lshr_b32 s28, s21, 1
    s_mul_i32 s45, s28, 6144
    s_and_b32 s28, s21, 1
    s_lshl_b32 s28, s28, 11
    s_add_u32 s45, s45, s28
    s_add_u32 s46, s45, 98304
    s_lshl_b32 s45, s21, 11
    s_lshl_b32 s28, s20, 13
    s_add_u32 s45, s45, s28
    s_add_u32 s45, s45, 0x9000000
    s_waitcnt vmcnt(16)
    s_barrier
    v_add_u32 v105, 61440, v103
    v_add_u32 v106, 61440, v104
    ds_read_b64_tr_b16 a[0:1], v106 offset:0
    ds_read_b64_tr_b16 a[2:3], v106 offset:512
    ds_read_b64_tr_b16 a[8:9], v106 offset:4096
    ds_read_b64_tr_b16 a[10:11], v106 offset:4608
    ds_read_b64_tr_b16 a[4:5], v106 offset:32
    ds_read_b64_tr_b16 a[6:7], v106 offset:544
    ds_read_b64_tr_b16 a[12:13], v106 offset:4128
    ds_read_b64_tr_b16 a[14:15], v106 offset:4640
    ds_read_b64_tr_b16 a[160:161], v105 offset:0
    ds_read_b64_tr_b16 a[162:163], v105 offset:256
    ds_read_b64_tr_b16 a[164:165], v105 offset:4096
    ds_read_b64_tr_b16 a[166:167], v105 offset:4352
    ds_read_b64_tr_b16 a[168:169], v105 offset:8192
    ds_read_b64_tr_b16 a[170:171], v105 offset:8448
    ds_read_b64_tr_b16 a[172:173], v105 offset:12288
    ds_read_b64_tr_b16 a[174:175], v105 offset:12544
    ds_read_b64_tr_b16 a[176:177], v105 offset:16384
    ds_read_b64_tr_b16 a[178:179], v105 offset:16640
    ds_read_b64_tr_b16 a[180:181], v105 offset:20480
    ds_read_b64_tr_b16 a[182:183], v105 offset:20736
    s_waitcnt lgkmcnt(0)
    s_barrier
    buffer_load_dwordx4 v[92:95], v100, s[88:91], 0 offen sc1
    s_add_u32 m0, s82, 61440
    s_add_u32 s85, s80, 384
    buffer_load_dwordx4 v96, s[12:15], s85 offen nt lds
    s_add_u32 m0, s82, 62464
    s_add_u32 s85, s80, 10624
    buffer_load_dwordx4 v96, s[12:15], s85 offen nt lds
    s_add_u32 m0, s82, 63488
    s_add_u32 s85, s80, 20864
    buffer_load_dwordx4 v96, s[12:15], s85 offen nt lds
    s_add_u32 m0, s82, 64512
    s_add_u32 s85, s80, 31104
    buffer_load_dwordx4 v96, s[12:15], s85 offen nt lds
    s_add_u32 m0, s82, 65536
    s_add_u32 s85, s80, 41344
    buffer_load_dwordx4 v96, s[12:15], s85 offen nt lds
    s_add_u32 m0, s82, 66560
    s_add_u32 s85, s80, 51584
    buffer_load_dwordx4 v96, s[12:15], s85 offen nt lds
    s_add_u32 m0, s84, 86016
    s_add_u32 s85, s81, 2359296
    buffer_load_dwordx4 v99, s[16:19], s85 offen nt lds
    s_add_u32 m0, s84, 87040
    s_add_u32 s85, s81, 2457600
    buffer_load_dwordx4 v99, s[16:19], s85 offen nt lds
    s_waitcnt vmcnt(17)
    s_barrier
    v_add_u32 v105, 94208, v103
    v_add_u32 v106, 94208, v104
    ds_read_b64_tr_b16 a[16:17], v106 offset:0
    ds_read_b64_tr_b16 a[18:19], v106 offset:512
    ds_read_b64_tr_b16 a[24:25], v106 offset:4096
    ds_read_b64_tr_b16 a[26:27], v106 offset:4608
    ds_read_b64_tr_b16 a[20:21], v106 offset:32
    ds_read_b64_tr_b16 a[22:23], v106 offset:544
    ds_read_b64_tr_b16 a[28:29], v106 offset:4128
    ds_read_b64_tr_b16 a[30:31], v106 offset:4640
    ds_read_b64_tr_b16 a[184:185], v105 offset:0
    ds_read_b64_tr_b16 a[186:187], v105 offset:256
    ds_read_b64_tr_b16 a[188:189], v105 offset:4096
    ds_read_b64_tr_b16 a[190:191], v105 offset:4352
    ds_read_b64_tr_b16 a[192:193], v105 offset:8192
    ds_read_b64_tr_b16 a[194:195], v105 offset:8448
    ds_read_b64_tr_b16 a[196:197], v105 offset:12288
    ds_read_b64_tr_b16 a[198:199], v105 offset:12544
    ds_read_b64_tr_b16 a[200:201], v105 offset:16384
    ds_read_b64_tr_b16 a[202:203], v105 offset:16640
    ds_read_b64_tr_b16 a[204:205], v105 offset:20480
    ds_read_b64_tr_b16 a[206:207], v105 offset:20736
    s_waitcnt lgkmcnt(0)
    s_barrier
    buffer_load_dwordx4 v[92:95], v100, s[88:91], 0 offen sc1
    s_add_u32 m0, s82, 94208
    s_add_u32 s85, s80, 512
    buffer_load_dwordx4 v96, s[12:15], s85 offen nt lds
    s_add_u32 m0, s82, 95232
    s_add_u32 s85, s80, 10752
    buffer_load_dwordx4 v96, s[12:15], s85 offen nt lds
    s_add_u32 m0, s82, 96256
    s_add_u32 s85, s80, 20992
    buffer_load_dwordx4 v96, s[12:15], s85 offen nt lds
    s_add_u32 m0, s82, 97280
    s_add_u32 s85, s80, 31232
    buffer_load_dwordx4 v96, s[12:15], s85 offen nt lds
    s_add_u32 m0, s82, 98304
    s_add_u32 s85, s80, 41472
    buffer_load_dwordx4 v96, s[12:15], s85 offen nt lds
    s_add_u32 m0, s82, 99328
    s_add_u32 s85, s80, 51712
    buffer_load_dwordx4 v96, s[12:15], s85 offen nt lds
    s_add_u32 m0, s84, 118784
    s_add_u32 s85, s81, 3145728
    buffer_load_dwordx4 v99, s[16:19], s85 offen nt lds
    s_add_u32 m0, s84, 119808
    s_add_u32 s85, s81, 3244032
    buffer_load_dwordx4 v99, s[16:19], s85 offen nt lds
    s_waitcnt vmcnt(17)
    s_barrier
    v_add_u32 v105, 126976, v103
    v_add_u32 v106, 126976, v104
    ds_read_b64_tr_b16 a[32:33], v106 offset:0
    ds_read_b64_tr_b16 a[34:35], v106 offset:512
    ds_read_b64_tr_b16 a[40:41], v106 offset:4096
    ds_read_b64_tr_b16 a[42:43], v106 offset:4608
    ds_read_b64_tr_b16 a[36:37], v106 offset:32
    ds_read_b64_tr_b16 a[38:39], v106 offset:544
    ds_read_b64_tr_b16 a[44:45], v106 offset:4128
    ds_read_b64_tr_b16 a[46:47], v106 offset:4640
    ds_read_b64_tr_b16 a[208:209], v105 offset:0
    ds_read_b64_tr_b16 a[210:211], v105 offset:256
    ds_read_b64_tr_b16 a[212:213], v105 offset:4096
    ds_read_b64_tr_b16 a[214:215], v105 offset:4352
    ds_read_b64_tr_b16 a[216:217], v105 offset:8192
    ds_read_b64_tr_b16 a[218:219], v105 offset:8448
    ds_read_b64_tr_b16 a[220:221], v105 offset:12288
    ds_read_b64_tr_b16 a[222:223], v105 offset:12544
    ds_read_b64_tr_b16 a[224:225], v105 offset:16384
    ds_read_b64_tr_b16 a[226:227], v105 offset:16640
    ds_read_b64_tr_b16 a[228:229], v105 offset:20480
    ds_read_b64_tr_b16 a[230:231], v105 offset:20736
    s_waitcnt lgkmcnt(0)
    s_barrier
    v_cmp_eq_u32 vcc, 0, v95
    s_cbranch_vccnz M_vu_r0
    v_readfirstlane_b32 s28, v95
    s_cmp_lg_u32 s28, s23
    s_cbranch_scc1 M_redo
    s_branch M_vu_r1
M_vu_r0:
    v_mov_b32 v101, 140
    s_mov_b32 s39, 0
L_rw_10:
    buffer_load_dword v102, v101, s[88:91], 0 offen sc1
    s_add_u32 s39, s39, 1
    s_cmp_gt_u32 s39, 400000
    s_cbranch_scc1 M_fail
    s_waitcnt vmcnt(0)
    v_cmp_eq_u32 vcc, 0, v102
    s_cbranch_vccnz L_rw_10
    v_readfirstlane_b32 s28, v102
    s_cmp_lg_u32 s28, s23
    s_cbranch_scc1 M_redo
M_vu_r1:
    s_cmp_lg_u32 s86, 0
    s_cbranch_scc1 M_vu_g2
    v_min_u32 v101, v93, v94
    v_cmp_ne_u32 vcc, 0, v101
    s_cbranch_vccz M_vu_g2
    s_add_u32 m0, s34, 0
    s_add_u32 s29, s35, 0
    buffer_load_dwordx4 v2, s[8:11], s29 offen offset:0 sc1 lds
    buffer_load_dwordx4 v2, s[8:11], s29 offen offset:1024 sc1 lds
    buffer_load_dwordx4 v2, s[8:11], s29 offen offset:2048 sc1 lds
    buffer_load_dwordx4 v2, s[8:11], s29 offen offset:3072 sc1 lds
    s_add_u32 m0, s34, 4096
    s_add_u32 s29, s35, 4096
    buffer_load_dwordx4 v2, s[8:11], s29 offen offset:0 sc1 lds
    buffer_load_dwordx4 v2, s[8:11], s29 offen offset:1024 sc1 lds
    buffer_load_dwordx4 v2, s[8:11], s29 offen offset:2048 sc1 lds
    buffer_load_dwordx4 v2, s[8:11], s29 offen offset:3072 sc1 lds
    s_add_u32 m0, s34, 8192
    s_add_u32 s29, s35, 8192
    buffer_load_dwordx4 v2, s[8:11], s29 offen offset:0 sc1 lds
    buffer_load_dwordx4 v2, s[8:11], s29 offen offset:1024 sc1 lds
    s_add_u32 s35, s35, 40960
    s_mov_b32 s86, 1
M_vu_g2:
    buffer_load_dwordx4 v[92:95], v100, s[88:91], 0 offen sc1
    s_add_u32 m0, s82, 126976
    s_add_u32 s85, s80, 640
    buffer_load_dwordx4 v96, s[12:15], s85 offen nt lds
    s_add_u32 m0, s82, 128000
    s_add_u32 s85, s80, 10880
    buffer_load_dwordx4 v96, s[12:15], s85 offen nt lds
    s_add_u32 m0, s82, 129024
    s_add_u32 s85, s80, 21120
    buffer_load_dwordx4 v96, s[12:15], s85 offen nt lds
    s_add_u32 m0, s82, 130048
    s_add_u32 s85, s80, 31360
    buffer_load_dwordx4 v96, s[12:15], s85 offen nt lds
    s_add_u32 m0, s82, 131072
    s_add_u32 s85, s80, 41600
    buffer_load_dwordx4 v96, s[12:15], s85 offen nt lds
    s_add_u32 m0, s82, 132096
    s_add_u32 s85, s80, 51840
    buffer_load_dwordx4 v96, s[12:15], s85 offen nt lds
    s_add_u32 m0, s84, 151552
    s_add_u32 s85, s81, 3932160
    buffer_load_dwordx4 v99, s[16:19], s85 offen nt lds
    s_add_u32 m0, s84, 152576
    s_add_u32 s85, s81, 4030464
    buffer_load_dwordx4 v99, s[16:19], s85 offen nt lds
    s_waitcnt vmcnt(17)
    s_barrier
    v_add_u32 v105, 61440, v103
    v_add_u32 v106, 61440, v104
    ds_read_b64_tr_b16 a[48:49], v106 offset:0
    ds_read_b64_tr_b16 a[50:51], v106 offset:512
    ds_read_b64_tr_b16 a[56:57], v106 offset:4096
    ds_read_b64_tr_b16 a[58:59], v106 offset:4608
    ds_read_b64_tr_b16 a[52:53], v106 offset:32
    ds_read_b64_tr_b16 a[54:55], v106 offset:544
    ds_read_b64_tr_b16 a[60:61], v106 offset:4128
    ds_read_b64_tr_b16 a[62:63], v106 offset:4640
    ds_read_b64_tr_b16 a[232:233], v105 offset:0
    ds_read_b64_tr_b16 a[234:235], v105 offset:256
    ds_read_b64_tr_b16 a[236:237], v105 offset:4096
    ds_read_b64_tr_b16 a[238:239], v105 offset:4352
    ds_read_b64_tr_b16 a[240:241], v105 offset:8192
    ds_read_b64_tr_b16 a[242:243], v105 offset:8448
    ds_read_b64_tr_b16 a[244:245], v105 offset:12288
    ds_read_b64_tr_b16 a[246:247], v105 offset:12544
    ds_read_b64_tr_b16 a[248:249], v105 offset:16384
    ds_read_b64_tr_b16 a[250:251], v105 offset:16640
    ds_read_b64_tr_b16 a[252:253], v105 offset:20480
    ds_read_b64_tr_b16 a[254:255], v105 offset:20736
    s_waitcnt lgkmcnt(0)
    s_barrier
    s_cmp_lg_u32 s86, 0
    s_cbranch_scc1 M_vu_g3
    v_min_u32 v101, v93, v94
    v_cmp_ne_u32 vcc, 0, v101
    s_cbranch_vccz M_vu_g3
    s_add_u32 m0, s34, 0
    s_add_u32 s29, s35, 0
    buffer_load_dwordx4 v2, s[8:11], s29 offen offset:0 sc1 lds
    buffer_load_dwordx4 v2, s[8:11], s29 offen offset:1024 sc1 lds
    buffer_load_dwordx4 v2, s[8:11], s29 offen offset:2048 sc1 lds
    buffer_load_dwordx4 v2, s[8:11], s29 offen offset:3072 sc1 lds
    s_add_u32 m0, s34, 4096
    s_add_u32 s29, s35, 4096
    buffer_load_dwordx4 v2, s[8:11], s29 offen offset:0 sc1 lds
    buffer_load_dwordx4 v2, s[8:11], s29 offen offset:1024 sc1 lds
    buffer_load_dwordx4 v2, s[8:11], s29 offen offset:2048 sc1 lds
    buffer_load_dwordx4 v2, s[8:11], s29 offen offset:3072 sc1 lds
    s_add_u32 m0, s34, 8192
    s_add_u32 s29, s35, 8192
    buffer_load_dwordx4 v2, s[8:11], s29 offen offset:0 sc1 lds
    buffer_load_dwordx4 v2, s[8:11], s29 offen offset:1024 sc1 lds
    s_add_u32 s35, s35, 40960
    s_mov_b32 s86, 1
M_vu_g3:
    buffer_load_dwordx4 v[92:95], v100, s[88:91], 0 offen sc1
    s_add_u32 m0, s82, 61440
    s_add_u32 s85, s80, 768
    buffer_load_dwordx4 v96, s[12:15], s85 offen nt lds
    s_add_u32 m0, s82, 62464
    s_add_u32 s85, s80, 11008
    buffer_load_dwordx4 v96, s[12:15], s85 offen nt lds
    s_add_u32 m0, s82, 63488
    s_add_u32 s85, s80, 21248
    buffer_load_dwordx4 v96, s[12:15], s85 offen nt lds
    s_add_u32 m0, s82, 64512
    s_add_u32 s85, s80, 31488
    buffer_load_dwordx4 v96, s[12:15], s85 offen nt lds
    s_add_u32 m0, s82, 65536
    s_add_u32 s85, s80, 41728
    buffer_load_dwordx4 v96, s[12:15], s85 offen nt lds
    s_add_u32 m0, s82, 66560
    s_add_u32 s85, s80, 51968
    buffer_load_dwordx4 v96, s[12:15], s85 offen nt lds
    s_add_u32 m0, s84, 86016
    s_add_u32 s85, s81, 4718592
    buffer_load_dwordx4 v99, s[16:19], s85 offen nt lds
    s_add_u32 m0, s84, 87040
    s_add_u32 s85, s81, 4816896
    buffer_load_dwordx4 v99, s[16:19], s85 offen nt lds
    s_waitcnt vmcnt(17)
    s_barrier
    v_add_u32 v105, 94208, v103
    v_add_u32 v106, 94208, v104
    ds_read_b64_tr_b16 a[64:65], v106 offset:0
    ds_read_b64_tr_b16 a[66:67], v106 offset:512
    ds_read_b64_tr_b16 a[72:73], v106 offset:4096
    ds_read_b64_tr_b16 a[74:75], v106 offset:4608
    ds_read_b64_tr_b16 a[68:69], v106 offset:32
    ds_read_b64_tr_b16 a[70:71], v106 offset:544
    ds_read_b64_tr_b16 a[76:77], v106 offset:4128
    ds_read_b64_tr_b16 a[78:79], v106 offset:4640
    ds_read_b64_tr_b16 v[112:113], v105 offset:0
    ds_read_b64_tr_b16 v[114:115], v105 offset:256
    ds_read_b64_tr_b16 v[116:117], v105 offset:4096
    ds_read_b64_tr_b16 v[118:119], v105 offset:4352
    ds_read_b64_tr_b16 v[120:121], v105 offset:8192
    ds_read_b64_tr_b16 v[122:123], v105 offset:8448
    ds_read_b64_tr_b16 v[124:125], v105 offset:12288
    ds_read_b64_tr_b16 v[126:127], v105 offset:12544
    ds_read_b64_tr_b16 v[128:129], v105 offset:16384
    ds_read_b64_tr_b16 v[130:131], v105 offset:16640
    ds_read_b64_tr_b16 v[132:133], v105 offset:20480
    ds_read_b64_tr_b16 v[134:135], v105 offset:20736
    s_waitcnt lgkmcnt(0)
    s_barrier
    s_cmp_lg_u32 s86, 0
    s_cbranch_scc1 M_vu_g4
    v_min_u32 v101, v93, v94
    v_cmp_ne_u32 vcc, 0, v101
    s_cbranch_vccz M_vu_g4
    s_add_u32 m0, s34, 0
    s_add_u32 s29, s35, 0
    buffer_load_dwordx4 v2, s[8:11], s29 offen offset:0 sc1 lds
    buffer_load_dwordx4 v2, s[8:11], s29 offen offset:1024 sc1 lds
    buffer_load_dwordx4 v2, s[8:11], s29 offen offset:2048 sc1 lds
    buffer_load_dwordx4 v2, s[8:11], s29 offen offset:3072 sc1 lds
    s_add_u32 m0, s34, 4096
    s_add_u32 s29, s35, 4096
    buffer_load_dwordx4 v2, s[8:11], s29 offen offset:0 sc1 lds
    buffer_load_dwordx4 v2, s[8:11], s29 offen offset:1024 sc1 lds
    buffer_load_dwordx4 v2, s[8:11], s29 offen offset:2048 sc1 lds
    buffer_load_dwordx4 v2, s[8:11], s29 offen offset:3072 sc1 lds
    s_add_u32 m0, s34, 8192
    s_add_u32 s29, s35, 8192
    buffer_load_dwordx4 v2, s[8:11], s29 offen offset:0 sc1 lds
    buffer_load_dwordx4 v2, s[8:11], s29 offen offset:1024 sc1 lds
    s_add_u32 s35, s35, 40960
    s_mov_b32 s86, 1
M_vu_g4:
    buffer_load_dwordx4 v[92:95], v100, s[88:91], 0 offen sc1
    s_add_u32 m0, s82, 94208
    s_add_u32 s85, s80, 896
    buffer_load_dwordx4 v96, s[12:15], s85 offen nt lds
    s_add_u32 m0, s82, 95232
    s_add_u32 s85, s80, 11136
    buffer_load_dwordx4 v96, s[12:15], s85 offen nt lds
    s_add_u32 m0, s82, 96256
    s_add_u32 s85, s80, 21376
    buffer_load_dwordx4 v96, s[12:15], s85 offen nt lds
    s_add_u32 m0, s82, 97280
    s_add_u32 s85, s80, 31616
    buffer_load_dwordx4 v96, s[12:15], s85 offen nt lds
    s_add_u32 m0, s82, 98304
    s_add_u32 s85, s80, 41856
    buffer_load_dwordx4 v96, s[12:15], s85 offen nt lds
    s_add_u32 m0, s82, 99328
    s_add_u32 s85, s80, 52096
    buffer_load_dwordx4 v96, s[12:15], s85 offen nt lds
    s_add_u32 m0, s84, 118784
    s_add_u32 s85, s81, 5505024
    buffer_load_dwordx4 v99, s[16:19], s85 offen nt lds
    s_add_u32 m0, s84, 119808
    s_add_u32 s85, s81, 5603328
    buffer_load_dwordx4 v99, s[16:19], s85 offen nt lds
    s_waitcnt vmcnt(17)
    s_barrier
    v_add_u32 v105, 126976, v103
    v_add_u32 v106, 126976, v104
    ds_read_b64_tr_b16 a[80:81], v106 offset:0
    ds_read_b64_tr_b16 a[82:83], v106 offset:512
    ds_read_b64_tr_b16 a[88:89], v106 offset:4096
    ds_read_b64_tr_b16 a[90:91], v106 offset:4608
    ds_read_b64_tr_b16 a[84:85], v106 offset:32
    ds_read_b64_tr_b16 a[86:87], v106 offset:544
    ds_read_b64_tr_b16 a[92:93], v106 offset:4128
    ds_read_b64_tr_b16 a[94:95], v106 offset:4640
    ds_read_b64_tr_b16 v[136:137], v105 offset:0
    ds_read_b64_tr_b16 v[138:139], v105 offset:256
    ds_read_b64_tr_b16 v[140:141], v105 offset:4096
    ds_read_b64_tr_b16 v[142:143], v105 offset:4352
    ds_read_b64_tr_b16 v[144:145], v105 offset:8192
    ds_read_b64_tr_b16 v[146:147], v105 offset:8448
    ds_read_b64_tr_b16 v[148:149], v105 offset:12288
    ds_read_b64_tr_b16 v[150:151], v105 offset:12544
    ds_read_b64_tr_b16 v[152:153], v105 offset:16384
    ds_read_b64_tr_b16 v[154:155], v105 offset:16640
    ds_read_b64_tr_b16 v[156:157], v105 offset:20480
    ds_read_b64_tr_b16 v[158:159], v105 offset:20736
    s_waitcnt lgkmcnt(0)
    s_barrier
    s_cmp_lg_u32 s86, 0
    s_cbranch_scc1 M_vu_g5
    v_min_u32 v101, v93, v94
    v_cmp_ne_u32 vcc, 0, v101
    s_cbranch_vccnz M_vu_gs
    v_mov_b32 v101, 128
    s_mov_b32 s39, 0
L_go_11:
    buffer_load_dword v102, v101, s[88:91], 0 offen sc1
    buffer_load_dword v107, v101, s[88:91], 0 offen offset:12 sc1
    s_add_u32 s39, s39, 1
    s_cmp_gt_u32 s39, 400000
    s_cbranch_scc1 M_fail
    s_waitcnt vmcnt(0)
    v_cmp_eq_u32 vcc, 0, v107
    s_cbranch_vccnz L_go_11
    v_readfirstlane_b32 s28, v107
    s_cmp_lg_u32 s28, s23
    s_cbranch_scc1 M_redo
    v_cmp_ne_u32 vcc, 0, v102
    s_cbranch_vccnz L_go_11k
    s_sleep 3
    s_branch L_go_11
L_go_11k:
    v_readfirstlane_b32 s53, v102
    s_sub_u32 s53, s53, 1
    s_and_b32 s53, s53, 1
    s_lshl_b32 s52, s53, 13
    s_add_u32 s52, s52, 0xa00000
    s_xor_b32 s56, s53, 1
    s_lshl_b32 s56, s56, 13
    s_lshr_b32 s55, s25, 2
    s_and_b32 s55, s55, 15
    s_mul_i32 s55, s55, 256
    s_mov_b32 s58, 0
M_vu_gs:
    s_add_u32 m0, s34, 0
    s_add_u32 s29, s35, 0
    buffer_load_dwordx4 v2, s[8:11], s29 offen offset:0 sc1 lds
    buffer_load_dwordx4 v2, s[8:11], s29 offen offset:1024 sc1 lds
    buffer_load_dwordx4 v2, s[8:11], s29 offen offset:2048 sc1 lds
    buffer_load_dwordx4 v2, s[8:11], s29 offen offset:3072 sc1 lds
    s_add_u32 m0, s34, 4096
    s_add_u32 s29, s35, 4096
    buffer_load_dwordx4 v2, s[8:11], s29 offen offset:0 sc1 lds
    buffer_load_dwordx4 v2, s[8:11], s29 offen offset:1024 sc1 lds
    buffer_load_dwordx4 v2, s[8:11], s29 offen offset:2048 sc1 lds
    buffer_load_dwordx4 v2, s[8:11], s29 offen offset:3072 sc1 lds
    s_add_u32 m0, s34, 8192
    s_add_u32 s29, s35, 8192
    buffer_load_dwordx4 v2, s[8:11], s29 offen offset:0 sc1 lds
    buffer_load_dwordx4 v2, s[8:11], s29 offen offset:1024 sc1 lds
    s_add_u32 s35, s35, 40960
    s_mov_b32 s86, 1
M_vu_g5:
    buffer_load_dwordx4 v[92:95], v100, s[88:91], 0 offen sc1
    s_add_u32 m0, s82, 126976
    s_add_u32 s85, s80, 1024
    buffer_load_dwordx4 v96, s[12:15], s85 offen nt lds
    s_add_u32 m0, s82, 128000
    s_add_u32 s85, s80, 11264
    buffer_load_dwordx4 v96, s[12:15], s85 offen nt lds
    s_add_u32 m0, s82, 129024
    s_add_u32 s85, s80, 21504
    buffer_load_dwordx4 v96, s[12:15], s85 offen nt lds
    s_add_u32 m0, s82, 130048
    s_add_u32 s85, s80, 31744
    buffer_load_dwordx4 v96, s[12:15], s85 offen nt lds
    s_add_u32 m0, s82, 131072
    s_add_u32 s85, s80, 41984
    buffer_load_dwordx4 v96, s[12:15], s85 offen nt lds
    s_add_u32 m0, s82, 132096
    s_add_u32 s85, s80, 52224
    buffer_load_dwordx4 v96, s[12:15], s85 offen nt lds
    s_add_u32 m0, s84, 151552
    s_add_u32 s85, s81, 6291456
    buffer_load_dwordx4 v99, s[16:19], s85 offen nt lds
    s_add_u32 m0, s84, 152576
    s_add_u32 s85, s81, 6389760
    buffer_load_dwordx4 v99, s[16:19], s85 offen nt lds
    s_waitcnt vmcnt(17)
    s_barrier
    v_add_u32 v105, 61440, v103
    v_add_u32 v106, 61440, v104
    ds_read_b64_tr_b16 a[96:97], v106 offset:0
    ds_read_b64_tr_b16 a[98:99], v106 offset:512
    ds_read_b64_tr_b16 a[104:105], v106 offset:4096
    ds_read_b64_tr_b16 a[106:107], v106 offset:4608
    ds_read_b64_tr_b16 a[100:101], v106 offset:32
    ds_read_b64_tr_b16 a[102:103], v106 offset:544
    ds_read_b64_tr_b16 a[108:109], v106 offset:4128
    ds_read_b64_tr_b16 a[110:111], v106 offset:4640
    ds_read_b64_tr_b16 v[160:161], v105 offset:0
    ds_read_b64_tr_b16 v[162:163], v105 offset:256
    ds_read_b64_tr_b16 v[164:165], v105 offset:4096
    ds_read_b64_tr_b16 v[166:167], v105 offset:4352
    ds_read_b64_tr_b16 v[168:169], v105 offset:8192
    ds_read_b64_tr_b16 v[170:171], v105 offset:8448
    ds_read_b64_tr_b16 v[172:173], v105 offset:12288
    ds_read_b64_tr_b16 v[174:175], v105 offset:12544
    ds_read_b64_tr_b16 v[176:177], v105 offset:16384
    ds_read_b64_tr_b16 v[178:179], v105 offset:16640
    ds_read_b64_tr_b16 v[180:181], v105 offset:20480
    ds_read_b64_tr_b16 v[182:183], v105 offset:20736
    s_waitcnt lgkmcnt(0)
    s_barrier
    buffer_load_dwordx4 v[92:95], v100, s[88:91], 0 offen sc1
    s_add_u32 m0, s82, 61440
    s_add_u32 s85, s80, 1152
    buffer_load_dwordx4 v96, s[12:15], s85 offen nt lds
    s_add_u32 m0, s82, 62464
    s_add_u32 s85, s80, 11392
    buffer_load_dwordx4 v96, s[12:15], s85 offen nt lds
    s_add_u32 m0, s82, 63488
    s_add_u32 s85, s80, 21632
    buffer_load_dwordx4 v96, s[12:15], s85 offen nt lds
    s_add_u32 m0, s82, 64512
    s_add_u32 s85, s80, 31872
    buffer_load_dwordx4 v96, s[12:15], s85 offen nt lds
    s_add_u32 m0, s82, 65536
    s_add_u32 s85, s80, 42112
    buffer_load_dwordx4 v96, s[12:15], s85 offen nt lds
    s_add_u32 m0, s82, 66560
    s_add_u32 s85, s80, 52352
    buffer_load_dwordx4 v96, s[12:15], s85 offen nt lds
    s_add_u32 m0, s84, 86016
    s_add_u32 s85, s81, 7077888
    buffer_load_dwordx4 v99, s[16:19], s85 offen nt lds
    s_add_u32 m0, s84, 87040
    s_add_u32 s85, s81, 7176192
    buffer_load_dwordx4 v99, s[16:19], s85 offen nt lds
    s_waitcnt vmcnt(17)
    s_barrier
    v_add_u32 v105, 94208, v103
    v_add_u32 v106, 94208, v104
    ds_read_b64_tr_b16 a[112:113], v106 offset:0
    ds_read_b64_tr_b16 a[114:115], v106 offset:512
    ds_read_b64_tr_b16 a[120:121], v106 offset:4096
    ds_read_b64_tr_b16 a[122:123], v106 offset:4608
    ds_read_b64_tr_b16 a[116:117], v106 offset:32
    ds_read_b64_tr_b16 a[118:119], v106 offset:544
    ds_read_b64_tr_b16 a[124:125], v106 offset:4128
    ds_read_b64_tr_b16 a[126:127], v106 offset:4640
    ds_read_b64_tr_b16 v[184:185], v105 offset:0
    ds_read_b64_tr_b16 v[186:187], v105 offset:256
    ds_read_b64_tr_b16 v[188:189], v105 offset:4096
    ds_read_b64_tr_b16 v[190:191], v105 offset:4352
    ds_read_b64_tr_b16 v[192:193], v105 offset:8192
    ds_read_b64_tr_b16 v[194:195], v105 offset:8448
    ds_read_b64_tr_b16 v[196:197], v105 offset:12288
    ds_read_b64_tr_b16 v[198:199], v105 offset:12544
    ds_read_b64_tr_b16 v[200:201], v105 offset:16384
    ds_read_b64_tr_b16 v[202:203], v105 offset:16640
    ds_read_b64_tr_b16 v[204:205], v105 offset:20480
    ds_read_b64_tr_b16 v[206:207], v105 offset:20736
    s_waitcnt lgkmcnt(0)
    s_waitcnt vmcnt(8)
    s_barrier
    v_add_u32 v105, 126976, v103
    v_add_u32 v106, 126976, v104
    ds_read_b64_tr_b16 a[128:129], v106 offset:0
    ds_read_b64_tr_b16 a[130:131], v106 offset:512
    ds_read_b64_tr_b16 a[136:137], v106 offset:4096
    ds_read_b64_tr_b16 a[138:139], v106 offset:4608
    ds_read_b64_tr_b16 a[132:133], v106 offset:32
    ds_read_b64_tr_b16 a[134:135], v106 offset:544
    ds_read_b64_tr_b16 a[140:141], v106 offset:4128
    ds_read_b64_tr_b16 a[142:143], v106 offset:4640
    ds_read_b64_tr_b16 v[208:209], v105 offset:0
    ds_read_b64_tr_b16 v[210:211], v105 offset:256
    ds_read_b64_tr_b16 v[212:213], v105 offset:4096
    ds_read_b64_tr_b16 v[214:215], v105 offset:4352
    ds_read_b64_tr_b16 v[216:217], v105 offset:8192
    ds_read_b64_tr_b16 v[218:219], v105 offset:8448
    ds_read_b64_tr_b16 v[220:221], v105 offset:12288
    ds_read_b64_tr_b16 v[222:223], v105 offset:12544
    ds_read_b64_tr_b16 v[224:225], v105 offset:16384
    ds_read_b64_tr_b16 v[226:227], v105 offset:16640
    ds_read_b64_tr_b16 v[228:229], v105 offset:20480
    ds_read_b64_tr_b16 v[230:231], v105 offset:20736
    s_waitcnt lgkmcnt(0)
    v_cmp_ne_u32 vcc, 0, v92
    s_cbranch_vccz M_vu_gw
    v_readfirstlane_b32 s53, v92
    s_sub_u32 s53, s53, 1
    s_and_b32 s53, s53, 1
    s_lshl_b32 s52, s53, 13
    s_add_u32 s52, s52, 0xa00000
    s_xor_b32 s56, s53, 1
    s_lshl_b32 s56, s56, 13
    s_lshr_b32 s55, s25, 2
    s_and_b32 s55, s55, 15
    s_mul_i32 s55, s55, 256
    s_mov_b32 s58, 0
    s_branch M_vu_gx
M_vu_gw:
    v_mov_b32 v101, 128
    s_mov_b32 s39, 0
L_go_12:
    buffer_load_dword v102, v101, s[88:91], 0 offen sc1
    buffer_load_dword v107, v101, s[88:91], 0 offen offset:12 sc1
    s_add_u32 s39, s39, 1
    s_cmp_gt_u32 s39, 400000
    s_cbranch_scc1 M_fail
    s_waitcnt vmcnt(0)
    v_cmp_eq_u32 vcc, 0, v107
    s_cbranch_vccnz L_go_12
    v_readfirstlane_b32 s28, v107
    s_cmp_lg_u32 s28, s23
    s_cbranch_scc1 M_redo
    v_cmp_ne_u32 vcc, 0, v102
    s_cbranch_vccnz L_go_12k
    s_sleep 3
    s_branch L_go_12
L_go_12k:
    v_readfirstlane_b32 s53, v102
    s_sub_u32 s53, s53, 1
    s_and_b32 s53, s53, 1
    s_lshl_b32 s52, s53, 13
    s_add_u32 s52, s52, 0xa00000
    s_xor_b32 s56, s53, 1
    s_lshl_b32 s56, s56, 13
    s_lshr_b32 s55, s25, 2
    s_and_b32 s55, s55, 15
    s_mul_i32 s55, s55, 256
    s_mov_b32 s58, 0
M_vu_gx:
    s_waitcnt vmcnt(0)
    s_barrier
    v_add_u32 v105, 61440, v103
    v_add_u32 v106, 61440, v104
    ds_read_b64_tr_b16 a[144:145], v106 offset:0
    ds_read_b64_tr_b16 a[146:147], v106 offset:512
    ds_read_b64_tr_b16 a[152:153], v106 offset:4096
    ds_read_b64_tr_b16 a[154:155], v106 offset:4608
    ds_read_b64_tr_b16 a[148:149], v106 offset:32
    ds_read_b64_tr_b16 a[150:151], v106 offset:544
    ds_read_b64_tr_b16 a[156:157], v106 offset:4128
    ds_read_b64_tr_b16 a[158:159], v106 offset:4640
    ds_read_b64_tr_b16 v[232:233], v105 offset:0
    ds_read_b64_tr_b16 v[234:235], v105 offset:256
    ds_read_b64_tr_b16 v[236:237], v105 offset:4096
    ds_read_b64_tr_b16 v[238:239], v105 offset:4352
    ds_read_b64_tr_b16 v[240:241], v105 offset:8192
    ds_read_b64_tr_b16 v[242:243], v105 offset:8448
    ds_read_b64_tr_b16 v[244:245], v105 offset:12288
    ds_read_b64_tr_b16 v[246:247], v105 offset:12544
    ds_read_b64_tr_b16 v[248:249], v105 offset:16384
    ds_read_b64_tr_b16 v[250:251], v105 offset:16640
    ds_read_b64_tr_b16 v[252:253], v105 offset:20480
    ds_read_b64_tr_b16 v[254:255], v105 offset:20736
    s_waitcnt lgkmcnt(0)
    s_barrier
    s_add_u32 m0, s34, 40960
    s_add_u32 s29, s35, 245760
    buffer_load_dwordx4 v2, s[8:11], s29 offen offset:0 sc1 lds
    buffer_load_dwordx4 v2, s[8:11], s29 offen offset:1024 sc1 lds
    buffer_load_dwordx4 v2, s[8:11], s29 offen offset:2048 sc1 lds
    buffer_load_dwordx4 v2, s[8:11], s29 offen offset:3072 sc1 lds
    s_add_u32 m0, s34, 45056
    s_add_u32 s29, s35, 249856
    buffer_load_dwordx4 v2, s[8:11], s29 offen offset:0 sc1 lds
    buffer_load_dwordx4 v2, s[8:11], s29 offen offset:1024 sc1 lds
    buffer_load_dwordx4 v2, s[8:11], s29 offen offset:2048 sc1 lds
    buffer_load_dwordx4 v2, s[8:11], s29 offen offset:3072 sc1 lds
    s_add_u32 m0, s34, 49152
    s_add_u32 s29, s35, 253952
    buffer_load_dwordx4 v2, s[8:11], s29 offen offset:0 sc1 lds
    buffer_load_dwordx4 v2, s[8:11], s29 offen offset:1024 sc1 lds
M_vu_loop:
    s_barrier
    ds_read_b128 v[48:51], v4 offset:0
    ds_read_b128 v[52:55], v4 offset:1024
    ds_read_b128 v[56:59], v4 offset:2048
    ds_read_b128 v[60:63], v4 offset:3072
    ds_read_b128 v[64:67], v4 offset:4096
    ds_read_b128 v[68:71], v4 offset:5120
    ds_read_b128 v[72:75], v4 offset:6144
    s_waitcnt lgkmcnt(6)
    v_mfma_f32_16x16x32_bf16 v[8:11], a[0:3], v[48:51], 0
    v_mfma_f32_16x16x32_bf16 v[12:15], a[4:7], v[48:51], 0
    ds_read_b128 v[76:79], v4 offset:7168
    s_waitcnt lgkmcnt(6)
    v_mfma_f32_16x16x32_bf16 v[8:11], a[8:11], v[52:55], v[8:11]
    v_mfma_f32_16x16x32_bf16 v[12:15], a[12:15], v[52:55], v[12:15]
    ds_read_b128 v[48:51], v4 offset:8192
    s_waitcnt lgkmcnt(6)
    v_mfma_f32_16x16x32_bf16 v[8:11], a[16:19], v[56:59], v[8:11]
    v_mfma_f32_16x16x32_bf16 v[12:15], a[20:23], v[56:59], v[12:15]
    ds_read_b128 v[52:55], v4 offset:9216
    s_waitcnt lgkmcnt(6)
    v_mfma_f32_16x16x32_bf16 v[8:11], a[24:27], v[60:63], v[8:11]
    v_mfma_f32_16x16x32_bf16 v[12:15], a[28:31], v[60:63], v[12:15]
    ds_read_b128 v[56:59], v4 offset:10240
    s_waitcnt lgkmcnt(6)
    v_mfma_f32_16x16x32_bf16 v[8:11], a[32:35], v[64:67], v[8:11]
    v_mfma_f32_16x16x32_bf16 v[12:15], a[36:39], v[64:67], v[12:15]
    ds_read_b128 v[60:63], v4 offset:11264
    s_waitcnt lgkmcnt(6)
    v_mfma_f32_16x16x32_bf16 v[8:11], a[40:43], v[68:71], v[8:11]
    v_mfma_f32_16x16x32_bf16 v[12:15], a[44:47], v[68:71], v[12:15]
    ds_read_b128 v[64:67], v4 offset:12288
    s_waitcnt lgkmcnt(6)
    v_mfma_f32_16x16x32_bf16 v[8:11], a[48:51], v[72:75], v[8:11]
    v_mfma_f32_16x16x32_bf16 v[12:15], a[52:55], v[72:75], v[12:15]
    ds_read_b128 v[68:71], v4 offset:13312
    s_waitcnt lgkmcnt(6)
    v_mfma_f32_16x16x32_bf16 v[8:11], a[56:59], v[76:79], v[8:11]
    v_mfma_f32_16x16x32_bf16 v[12:15], a[60:63], v[76:79], v[12:15]
    ds_read_b128 v[72:75], v4 offset:14336
    s_waitcnt lgkmcnt(6)
    v_mfma_f32_16x16x32_bf16 v[8:11], a[64:67], v[48:51], v[8:11]
    v_mfma_f32_16x16x32_bf16 v[12:15], a[68:71], v[48:51], v[12:15]
    ds_read_b128 v[76:79], v4 offset:15360
    s_waitcnt lgkmcnt(6)
    v_mfma_f32_16x16x32_bf16 v[8:11], a[72:75], v[52:55], v[8:11]
    v_mfma_f32_16x16x32_bf16 v[12:15], a[76:79], v[52:55], v[12:15]
    ds_read_b128 v[48:51], v4 offset:16384
    s_waitcnt lgkmcnt(6)
    v_mfma_f32_16x16x32_bf16 v[8:11], a[80:83], v[56:59], v[8:11]
    v_mfma_f32_16x16x32_bf16 v[12:15], a[84:87], v[56:59], v[12:15]
    ds_read_b128 v[52:55], v4 offset:17408
    s_waitcnt lgkmcnt(6)
    v_mfma_f32_16x16x32_bf16 v[8:11], a[88:91], v[60:63], v[8:11]
    v_mfma_f32_16x16x32_bf16 v[12:15], a[92:95], v[60:63], v[12:15]
    ds_read_b128 v[56:59], v4 offset:18432
    s_waitcnt lgkmcnt(6)
    v_mfma_f32_16x16x32_bf16 v[8:11], a[96:99], v[64:67], v[8:11]
    v_mfma_f32_16x16x32_bf16 v[12:15], a[100:103], v[64:67], v[12:15]
    ds_read_b128 v[60:63], v4 offset:19456
    s_waitcnt lgkmcnt(6)
    v_mfma_f32_16x16x32_bf16 v[8:11], a[104:107], v[68:71], v[8:11]
    v_mfma_f32_16x16x32_bf16 v[12:15], a[108:111], v[68:71], v[12:15]
    s_waitcnt lgkmcnt(5)
    v_mfma_f32_16x16x32_bf16 v[8:11], a[112:115], v[72:75], v[8:11]
    v_mfma_f32_16x16x32_bf16 v[12:15], a[116:119], v[72:75], v[12:15]
    s_waitcnt lgkmcnt(4)
    v_mfma_f32_16x16x32_bf16 v[8:11], a[120:123], v[76:79], v[8:11]
    v_mfma_f32_16x16x32_bf16 v[12:15], a[124:127], v[76:79], v[12:15]
    s_waitcnt lgkmcnt(3)
    v_mfma_f32_16x16x32_bf16 v[8:11], a[128:131], v[48:51], v[8:11]
    v_mfma_f32_16x16x32_bf16 v[12:15], a[132:135], v[48:51], v[12:15]
    s_waitcnt lgkmcnt(2)
    v_mfma_f32_16x16x32_bf16 v[8:11], a[136:139], v[52:55], v[8:11]
    v_mfma_f32_16x16x32_bf16 v[12:15], a[140:143], v[52:55], v[12:15]
    s_waitcnt lgkmcnt(1)
    v_mfma_f32_16x16x32_bf16 v[8:11], a[144:147], v[56:59], v[8:11]
    v_mfma_f32_16x16x32_bf16 v[12:15], a[148:151], v[56:59], v[12:15]
    s_waitcnt lgkmcnt(0)
    v_mfma_f32_16x16x32_bf16 v[8:11], a[152:155], v[60:63], v[8:11]
    v_mfma_f32_16x16x32_bf16 v[12:15], a[156:159], v[60:63], v[12:15]
    s_cmp_eq_u32 s47, 0
    s_cbranch_scc1 M_vu_nf
    s_mov_b32 s39, 0
M_vu_f0:
    buffer_load_dword v109, v108, s[8:11], s44 offen sc1
    s_add_u32 s39, s39, 1
    s_cmp_gt_u32 s39, 400000
    s_cbranch_scc1 M_fail
    s_waitcnt vmcnt(0)
    v_cmp_eq_u32 vcc, 0, v109
    s_cbranch_vccz M_vu_f0_ok
    s_sleep 1
    s_branch M_vu_f0
M_vu_f0_ok:
    s_mov_b32 m0, s46
    s_xor_b32 s46, s46, 16384
    buffer_load_dwordx4 v2, s[8:11], s45 offen sc1 lds
    buffer_load_dwordx4 v2, s[8:11], s45 offen offset:1024 sc1 lds
    s_add_u32 s45, s45, 262144
M_vu_nf:
    s_nop 5
    v_cvt_pk_bf16_f32 v32, v8, v12
    v_cvt_pk_bf16_f32 v33, v9, v13
    v_cvt_pk_bf16_f32 v34, v10, v14
    v_cvt_pk_bf16_f32 v35, v11, v15
    ds_write_b128 v3, v[32:35]
    s_add_u32 s44, s44, 4096
    s_min_u32 s44, s44, 0x87f000
    s_waitcnt lgkmcnt(0)
    s_waitcnt vmcnt(0)
    s_barrier
    ds_read_b128 v[48:51], v5 offset:0
    ds_read_b128 v[52:55], v5 offset:6144
    ds_read_b128 v[56:59], v5 offset:1024
    ds_read_b128 v[60:63], v5 offset:7168
    ds_read_b128 v[64:67], v5 offset:2048
    ds_read_b128 v[68:71], v5 offset:8192
    ds_read_b128 v[72:75], v5 offset:3072
    ds_read_b128 v[76:79], v5 offset:9216
    ds_read_b128 v[80:83], v5 offset:4096
    ds_read_b128 v[84:87], v5 offset:10240
    ds_read_b128 v[88:91], v5 offset:5120
    ds_read_b128 v[92:95], v5 offset:11264
    s_cmp_eq_u32 s22, 6
    s_cbranch_scc1 M_vu_pl
    buffer_store_dword v7, v6, s[8:11], s37 offen sc1
    buffer_load_dword v109, v108, s[8:11], s44 offen sc1
    s_mov_b32 s37, s43
    s_add_u32 s43, s43, 4096
    s_mov_b32 s38, s36
    s_add_u32 s36, s36, 1310720
    v_xor_b32 v5, 16384, v5
    v_xor_b32 v3, 16384, v3
    s_waitcnt lgkmcnt(11)
    v_mfma_f32_16x16x32_bf16 v[8:11], v[48:51], a[160:163], 0
    s_waitcnt lgkmcnt(10)
    v_mfma_f32_16x16x32_bf16 v[12:15], v[52:55], a[160:163], 0
    s_waitcnt lgkmcnt(9)
    v_mfma_f32_16x16x32_bf16 v[8:11], v[56:59], a[164:167], v[8:11]
    s_add_u32 m0, s34, 0
    s_add_u32 s29, s35, 0
    buffer_load_dwordx4 v2, s[8:11], s29 offen offset:0 sc1 lds
    s_waitcnt lgkmcnt(8)
    v_mfma_f32_16x16x32_bf16 v[12:15], v[60:63], a[164:167], v[12:15]
    s_waitcnt lgkmcnt(7)
    v_mfma_f32_16x16x32_bf16 v[8:11], v[64:67], a[168:171], v[8:11]
    s_waitcnt lgkmcnt(6)
    v_mfma_f32_16x16x32_bf16 v[12:15], v[68:71], a[168:171], v[12:15]
    buffer_load_dwordx4 v2, s[8:11], s29 offen offset:1024 sc1 lds
    s_waitcnt lgkmcnt(5)
    v_mfma_f32_16x16x32_bf16 v[8:11], v[72:75], a[172:175], v[8:11]
    s_waitcnt lgkmcnt(4)
    v_mfma_f32_16x16x32_bf16 v[12:15], v[76:79], a[172:175], v[12:15]
    s_waitcnt lgkmcnt(3)
    v_mfma_f32_16x16x32_bf16 v[8:11], v[80:83], a[176:179], v[8:11]
    s_waitcnt lgkmcnt(2)
    v_mfma_f32_16x16x32_bf16 v[12:15], v[84:87], a[176:179], v[12:15]
    s_waitcnt lgkmcnt(1)
    v_mfma_f32_16x16x32_bf16 v[8:11], v[88:91], a[180:183], v[8:11]
    s_waitcnt lgkmcnt(0)
    v_mfma_f32_16x16x32_bf16 v[12:15], v[92:95], a[180:183], v[12:15]
    v_mfma_f32_16x16x32_bf16 v[16:19], v[48:51], a[184:187], 0
    v_mfma_f32_16x16x32_bf16 v[20:23], v[52:55], a[184:187], 0
    v_mfma_f32_16x16x32_bf16 v[16:19], v[56:59], a[188:191], v[16:19]
    buffer_load_dwordx4 v2, s[8:11], s29 offen offset:2048 sc1 lds
    v_mfma_f32_16x16x32_bf16 v[20:23], v[60:63], a[188:191], v[20:23]
    v_mfma_f32_16x16x32_bf16 v[16:19], v[64:67], a[192:195], v[16:19]
    v_mfma_f32_16x16x32_bf16 v[20:23], v[68:71], a[192:195], v[20:23]
    buffer_load_dwordx4 v2, s[8:11], s29 offen offset:3072 sc1 lds
    v_mfma_f32_16x16x32_bf16 v[16:19], v[72:75], a[196:199], v[16:19]
    v_mfma_f32_16x16x32_bf16 v[20:23], v[76:79], a[196:199], v[20:23]
    v_cvt_pk_bf16_f32 v32, v8, v9
    v_mfma_f32_16x16x32_bf16 v[16:19], v[80:83], a[200:203], v[16:19]
    v_cvt_pk_bf16_f32 v33, v10, v11
    v_mfma_f32_16x16x32_bf16 v[20:23], v[84:87], a[200:203], v[20:23]
    v_cvt_pk_bf16_f32 v34, v12, v13
    v_mfma_f32_16x16x32_bf16 v[16:19], v[88:91], a[204:207], v[16:19]
    v_cvt_pk_bf16_f32 v35, v14, v15
    v_mfma_f32_16x16x32_bf16 v[20:23], v[92:95], a[204:207], v[20:23]
    buffer_store_dwordx4 v[32:35], v2, s[8:11], s38 offen sc1
    s_add_u32 s38, s38, 131072
    v_mfma_f32_16x16x32_bf16 v[24:27], v[48:51], a[208:211], 0
    v_mfma_f32_16x16x32_bf16 v[28:31], v[52:55], a[208:211], 0
    v_mfma_f32_16x16x32_bf16 v[24:27], v[56:59], a[212:215], v[24:27]
    s_add_u32 m0, s34, 4096
    s_add_u32 s29, s35, 4096
    buffer_load_dwordx4 v2, s[8:11], s29 offen offset:0 sc1 lds
    v_mfma_f32_16x16x32_bf16 v[28:31], v[60:63], a[212:215], v[28:31]
    v_mfma_f32_16x16x32_bf16 v[24:27], v[64:67], a[216:219], v[24:27]
    v_mfma_f32_16x16x32_bf16 v[28:31], v[68:71], a[216:219], v[28:31]
    buffer_load_dwordx4 v2, s[8:11], s29 offen offset:1024 sc1 lds
    v_mfma_f32_16x16x32_bf16 v[24:27], v[72:75], a[220:223], v[24:27]
    v_mfma_f32_16x16x32_bf16 v[28:31], v[76:79], a[220:223], v[28:31]
    v_cvt_pk_bf16_f32 v36, v16, v17
    v_mfma_f32_16x16x32_bf16 v[24:27], v[80:83], a[224:227], v[24:27]
    v_cvt_pk_bf16_f32 v37, v18, v19
    v_mfma_f32_16x16x32_bf16 v[28:31], v[84:87], a[224:227], v[28:31]
    v_cvt_pk_bf16_f32 v38, v20, v21
    v_mfma_f32_16x16x32_bf16 v[24:27], v[88:91], a[228:231], v[24:27]
    v_cvt_pk_bf16_f32 v39, v22, v23
    v_mfma_f32_16x16x32_bf16 v[28:31], v[92:95], a[228:231], v[28:31]
    buffer_store_dwordx4 v[36:39], v2, s[8:11], s38 offen sc1
    s_add_u32 s38, s38, 131072
    v_mfma_f32_16x16x32_bf16 v[8:11], v[48:51], a[232:235], 0
    v_mfma_f32_16x16x32_bf16 v[12:15], v[52:55], a[232:235], 0
    v_mfma_f32_16x16x32_bf16 v[8:11], v[56:59], a[236:239], v[8:11]
    buffer_load_dwordx4 v2, s[8:11], s29 offen offset:2048 sc1 lds
    v_mfma_f32_16x16x32_bf16 v[12:15], v[60:63], a[236:239], v[12:15]
    v_mfma_f32_16x16x32_bf16 v[8:11], v[64:67], a[240:243], v[8:11]
    v_mfma_f32_16x16x32_bf16 v[12:15], v[68:71], a[240:243], v[12:15]
    buffer_load_dwordx4 v2, s[8:11], s29 offen offset:3072 sc1 lds
    v_mfma_f32_16x16x32_bf16 v[8:11], v[72:75], a[244:247], v[8:11]
    v_mfma_f32_16x16x32_bf16 v[12:15], v[76:79], a[244:247], v[12:15]
    v_cvt_pk_bf16_f32 v40, v24, v25
    v_mfma_f32_16x16x32_bf16 v[8:11], v[80:83], a[248:251], v[8:11]
    v_cvt_pk_bf16_f32 v41, v26, v27
    v_mfma_f32_16x16x32_bf16 v[12:15], v[84:87], a[248:251], v[12:15]
    v_cvt_pk_bf16_f32 v42, v28, v29
    v_mfma_f32_16x16x32_bf16 v[8:11], v[88:91], a[252:255], v[8:11]
    v_cvt_pk_bf16_f32 v43, v30, v31
    v_mfma_f32_16x16x32_bf16 v[12:15], v[92:95], a[252:255], v[12:15]
    buffer_store_dwordx4 v[40:43], v2, s[8:11], s38 offen sc1
    s_add_u32 s38, s38, 131072
    v_mfma_f32_16x16x32_bf16 v[16:19], v[48:51], v[112:115], 0
    v_mfma_f32_16x16x32_bf16 v[20:23], v[52:55], v[112:115], 0
    v_mfma_f32_16x16x32_bf16 v[16:19], v[56:59], v[116:119], v[16:19]
    s_add_u32 m0, s34, 8192
    s_add_u32 s29, s35, 8192
    buffer_load_dwordx4 v2, s[8:11], s29 offen offset:0 sc1 lds
    v_mfma_f32_16x16x32_bf16 v[20:23], v[60:63], v[116:119], v[20:23]
    v_mfma_f32_16x16x32_bf16 v[16:19], v[64:67], v[120:123], v[16:19]
    v_mfma_f32_16x16x32_bf16 v[20:23], v[68:71], v[120:123], v[20:23]
    buffer_load_dwordx4 v2, s[8:11], s29 offen offset:1024 sc1 lds
    s_add_u32 s35, s35, 40960
    v_mfma_f32_16x16x32_bf16 v[16:19], v[72:75], v[124:127], v[16:19]
    v_mfma_f32_16x16x32_bf16 v[20:23], v[76:79], v[124:127], v[20:23]
    v_cvt_pk_bf16_f32 v32, v8, v9
    v_mfma_f32_16x16x32_bf16 v[16:19], v[80:83], v[128:131], v[16:19]
    v_cvt_pk_bf16_f32 v33, v10, v11
    v_mfma_f32_16x16x32_bf16 v[20:23], v[84:87], v[128:131], v[20:23]
    v_cvt_pk_bf16_f32 v34, v12, v13
    v_mfma_f32_16x16x32_bf16 v[16:19], v[88:91], v[132:135], v[16:19]
    v_cvt_pk_bf16_f32 v35, v14, v15
    v_mfma_f32_16x16x32_bf16 v[20:23], v[92:95], v[132:135], v[20:23]
    buffer_store_dwordx4 v[32:35], v2, s[8:11], s38 offen sc1
    s_add_u32 s38, s38, 131072
    v_mfma_f32_16x16x32_bf16 v[24:27], v[48:51], v[136:139], 0
    v_mfma_f32_16x16x32_bf16 v[28:31], v[52:55], v[136:139], 0
    v_mfma_f32_16x16x32_bf16 v[24:27], v[56:59], v[140:143], v[24:27]
    v_mfma_f32_16x16x32_bf16 v[28:31], v[60:63], v[140:143], v[28:31]
    v_mfma_f32_16x16x32_bf16 v[24:27], v[64:67], v[144:147], v[24:27]
    v_mfma_f32_16x16x32_bf16 v[28:31], v[68:71], v[144:147], v[28:31]
    v_mfma_f32_16x16x32_bf16 v[24:27], v[72:75], v[148:151], v[24:27]
    v_mfma_f32_16x16x32_bf16 v[28:31], v[76:79], v[148:151], v[28:31]
    v_cvt_pk_bf16_f32 v36, v16, v17
    v_mfma_f32_16x16x32_bf16 v[24:27], v[80:83], v[152:155], v[24:27]
    v_cvt_pk_bf16_f32 v37, v18, v19
    v_mfma_f32_16x16x32_bf16 v[28:31], v[84:87], v[152:155], v[28:31]
    v_cvt_pk_bf16_f32 v38, v20, v21
    v_mfma_f32_16x16x32_bf16 v[24:27], v[88:91], v[156:159], v[24:27]
    v_cvt_pk_bf16_f32 v39, v22, v23
    v_mfma_f32_16x16x32_bf16 v[28:31], v[92:95], v[156:159], v[28:31]
    buffer_store_dwordx4 v[36:39], v2, s[8:11], s38 offen sc1
    s_add_u32 s38, s38, 131072
    v_mfma_f32_16x16x32_bf16 v[8:11], v[48:51], v[160:163], 0
    s_waitcnt vmcnt(15)
    v_cmp_eq_u32 vcc, 0, v109
    v_mfma_f32_16x16x32_bf16 v[12:15], v[52:55], v[160:163], 0
    v_mfma_f32_16x16x32_bf16 v[8:11], v[56:59], v[164:167], v[8:11]
    s_mov_b32 s47, 1
    s_cbranch_vccnz M_vu_late
    s_mov_b32 s47, 0
    s_mov_b32 m0, s46
    s_xor_b32 s46, s46, 16384
    buffer_load_dwordx4 v2, s[8:11], s45 offen sc1 lds
    buffer_load_dwordx4 v2, s[8:11], s45 offen offset:1024 sc1 lds
    s_add_u32 s45, s45, 262144
M_vu_late:
    v_mfma_f32_16x16x32_bf16 v[12:15], v[60:63], v[164:167], v[12:15]
    v_mfma_f32_16x16x32_bf16 v[8:11], v[64:67], v[168:171], v[8:11]
    v_mfma_f32_16x16x32_bf16 v[12:15], v[68:71], v[168:171], v[12:15]
    v_mfma_f32_16x16x32_bf16 v[8:11], v[72:75], v[172:175], v[8:11]
    v_mfma_f32_16x16x32_bf16 v[12:15], v[76:79], v[172:175], v[12:15]
    v_cvt_pk_bf16_f32 v40, v24, v25
    v_mfma_f32_16x16x32_bf16 v[8:11], v[80:83], v[176:179], v[8:11]
    v_cvt_pk_bf16_f32 v41, v26, v27
    v_mfma_f32_16x16x32_bf16 v[12:15], v[84:87], v[176:179], v[12:15]
    v_cvt_pk_bf16_f32 v42, v28, v29
    v_mfma_f32_16x16x32_bf16 v[8:11], v[88:91], v[180:183], v[8:11]
    v_cvt_pk_bf16_f32 v43, v30, v31
    v_mfma_f32_16x16x32_bf16 v[12:15], v[92:95], v[180:183], v[12:15]
    buffer_store_dwordx4 v[40:43], v2, s[8:11], s38 offen sc1
    s_add_u32 s38, s38, 131072
    v_mfma_f32_16x16x32_bf16 v[16:19], v[48:51], v[184:187], 0
    v_mfma_f32_16x16x32_bf16 v[20:23], v[52:55], v[184:187], 0
    v_mfma_f32_16x16x32_bf16 v[16:19], v[56:59], v[188:191], v[16:19]
    v_mfma_f32_16x16x32_bf16 v[20:23], v[60:63], v[188:191], v[20:23]
    v_mfma_f32_16x16x32_bf16 v[16:19], v[64:67], v[192:195], v[16:19]
    v_mfma_f32_16x16x32_bf16 v[20:23], v[68:71], v[192:195], v[20:23]
    v_mfma_f32_16x16x32_bf16 v[16:19], v[72:75], v[196:199], v[16:19]
    v_mfma_f32_16x16x32_bf16 v[20:23], v[76:79], v[196:199], v[20:23]
    v_cvt_pk_bf16_f32 v32, v8, v9
    v_mfma_f32_16x16x32_bf16 v[16:19], v[80:83], v[200:203], v[16:19]
    v_cvt_pk_bf16_f32 v33, v10, v11
    v_mfma_f32_16x16x32_bf16 v[20:23], v[84:87], v[200:203], v[20:23]
    v_cvt_pk_bf16_f32 v34, v12, v13
    v_mfma_f32_16x16x32_bf16 v[16:19], v[88:91], v[204:207], v[16:19]
    v_cvt_pk_bf16_f32 v35, v14, v15
    v_mfma_f32_16x16x32_bf16 v[20:23], v[92:95], v[204:207], v[20:23]
    buffer_store_dwordx4 v[32:35], v2, s[8:11], s38 offen sc1
    s_add_u32 s38, s38, 131072
    v_mfma_f32_16x16x32_bf16 v[24:27], v[48:51], v[208:211], 0
    v_mfma_f32_16x16x32_bf16 v[28:31], v[52:55], v[208:211], 0
    v_mfma_f32_16x16x32_bf16 v[24:27], v[56:59], v[212:215], v[24:27]
    v_mfma_f32_16x16x32_bf16 v[28:31], v[60:63], v[212:215], v[28:31]
    v_mfma_f32_16x16x32_bf16 v[24:27], v[64:67], v[216:219], v[24:27]
    v_mfma_f32_16x16x32_bf16 v[28:31], v[68:71], v[216:219], v[28:31]
    v_mfma_f32_16x16x32_bf16 v[24:27], v[72:75], v[220:223], v[24:27]
    v_mfma_f32_16x16x32_bf16 v[28:31], v[76:79], v[220:223], v[28:31]
    v_cvt_pk_bf16_f32 v36, v16, v17
    v_mfma_f32_16x16x32_bf16 v[24:27], v[80:83], v[224:227], v[24:27]
    v_cvt_pk_bf16_f32 v37, v18, v19
    v_mfma_f32_16x16x32_bf16 v[28:31], v[84:87], v[224:227], v[28:31]
    v_cvt_pk_bf16_f32 v38, v20, v21
    v_mfma_f32_16x16x32_bf16 v[24:27], v[88:91], v[228:231], v[24:27]
    v_cvt_pk_bf16_f32 v39, v22, v23
    v_mfma_f32_16x16x32_bf16 v[28:31], v[92:95], v[228:231], v[28:31]
    buffer_store_dwordx4 v[36:39], v2, s[8:11], s38 offen sc1
    s_add_u32 s38, s38, 131072
    v_mfma_f32_16x16x32_bf16 v[8:11], v[48:51], v[232:235], 0
    v_mfma_f32_16x16x32_bf16 v[12:15], v[52:55], v[232:235], 0
    v_mfma_f32_16x16x32_bf16 v[8:11], v[56:59], v[236:239], v[8:11]
    v_mfma_f32_16x16x32_bf16 v[12:15], v[60:63], v[236:239], v[12:15]
    v_mfma_f32_16x16x32_bf16 v[8:11], v[64:67], v[240:243], v[8:11]
    v_mfma_f32_16x16x32_bf16 v[12:15], v[68:71], v[240:243], v[12:15]
    v_mfma_f32_16x16x32_bf16 v[8:11], v[72:75], v[244:247], v[8:11]
    v_mfma_f32_16x16x32_bf16 v[12:15], v[76:79], v[244:247], v[12:15]
    v_cvt_pk_bf16_f32 v40, v24, v25
    v_mfma_f32_16x16x32_bf16 v[8:11], v[80:83], v[248:251], v[8:11]
    v_cvt_pk_bf16_f32 v41, v26, v27
    v_mfma_f32_16x16x32_bf16 v[12:15], v[84:87], v[248:251], v[12:15]
    v_cvt_pk_bf16_f32 v42, v28, v29
    v_mfma_f32_16x16x32_bf16 v[8:11], v[88:91], v[252:255], v[8:11]
    v_cvt_pk_bf16_f32 v43, v30, v31
    v_mfma_f32_16x16x32_bf16 v[12:15], v[92:95], v[252:255], v[12:15]
    buffer_store_dwordx4 v[40:43], v2, s[8:11], s38 offen sc1
    s_add_u32 s38, s38, 131072
    s_nop 7
    v_cvt_pk_bf16_f32 v32, v8, v9
    v_cvt_pk_bf16_f32 v33, v10, v11
    v_cvt_pk_bf16_f32 v34, v12, v13
    v_cvt_pk_bf16_f32 v35, v14, v15
    buffer_store_dwordx4 v[32:35], v2, s[8:11], s38 offen sc1
    s_add_u32 s38, s38, 131072
    s_add_u32 s22, s22, 1
    s_cmp_gt_u32 s22, 2
    s_waitcnt vmcnt(7)
    s_cbranch_scc1 M_vu_loop
    s_waitcnt vmcnt(0)
    s_barrier
    buffer_store_dword v7, v6, s[8:11], s37 offen sc1
    s_mov_b32 s37, 0x9c0000
    s_branch M_vu_loop
M_vu_pl:
    buffer_store_dword v7, v6, s[8:11], s37 offen sc1
    s_mov_b32 s37, 0x9c0000
    v_xor_b32 v5, 16384, v5
    v_xor_b32 v3, 16384, v3
    v_xor_b32 v4, 40960, v4
    s_mov_b32 s38, 0x9c1000
    s_mov_b32 s48, 0
    s_add_u32 s35, s35, 40960
M_vu_pll:
    s_waitcnt lgkmcnt(11)
    v_mfma_f32_16x16x32_bf16 v[8:11], v[48:51], a[160:163], 0
    s_waitcnt lgkmcnt(8)
    s_nop 0
    v_mfma_f32_16x16x32_bf16 v[12:15], v[52:55], a[160:163], 0
    buffer_load_dword v109, v108, s[8:11], s44 offen sc1
    s_nop 0
    v_mfma_f32_16x16x32_bf16 v[8:11], v[56:59], a[164:167], v[8:11]
    s_nop 1
    v_mfma_f32_16x16x32_bf16 v[12:15], v[60:63], a[164:167], v[12:15]
    s_waitcnt lgkmcnt(5)
    v_cvt_pk_bf16_f32 v36, v16, v17
    v_mfma_f32_16x16x32_bf16 v[8:11], v[64:67], a[168:171], v[8:11]
    v_cvt_pk_bf16_f32 v37, v18, v19
    v_cvt_pk_bf16_f32 v38, v20, v21
    v_mfma_f32_16x16x32_bf16 v[12:15], v[68:71], a[168:171], v[12:15]
    v_cvt_pk_bf16_f32 v39, v22, v23
    v_mfma_f32_16x16x32_bf16 v[8:11], v[72:75], a[172:175], v[8:11]
    s_waitcnt lgkmcnt(2)
    buffer_store_dwordx4 v[36:39], v2, s[8:11], s38 offen sc1
    v_mfma_f32_16x16x32_bf16 v[12:15], v[76:79], a[172:175], v[12:15]
    s_mov_b32 s38, s36
    v_mfma_f32_16x16x32_bf16 v[8:11], v[80:83], a[176:179], v[8:11]
    v_mfma_f32_16x16x32_bf16 v[12:15], v[84:87], a[176:179], v[12:15]
    s_waitcnt lgkmcnt(1)
    v_mfma_f32_16x16x32_bf16 v[8:11], v[88:91], a[180:183], v[8:11]
    s_waitcnt lgkmcnt(0)
    v_mfma_f32_16x16x32_bf16 v[12:15], v[92:95], a[180:183], v[12:15]
    s_nop 1
    v_mfma_f32_16x16x32_bf16 v[16:19], v[48:51], a[184:187], 0
    s_add_u32 s49, s34, s48
    s_nop 0
    v_mfma_f32_16x16x32_bf16 v[20:23], v[52:55], a[184:187], 0
    s_add_u32 s36, s36, 1310720
    s_xor_b32 s48, s48, 40960
    v_mfma_f32_16x16x32_bf16 v[16:19], v[56:59], a[188:191], v[16:19]
    v_cvt_pk_bf16_f32 v32, v8, v9
    v_cvt_pk_bf16_f32 v33, v10, v11
    v_mfma_f32_16x16x32_bf16 v[20:23], v[60:63], a[188:191], v[20:23]
    v_cvt_pk_bf16_f32 v34, v12, v13
    v_cvt_pk_bf16_f32 v35, v14, v15
    v_mfma_f32_16x16x32_bf16 v[16:19], v[64:67], a[192:195], v[16:19]
    s_nop 0
    v_mfma_f32_16x16x32_bf16 v[20:23], v[68:71], a[192:195], v[20:23]
    v_mfma_f32_16x16x32_bf16 v[16:19], v[72:75], a[196:199], v[16:19]
    buffer_store_dwordx4 v[32:35], v2, s[8:11], s38 offen sc1
    s_add_u32 s38, s38, 131072
    v_mfma_f32_16x16x32_bf16 v[20:23], v[76:79], a[196:199], v[20:23]
    v_mfma_f32_16x16x32_bf16 v[16:19], v[80:83], a[200:203], v[16:19]
    s_add_u32 m0, s49, 0
    s_add_u32 s29, s35, 0
    v_mfma_f32_16x16x32_bf16 v[20:23], v[84:87], a[200:203], v[20:23]
    buffer_load_dwordx4 v2, s[8:11], s29 offen offset:0 sc1 lds
    v_mfma_f32_16x16x32_bf16 v[16:19], v[88:91], a[204:207], v[16:19]
    v_mfma_f32_16x16x32_bf16 v[20:23], v[92:95], a[204:207], v[20:23]
    buffer_load_dwordx4 v2, s[8:11], s29 offen offset:1024 sc1 lds
    s_nop 0
    v_mfma_f32_16x16x32_bf16 v[8:11], v[48:51], a[208:211], 0
    s_nop 1
    v_mfma_f32_16x16x32_bf16 v[12:15], v[52:55], a[208:211], 0
    buffer_load_dwordx4 v2, s[8:11], s29 offen offset:2048 sc1 lds
    s_nop 0
    v_mfma_f32_16x16x32_bf16 v[8:11], v[56:59], a[212:215], v[8:11]
    v_cvt_pk_bf16_f32 v36, v16, v17
    v_cvt_pk_bf16_f32 v37, v18, v19
    v_mfma_f32_16x16x32_bf16 v[12:15], v[60:63], a[212:215], v[12:15]
    buffer_load_dwordx4 v2, s[8:11], s29 offen offset:3072 sc1 lds
    v_cvt_pk_bf16_f32 v38, v20, v21
    v_mfma_f32_16x16x32_bf16 v[8:11], v[64:67], a[216:219], v[8:11]
    v_cvt_pk_bf16_f32 v39, v22, v23
    v_mfma_f32_16x16x32_bf16 v[12:15], v[68:71], a[216:219], v[12:15]
    s_add_u32 m0, s49, 4096
    s_add_u32 s29, s35, 4096
    v_mfma_f32_16x16x32_bf16 v[8:11], v[72:75], a[220:223], v[8:11]
    buffer_store_dwordx4 v[36:39], v2, s[8:11], s38 offen sc1
    s_add_u32 s38, s38, 131072
    v_mfma_f32_16x16x32_bf16 v[12:15], v[76:79], a[220:223], v[12:15]
    buffer_load_dwordx4 v2, s[8:11], s29 offen offset:0 sc1 lds
    v_mfma_f32_16x16x32_bf16 v[8:11], v[80:83], a[224:227], v[8:11]
    buffer_load_dwordx4 v2, s[8:11], s29 offen offset:1024 sc1 lds
    v_mfma_f32_16x16x32_bf16 v[12:15], v[84:87], a[224:227], v[12:15]
    v_mfma_f32_16x16x32_bf16 v[8:11], v[88:91], a[228:231], v[8:11]
    buffer_load_dwordx4 v2, s[8:11], s29 offen offset:2048 sc1 lds
    v_mfma_f32_16x16x32_bf16 v[12:15], v[92:95], a[228:231], v[12:15]
    s_nop 1
    v_mfma_f32_16x16x32_bf16 v[16:19], v[48:51], a[232:235], 0
    buffer_load_dwordx4 v2, s[8:11], s29 offen offset:3072 sc1 lds
    s_nop 0
    v_mfma_f32_16x16x32_bf16 v[20:23], v[52:55], a[232:235], 0
    s_nop 1
    v_mfma_f32_16x16x32_bf16 v[16:19], v[56:59], a[236:239], v[16:19]
    s_add_u32 m0, s49, 8192
    v_cvt_pk_bf16_f32 v32, v8, v9
    v_mfma_f32_16x16x32_bf16 v[20:23], v[60:63], a[236:239], v[20:23]
    s_add_u32 s29, s35, 8192
    v_cvt_pk_bf16_f32 v33, v10, v11
    v_mfma_f32_16x16x32_bf16 v[16:19], v[64:67], a[240:243], v[16:19]
    buffer_load_dwordx4 v2, s[8:11], s29 offen offset:0 sc1 lds
    v_cvt_pk_bf16_f32 v34, v12, v13
    v_mfma_f32_16x16x32_bf16 v[20:23], v[68:71], a[240:243], v[20:23]
    buffer_load_dwordx4 v2, s[8:11], s29 offen offset:1024 sc1 lds
    v_cvt_pk_bf16_f32 v35, v14, v15
    v_mfma_f32_16x16x32_bf16 v[16:19], v[72:75], a[244:247], v[16:19]
    buffer_store_dwordx4 v[32:35], v2, s[8:11], s38 offen sc1
    s_add_u32 s38, s38, 131072
    v_mfma_f32_16x16x32_bf16 v[20:23], v[76:79], a[244:247], v[20:23]
    s_add_u32 s35, s35, 40960
    v_mfma_f32_16x16x32_bf16 v[16:19], v[80:83], a[248:251], v[16:19]
    v_mfma_f32_16x16x32_bf16 v[20:23], v[84:87], a[248:251], v[20:23]
    v_mfma_f32_16x16x32_bf16 v[16:19], v[88:91], a[252:255], v[16:19]
    v_mfma_f32_16x16x32_bf16 v[20:23], v[92:95], a[252:255], v[20:23]
    s_nop 1
    v_mfma_f32_16x16x32_bf16 v[8:11], v[48:51], v[112:115], 0
    s_nop 1
    v_mfma_f32_16x16x32_bf16 v[12:15], v[52:55], v[112:115], 0
    s_nop 1
    v_mfma_f32_16x16x32_bf16 v[8:11], v[56:59], v[116:119], v[8:11]
    v_cvt_pk_bf16_f32 v36, v16, v17
    v_cvt_pk_bf16_f32 v37, v18, v19
    v_mfma_f32_16x16x32_bf16 v[12:15], v[60:63], v[116:119], v[12:15]
    v_cvt_pk_bf16_f32 v38, v20, v21
    v_cvt_pk_bf16_f32 v39, v22, v23
    v_mfma_f32_16x16x32_bf16 v[8:11], v[64:67], v[120:123], v[8:11]
    v_mfma_f32_16x16x32_bf16 v[12:15], v[68:71], v[120:123], v[12:15]
    ds_read_b128 v[44:47], v4 offset:0
    v_mfma_f32_16x16x32_bf16 v[8:11], v[72:75], v[124:127], v[8:11]
    buffer_store_dwordx4 v[36:39], v2, s[8:11], s38 offen sc1
    s_add_u32 s38, s38, 131072
    v_mfma_f32_16x16x32_bf16 v[12:15], v[76:79], v[124:127], v[12:15]
    ds_read_b128 v[96:99], v4 offset:1024
    v_mfma_f32_16x16x32_bf16 v[8:11], v[80:83], v[128:131], v[8:11]
    s_waitcnt vmcnt(14)
    s_barrier
    v_mfma_f32_16x16x32_bf16 v[12:15], v[84:87], v[128:131], v[12:15]
    ds_read_b128 v[100:103], v4 offset:2048
    v_mfma_f32_16x16x32_bf16 v[8:11], v[88:91], v[132:135], v[8:11]
    buffer_store_dword v7, v6, s[8:11], s37 offen sc1
    v_mfma_f32_16x16x32_bf16 v[12:15], v[92:95], v[132:135], v[12:15]
    s_waitcnt lgkmcnt(2)
    ds_read_b128 v[104:107], v4 offset:3072
    v_mfma_f32_16x16x32_bf16 v[24:27], a[0:3], v[44:47], 0
    s_nop 1
    v_mfma_f32_16x16x32_bf16 v[28:31], a[4:7], v[44:47], 0
    s_waitcnt lgkmcnt(2)
    ds_read_b128 v[44:47], v4 offset:4096
    v_mfma_f32_16x16x32_bf16 v[24:27], a[8:11], v[96:99], v[24:27]
    v_cvt_pk_bf16_f32 v32, v8, v9
    v_cvt_pk_bf16_f32 v33, v10, v11
    v_mfma_f32_16x16x32_bf16 v[28:31], a[12:15], v[96:99], v[28:31]
    s_waitcnt lgkmcnt(2)
    v_cvt_pk_bf16_f32 v34, v12, v13
    v_mfma_f32_16x16x32_bf16 v[24:27], a[16:19], v[100:103], v[24:27]
    ds_read_b128 v[96:99], v4 offset:5120
    v_cvt_pk_bf16_f32 v35, v14, v15
    v_mfma_f32_16x16x32_bf16 v[28:31], a[20:23], v[100:103], v[28:31]
    s_waitcnt lgkmcnt(2)
    ds_read_b128 v[100:103], v4 offset:6144
    v_mfma_f32_16x16x32_bf16 v[24:27], a[24:27], v[104:107], v[24:27]
    buffer_store_dwordx4 v[32:35], v2, s[8:11], s38 offen sc1
    s_add_u32 s38, s38, 131072
    v_mfma_f32_16x16x32_bf16 v[28:31], a[28:31], v[104:107], v[28:31]
    s_waitcnt lgkmcnt(2)
    ds_read_b128 v[104:107], v4 offset:7168
    v_mfma_f32_16x16x32_bf16 v[24:27], a[32:35], v[44:47], v[24:27]
    v_cmp_eq_u32 vcc, 0, v109
    v_mfma_f32_16x16x32_bf16 v[28:31], a[36:39], v[44:47], v[28:31]
    s_waitcnt lgkmcnt(2)
    ds_read_b128 v[44:47], v4 offset:8192
    v_mfma_f32_16x16x32_bf16 v[24:27], a[40:43], v[96:99], v[24:27]
    s_cbranch_vccnz M_vu_plate
M_vu_pon:
    s_mov_b32 m0, s46
    v_mfma_f32_16x16x32_bf16 v[28:31], a[44:47], v[96:99], v[28:31]
    s_waitcnt lgkmcnt(2)
    ds_read_b128 v[96:99], v4 offset:9216
    v_mfma_f32_16x16x32_bf16 v[24:27], a[48:51], v[100:103], v[24:27]
    buffer_load_dwordx4 v2, s[8:11], s45 offen sc1 lds
    v_mfma_f32_16x16x32_bf16 v[28:31], a[52:55], v[100:103], v[28:31]
    s_waitcnt lgkmcnt(2)
    ds_read_b128 v[100:103], v4 offset:10240
    v_mfma_f32_16x16x32_bf16 v[24:27], a[56:59], v[104:107], v[24:27]
    buffer_load_dwordx4 v2, s[8:11], s45 offen offset:1024 sc1 lds
    v_mfma_f32_16x16x32_bf16 v[28:31], a[60:63], v[104:107], v[28:31]
    s_waitcnt lgkmcnt(2)
    ds_read_b128 v[104:107], v4 offset:11264
    v_mfma_f32_16x16x32_bf16 v[24:27], a[64:67], v[44:47], v[24:27]
    v_mfma_f32_16x16x32_bf16 v[28:31], a[68:71], v[44:47], v[28:31]
    s_waitcnt lgkmcnt(2)
    ds_read_b128 v[44:47], v4 offset:12288
    v_mfma_f32_16x16x32_bf16 v[24:27], a[72:75], v[96:99], v[24:27]
    v_mfma_f32_16x16x32_bf16 v[28:31], a[76:79], v[96:99], v[28:31]
    s_waitcnt lgkmcnt(2)
    ds_read_b128 v[96:99], v4 offset:13312
    v_mfma_f32_16x16x32_bf16 v[24:27], a[80:83], v[100:103], v[24:27]
    v_mfma_f32_16x16x32_bf16 v[28:31], a[84:87], v[100:103], v[28:31]
    s_waitcnt lgkmcnt(2)
    ds_read_b128 v[100:103], v4 offset:14336
    v_mfma_f32_16x16x32_bf16 v[24:27], a[88:91], v[104:107], v[24:27]
    v_mfma_f32_16x16x32_bf16 v[28:31], a[92:95], v[104:107], v[28:31]
    s_waitcnt lgkmcnt(2)
    ds_read_b128 v[104:107], v4 offset:15360
    v_mfma_f32_16x16x32_bf16 v[24:27], a[96:99], v[44:47], v[24:27]
    v_mfma_f32_16x16x32_bf16 v[28:31], a[100:103], v[44:47], v[28:31]
    s_waitcnt lgkmcnt(2)
    ds_read_b128 v[44:47], v4 offset:16384
    v_mfma_f32_16x16x32_bf16 v[24:27], a[104:107], v[96:99], v[24:27]
    v_mfma_f32_16x16x32_bf16 v[28:31], a[108:111], v[96:99], v[28:31]
    s_waitcnt lgkmcnt(2)
    ds_read_b128 v[96:99], v4 offset:17408
    v_mfma_f32_16x16x32_bf16 v[24:27], a[112:115], v[100:103], v[24:27]
    v_mfma_f32_16x16x32_bf16 v[28:31], a[116:119], v[100:103], v[28:31]
    s_waitcnt lgkmcnt(2)
    ds_read_b128 v[100:103], v4 offset:18432
    v_mfma_f32_16x16x32_bf16 v[24:27], a[120:123], v[104:107], v[24:27]
    v_mfma_f32_16x16x32_bf16 v[28:31], a[124:127], v[104:107], v[28:31]
    s_waitcnt lgkmcnt(2)
    ds_read_b128 v[104:107], v4 offset:19456
    v_mfma_f32_16x16x32_bf16 v[24:27], a[128:131], v[44:47], v[24:27]
    v_mfma_f32_16x16x32_bf16 v[28:31], a[132:135], v[44:47], v[28:31]
    s_waitcnt lgkmcnt(2)
    v_mfma_f32_16x16x32_bf16 v[24:27], a[136:139], v[96:99], v[24:27]
    v_mfma_f32_16x16x32_bf16 v[28:31], a[140:143], v[96:99], v[28:31]
    s_waitcnt lgkmcnt(1)
    v_mfma_f32_16x16x32_bf16 v[24:27], a[144:147], v[100:103], v[24:27]
    v_mfma_f32_16x16x32_bf16 v[28:31], a[148:151], v[100:103], v[28:31]
    s_waitcnt lgkmcnt(0)
    v_mfma_f32_16x16x32_bf16 v[24:27], a[152:155], v[104:107], v[24:27]
    v_mfma_f32_16x16x32_bf16 v[28:31], a[156:159], v[104:107], v[28:31]
    s_nop 1
    v_mfma_f32_16x16x32_bf16 v[16:19], v[48:51], v[136:139], 0
    s_nop 1
    v_mfma_f32_16x16x32_bf16 v[20:23], v[52:55], v[136:139], 0
    s_nop 1
    v_mfma_f32_16x16x32_bf16 v[16:19], v[56:59], v[140:143], v[16:19]
    v_cvt_pk_bf16_f32 v40, v24, v28
    v_cvt_pk_bf16_f32 v41, v25, v29
    v_mfma_f32_16x16x32_bf16 v[20:23], v[60:63], v[140:143], v[20:23]
    v_cvt_pk_bf16_f32 v42, v26, v30
    v_cvt_pk_bf16_f32 v43, v27, v31
    v_mfma_f32_16x16x32_bf16 v[16:19], v[64:67], v[144:147], v[16:19]
    v_mfma_f32_16x16x32_bf16 v[20:23], v[68:71], v[144:147], v[20:23]
    v_mfma_f32_16x16x32_bf16 v[16:19], v[72:75], v[148:151], v[16:19]
    ds_write_b128 v3, v[40:43]
    v_mfma_f32_16x16x32_bf16 v[20:23], v[76:79], v[148:151], v[20:23]
    v_mfma_f32_16x16x32_bf16 v[16:19], v[80:83], v[152:155], v[16:19]
    s_xor_b32 s46, s46, 16384
    s_add_u32 s45, s45, 262144
    v_mfma_f32_16x16x32_bf16 v[20:23], v[84:87], v[152:155], v[20:23]
    s_add_u32 s44, s44, 4096
    s_min_u32 s44, s44, 0x87f000
    v_mfma_f32_16x16x32_bf16 v[16:19], v[88:91], v[156:159], v[16:19]
    v_mfma_f32_16x16x32_bf16 v[20:23], v[92:95], v[156:159], v[20:23]
    s_nop 1
    v_mfma_f32_16x16x32_bf16 v[8:11], v[48:51], v[160:163], 0
    s_nop 1
    v_mfma_f32_16x16x32_bf16 v[12:15], v[52:55], v[160:163], 0
    s_nop 1
    v_mfma_f32_16x16x32_bf16 v[8:11], v[56:59], v[164:167], v[8:11]
    v_cvt_pk_bf16_f32 v36, v16, v17
    v_cvt_pk_bf16_f32 v37, v18, v19
    v_mfma_f32_16x16x32_bf16 v[12:15], v[60:63], v[164:167], v[12:15]
    v_cvt_pk_bf16_f32 v38, v20, v21
    v_cvt_pk_bf16_f32 v39, v22, v23
    v_mfma_f32_16x16x32_bf16 v[8:11], v[64:67], v[168:171], v[8:11]
    s_nop 0
    v_mfma_f32_16x16x32_bf16 v[12:15], v[68:71], v[168:171], v[12:15]
    v_mfma_f32_16x16x32_bf16 v[8:11], v[72:75], v[172:175], v[8:11]
    buffer_store_dwordx4 v[36:39], v2, s[8:11], s38 offen sc1
    s_add_u32 s38, s38, 131072
    v_mfma_f32_16x16x32_bf16 v[12:15], v[76:79], v[172:175], v[12:15]
    v_mfma_f32_16x16x32_bf16 v[8:11], v[80:83], v[176:179], v[8:11]
    v_mfma_f32_16x16x32_bf16 v[12:15], v[84:87], v[176:179], v[12:15]
    v_mfma_f32_16x16x32_bf16 v[8:11], v[88:91], v[180:183], v[8:11]
    v_mfma_f32_16x16x32_bf16 v[12:15], v[92:95], v[180:183], v[12:15]
    s_nop 1
    v_mfma_f32_16x16x32_bf16 v[16:19], v[48:51], v[184:187], 0
    s_nop 1
    v_mfma_f32_16x16x32_bf16 v[20:23], v[52:55], v[184:187], 0
    s_nop 1
    v_mfma_f32_16x16x32_bf16 v[16:19], v[56:59], v[188:191], v[16:19]
    v_cvt_pk_bf16_f32 v32, v8, v9
    v_cvt_pk_bf16_f32 v33, v10, v11
    v_mfma_f32_16x16x32_bf16 v[20:23], v[60:63], v[188:191], v[20:23]
    v_cvt_pk_bf16_f32 v34, v12, v13
    v_cvt_pk_bf16_f32 v35, v14, v15
    v_mfma_f32_16x16x32_bf16 v[16:19], v[64:67], v[192:195], v[16:19]
    v_mfma_f32_16x16x32_bf16 v[20:23], v[68:71], v[192:195], v[20:23]
    v_mfma_f32_16x16x32_bf16 v[16:19], v[72:75], v[196:199], v[16:19]
    buffer_store_dwordx4 v[32:35], v2, s[8:11], s38 offen sc1
    s_add_u32 s38, s38, 131072
    v_mfma_f32_16x16x32_bf16 v[20:23], v[76:79], v[196:199], v[20:23]
    v_mfma_f32_16x16x32_bf16 v[16:19], v[80:83], v[200:203], v[16:19]
    v_mfma_f32_16x16x32_bf16 v[20:23], v[84:87], v[200:203], v[20:23]
    v_mfma_f32_16x16x32_bf16 v[16:19], v[88:91], v[204:207], v[16:19]
    v_mfma_f32_16x16x32_bf16 v[20:23], v[92:95], v[204:207], v[20:23]
    s_nop 1
    v_mfma_f32_16x16x32_bf16 v[8:11], v[48:51], v[208:211], 0
    s_nop 1
    v_mfma_f32_16x16x32_bf16 v[12:15], v[52:55], v[208:211], 0
    s_nop 1
    v_mfma_f32_16x16x32_bf16 v[8:11], v[56:59], v[212:215], v[8:11]
    v_cvt_pk_bf16_f32 v36, v16, v17
    v_cvt_pk_bf16_f32 v37, v18, v19
    v_mfma_f32_16x16x32_bf16 v[12:15], v[60:63], v[212:215], v[12:15]
    v_cvt_pk_bf16_f32 v38, v20, v21
    v_cvt_pk_bf16_f32 v39, v22, v23
    v_mfma_f32_16x16x32_bf16 v[8:11], v[64:67], v[216:219], v[8:11]
    s_waitcnt lgkmcnt(0)
    s_waitcnt vmcnt(2)
    s_barrier
    v_mfma_f32_16x16x32_bf16 v[12:15], v[68:71], v[216:219], v[12:15]
    v_mfma_f32_16x16x32_bf16 v[8:11], v[72:75], v[220:223], v[8:11]
    buffer_store_dwordx4 v[36:39], v2, s[8:11], s38 offen sc1
    s_add_u32 s38, s38, 131072
    v_mfma_f32_16x16x32_bf16 v[12:15], v[76:79], v[220:223], v[12:15]
    v_mfma_f32_16x16x32_bf16 v[8:11], v[80:83], v[224:227], v[8:11]
    s_mov_b32 s37, s43
    s_add_u32 s43, s43, 4096
    v_mfma_f32_16x16x32_bf16 v[12:15], v[84:87], v[224:227], v[12:15]
    s_add_u32 s22, s22, 1
    v_xor_b32 v4, 40960, v4
    v_mfma_f32_16x16x32_bf16 v[8:11], v[88:91], v[228:231], v[8:11]
    v_xor_b32 v3, 16384, v3
    v_mfma_f32_16x16x32_bf16 v[12:15], v[92:95], v[228:231], v[12:15]
    s_nop 1
    v_mfma_f32_16x16x32_bf16 v[16:19], v[48:51], v[232:235], 0
    ds_read_b128 v[48:51], v5 offset:0
    s_nop 0
    v_mfma_f32_16x16x32_bf16 v[20:23], v[52:55], v[232:235], 0
    ds_read_b128 v[52:55], v5 offset:6144
    s_nop 0
    v_mfma_f32_16x16x32_bf16 v[16:19], v[56:59], v[236:239], v[16:19]
    ds_read_b128 v[56:59], v5 offset:1024
    v_cvt_pk_bf16_f32 v32, v8, v9
    v_mfma_f32_16x16x32_bf16 v[20:23], v[60:63], v[236:239], v[20:23]
    ds_read_b128 v[60:63], v5 offset:7168
    v_cvt_pk_bf16_f32 v33, v10, v11
    v_mfma_f32_16x16x32_bf16 v[16:19], v[64:67], v[240:243], v[16:19]
    ds_read_b128 v[64:67], v5 offset:2048
    v_cvt_pk_bf16_f32 v34, v12, v13
    v_mfma_f32_16x16x32_bf16 v[20:23], v[68:71], v[240:243], v[20:23]
    ds_read_b128 v[68:71], v5 offset:8192
    v_cvt_pk_bf16_f32 v35, v14, v15
    v_mfma_f32_16x16x32_bf16 v[16:19], v[72:75], v[244:247], v[16:19]
    ds_read_b128 v[72:75], v5 offset:3072
    buffer_store_dwordx4 v[32:35], v2, s[8:11], s38 offen sc1
    v_mfma_f32_16x16x32_bf16 v[20:23], v[76:79], v[244:247], v[20:23]
    s_add_u32 s38, s38, 131072
    ds_read_b128 v[76:79], v5 offset:9216
    v_mfma_f32_16x16x32_bf16 v[16:19], v[80:83], v[248:251], v[16:19]
    ds_read_b128 v[80:83], v5 offset:4096
    v_mfma_f32_16x16x32_bf16 v[20:23], v[84:87], v[248:251], v[20:23]
    ds_read_b128 v[84:87], v5 offset:10240
    v_mfma_f32_16x16x32_bf16 v[16:19], v[88:91], v[252:255], v[16:19]
    ds_read_b128 v[88:91], v5 offset:5120
    v_mfma_f32_16x16x32_bf16 v[20:23], v[92:95], v[252:255], v[20:23]
    ds_read_b128 v[92:95], v5 offset:11264
    v_xor_b32 v5, 16384, v5
    s_cmp_lt_u32 s22, 64
    s_cbranch_scc1 M_vu_pll
    s_waitcnt lgkmcnt(0)
    s_nop 3
    v_cvt_pk_bf16_f32 v36, v16, v17
    v_cvt_pk_bf16_f32 v37, v18, v19
    v_cvt_pk_bf16_f32 v38, v20, v21
    v_cvt_pk_bf16_f32 v39, v22, v23
    buffer_store_dwordx4 v[36:39], v2, s[8:11], s38 offen sc1
    s_waitcnt vmcnt(0)
    s_barrier
    buffer_store_dword v7, v6, s[8:11], s37 offen sc1
    s_branch M_vue
M_vu_plate:
    s_mov_b32 s39, 0
M_vu_f1:
    buffer_load_dword v109, v108, s[8:11], s44 offen sc1
    s_add_u32 s39, s39, 1
    s_cmp_gt_u32 s39, 400000
    s_cbranch_scc1 M_fail
    s_waitcnt vmcnt(0)
    v_cmp_eq_u32 vcc, 0, v109
    s_cbranch_vccz M_vu_f1_ok
    s_sleep 2
    s_branch M_vu_f1
M_vu_f1_ok:
    s_branch M_vu_pon
M_vue:
    s_cmp_lt_u32 s25, 208
    s_cbranch_scc1 M_g3
    s_cmp_ge_u32 s25, 216
    s_cbranch_scc1 M_vug
    v_mov_b32 v16, 0
    s_add_u32 s44, s56, 0x8fd000
    s_mov_b32 s39, 0
M_xw:
    buffer_load_dword v17, v16, s[8:11], s44 offen sc1
    s_add_u32 s39, s39, 1
    s_cmp_gt_u32 s39, 400000
    s_cbranch_scc1 M_fail
    s_waitcnt vmcnt(0)
    v_cmp_eq_u32 vcc, 0, v17
    s_cbranch_vccz M_xw_ok
    s_sleep 12
    s_branch M_xw
M_xw_ok:
    s_and_b32 s20, s25, 7
    s_mov_b32 s22, 63
    s_mov_b32 s26, 64
    s_branch M_xe
M_vug:
    s_and_b32 s20, s25, 3
    s_bfe_u32 s22, s25, 0x10002
    s_add_u32 s22, s22, 52
    s_mov_b32 s24, 2
    s_mov_b32 s26, 64
    s_branch M_g1e
M_fail:
    v_mov_b32 v4, 16
    s_lshl_b32 s28, s25, 8
    s_add_u32 s28, s28, s22
    s_add_u32 s28, s28, 0x10000
    v_mov_b32 v5, s28
    buffer_store_dword v5, v4, s[88:91], 0 offen
    s_endpgm
M_end:
    s_endpgm
.section .rodata,"a"
.p2align 6
.amdhsa_kernel sequential_preLN__memory_aug_recurrent_mem_tr__mixer_gmlp__prompt_kernel
  .amdhsa_next_free_vgpr 512
  .amdhsa_next_free_sgpr 102
  .amdhsa_accum_offset 256
  .amdhsa_group_segment_fixed_size 0
  .amdhsa_kernarg_size 120
  .amdhsa_user_sgpr_count 2
  .amdhsa_user_sgpr_kernarg_segment_ptr 1
  .amdhsa_system_sgpr_workgroup_id_x 1
  .amdhsa_float_denorm_mode_32 3
  .amdhsa_float_denorm_mode_16_64 3
.end_amdhsa_kernel
```
